```python
import torch

def _softmax(x, axis=-1):
    return torch.softmax(x, dim=axis)
def _gelu(x):
    return torch.nn.functional.gelu(x, approximate="tanh")
def _silu(x):
    return torch.nn.functional.silu(x)
def _sigmoid(x):
    return torch.sigmoid(x)
def _layernorm(x, axis=-1, eps=1e-5):
    m = x.mean(dim=axis, keepdim=True)
    v = x.var(dim=axis, keepdim=True, unbiased=False)
    return (x - m) / torch.sqrt(v + eps)
def _scatter_add(tgt, idx, src, axis=0):
    return tgt.clone().index_add_(axis, idx, src)
def _segment_sum(src, seg, n):
    out = torch.zeros((n,) + src.shape[1:], dtype=src.dtype)
    return out.index_add_(0, seg, src)
def _pad(x, pw):
    flat = tuple(v for pair in reversed(pw) for v in pair)
    return torch.nn.functional.pad(x, flat)

kernel_name = 'interleave_layers__spectral_gfnet__softmax_full_mha__prompt'

def setup_inputs():

    _w = (lambda a: (lambda t: t.to(torch.bfloat16) if t.is_floating_point() else t)(torch.as_tensor(a)))
    def _A_setup():
        B, S, D = 1, 2048, 640
        Df = D // 2 + 1
        return {
            "x": _w((lambda *s: torch.randn(*s, dtype=torch.bfloat16) * 0.05)(B, S, D)),
            "w_r": _w((lambda *s: torch.randn(*s, dtype=torch.bfloat16) * 1.6)(S, Df) * 0.02),
            "w_i": _w((lambda *s: torch.randn(*s, dtype=torch.bfloat16) * 1.6)(S, Df) * 0.02),
        }
    _A_in = _A_setup()

    def _B_setup():
        B, S, D = 1, 2048, 640
        return {
            "x": _w((lambda *s: torch.randn(*s, dtype=torch.bfloat16) * 0.05)(B, S, D)),
            "wqkv": _w((lambda *s: torch.randn(*s, dtype=torch.bfloat16) * 0.05)(D, 3 * D)),
            "wo": _w((lambda *s: torch.randn(*s, dtype=torch.bfloat16) * 0.05)(D, D)),
        }
    _B_in = _B_setup()

    return {
        "A_x": _A_in["x"],
        "A_w_r": _A_in["w_r"],
        "A_w_i": _A_in["w_i"],
        "B_x": _B_in["x"],
        "B_wqkv": _B_in["wqkv"],
        "B_wo": _B_in["wo"],
    }

def reference(A_x, A_w_r, A_w_i, B_x, B_wqkv, B_wo):
    def _A_ref(x, w_r, w_i):
        B, S, D = x.shape
        X = (lambda x, axes=(-2,-1): torch.fft.rfft2(x.float(), dim=axes))(x, axes=(-2, -1))
        W = w_r + 1j * w_i
        X = X * W
        y = (lambda x, s, axes=(-2,-1): torch.fft.irfft2(x, s=s, dim=axes).to(torch.bfloat16))(X, (S, D), axes=(-2, -1))
        return y

    def _B_ref(x, wqkv, wo):
        B, S, D = x.shape
        H = 32; Dh = D // H
        qkv = (lambda x, *d: x.permute(*d))((x @ wqkv).reshape(B, S, 3, H, Dh), 2, 0, 3, 1, 4)
        q, k, v = qkv[0], qkv[1], qkv[2]
        scale = Dh ** -0.5
        scores = torch.einsum("bhqd,bhkd->bhqk", q, k) * scale
        p = _softmax(scores, axis=-1)
        o = torch.einsum("bhqk,bhkd->bhqd", p, v)
        return (lambda x, *d: x.permute(*d))(o, 0, 2, 1, 3).reshape(B, S, D) @ wo

    x = A_x
    x = x + _A_ref(_layernorm(x, axis=-1), A_w_r, A_w_i)
    x = x + _B_ref(_layernorm(x, axis=-1), B_wqkv, B_wo)
    x = x + _A_ref(_layernorm(x, axis=-1), A_w_r, A_w_i)
    x = x + _B_ref(_layernorm(x, axis=-1), B_wqkv, B_wo)
    return x
```

```asm
; @launch kernel=k0_kernel grid=(512,1,1) block=(256,1,1) lds=81920
; @launch kernel=k1_kernel grid=(440,1,1) block=(256,1,1) lds=75776
; @launch kernel=qkv_kernel grid=(256,1,1) block=(256,1,1) lds=131584
; @launch kernel=at_kernel grid=(256,1,1) block=(512,1,1) lds=163840
; @launch kernel=p4_kernel grid=(256,1,1) block=(256,1,1) lds=92160
; @launch kernel=cf2_kernel grid=(320,1,1) block=(256,1,1) lds=36880
; @launch kernel=qkv2_kernel grid=(256,1,1) block=(256,1,1) lds=131584
; @launch kernel=at2_kernel grid=(256,1,1) block=(512,1,1) lds=163840
; @launch kernel=fin_kernel grid=(256,1,1) block=(256,1,1) lds=81920
.amdgcn_target "amdgcn-amd-amdhsa--gfx950"
.text
.p2align 8
.Ltext0:
.p2align 8
.globl k0_kernel
.type k0_kernel,@function
k0_kernel:
s_getpc_b64 s[44:45]
s_add_u32 s44, s44, .Ltext0@rel32@lo+4
s_addc_u32 s45, s45, .Ltext0@rel32@hi+12
s_lshr_b32 s47, s2, 3
s_lshl_b32 s47, s47, 15
v_lshl_add_u32 v206, v0, 7, s47
s_mov_b32 s46, .Ltext1-.Ltext0
s_mov_b32 s47, 0x00020000
buffer_load_dword v207, v206, s[44:47], 0 offen
s_cmp_lt_u32 s2, 256
s_cbranch_scc1 .Lk0_role1
s_sub_u32 s2, s2, 256
s_cmp_lt_u32 s2, 160
s_cbranch_scc1 .Lk0_role2
s_sub_u32 s2, s2, 160
s_cmp_lt_u32 s2, 80
s_cbranch_scc1 .Lk0_role3
s_sub_u32 s2, s2, 80
s_cmp_lt_u32 s2, 16
s_cbranch_scc1 .Lk0_role4
s_sub_u32 s2, s2, 16
s_endpgm
.Lk0_role1:
s_load_dwordx2 s[4:5], s[0:1], 0
s_load_dwordx2 s[6:7], s[0:1], 64
s_and_b32 s24, s2, 7
s_bfe_u32 s25, s2, 0x20003
s_lshl_b32 s20, s24, 2
s_add_u32 s20, s20, s25
s_lshr_b32 s21, s2, 5
v_lshrrev_b32 v1, 6, v0
v_and_b32 v2, 63, v0
v_readfirstlane_b32 s22, v1
v_and_b32 v3, 15, v0
v_bfe_u32 v4, v0, 4, 2
v_lshlrev_b32 v5, 4, v2
s_sub_u32 s37, s21, 5
s_cmp_lt_u32 s21, 5
s_cselect_b32 s37, s21, s37
s_lshl_b32 s27, s37, 7
s_add_u32 s36, s27, 640
s_lshl_b32 s25, s20, 6
s_lshl_b32 s26, s22, 4
s_add_u32 s25, s25, s26
v_lshrrev_b32 v1, 3, v2
v_xor_b32 v11, v1, v2
v_and_b32 v11, 7, v11
v_lshlrev_b32 v11, 4, v11
v_add_u32 v6, s25, v1
v_and_b32 v8, 3, v6
v_bfe_u32 v9, v6, 2, 1
v_lshl_or_b32 v8, v9, 4, v8
v_bfe_u32 v9, v6, 7, 2
v_lshl_or_b32 v8, v9, 2, v8
v_bfe_u32 v9, v6, 9, 1
v_lshl_or_b32 v8, v9, 5, v8
v_bfe_u32 v9, v6, 3, 4
v_lshl_or_b32 v8, v8, 5, v9
v_lshrrev_b32 v9, 10, v6
v_lshl_or_b32 v7, v9, 4, v8
v_mul_u32_u24 v7, 1280, v7
v_add_u32 v7, v7, v11
v_add_u32 v12, 256, v7
s_mul_i32 s23, s22, 6144
s_add_u32 s23, s23, 51200
s_waitcnt lgkmcnt(0)
s_add_u32 s12, s4, 0
s_addc_u32 s13, s5, 0
s_mov_b32 s14, 2621440
s_mov_b32 s15, 0x00020000
s_add_u32 m0, s23, 0
s_nop 0
buffer_load_dwordx4 v7, s[12:15], s27 offen lds
buffer_load_dwordx4 v12, s[12:15], s27 offen offset:1024 lds
s_add_u32 m0, s23, 2048
s_nop 0
buffer_load_dwordx4 v7, s[12:15], s36 offen lds
buffer_load_dwordx4 v12, s[12:15], s36 offen offset:1024 lds
s_add_u32 s27, s27, 128
s_cmp_eq_u32 s27, 1280
s_cselect_b32 s27, 0, s27
s_add_u32 m0, s23, 4096
s_nop 0
buffer_load_dwordx4 v7, s[12:15], s27 offen lds
buffer_load_dwordx4 v12, s[12:15], s27 offen offset:1024 lds
v_lshlrev_b32 v8, 3, v4
v_cvt_f32_u32 v8, v8
s_mul_i32 s24, s21, 80
s_add_u32 s26, s24, s26
v_add_u32 v9, s26, v3
v_lshrrev_b32 v96, 1, v9
v_and_b32 v97, 1, v9
v_cmp_eq_u32 vcc, 0, v9
v_mov_b32 v98, 320
s_nop 0
v_cndmask_b32 v96, v96, v98, vcc
v_cmp_eq_u32 vcc, 1, v9
s_nop 1
v_cndmask_b32 v97, v97, 0, vcc
v_cvt_f32_u32 v96, v96
v_cvt_f32_u32 v97, v97
v_mul_f32 v96, 0x3acccccd, v96
v_mul_f32 v97, 0x3e800000, v97
v_fmac_f32 v97, v96, v8
v_mov_b32 v98, 0
v_mov_b32 v99, v96
v_mul_f32 v100, 0x40000000, v96
v_mul_f32 v101, 0x40400000, v96
v_mul_f32 v102, 0x40800000, v96
v_mul_f32 v103, 0x40a00000, v96
v_mul_f32 v104, 0x40c00000, v96
v_mul_f32 v105, 0x40e00000, v96
s_add_u32 s24, s24, 64
v_add_u32 v9, s24, v3
v_lshrrev_b32 v106, 1, v9
v_and_b32 v107, 1, v9
v_cvt_f32_u32 v106, v106
v_cvt_f32_u32 v107, v107
v_mul_f32 v106, 0x3acccccd, v106
v_mul_f32 v107, 0x3e800000, v107
v_fmac_f32 v107, v106, v8
v_mov_b32 v108, 0
v_mov_b32 v109, v106
v_mul_f32 v110, 0x40000000, v106
v_mul_f32 v111, 0x40400000, v106
v_mul_f32 v112, 0x40800000, v106
v_mul_f32 v113, 0x40a00000, v106
v_mul_f32 v114, 0x40c00000, v106
v_mul_f32 v115, 0x40e00000, v106
s_lshl_b32 s38, s37, 6
s_add_u32 s39, s38, 32
s_lshl_b32 s26, s22, 10
v_add_u32 v11, s26, v5
v_cvt_f32_u32 v116, s38
v_fma_f32 v116, v96, v116, v97
v_pk_add_f32 v[136:137], v[98:99], v[116:117] op_sel_hi:[1,0]
v_pk_add_f32 v[138:139], v[100:101], v[116:117] op_sel_hi:[1,0]
v_pk_add_f32 v[140:141], v[102:103], v[116:117] op_sel_hi:[1,0]
v_pk_add_f32 v[142:143], v[104:105], v[116:117] op_sel_hi:[1,0]
v_cos_f32 v136, v136
v_cos_f32 v137, v137
v_cos_f32 v138, v138
v_cos_f32 v139, v139
v_cos_f32 v140, v140
v_cos_f32 v141, v141
v_cos_f32 v142, v142
v_cos_f32 v143, v143
v_cvt_f32_u32 v118, s39
v_fma_f32 v118, v96, v118, v97
v_pk_add_f32 v[144:145], v[98:99], v[118:119] op_sel_hi:[1,0]
v_pk_add_f32 v[146:147], v[100:101], v[118:119] op_sel_hi:[1,0]
v_pk_add_f32 v[148:149], v[102:103], v[118:119] op_sel_hi:[1,0]
v_pk_add_f32 v[150:151], v[104:105], v[118:119] op_sel_hi:[1,0]
v_cos_f32 v144, v144
v_cos_f32 v145, v145
v_cos_f32 v146, v146
v_cos_f32 v147, v147
v_cos_f32 v148, v148
v_cos_f32 v149, v149
v_cos_f32 v150, v150
v_cos_f32 v151, v151
v_mul_f32 v152, 0x42000000, v96
v_cos_f32 v152, v152
s_nop 0
v_add_f32 v152, v152, v152
v_cvt_pk_bf16_f32 v128, v136, v137
v_cvt_pk_bf16_f32 v129, v138, v139
v_cvt_pk_bf16_f32 v130, v140, v141
v_cvt_pk_bf16_f32 v131, v142, v143
ds_write_b128 v11, v[128:131] offset:0
v_cvt_pk_bf16_f32 v132, v144, v145
v_cvt_pk_bf16_f32 v133, v146, v147
v_cvt_pk_bf16_f32 v134, v148, v149
v_cvt_pk_bf16_f32 v135, v150, v151
ds_write_b128 v11, v[132:135] offset:5120
v_pk_fma_f32 v[136:137], v[144:145], v[152:153], v[136:137] op_sel_hi:[1,0,1] neg_lo:[0,0,1] neg_hi:[0,0,1]
v_pk_fma_f32 v[138:139], v[146:147], v[152:153], v[138:139] op_sel_hi:[1,0,1] neg_lo:[0,0,1] neg_hi:[0,0,1]
v_pk_fma_f32 v[140:141], v[148:149], v[152:153], v[140:141] op_sel_hi:[1,0,1] neg_lo:[0,0,1] neg_hi:[0,0,1]
v_pk_fma_f32 v[142:143], v[150:151], v[152:153], v[142:143] op_sel_hi:[1,0,1] neg_lo:[0,0,1] neg_hi:[0,0,1]
v_cvt_pk_bf16_f32 v128, v136, v137
v_cvt_pk_bf16_f32 v129, v138, v139
v_cvt_pk_bf16_f32 v130, v140, v141
v_cvt_pk_bf16_f32 v131, v142, v143
ds_write_b128 v11, v[128:131] offset:10240
v_pk_fma_f32 v[144:145], v[136:137], v[152:153], v[144:145] op_sel_hi:[1,0,1] neg_lo:[0,0,1] neg_hi:[0,0,1]
v_pk_fma_f32 v[146:147], v[138:139], v[152:153], v[146:147] op_sel_hi:[1,0,1] neg_lo:[0,0,1] neg_hi:[0,0,1]
v_pk_fma_f32 v[148:149], v[140:141], v[152:153], v[148:149] op_sel_hi:[1,0,1] neg_lo:[0,0,1] neg_hi:[0,0,1]
v_pk_fma_f32 v[150:151], v[142:143], v[152:153], v[150:151] op_sel_hi:[1,0,1] neg_lo:[0,0,1] neg_hi:[0,0,1]
v_cvt_pk_bf16_f32 v132, v144, v145
v_cvt_pk_bf16_f32 v133, v146, v147
v_cvt_pk_bf16_f32 v134, v148, v149
v_cvt_pk_bf16_f32 v135, v150, v151
ds_write_b128 v11, v[132:135] offset:15360
v_pk_fma_f32 v[136:137], v[144:145], v[152:153], v[136:137] op_sel_hi:[1,0,1] neg_lo:[0,0,1] neg_hi:[0,0,1]
v_pk_fma_f32 v[138:139], v[146:147], v[152:153], v[138:139] op_sel_hi:[1,0,1] neg_lo:[0,0,1] neg_hi:[0,0,1]
v_pk_fma_f32 v[140:141], v[148:149], v[152:153], v[140:141] op_sel_hi:[1,0,1] neg_lo:[0,0,1] neg_hi:[0,0,1]
v_pk_fma_f32 v[142:143], v[150:151], v[152:153], v[142:143] op_sel_hi:[1,0,1] neg_lo:[0,0,1] neg_hi:[0,0,1]
v_cvt_pk_bf16_f32 v128, v136, v137
v_cvt_pk_bf16_f32 v129, v138, v139
v_cvt_pk_bf16_f32 v130, v140, v141
v_cvt_pk_bf16_f32 v131, v142, v143
ds_write_b128 v11, v[128:131] offset:20480
v_pk_fma_f32 v[144:145], v[136:137], v[152:153], v[144:145] op_sel_hi:[1,0,1] neg_lo:[0,0,1] neg_hi:[0,0,1]
v_pk_fma_f32 v[146:147], v[138:139], v[152:153], v[146:147] op_sel_hi:[1,0,1] neg_lo:[0,0,1] neg_hi:[0,0,1]
v_pk_fma_f32 v[148:149], v[140:141], v[152:153], v[148:149] op_sel_hi:[1,0,1] neg_lo:[0,0,1] neg_hi:[0,0,1]
v_pk_fma_f32 v[150:151], v[142:143], v[152:153], v[150:151] op_sel_hi:[1,0,1] neg_lo:[0,0,1] neg_hi:[0,0,1]
v_cvt_pk_bf16_f32 v132, v144, v145
v_cvt_pk_bf16_f32 v133, v146, v147
v_cvt_pk_bf16_f32 v134, v148, v149
v_cvt_pk_bf16_f32 v135, v150, v151
ds_write_b128 v11, v[132:135] offset:25600
v_pk_fma_f32 v[136:137], v[144:145], v[152:153], v[136:137] op_sel_hi:[1,0,1] neg_lo:[0,0,1] neg_hi:[0,0,1]
v_pk_fma_f32 v[138:139], v[146:147], v[152:153], v[138:139] op_sel_hi:[1,0,1] neg_lo:[0,0,1] neg_hi:[0,0,1]
v_pk_fma_f32 v[140:141], v[148:149], v[152:153], v[140:141] op_sel_hi:[1,0,1] neg_lo:[0,0,1] neg_hi:[0,0,1]
v_pk_fma_f32 v[142:143], v[150:151], v[152:153], v[142:143] op_sel_hi:[1,0,1] neg_lo:[0,0,1] neg_hi:[0,0,1]
v_cvt_pk_bf16_f32 v128, v136, v137
v_cvt_pk_bf16_f32 v129, v138, v139
v_cvt_pk_bf16_f32 v130, v140, v141
v_cvt_pk_bf16_f32 v131, v142, v143
ds_write_b128 v11, v[128:131] offset:30720
v_pk_fma_f32 v[144:145], v[136:137], v[152:153], v[144:145] op_sel_hi:[1,0,1] neg_lo:[0,0,1] neg_hi:[0,0,1]
v_pk_fma_f32 v[146:147], v[138:139], v[152:153], v[146:147] op_sel_hi:[1,0,1] neg_lo:[0,0,1] neg_hi:[0,0,1]
v_pk_fma_f32 v[148:149], v[140:141], v[152:153], v[148:149] op_sel_hi:[1,0,1] neg_lo:[0,0,1] neg_hi:[0,0,1]
v_pk_fma_f32 v[150:151], v[142:143], v[152:153], v[150:151] op_sel_hi:[1,0,1] neg_lo:[0,0,1] neg_hi:[0,0,1]
v_cvt_pk_bf16_f32 v132, v144, v145
v_cvt_pk_bf16_f32 v133, v146, v147
v_cvt_pk_bf16_f32 v134, v148, v149
v_cvt_pk_bf16_f32 v135, v150, v151
ds_write_b128 v11, v[132:135] offset:35840
v_pk_fma_f32 v[136:137], v[144:145], v[152:153], v[136:137] op_sel_hi:[1,0,1] neg_lo:[0,0,1] neg_hi:[0,0,1]
v_pk_fma_f32 v[138:139], v[146:147], v[152:153], v[138:139] op_sel_hi:[1,0,1] neg_lo:[0,0,1] neg_hi:[0,0,1]
v_pk_fma_f32 v[140:141], v[148:149], v[152:153], v[140:141] op_sel_hi:[1,0,1] neg_lo:[0,0,1] neg_hi:[0,0,1]
v_pk_fma_f32 v[142:143], v[150:151], v[152:153], v[142:143] op_sel_hi:[1,0,1] neg_lo:[0,0,1] neg_hi:[0,0,1]
v_cvt_pk_bf16_f32 v128, v136, v137
v_cvt_pk_bf16_f32 v129, v138, v139
v_cvt_pk_bf16_f32 v130, v140, v141
v_cvt_pk_bf16_f32 v131, v142, v143
ds_write_b128 v11, v[128:131] offset:40960
v_pk_fma_f32 v[144:145], v[136:137], v[152:153], v[144:145] op_sel_hi:[1,0,1] neg_lo:[0,0,1] neg_hi:[0,0,1]
v_pk_fma_f32 v[146:147], v[138:139], v[152:153], v[146:147] op_sel_hi:[1,0,1] neg_lo:[0,0,1] neg_hi:[0,0,1]
v_pk_fma_f32 v[148:149], v[140:141], v[152:153], v[148:149] op_sel_hi:[1,0,1] neg_lo:[0,0,1] neg_hi:[0,0,1]
v_pk_fma_f32 v[150:151], v[142:143], v[152:153], v[150:151] op_sel_hi:[1,0,1] neg_lo:[0,0,1] neg_hi:[0,0,1]
v_cvt_pk_bf16_f32 v132, v144, v145
v_cvt_pk_bf16_f32 v133, v146, v147
v_cvt_pk_bf16_f32 v134, v148, v149
v_cvt_pk_bf16_f32 v135, v150, v151
ds_write_b128 v11, v[132:135] offset:46080
s_mov_b32 s39, s22
.Lk0_g5:
s_min_u32 s40, s39, 9
s_mul_i32 s41, s40, 5120
v_add_u32 v11, s41, v5
s_lshl_b32 s40, s40, 5
s_add_u32 s40, s40, s38
v_cvt_f32_u32 v124, s40
v_fma_f32 v124, v106, v124, v107
v_fract_f32 v124, v124
v_pk_add_f32 v[116:117], v[108:109], v[124:125] op_sel_hi:[1,0]
v_pk_add_f32 v[118:119], v[110:111], v[124:125] op_sel_hi:[1,0]
v_pk_add_f32 v[120:121], v[112:113], v[124:125] op_sel_hi:[1,0]
v_pk_add_f32 v[122:123], v[114:115], v[124:125] op_sel_hi:[1,0]
v_cos_f32 v116, v116
v_cos_f32 v117, v117
v_cos_f32 v118, v118
v_cos_f32 v119, v119
v_cos_f32 v120, v120
v_cvt_pk_bf16_f32 v128, v116, v117
v_cos_f32 v121, v121
v_cos_f32 v122, v122
v_cvt_pk_bf16_f32 v129, v118, v119
v_cos_f32 v123, v123
v_cvt_pk_bf16_f32 v130, v120, v121
v_cvt_pk_bf16_f32 v131, v122, v123
ds_write_b128 v11, v[128:131] offset:4096
s_add_u32 s39, s39, 4
s_cmp_lt_u32 s39, 12
s_cbranch_scc1 .Lk0_g5
v_xor_b32 v8, v4, v3
v_and_b32 v8, 7, v8
v_lshl_add_u32 v8, v3, 3, v8
v_lshl_add_u32 v8, v8, 4, s23
v_xor_b32 v9, 64, v8
v_add_u32 v6, s25, v3
v_mov_b32 v200, 0x3d64f92e
v_lshlrev_b32 v204, 30, v3
v_and_b32 v204, 0x80000000, v204
v_xor_b32 v204, v200, v204
s_cmp_eq_u32 s21, 0
s_cselect_b32 s30, 0, 99
s_cselect_b32 s31, 1, 99
v_mov_b32 v1, 0x3d21e89b
v_cmp_eq_u32 vcc, s30, v3
s_nop 1
v_cndmask_b32 v202, v200, v1, vcc
v_cndmask_b32 v14, v204, v1, vcc
v_mov_b32 v1, 0x3acccccd
v_cmp_eq_u32 vcc, s31, v3
s_nop 1
v_cndmask_b32 v202, v202, v1, vcc
v_cndmask_b32 v14, v14, v1, vcc
v_lshrrev_b32 v1, 3, v2
v_and_b32 v13, 7, v2
v_lshlrev_b32 v10, 12, v1
v_lshl_add_u32 v10, v13, 4, v10
s_mul_i32 s28, s21, 80*4096
s_lshl_b32 s29, s20, 7
s_add_u32 s28, s28, s29
s_lshl_b32 s29, s22, 15
s_add_u32 s28, s28, s29
s_add_u32 s28, s28, 0
s_lshl_b32 s29, s22, 5
s_add_u32 s29, s29, s23
v_lshl_add_u32 v201, v3, 2, v4
v_lshl_add_u32 v201, v201, 3, s29
v_bfe_u32 v13, v2, 1, 2
v_mul_u32_u24 v13, 6176, v13
v_lshl_add_u32 v13, v1, 5, v13
v_and_b32 v1, 1, v2
v_lshl_add_u32 v13, v1, 4, v13
s_lshl_b32 s29, s22, 8
s_add_u32 s29, s29, 51200
v_add_u32 v203, s29, v13
s_add_u32 s16, s6, 0
s_addc_u32 s17, s7, 0
s_mov_b32 s18, 44564480
s_mov_b32 s19, 0x00020000
s_waitcnt lgkmcnt(0)
s_barrier
ds_read_b128 v[96:99], v5 offset:0
ds_read_b128 v[100:103], v5 offset:1024
ds_read_b128 v[104:107], v5 offset:2048
ds_read_b128 v[108:111], v5 offset:3072
ds_read_b128 v[112:115], v5 offset:4096
s_waitcnt vmcnt(4)
ds_read_b128 v[16:19], v8 offset:0
ds_read_b128 v[24:27], v9 offset:0
s_waitcnt vmcnt(2)
ds_read_b128 v[20:23], v8 offset:2048
ds_read_b128 v[28:31], v9 offset:2048
s_waitcnt lgkmcnt(2)
s_add_u32 s36, s36, 128
s_cmp_eq_u32 s36, 1280
s_cselect_b32 s36, 0, s36
s_add_u32 m0, s23, 0
s_nop 0
buffer_load_dwordx4 v7, s[12:15], s36 offen lds
buffer_load_dwordx4 v12, s[12:15], s36 offen offset:1024 lds
s_waitcnt lgkmcnt(0)
s_add_u32 s27, s27, 128
s_cmp_eq_u32 s27, 1280
s_cselect_b32 s27, 0, s27
s_add_u32 m0, s23, 2048
s_nop 0
buffer_load_dwordx4 v7, s[12:15], s27 offen lds
buffer_load_dwordx4 v12, s[12:15], s27 offen offset:1024 lds
ds_read_b128 v[116:119], v5 offset:5120
ds_read_b128 v[120:123], v5 offset:6144
ds_read_b128 v[124:127], v5 offset:7168
ds_read_b128 v[128:131], v5 offset:8192
ds_read_b128 v[132:135], v5 offset:9216
s_waitcnt lgkmcnt(5)
v_mfma_f32_16x16x32_bf16 v[156:159], v[16:19], v[96:99], 0
ds_read_b128 v[136:139], v5 offset:10240
v_mfma_f32_16x16x32_bf16 v[176:179], v[20:23], v[96:99], 0
s_waitcnt lgkmcnt(6)
v_mfma_f32_16x16x32_bf16 v[160:163], v[16:19], v[100:103], 0
ds_read_b128 v[140:143], v5 offset:11264
v_mfma_f32_16x16x32_bf16 v[180:183], v[20:23], v[100:103], 0
s_waitcnt vmcnt(4)
ds_read_b128 v[32:35], v8 offset:4096
ds_read_b128 v[40:43], v9 offset:4096
s_waitcnt lgkmcnt(9)
v_mfma_f32_16x16x32_bf16 v[164:167], v[16:19], v[104:107], 0
ds_read_b128 v[144:147], v5 offset:12288
v_mfma_f32_16x16x32_bf16 v[184:187], v[20:23], v[104:107], 0
s_waitcnt lgkmcnt(10)
v_mfma_f32_16x16x32_bf16 v[168:171], v[16:19], v[108:111], 0
ds_read_b128 v[148:151], v5 offset:13312
v_mfma_f32_16x16x32_bf16 v[188:191], v[20:23], v[108:111], 0
s_waitcnt lgkmcnt(2)
s_add_u32 s36, s36, 128
s_cmp_eq_u32 s36, 1280
s_cselect_b32 s36, 0, s36
s_add_u32 m0, s23, 4096
s_nop 0
buffer_load_dwordx4 v7, s[12:15], s36 offen lds
buffer_load_dwordx4 v12, s[12:15], s36 offen offset:1024 lds
s_waitcnt lgkmcnt(11)
v_mfma_f32_16x16x32_bf16 v[172:175], v[16:19], v[112:115], 0
ds_read_b128 v[152:155], v5 offset:14336
v_mfma_f32_16x16x32_bf16 v[192:195], v[20:23], v[112:115], 0
s_cmp_lg_u32 s21, 0
s_cbranch_scc1 .Lk0_s6
v_mfma_f32_16x16x32_bf16 v[196:199], v[16:19], v[16:19], 0
v_mfma_f32_16x16x32_bf16 v[196:199], v[20:23], v[20:23], v[196:199]
.Lk0_s6:
s_waitcnt lgkmcnt(11)
v_mfma_f32_16x16x32_bf16 v[156:159], v[24:27], v[116:119], v[156:159]
ds_read_b128 v[96:99], v5 offset:15360
v_mfma_f32_16x16x32_bf16 v[176:179], v[28:31], v[116:119], v[176:179]
s_waitcnt lgkmcnt(11)
v_mfma_f32_16x16x32_bf16 v[160:163], v[24:27], v[120:123], v[160:163]
ds_read_b128 v[100:103], v5 offset:16384
v_mfma_f32_16x16x32_bf16 v[180:183], v[28:31], v[120:123], v[180:183]
s_waitcnt vmcnt(4)
ds_read_b128 v[36:39], v8 offset:0
ds_read_b128 v[44:47], v9 offset:0
s_waitcnt lgkmcnt(13)
v_mfma_f32_16x16x32_bf16 v[164:167], v[24:27], v[124:127], v[164:167]
ds_read_b128 v[104:107], v5 offset:17408
v_mfma_f32_16x16x32_bf16 v[184:187], v[28:31], v[124:127], v[184:187]
s_waitcnt lgkmcnt(13)
v_mfma_f32_16x16x32_bf16 v[168:171], v[24:27], v[128:131], v[168:171]
ds_read_b128 v[108:111], v5 offset:18432
v_mfma_f32_16x16x32_bf16 v[188:191], v[28:31], v[128:131], v[188:191]
s_waitcnt lgkmcnt(2)
s_add_u32 s27, s27, 128
s_cmp_eq_u32 s27, 1280
s_cselect_b32 s27, 0, s27
s_add_u32 m0, s23, 0
s_nop 0
buffer_load_dwordx4 v7, s[12:15], s27 offen lds
buffer_load_dwordx4 v12, s[12:15], s27 offen offset:1024 lds
s_waitcnt lgkmcnt(13)
v_mfma_f32_16x16x32_bf16 v[172:175], v[24:27], v[132:135], v[172:175]
ds_read_b128 v[112:115], v5 offset:19456
v_mfma_f32_16x16x32_bf16 v[192:195], v[28:31], v[132:135], v[192:195]
s_cmp_lg_u32 s21, 0
s_cbranch_scc1 .Lk0_s7
v_mfma_f32_16x16x32_bf16 v[196:199], v[24:27], v[24:27], v[196:199]
v_mfma_f32_16x16x32_bf16 v[196:199], v[28:31], v[28:31], v[196:199]
.Lk0_s7:
s_waitcnt lgkmcnt(3)
v_mfma_f32_16x16x32_bf16 v[156:159], v[32:35], v[136:139], v[156:159]
ds_read_b128 v[116:119], v5 offset:20480
v_mfma_f32_16x16x32_bf16 v[176:179], v[36:39], v[136:139], v[176:179]
s_waitcnt lgkmcnt(4)
v_mfma_f32_16x16x32_bf16 v[160:163], v[32:35], v[140:143], v[160:163]
ds_read_b128 v[120:123], v5 offset:21504
v_mfma_f32_16x16x32_bf16 v[180:183], v[36:39], v[140:143], v[180:183]
s_waitcnt vmcnt(4)
ds_read_b128 v[48:51], v8 offset:2048
ds_read_b128 v[56:59], v9 offset:2048
s_waitcnt lgkmcnt(7)
v_mfma_f32_16x16x32_bf16 v[164:167], v[32:35], v[144:147], v[164:167]
ds_read_b128 v[124:127], v5 offset:22528
v_mfma_f32_16x16x32_bf16 v[184:187], v[36:39], v[144:147], v[184:187]
s_waitcnt lgkmcnt(8)
v_mfma_f32_16x16x32_bf16 v[168:171], v[32:35], v[148:151], v[168:171]
ds_read_b128 v[128:131], v5 offset:23552
v_mfma_f32_16x16x32_bf16 v[188:191], v[36:39], v[148:151], v[188:191]
s_waitcnt lgkmcnt(2)
s_add_u32 s36, s36, 128
s_cmp_eq_u32 s36, 1280
s_cselect_b32 s36, 0, s36
s_add_u32 m0, s23, 2048
s_nop 0
buffer_load_dwordx4 v7, s[12:15], s36 offen lds
buffer_load_dwordx4 v12, s[12:15], s36 offen offset:1024 lds
s_waitcnt lgkmcnt(9)
v_mfma_f32_16x16x32_bf16 v[172:175], v[32:35], v[152:155], v[172:175]
ds_read_b128 v[132:135], v5 offset:24576
v_mfma_f32_16x16x32_bf16 v[192:195], v[36:39], v[152:155], v[192:195]
s_cmp_lg_u32 s21, 0
s_cbranch_scc1 .Lk0_s8
v_mfma_f32_16x16x32_bf16 v[196:199], v[32:35], v[32:35], v[196:199]
v_mfma_f32_16x16x32_bf16 v[196:199], v[36:39], v[36:39], v[196:199]
.Lk0_s8:
s_waitcnt lgkmcnt(10)
v_mfma_f32_16x16x32_bf16 v[156:159], v[40:43], v[96:99], v[156:159]
ds_read_b128 v[136:139], v5 offset:25600
v_mfma_f32_16x16x32_bf16 v[176:179], v[44:47], v[96:99], v[176:179]
s_waitcnt lgkmcnt(11)
v_mfma_f32_16x16x32_bf16 v[160:163], v[40:43], v[100:103], v[160:163]
ds_read_b128 v[140:143], v5 offset:26624
v_mfma_f32_16x16x32_bf16 v[180:183], v[44:47], v[100:103], v[180:183]
s_waitcnt vmcnt(4)
ds_read_b128 v[52:55], v8 offset:4096
ds_read_b128 v[60:63], v9 offset:4096
s_waitcnt lgkmcnt(13)
v_mfma_f32_16x16x32_bf16 v[164:167], v[40:43], v[104:107], v[164:167]
ds_read_b128 v[144:147], v5 offset:27648
v_mfma_f32_16x16x32_bf16 v[184:187], v[44:47], v[104:107], v[184:187]
s_waitcnt lgkmcnt(13)
v_mfma_f32_16x16x32_bf16 v[168:171], v[40:43], v[108:111], v[168:171]
ds_read_b128 v[148:151], v5 offset:28672
v_mfma_f32_16x16x32_bf16 v[188:191], v[44:47], v[108:111], v[188:191]
s_waitcnt lgkmcnt(2)
s_add_u32 s27, s27, 128
s_cmp_eq_u32 s27, 1280
s_cselect_b32 s27, 0, s27
s_add_u32 m0, s23, 4096
s_nop 0
buffer_load_dwordx4 v7, s[12:15], s27 offen lds
buffer_load_dwordx4 v12, s[12:15], s27 offen offset:1024 lds
s_waitcnt lgkmcnt(13)
v_mfma_f32_16x16x32_bf16 v[172:175], v[40:43], v[112:115], v[172:175]
ds_read_b128 v[152:155], v5 offset:29696
v_mfma_f32_16x16x32_bf16 v[192:195], v[44:47], v[112:115], v[192:195]
s_cmp_lg_u32 s21, 0
s_cbranch_scc1 .Lk0_s9
v_mfma_f32_16x16x32_bf16 v[196:199], v[40:43], v[40:43], v[196:199]
v_mfma_f32_16x16x32_bf16 v[196:199], v[44:47], v[44:47], v[196:199]
.Lk0_s9:
s_waitcnt lgkmcnt(3)
v_mfma_f32_16x16x32_bf16 v[156:159], v[48:51], v[116:119], v[156:159]
ds_read_b128 v[96:99], v5 offset:30720
v_mfma_f32_16x16x32_bf16 v[176:179], v[52:55], v[116:119], v[176:179]
s_waitcnt lgkmcnt(4)
v_mfma_f32_16x16x32_bf16 v[160:163], v[48:51], v[120:123], v[160:163]
ds_read_b128 v[100:103], v5 offset:31744
v_mfma_f32_16x16x32_bf16 v[180:183], v[52:55], v[120:123], v[180:183]
s_waitcnt vmcnt(4)
ds_read_b128 v[64:67], v8 offset:0
ds_read_b128 v[72:75], v9 offset:0
s_waitcnt lgkmcnt(7)
v_mfma_f32_16x16x32_bf16 v[164:167], v[48:51], v[124:127], v[164:167]
ds_read_b128 v[104:107], v5 offset:32768
v_mfma_f32_16x16x32_bf16 v[184:187], v[52:55], v[124:127], v[184:187]
s_waitcnt lgkmcnt(8)
v_mfma_f32_16x16x32_bf16 v[168:171], v[48:51], v[128:131], v[168:171]
ds_read_b128 v[108:111], v5 offset:33792
v_mfma_f32_16x16x32_bf16 v[188:191], v[52:55], v[128:131], v[188:191]
s_waitcnt lgkmcnt(2)
s_add_u32 s36, s36, 128
s_cmp_eq_u32 s36, 1280
s_cselect_b32 s36, 0, s36
s_add_u32 m0, s23, 0
s_nop 0
buffer_load_dwordx4 v7, s[12:15], s36 offen lds
buffer_load_dwordx4 v12, s[12:15], s36 offen offset:1024 lds
s_waitcnt lgkmcnt(9)
v_mfma_f32_16x16x32_bf16 v[172:175], v[48:51], v[132:135], v[172:175]
ds_read_b128 v[112:115], v5 offset:34816
v_mfma_f32_16x16x32_bf16 v[192:195], v[52:55], v[132:135], v[192:195]
s_cmp_lg_u32 s21, 0
s_cbranch_scc1 .Lk0_s10
v_mfma_f32_16x16x32_bf16 v[196:199], v[48:51], v[48:51], v[196:199]
v_mfma_f32_16x16x32_bf16 v[196:199], v[52:55], v[52:55], v[196:199]
.Lk0_s10:
s_waitcnt lgkmcnt(10)
v_mfma_f32_16x16x32_bf16 v[156:159], v[56:59], v[136:139], v[156:159]
ds_read_b128 v[116:119], v5 offset:35840
v_mfma_f32_16x16x32_bf16 v[176:179], v[60:63], v[136:139], v[176:179]
s_waitcnt lgkmcnt(11)
v_mfma_f32_16x16x32_bf16 v[160:163], v[56:59], v[140:143], v[160:163]
ds_read_b128 v[120:123], v5 offset:36864
v_mfma_f32_16x16x32_bf16 v[180:183], v[60:63], v[140:143], v[180:183]
s_waitcnt vmcnt(4)
ds_read_b128 v[68:71], v8 offset:2048
ds_read_b128 v[76:79], v9 offset:2048
s_waitcnt lgkmcnt(13)
v_mfma_f32_16x16x32_bf16 v[164:167], v[56:59], v[144:147], v[164:167]
ds_read_b128 v[124:127], v5 offset:37888
v_mfma_f32_16x16x32_bf16 v[184:187], v[60:63], v[144:147], v[184:187]
s_waitcnt lgkmcnt(13)
v_mfma_f32_16x16x32_bf16 v[168:171], v[56:59], v[148:151], v[168:171]
ds_read_b128 v[128:131], v5 offset:38912
v_mfma_f32_16x16x32_bf16 v[188:191], v[60:63], v[148:151], v[188:191]
s_waitcnt lgkmcnt(13)
v_mfma_f32_16x16x32_bf16 v[172:175], v[56:59], v[152:155], v[172:175]
ds_read_b128 v[132:135], v5 offset:39936
v_mfma_f32_16x16x32_bf16 v[192:195], v[60:63], v[152:155], v[192:195]
s_cmp_lg_u32 s21, 0
s_cbranch_scc1 .Lk0_s11
v_mfma_f32_16x16x32_bf16 v[196:199], v[56:59], v[56:59], v[196:199]
v_mfma_f32_16x16x32_bf16 v[196:199], v[60:63], v[60:63], v[196:199]
.Lk0_s11:
s_waitcnt lgkmcnt(3)
v_mfma_f32_16x16x32_bf16 v[156:159], v[64:67], v[96:99], v[156:159]
ds_read_b128 v[136:139], v5 offset:40960
v_mfma_f32_16x16x32_bf16 v[176:179], v[68:71], v[96:99], v[176:179]
s_waitcnt lgkmcnt(4)
v_mfma_f32_16x16x32_bf16 v[160:163], v[64:67], v[100:103], v[160:163]
ds_read_b128 v[140:143], v5 offset:41984
v_mfma_f32_16x16x32_bf16 v[180:183], v[68:71], v[100:103], v[180:183]
s_waitcnt vmcnt(2)
ds_read_b128 v[80:83], v8 offset:4096
ds_read_b128 v[88:91], v9 offset:4096
s_waitcnt lgkmcnt(7)
v_mfma_f32_16x16x32_bf16 v[164:167], v[64:67], v[104:107], v[164:167]
ds_read_b128 v[144:147], v5 offset:43008
v_mfma_f32_16x16x32_bf16 v[184:187], v[68:71], v[104:107], v[184:187]
s_waitcnt lgkmcnt(8)
v_mfma_f32_16x16x32_bf16 v[168:171], v[64:67], v[108:111], v[168:171]
ds_read_b128 v[148:151], v5 offset:44032
v_mfma_f32_16x16x32_bf16 v[188:191], v[68:71], v[108:111], v[188:191]
s_waitcnt lgkmcnt(9)
v_mfma_f32_16x16x32_bf16 v[172:175], v[64:67], v[112:115], v[172:175]
ds_read_b128 v[152:155], v5 offset:45056
v_mfma_f32_16x16x32_bf16 v[192:195], v[68:71], v[112:115], v[192:195]
s_cmp_lg_u32 s21, 0
s_cbranch_scc1 .Lk0_s12
v_mfma_f32_16x16x32_bf16 v[196:199], v[64:67], v[64:67], v[196:199]
v_mfma_f32_16x16x32_bf16 v[196:199], v[68:71], v[68:71], v[196:199]
.Lk0_s12:
s_waitcnt lgkmcnt(10)
v_mfma_f32_16x16x32_bf16 v[156:159], v[72:75], v[116:119], v[156:159]
ds_read_b128 v[96:99], v5 offset:46080
v_mfma_f32_16x16x32_bf16 v[176:179], v[76:79], v[116:119], v[176:179]
s_waitcnt lgkmcnt(11)
v_mfma_f32_16x16x32_bf16 v[160:163], v[72:75], v[120:123], v[160:163]
ds_read_b128 v[100:103], v5 offset:47104
v_mfma_f32_16x16x32_bf16 v[180:183], v[76:79], v[120:123], v[180:183]
s_waitcnt vmcnt(0)
ds_read_b128 v[84:87], v8 offset:0
ds_read_b128 v[92:95], v9 offset:0
s_waitcnt lgkmcnt(13)
v_mfma_f32_16x16x32_bf16 v[164:167], v[72:75], v[124:127], v[164:167]
ds_read_b128 v[104:107], v5 offset:48128
v_mfma_f32_16x16x32_bf16 v[184:187], v[76:79], v[124:127], v[184:187]
s_waitcnt lgkmcnt(13)
v_mfma_f32_16x16x32_bf16 v[168:171], v[72:75], v[128:131], v[168:171]
ds_read_b128 v[108:111], v5 offset:49152
v_mfma_f32_16x16x32_bf16 v[188:191], v[76:79], v[128:131], v[188:191]
s_waitcnt lgkmcnt(13)
v_mfma_f32_16x16x32_bf16 v[172:175], v[72:75], v[132:135], v[172:175]
ds_read_b128 v[112:115], v5 offset:50176
v_mfma_f32_16x16x32_bf16 v[192:195], v[76:79], v[132:135], v[192:195]
s_cmp_lg_u32 s21, 0
s_cbranch_scc1 .Lk0_s13
v_mfma_f32_16x16x32_bf16 v[196:199], v[72:75], v[72:75], v[196:199]
v_mfma_f32_16x16x32_bf16 v[196:199], v[76:79], v[76:79], v[196:199]
.Lk0_s13:
s_waitcnt lgkmcnt(3)
v_mfma_f32_16x16x32_bf16 v[156:159], v[80:83], v[136:139], v[156:159]
v_mfma_f32_16x16x32_bf16 v[176:179], v[84:87], v[136:139], v[176:179]
s_waitcnt lgkmcnt(3)
v_mfma_f32_16x16x32_bf16 v[160:163], v[80:83], v[140:143], v[160:163]
v_mfma_f32_16x16x32_bf16 v[180:183], v[84:87], v[140:143], v[180:183]
s_waitcnt lgkmcnt(3)
v_mfma_f32_16x16x32_bf16 v[164:167], v[80:83], v[144:147], v[164:167]
v_mfma_f32_16x16x32_bf16 v[184:187], v[84:87], v[144:147], v[184:187]
s_waitcnt lgkmcnt(3)
v_mfma_f32_16x16x32_bf16 v[168:171], v[80:83], v[148:151], v[168:171]
v_mfma_f32_16x16x32_bf16 v[188:191], v[84:87], v[148:151], v[188:191]
s_waitcnt lgkmcnt(3)
v_mfma_f32_16x16x32_bf16 v[172:175], v[80:83], v[152:155], v[172:175]
v_mfma_f32_16x16x32_bf16 v[192:195], v[84:87], v[152:155], v[192:195]
s_cmp_lg_u32 s21, 0
s_cbranch_scc1 .Lk0_s14
v_mfma_f32_16x16x32_bf16 v[196:199], v[80:83], v[80:83], v[196:199]
v_mfma_f32_16x16x32_bf16 v[196:199], v[84:87], v[84:87], v[196:199]
.Lk0_s14:
s_waitcnt lgkmcnt(3)
v_mfma_f32_16x16x32_bf16 v[156:159], v[88:91], v[96:99], v[156:159]
v_mfma_f32_16x16x32_bf16 v[176:179], v[92:95], v[96:99], v[176:179]
s_waitcnt lgkmcnt(3)
v_mfma_f32_16x16x32_bf16 v[160:163], v[88:91], v[100:103], v[160:163]
v_mfma_f32_16x16x32_bf16 v[180:183], v[92:95], v[100:103], v[180:183]
s_waitcnt lgkmcnt(2)
v_mfma_f32_16x16x32_bf16 v[164:167], v[88:91], v[104:107], v[164:167]
v_mfma_f32_16x16x32_bf16 v[184:187], v[92:95], v[104:107], v[184:187]
s_waitcnt lgkmcnt(1)
v_mfma_f32_16x16x32_bf16 v[168:171], v[88:91], v[108:111], v[168:171]
v_mfma_f32_16x16x32_bf16 v[188:191], v[92:95], v[108:111], v[188:191]
s_waitcnt lgkmcnt(0)
v_mfma_f32_16x16x32_bf16 v[172:175], v[88:91], v[112:115], v[172:175]
v_mfma_f32_16x16x32_bf16 v[192:195], v[92:95], v[112:115], v[192:195]
s_cmp_lg_u32 s21, 0
s_cbranch_scc1 .Lk0_s15
v_mfma_f32_16x16x32_bf16 v[196:199], v[88:91], v[88:91], v[196:199]
v_mfma_f32_16x16x32_bf16 v[196:199], v[92:95], v[92:95], v[196:199]
.Lk0_s15:
v_pk_mul_f32 v[156:157], v[156:157], v[202:203] op_sel_hi:[1,0]
v_pk_mul_f32 v[158:159], v[158:159], v[202:203] op_sel_hi:[1,0]
v_pk_mul_f32 v[160:161], v[160:161], v[200:201] op_sel_hi:[1,0]
v_pk_mul_f32 v[162:163], v[162:163], v[200:201] op_sel_hi:[1,0]
v_pk_mul_f32 v[164:165], v[164:165], v[200:201] op_sel_hi:[1,0]
v_pk_mul_f32 v[166:167], v[166:167], v[200:201] op_sel_hi:[1,0]
v_pk_mul_f32 v[168:169], v[168:169], v[200:201] op_sel_hi:[1,0]
v_pk_mul_f32 v[170:171], v[170:171], v[200:201] op_sel_hi:[1,0]
v_pk_mul_f32 v[172:173], v[172:173], v[200:201] op_sel_hi:[1,0]
v_pk_mul_f32 v[174:175], v[174:175], v[200:201] op_sel_hi:[1,0]
v_pk_fma_f32 v[156:157], v[176:177], v[14:15], v[156:157] op_sel_hi:[1,0,1]
v_pk_fma_f32 v[158:159], v[178:179], v[14:15], v[158:159] op_sel_hi:[1,0,1]
v_pk_fma_f32 v[160:161], v[180:181], v[204:205], v[160:161] op_sel_hi:[1,0,1]
v_pk_fma_f32 v[162:163], v[182:183], v[204:205], v[162:163] op_sel_hi:[1,0,1]
v_pk_fma_f32 v[164:165], v[184:185], v[204:205], v[164:165] op_sel_hi:[1,0,1]
v_pk_fma_f32 v[166:167], v[186:187], v[204:205], v[166:167] op_sel_hi:[1,0,1]
v_pk_fma_f32 v[168:169], v[188:189], v[204:205], v[168:169] op_sel_hi:[1,0,1]
v_pk_fma_f32 v[170:171], v[190:191], v[204:205], v[170:171] op_sel_hi:[1,0,1]
v_pk_fma_f32 v[172:173], v[192:193], v[204:205], v[172:173] op_sel_hi:[1,0,1]
v_pk_fma_f32 v[174:175], v[194:195], v[204:205], v[174:175] op_sel_hi:[1,0,1]
v_mov_b32 v176, v156
v_mov_b32 v177, v157
v_mov_b32 v178, v158
v_mov_b32 v179, v159
v_cndmask_b32 v156, v156, 0, vcc
v_cndmask_b32 v157, v157, 0, vcc
v_cndmask_b32 v158, v158, 0, vcc
v_cndmask_b32 v159, v159, 0, vcc
v_cvt_pk_bf16_f32 v16, v156, v157
v_cvt_pk_bf16_f32 v17, v158, v159
ds_write_b64 v201, v[16:17] offset:0
v_cvt_pk_bf16_f32 v18, v160, v161
v_cvt_pk_bf16_f32 v19, v162, v163
ds_write_b64 v201, v[18:19] offset:512
v_cvt_pk_bf16_f32 v20, v164, v165
v_cvt_pk_bf16_f32 v21, v166, v167
ds_write_b64 v201, v[20:21] offset:1024
v_cvt_pk_bf16_f32 v22, v168, v169
v_cvt_pk_bf16_f32 v23, v170, v171
ds_write_b64 v201, v[22:23] offset:1536
v_cvt_pk_bf16_f32 v24, v172, v173
v_cvt_pk_bf16_f32 v25, v174, v175
ds_write_b64 v201, v[24:25] offset:2048
s_waitcnt lgkmcnt(0)
s_barrier
ds_read_b128 v[16:19], v203 offset:0
ds_read_b128 v[20:23], v203 offset:1024
s_cmp_ge_u32 s22, 2
s_cbranch_scc1 .Lk0_q17
ds_read_b128 v[24:27], v203 offset:2048
s_add_u32 s29, s28, 262144
s_waitcnt lgkmcnt(0)
buffer_store_dwordx4 v[24:27], v10, s[16:19], s29 offen sc1
.Lk0_q17:
s_add_u32 s29, s28, 131072
s_waitcnt lgkmcnt(1)
buffer_store_dwordx4 v[16:19], v10, s[16:19], s28 offen sc1
s_waitcnt lgkmcnt(0)
buffer_store_dwordx4 v[20:23], v10, s[16:19], s29 offen sc1
s_cmp_lg_u32 s21, 0
s_cbranch_scc1 .Lk0_end16
v_mov_b32_dpp v180, v176 row_newbcast:1 row_mask:0xf bank_mask:0xf
v_mov_b32_dpp v181, v177 row_newbcast:1 row_mask:0xf bank_mask:0xf
v_mov_b32_dpp v182, v178 row_newbcast:1 row_mask:0xf bank_mask:0xf
v_mov_b32_dpp v183, v179 row_newbcast:1 row_mask:0xf bank_mask:0xf
v_and_b32 v12, 3, v3
v_cmp_eq_u32 vcc, 1, v12
s_nop 1
v_cndmask_b32 v196, v196, v197, vcc
v_cndmask_b32 v180, v180, v181, vcc
v_cmp_eq_u32 vcc, 2, v12
s_nop 1
v_cndmask_b32 v196, v196, v198, vcc
v_cndmask_b32 v180, v180, v182, vcc
v_cmp_eq_u32 vcc, 3, v12
s_nop 1
v_cndmask_b32 v196, v196, v199, vcc
v_cndmask_b32 v180, v180, v183, vcc
v_mul_f32 v13, 0x44200000, v180
v_fma_f32 v14, -v13, v180, v196
v_max_f32 v14, 0, v14
v_lshrrev_b32 v12, 2, v3
v_cmp_eq_u32 vcc, v12, v4
v_lshlrev_b32 v15, 2, v6
s_mov_b32 s28, 25690112
s_mov_b32 s29, 25706496
s_mov_b64 exec, vcc
buffer_store_dword v14, v15, s[16:19], s28 offen
buffer_store_dword v180, v15, s[16:19], s29 offen
.Lk0_end16:
s_endpgm
.Lk0_role2:
s_load_dwordx2 s[4:5], s[0:1], 64
s_load_dwordx2 s[6:7], s[0:1], 32
v_lshrrev_b32 v1, 6, v0
v_and_b32 v2, 63, v0
v_readfirstlane_b32 s22, v1
s_and_b32 s20, s2, 31
s_lshr_b32 s21, s2, 5
s_cmp_lt_u32 s20, 30
s_cbranch_scc1 .Lk0_go18
s_endpgm
.Lk0_go18:
s_lshl_b32 s23, s21, 2
s_add_u32 s23, s23, s22
v_lshrrev_b32 v4, 4, v2
v_and_b32 v5, 15, v2
v_lshlrev_b32 v6, 2, v4
v_xor_b32 v6, v6, v5
v_lshrrev_b32 v7, 3, v6
v_mul_u32_u24 v7, 320, v7
s_lshl_b32 s46, s21, 6
v_add3_u32 v7, v7, v4, s46
v_and_b32 v6, 7, v6
v_lshlrev_b32 v6, 4, v6
v_mul_u32_u24 v7, 3840, v7
v_add_u32 v8, v6, v7
v_add_u32 v9, 14336, v8
v_add_u32 v10, 14336, v9
v_add_u32 v11, 14336, v10
s_lshl_b32 s24, s20, 7
s_mul_i32 s26, s22, 61440
s_add_u32 s24, s24, s26
s_lshl_b32 s26, s22, 12
s_waitcnt lgkmcnt(0)
s_add_u32 s8, s6, 0
s_addc_u32 s9, s7, 0
s_mov_b32 s10, 2457600
s_mov_b32 s11, 0x00020000
s_add_u32 m0, s26, 0
s_nop 0
buffer_load_dwordx4 v8, s[8:11], s24 offen offset:0 lds
buffer_load_dwordx4 v9, s[8:11], s24 offen offset:1024 lds
buffer_load_dwordx4 v10, s[8:11], s24 offen offset:2048 lds
buffer_load_dwordx4 v11, s[8:11], s24 offen offset:3072 lds
v_add_u32 v8, 245760, v8
v_subrev_u32 v9, 2457600, v8
v_min_u32 v8, v8, v9
v_add_u32 v9, 14336, v8
v_add_u32 v10, 14336, v9
v_add_u32 v11, 14336, v10
s_add_u32 m0, s26, 16384
s_nop 0
buffer_load_dwordx4 v8, s[8:11], s24 offen offset:0 lds
buffer_load_dwordx4 v9, s[8:11], s24 offen offset:1024 lds
buffer_load_dwordx4 v10, s[8:11], s24 offen offset:2048 lds
buffer_load_dwordx4 v11, s[8:11], s24 offen offset:3072 lds
v_lshrrev_b32 v6, 2, v5
v_lshrrev_b32 v7, 5, v2
v_lshl_add_u32 v1, v7, 3, v6
v_lshlrev_b32 v1, 8, v1
v_and_b32 v21, 3, v5
v_lshl_add_u32 v1, v21, 3, v1
v_and_b32 v21, 1, v4
v_lshl_add_u32 v1, v21, 5, v1
v_xor_b32 v21, 0, v6
v_lshl_add_u32 v12, v21, 6, v1
v_xor_b32 v21, 1, v6
v_lshl_add_u32 v13, v21, 6, v1
v_xor_b32 v21, 2, v6
v_lshl_add_u32 v14, v21, 6, v1
v_xor_b32 v21, 3, v6
v_lshl_add_u32 v15, v21, 6, v1
v_and_b32 v1, 31, v2
s_lshl_b32 s28, s23, 5
v_add_u32 v21, s28, v1
v_lshlrev_b32 v22, 3, v7
v_cvt_f32_u32 v22, v22
v_lshrrev_b32 v156, 1, v21
v_and_b32 v157, 1, v21
v_cmp_eq_u32 vcc, 0, v21
v_mov_b32 v158, 320
s_nop 0
v_cndmask_b32 v156, v156, v158, vcc
v_cvt_f32_u32 v156, v156
v_cvt_f32_u32 v157, v157
v_mul_f32 v156, 0x3acccccd, v156
v_mul_f32 v157, 0x3e800000, v157
v_fmac_f32 v157, v156, v22
v_mov_b32 v158, 0
v_mov_b32 v159, v156
v_mul_f32 v160, 0x40000000, v156
v_mul_f32 v161, 0x40400000, v156
v_mul_f32 v162, 0x40800000, v156
v_mul_f32 v163, 0x40a00000, v156
v_mul_f32 v164, 0x40c00000, v156
v_mul_f32 v165, 0x40e00000, v156
s_add_u32 s47, s46, 16
v_cvt_f32_u32 v166, s46
v_fma_f32 v166, v156, v166, v157
v_pk_add_f32 v[180:181], v[158:159], v[166:167] op_sel_hi:[1,0]
v_pk_add_f32 v[182:183], v[160:161], v[166:167] op_sel_hi:[1,0]
v_pk_add_f32 v[184:185], v[162:163], v[166:167] op_sel_hi:[1,0]
v_pk_add_f32 v[186:187], v[164:165], v[166:167] op_sel_hi:[1,0]
v_cos_f32 v180, v180
v_cos_f32 v181, v181
v_cos_f32 v182, v182
v_cos_f32 v183, v183
v_cos_f32 v184, v184
v_cos_f32 v185, v185
v_cos_f32 v186, v186
v_cos_f32 v187, v187
v_cvt_f32_u32 v168, s47
v_fma_f32 v168, v156, v168, v157
v_pk_add_f32 v[188:189], v[158:159], v[168:169] op_sel_hi:[1,0]
v_pk_add_f32 v[190:191], v[160:161], v[168:169] op_sel_hi:[1,0]
v_pk_add_f32 v[192:193], v[162:163], v[168:169] op_sel_hi:[1,0]
v_pk_add_f32 v[194:195], v[164:165], v[168:169] op_sel_hi:[1,0]
v_cos_f32 v188, v188
v_cos_f32 v189, v189
v_cos_f32 v190, v190
v_cos_f32 v191, v191
v_cos_f32 v192, v192
v_cos_f32 v193, v193
v_cos_f32 v194, v194
v_cos_f32 v195, v195
v_mul_f32 v196, 0x41800000, v156
v_cos_f32 v196, v196
s_nop 0
v_add_f32 v196, v196, v196
v_cvt_pk_bf16_f32 v144, v180, v181
v_cvt_pk_bf16_f32 v145, v182, v183
v_cvt_pk_bf16_f32 v146, v184, v185
v_cvt_pk_bf16_f32 v147, v186, v187
v_cvt_pk_bf16_f32 v148, v188, v189
v_cvt_pk_bf16_f32 v149, v190, v191
v_cvt_pk_bf16_f32 v150, v192, v193
v_cvt_pk_bf16_f32 v151, v194, v195
s_add_u32 s16, s4, 0
s_addc_u32 s17, s5, 0
s_mov_b32 s18, 44564480
s_mov_b32 s19, 0x00020000
s_mov_b32 s30, 0x3d64f92e
s_cmp_lt_u32 s20, 10
s_cselect_b32 s30, 0x3c93bb63, s30
s_cmp_lt_u32 s20, 20
s_cselect_b32 s31, 1, 0
s_mul_i32 s32, s20, 205
s_lshr_b32 s32, s32, 11
s_mul_i32 s33, s32, 10
s_sub_u32 s33, s20, s33
s_lshl_b32 s33, s33, 6
s_mul_i32 s32, s32, 20*40960
s_lshl_b32 s34, s23, 11
s_add_u32 s32, s32, s34
s_add_u32 s32, s32, 18350080
s_add_u32 s34, s33, 0
v_add_u32 v24, s34, v1
v_mul_u32_u24 v25, 3277, v24
v_lshrrev_b32 v25, 16, v25
v_mul_u32_u24 v26, 20, v25
v_sub_u32 v26, v24, v26
v_lshrrev_b32 v27, 1, v25
v_and_b32 v28, 1, v25
v_lshl_add_u32 v28, v28, 4, v26
v_lshrrev_b32 v29, 3, v25
v_add_u32 v29, 16, v29
v_and_b32 v30, 7, v25
v_lshl_add_u32 v30, v30, 2, v26
v_subrev_u32 v30, 16, v30
v_cmp_gt_u32 vcc, 16, v26
s_nop 1
v_cndmask_b32 v27, v29, v27, vcc
v_cndmask_b32 v28, v30, v28, vcc
v_lshrrev_b32 v29, 5, v24
v_cmp_eq_u32 vcc, 1, s31
s_nop 1
v_cndmask_b32 v27, v29, v27, vcc
v_cndmask_b32 v28, v1, v28, vcc
v_mul_u32_u24 v27, 40960, v27
v_lshl_add_u32 v27, v28, 4, v27
v_lshl_add_u32 v176, v7, 9, v27
s_add_u32 s34, s33, 32
v_add_u32 v24, s34, v1
v_mul_u32_u24 v25, 3277, v24
v_lshrrev_b32 v25, 16, v25
v_mul_u32_u24 v26, 20, v25
v_sub_u32 v26, v24, v26
v_lshrrev_b32 v27, 1, v25
v_and_b32 v28, 1, v25
v_lshl_add_u32 v28, v28, 4, v26
v_lshrrev_b32 v29, 3, v25
v_add_u32 v29, 16, v29
v_and_b32 v30, 7, v25
v_lshl_add_u32 v30, v30, 2, v26
v_subrev_u32 v30, 16, v30
v_cmp_gt_u32 vcc, 16, v26
s_nop 1
v_cndmask_b32 v27, v29, v27, vcc
v_cndmask_b32 v28, v30, v28, vcc
v_lshrrev_b32 v29, 5, v24
v_cmp_eq_u32 vcc, 1, s31
s_nop 1
v_cndmask_b32 v27, v29, v27, vcc
v_cndmask_b32 v28, v1, v28, vcc
v_mul_u32_u24 v27, 40960, v27
v_lshl_add_u32 v27, v28, 4, v27
v_lshl_add_u32 v177, v7, 9, v27
v_mov_b32 v179, s30
v_mul_f32 v24, 0x3f3504f3, v179
v_add_u32 v25, s23, v7
v_cmp_eq_u32 vcc, 0, v25
s_nop 1
v_cndmask_b32 v178, v179, v24, vcc
v_mov_b32 v26, s30
v_add_u32 v8, 245760, v8
v_subrev_u32 v9, 2457600, v8
v_min_u32 v8, v8, v9
v_add_u32 v9, 14336, v8
v_add_u32 v10, 14336, v9
v_add_u32 v11, 14336, v10
s_add_u32 m0, s26, 32768
s_nop 0
buffer_load_dwordx4 v8, s[8:11], s24 offen offset:0 lds
buffer_load_dwordx4 v9, s[8:11], s24 offen offset:1024 lds
buffer_load_dwordx4 v10, s[8:11], s24 offen offset:2048 lds
buffer_load_dwordx4 v11, s[8:11], s24 offen offset:3072 lds
v_add_u32 v8, 245760, v8
v_subrev_u32 v9, 2457600, v8
v_min_u32 v8, v8, v9
v_add_u32 v9, 14336, v8
v_add_u32 v10, 14336, v9
v_add_u32 v11, 14336, v10
s_add_u32 m0, s26, 49152
s_nop 0
buffer_load_dwordx4 v8, s[8:11], s24 offen offset:0 lds
buffer_load_dwordx4 v9, s[8:11], s24 offen offset:1024 lds
buffer_load_dwordx4 v10, s[8:11], s24 offen offset:2048 lds
buffer_load_dwordx4 v11, s[8:11], s24 offen offset:3072 lds
v_add_u32 v8, 245760, v8
v_subrev_u32 v9, 2457600, v8
v_min_u32 v8, v8, v9
v_add_u32 v9, 14336, v8
v_add_u32 v10, 14336, v9
v_add_u32 v11, 14336, v10
s_add_u32 m0, s26, 65536
s_nop 0
buffer_load_dwordx4 v8, s[8:11], s24 offen offset:0 lds
buffer_load_dwordx4 v9, s[8:11], s24 offen offset:1024 lds
buffer_load_dwordx4 v10, s[8:11], s24 offen offset:2048 lds
buffer_load_dwordx4 v11, s[8:11], s24 offen offset:3072 lds
s_waitcnt vmcnt(16)
s_barrier
ds_read_b64_tr_b16 v[32:33], v12 offset:0
ds_read_b64_tr_b16 v[34:35], v12 offset:1024
ds_read_b64_tr_b16 v[36:37], v13 offset:0
ds_read_b64_tr_b16 v[38:39], v13 offset:1024
ds_read_b64_tr_b16 v[40:41], v14 offset:0
ds_read_b64_tr_b16 v[42:43], v14 offset:1024
ds_read_b64_tr_b16 v[44:45], v15 offset:0
ds_read_b64_tr_b16 v[46:47], v15 offset:1024
ds_read_b64_tr_b16 v[48:49], v12 offset:4096
ds_read_b64_tr_b16 v[50:51], v12 offset:5120
ds_read_b64_tr_b16 v[52:53], v13 offset:4096
ds_read_b64_tr_b16 v[54:55], v13 offset:5120
ds_read_b64_tr_b16 v[56:57], v14 offset:4096
ds_read_b64_tr_b16 v[58:59], v14 offset:5120
ds_read_b64_tr_b16 v[60:61], v15 offset:4096
ds_read_b64_tr_b16 v[62:63], v15 offset:5120
s_waitcnt lgkmcnt(14)
v_mfma_f32_32x32x16_bf16 v[80:95], v[144:147], v[32:35], 0
ds_read_b64_tr_b16 v[64:65], v12 offset:8192
ds_read_b64_tr_b16 v[66:67], v12 offset:9216
v_pk_fma_f32 v[180:181], v[188:189], v[196:197], v[180:181] op_sel_hi:[1,0,1] neg_lo:[0,0,1] neg_hi:[0,0,1]
v_pk_fma_f32 v[182:183], v[190:191], v[196:197], v[182:183] op_sel_hi:[1,0,1] neg_lo:[0,0,1] neg_hi:[0,0,1]
s_waitcnt lgkmcnt(14)
v_mfma_f32_32x32x16_bf16 v[96:111], v[144:147], v[36:39], 0
ds_read_b64_tr_b16 v[68:69], v13 offset:8192
ds_read_b64_tr_b16 v[70:71], v13 offset:9216
v_pk_fma_f32 v[184:185], v[192:193], v[196:197], v[184:185] op_sel_hi:[1,0,1] neg_lo:[0,0,1] neg_hi:[0,0,1]
v_pk_fma_f32 v[186:187], v[194:195], v[196:197], v[186:187] op_sel_hi:[1,0,1] neg_lo:[0,0,1] neg_hi:[0,0,1]
s_waitcnt lgkmcnt(14)
v_mfma_f32_32x32x16_bf16 v[112:127], v[144:147], v[40:43], 0
ds_read_b64_tr_b16 v[72:73], v14 offset:8192
ds_read_b64_tr_b16 v[74:75], v14 offset:9216
v_cvt_pk_bf16_f32 v152, v180, v181
v_cvt_pk_bf16_f32 v153, v182, v183
s_waitcnt lgkmcnt(14)
v_mfma_f32_32x32x16_bf16 v[128:143], v[144:147], v[44:47], 0
ds_read_b64_tr_b16 v[76:77], v15 offset:8192
ds_read_b64_tr_b16 v[78:79], v15 offset:9216
v_cvt_pk_bf16_f32 v154, v184, v185
v_cvt_pk_bf16_f32 v155, v186, v187
s_waitcnt lgkmcnt(14)
v_mfma_f32_32x32x16_bf16 v[80:95], v[148:151], v[48:51], v[80:95]
ds_read_b64_tr_b16 v[32:33], v12 offset:12288
ds_read_b64_tr_b16 v[34:35], v12 offset:13312
v_pk_fma_f32 v[188:189], v[180:181], v[196:197], v[188:189] op_sel_hi:[1,0,1] neg_lo:[0,0,1] neg_hi:[0,0,1]
v_pk_fma_f32 v[190:191], v[182:183], v[196:197], v[190:191] op_sel_hi:[1,0,1] neg_lo:[0,0,1] neg_hi:[0,0,1]
s_waitcnt lgkmcnt(14)
v_mfma_f32_32x32x16_bf16 v[96:111], v[148:151], v[52:55], v[96:111]
ds_read_b64_tr_b16 v[36:37], v13 offset:12288
ds_read_b64_tr_b16 v[38:39], v13 offset:13312
v_pk_fma_f32 v[192:193], v[184:185], v[196:197], v[192:193] op_sel_hi:[1,0,1] neg_lo:[0,0,1] neg_hi:[0,0,1]
v_pk_fma_f32 v[194:195], v[186:187], v[196:197], v[194:195] op_sel_hi:[1,0,1] neg_lo:[0,0,1] neg_hi:[0,0,1]
s_waitcnt lgkmcnt(14)
v_mfma_f32_32x32x16_bf16 v[112:127], v[148:151], v[56:59], v[112:127]
ds_read_b64_tr_b16 v[40:41], v14 offset:12288
ds_read_b64_tr_b16 v[42:43], v14 offset:13312
v_cvt_pk_bf16_f32 v144, v188, v189
v_cvt_pk_bf16_f32 v145, v190, v191
s_waitcnt lgkmcnt(14)
v_mfma_f32_32x32x16_bf16 v[128:143], v[148:151], v[60:63], v[128:143]
ds_read_b64_tr_b16 v[44:45], v15 offset:12288
ds_read_b64_tr_b16 v[46:47], v15 offset:13312
v_cvt_pk_bf16_f32 v146, v192, v193
v_cvt_pk_bf16_f32 v147, v194, v195
s_waitcnt lgkmcnt(14)
v_mfma_f32_32x32x16_bf16 v[80:95], v[152:155], v[64:67], v[80:95]
s_waitcnt vmcnt(12)
s_barrier
ds_read_b64_tr_b16 v[48:49], v12 offset:16384
ds_read_b64_tr_b16 v[50:51], v12 offset:17408
v_pk_fma_f32 v[180:181], v[188:189], v[196:197], v[180:181] op_sel_hi:[1,0,1] neg_lo:[0,0,1] neg_hi:[0,0,1]
v_pk_fma_f32 v[182:183], v[190:191], v[196:197], v[182:183] op_sel_hi:[1,0,1] neg_lo:[0,0,1] neg_hi:[0,0,1]
s_waitcnt lgkmcnt(14)
v_mfma_f32_32x32x16_bf16 v[96:111], v[152:155], v[68:71], v[96:111]
ds_read_b64_tr_b16 v[52:53], v13 offset:16384
ds_read_b64_tr_b16 v[54:55], v13 offset:17408
v_pk_fma_f32 v[184:185], v[192:193], v[196:197], v[184:185] op_sel_hi:[1,0,1] neg_lo:[0,0,1] neg_hi:[0,0,1]
v_pk_fma_f32 v[186:187], v[194:195], v[196:197], v[186:187] op_sel_hi:[1,0,1] neg_lo:[0,0,1] neg_hi:[0,0,1]
s_waitcnt lgkmcnt(14)
v_mfma_f32_32x32x16_bf16 v[112:127], v[152:155], v[72:75], v[112:127]
ds_read_b64_tr_b16 v[56:57], v14 offset:16384
ds_read_b64_tr_b16 v[58:59], v14 offset:17408
v_cvt_pk_bf16_f32 v148, v180, v181
v_cvt_pk_bf16_f32 v149, v182, v183
s_waitcnt lgkmcnt(14)
v_mfma_f32_32x32x16_bf16 v[128:143], v[152:155], v[76:79], v[128:143]
ds_read_b64_tr_b16 v[60:61], v15 offset:16384
ds_read_b64_tr_b16 v[62:63], v15 offset:17408
v_cvt_pk_bf16_f32 v150, v184, v185
v_cvt_pk_bf16_f32 v151, v186, v187
s_waitcnt lgkmcnt(14)
v_mfma_f32_32x32x16_bf16 v[80:95], v[144:147], v[32:35], v[80:95]
ds_read_b64_tr_b16 v[64:65], v12 offset:20480
ds_read_b64_tr_b16 v[66:67], v12 offset:21504
v_pk_fma_f32 v[188:189], v[180:181], v[196:197], v[188:189] op_sel_hi:[1,0,1] neg_lo:[0,0,1] neg_hi:[0,0,1]
v_pk_fma_f32 v[190:191], v[182:183], v[196:197], v[190:191] op_sel_hi:[1,0,1] neg_lo:[0,0,1] neg_hi:[0,0,1]
s_waitcnt lgkmcnt(14)
v_mfma_f32_32x32x16_bf16 v[96:111], v[144:147], v[36:39], v[96:111]
ds_read_b64_tr_b16 v[68:69], v13 offset:20480
ds_read_b64_tr_b16 v[70:71], v13 offset:21504
v_pk_fma_f32 v[192:193], v[184:185], v[196:197], v[192:193] op_sel_hi:[1,0,1] neg_lo:[0,0,1] neg_hi:[0,0,1]
v_pk_fma_f32 v[194:195], v[186:187], v[196:197], v[194:195] op_sel_hi:[1,0,1] neg_lo:[0,0,1] neg_hi:[0,0,1]
s_waitcnt lgkmcnt(14)
v_mfma_f32_32x32x16_bf16 v[112:127], v[144:147], v[40:43], v[112:127]
ds_read_b64_tr_b16 v[72:73], v14 offset:20480
ds_read_b64_tr_b16 v[74:75], v14 offset:21504
v_cvt_pk_bf16_f32 v152, v188, v189
v_cvt_pk_bf16_f32 v153, v190, v191
s_waitcnt lgkmcnt(14)
v_mfma_f32_32x32x16_bf16 v[128:143], v[144:147], v[44:47], v[128:143]
ds_read_b64_tr_b16 v[76:77], v15 offset:20480
ds_read_b64_tr_b16 v[78:79], v15 offset:21504
v_cvt_pk_bf16_f32 v154, v192, v193
v_cvt_pk_bf16_f32 v155, v194, v195
s_waitcnt lgkmcnt(14)
v_mfma_f32_32x32x16_bf16 v[80:95], v[148:151], v[48:51], v[80:95]
ds_read_b64_tr_b16 v[32:33], v12 offset:24576
ds_read_b64_tr_b16 v[34:35], v12 offset:25600
v_pk_fma_f32 v[180:181], v[188:189], v[196:197], v[180:181] op_sel_hi:[1,0,1] neg_lo:[0,0,1] neg_hi:[0,0,1]
v_pk_fma_f32 v[182:183], v[190:191], v[196:197], v[182:183] op_sel_hi:[1,0,1] neg_lo:[0,0,1] neg_hi:[0,0,1]
s_waitcnt lgkmcnt(14)
v_mfma_f32_32x32x16_bf16 v[96:111], v[148:151], v[52:55], v[96:111]
ds_read_b64_tr_b16 v[36:37], v13 offset:24576
ds_read_b64_tr_b16 v[38:39], v13 offset:25600
v_pk_fma_f32 v[184:185], v[192:193], v[196:197], v[184:185] op_sel_hi:[1,0,1] neg_lo:[0,0,1] neg_hi:[0,0,1]
v_pk_fma_f32 v[186:187], v[194:195], v[196:197], v[186:187] op_sel_hi:[1,0,1] neg_lo:[0,0,1] neg_hi:[0,0,1]
s_waitcnt lgkmcnt(14)
v_mfma_f32_32x32x16_bf16 v[112:127], v[148:151], v[56:59], v[112:127]
ds_read_b64_tr_b16 v[40:41], v14 offset:24576
ds_read_b64_tr_b16 v[42:43], v14 offset:25600
v_cvt_pk_bf16_f32 v144, v180, v181
v_cvt_pk_bf16_f32 v145, v182, v183
s_waitcnt lgkmcnt(14)
v_mfma_f32_32x32x16_bf16 v[128:143], v[148:151], v[60:63], v[128:143]
ds_read_b64_tr_b16 v[44:45], v15 offset:24576
ds_read_b64_tr_b16 v[46:47], v15 offset:25600
v_cvt_pk_bf16_f32 v146, v184, v185
v_cvt_pk_bf16_f32 v147, v186, v187
s_waitcnt lgkmcnt(14)
v_mfma_f32_32x32x16_bf16 v[80:95], v[152:155], v[64:67], v[80:95]
ds_read_b64_tr_b16 v[48:49], v12 offset:28672
ds_read_b64_tr_b16 v[50:51], v12 offset:29696
v_pk_fma_f32 v[188:189], v[180:181], v[196:197], v[188:189] op_sel_hi:[1,0,1] neg_lo:[0,0,1] neg_hi:[0,0,1]
v_pk_fma_f32 v[190:191], v[182:183], v[196:197], v[190:191] op_sel_hi:[1,0,1] neg_lo:[0,0,1] neg_hi:[0,0,1]
s_waitcnt lgkmcnt(14)
v_mfma_f32_32x32x16_bf16 v[96:111], v[152:155], v[68:71], v[96:111]
ds_read_b64_tr_b16 v[52:53], v13 offset:28672
ds_read_b64_tr_b16 v[54:55], v13 offset:29696
v_pk_fma_f32 v[192:193], v[184:185], v[196:197], v[192:193] op_sel_hi:[1,0,1] neg_lo:[0,0,1] neg_hi:[0,0,1]
v_pk_fma_f32 v[194:195], v[186:187], v[196:197], v[194:195] op_sel_hi:[1,0,1] neg_lo:[0,0,1] neg_hi:[0,0,1]
s_waitcnt lgkmcnt(14)
v_mfma_f32_32x32x16_bf16 v[112:127], v[152:155], v[72:75], v[112:127]
ds_read_b64_tr_b16 v[56:57], v14 offset:28672
ds_read_b64_tr_b16 v[58:59], v14 offset:29696
v_cvt_pk_bf16_f32 v148, v188, v189
v_cvt_pk_bf16_f32 v149, v190, v191
s_waitcnt lgkmcnt(14)
v_mfma_f32_32x32x16_bf16 v[128:143], v[152:155], v[76:79], v[128:143]
ds_read_b64_tr_b16 v[60:61], v15 offset:28672
ds_read_b64_tr_b16 v[62:63], v15 offset:29696
v_cvt_pk_bf16_f32 v150, v192, v193
v_cvt_pk_bf16_f32 v151, v194, v195
s_waitcnt lgkmcnt(14)
v_mfma_f32_32x32x16_bf16 v[80:95], v[144:147], v[32:35], v[80:95]
s_waitcnt vmcnt(8)
s_barrier
ds_read_b64_tr_b16 v[64:65], v12 offset:32768
ds_read_b64_tr_b16 v[66:67], v12 offset:33792
v_pk_fma_f32 v[180:181], v[188:189], v[196:197], v[180:181] op_sel_hi:[1,0,1] neg_lo:[0,0,1] neg_hi:[0,0,1]
v_pk_fma_f32 v[182:183], v[190:191], v[196:197], v[182:183] op_sel_hi:[1,0,1] neg_lo:[0,0,1] neg_hi:[0,0,1]
s_waitcnt lgkmcnt(14)
v_mfma_f32_32x32x16_bf16 v[96:111], v[144:147], v[36:39], v[96:111]
ds_read_b64_tr_b16 v[68:69], v13 offset:32768
ds_read_b64_tr_b16 v[70:71], v13 offset:33792
v_pk_fma_f32 v[184:185], v[192:193], v[196:197], v[184:185] op_sel_hi:[1,0,1] neg_lo:[0,0,1] neg_hi:[0,0,1]
v_pk_fma_f32 v[186:187], v[194:195], v[196:197], v[186:187] op_sel_hi:[1,0,1] neg_lo:[0,0,1] neg_hi:[0,0,1]
s_waitcnt lgkmcnt(14)
v_mfma_f32_32x32x16_bf16 v[112:127], v[144:147], v[40:43], v[112:127]
ds_read_b64_tr_b16 v[72:73], v14 offset:32768
ds_read_b64_tr_b16 v[74:75], v14 offset:33792
v_cvt_pk_bf16_f32 v152, v180, v181
v_cvt_pk_bf16_f32 v153, v182, v183
s_waitcnt lgkmcnt(14)
v_mfma_f32_32x32x16_bf16 v[128:143], v[144:147], v[44:47], v[128:143]
ds_read_b64_tr_b16 v[76:77], v15 offset:32768
ds_read_b64_tr_b16 v[78:79], v15 offset:33792
v_cvt_pk_bf16_f32 v154, v184, v185
v_cvt_pk_bf16_f32 v155, v186, v187
s_waitcnt lgkmcnt(14)
v_mfma_f32_32x32x16_bf16 v[80:95], v[148:151], v[48:51], v[80:95]
ds_read_b64_tr_b16 v[32:33], v12 offset:36864
ds_read_b64_tr_b16 v[34:35], v12 offset:37888
v_pk_fma_f32 v[188:189], v[180:181], v[196:197], v[188:189] op_sel_hi:[1,0,1] neg_lo:[0,0,1] neg_hi:[0,0,1]
v_pk_fma_f32 v[190:191], v[182:183], v[196:197], v[190:191] op_sel_hi:[1,0,1] neg_lo:[0,0,1] neg_hi:[0,0,1]
s_waitcnt lgkmcnt(14)
v_mfma_f32_32x32x16_bf16 v[96:111], v[148:151], v[52:55], v[96:111]
ds_read_b64_tr_b16 v[36:37], v13 offset:36864
ds_read_b64_tr_b16 v[38:39], v13 offset:37888
v_pk_fma_f32 v[192:193], v[184:185], v[196:197], v[192:193] op_sel_hi:[1,0,1] neg_lo:[0,0,1] neg_hi:[0,0,1]
v_pk_fma_f32 v[194:195], v[186:187], v[196:197], v[194:195] op_sel_hi:[1,0,1] neg_lo:[0,0,1] neg_hi:[0,0,1]
s_waitcnt lgkmcnt(14)
v_mfma_f32_32x32x16_bf16 v[112:127], v[148:151], v[56:59], v[112:127]
ds_read_b64_tr_b16 v[40:41], v14 offset:36864
ds_read_b64_tr_b16 v[42:43], v14 offset:37888
v_cvt_pk_bf16_f32 v144, v188, v189
v_cvt_pk_bf16_f32 v145, v190, v191
s_waitcnt lgkmcnt(14)
v_mfma_f32_32x32x16_bf16 v[128:143], v[148:151], v[60:63], v[128:143]
ds_read_b64_tr_b16 v[44:45], v15 offset:36864
ds_read_b64_tr_b16 v[46:47], v15 offset:37888
v_cvt_pk_bf16_f32 v146, v192, v193
v_cvt_pk_bf16_f32 v147, v194, v195
s_waitcnt lgkmcnt(14)
v_mfma_f32_32x32x16_bf16 v[80:95], v[152:155], v[64:67], v[80:95]
ds_read_b64_tr_b16 v[48:49], v12 offset:40960
ds_read_b64_tr_b16 v[50:51], v12 offset:41984
v_pk_fma_f32 v[180:181], v[188:189], v[196:197], v[180:181] op_sel_hi:[1,0,1] neg_lo:[0,0,1] neg_hi:[0,0,1]
v_pk_fma_f32 v[182:183], v[190:191], v[196:197], v[182:183] op_sel_hi:[1,0,1] neg_lo:[0,0,1] neg_hi:[0,0,1]
s_waitcnt lgkmcnt(14)
v_mfma_f32_32x32x16_bf16 v[96:111], v[152:155], v[68:71], v[96:111]
ds_read_b64_tr_b16 v[52:53], v13 offset:40960
ds_read_b64_tr_b16 v[54:55], v13 offset:41984
v_pk_fma_f32 v[184:185], v[192:193], v[196:197], v[184:185] op_sel_hi:[1,0,1] neg_lo:[0,0,1] neg_hi:[0,0,1]
v_pk_fma_f32 v[186:187], v[194:195], v[196:197], v[186:187] op_sel_hi:[1,0,1] neg_lo:[0,0,1] neg_hi:[0,0,1]
s_waitcnt lgkmcnt(14)
v_mfma_f32_32x32x16_bf16 v[112:127], v[152:155], v[72:75], v[112:127]
ds_read_b64_tr_b16 v[56:57], v14 offset:40960
ds_read_b64_tr_b16 v[58:59], v14 offset:41984
v_cvt_pk_bf16_f32 v148, v180, v181
v_cvt_pk_bf16_f32 v149, v182, v183
s_waitcnt lgkmcnt(14)
v_mfma_f32_32x32x16_bf16 v[128:143], v[152:155], v[76:79], v[128:143]
ds_read_b64_tr_b16 v[60:61], v15 offset:40960
ds_read_b64_tr_b16 v[62:63], v15 offset:41984
v_cvt_pk_bf16_f32 v150, v184, v185
v_cvt_pk_bf16_f32 v151, v186, v187
s_waitcnt lgkmcnt(14)
v_mfma_f32_32x32x16_bf16 v[80:95], v[144:147], v[32:35], v[80:95]
ds_read_b64_tr_b16 v[64:65], v12 offset:45056
ds_read_b64_tr_b16 v[66:67], v12 offset:46080
v_pk_fma_f32 v[188:189], v[180:181], v[196:197], v[188:189] op_sel_hi:[1,0,1] neg_lo:[0,0,1] neg_hi:[0,0,1]
v_pk_fma_f32 v[190:191], v[182:183], v[196:197], v[190:191] op_sel_hi:[1,0,1] neg_lo:[0,0,1] neg_hi:[0,0,1]
s_waitcnt lgkmcnt(14)
v_mfma_f32_32x32x16_bf16 v[96:111], v[144:147], v[36:39], v[96:111]
ds_read_b64_tr_b16 v[68:69], v13 offset:45056
ds_read_b64_tr_b16 v[70:71], v13 offset:46080
v_pk_fma_f32 v[192:193], v[184:185], v[196:197], v[192:193] op_sel_hi:[1,0,1] neg_lo:[0,0,1] neg_hi:[0,0,1]
v_pk_fma_f32 v[194:195], v[186:187], v[196:197], v[194:195] op_sel_hi:[1,0,1] neg_lo:[0,0,1] neg_hi:[0,0,1]
s_waitcnt lgkmcnt(14)
v_mfma_f32_32x32x16_bf16 v[112:127], v[144:147], v[40:43], v[112:127]
ds_read_b64_tr_b16 v[72:73], v14 offset:45056
ds_read_b64_tr_b16 v[74:75], v14 offset:46080
v_cvt_pk_bf16_f32 v152, v188, v189
v_cvt_pk_bf16_f32 v153, v190, v191
s_waitcnt lgkmcnt(14)
v_mfma_f32_32x32x16_bf16 v[128:143], v[144:147], v[44:47], v[128:143]
ds_read_b64_tr_b16 v[76:77], v15 offset:45056
ds_read_b64_tr_b16 v[78:79], v15 offset:46080
v_cvt_pk_bf16_f32 v154, v192, v193
v_cvt_pk_bf16_f32 v155, v194, v195
s_waitcnt lgkmcnt(14)
v_mfma_f32_32x32x16_bf16 v[80:95], v[148:151], v[48:51], v[80:95]
s_waitcnt vmcnt(4)
s_barrier
ds_read_b64_tr_b16 v[32:33], v12 offset:49152
ds_read_b64_tr_b16 v[34:35], v12 offset:50176
v_pk_fma_f32 v[180:181], v[188:189], v[196:197], v[180:181] op_sel_hi:[1,0,1] neg_lo:[0,0,1] neg_hi:[0,0,1]
v_pk_fma_f32 v[182:183], v[190:191], v[196:197], v[182:183] op_sel_hi:[1,0,1] neg_lo:[0,0,1] neg_hi:[0,0,1]
s_waitcnt lgkmcnt(14)
v_mfma_f32_32x32x16_bf16 v[96:111], v[148:151], v[52:55], v[96:111]
ds_read_b64_tr_b16 v[36:37], v13 offset:49152
ds_read_b64_tr_b16 v[38:39], v13 offset:50176
v_pk_fma_f32 v[184:185], v[192:193], v[196:197], v[184:185] op_sel_hi:[1,0,1] neg_lo:[0,0,1] neg_hi:[0,0,1]
v_pk_fma_f32 v[186:187], v[194:195], v[196:197], v[186:187] op_sel_hi:[1,0,1] neg_lo:[0,0,1] neg_hi:[0,0,1]
s_waitcnt lgkmcnt(14)
v_mfma_f32_32x32x16_bf16 v[112:127], v[148:151], v[56:59], v[112:127]
ds_read_b64_tr_b16 v[40:41], v14 offset:49152
ds_read_b64_tr_b16 v[42:43], v14 offset:50176
v_cvt_pk_bf16_f32 v144, v180, v181
v_cvt_pk_bf16_f32 v145, v182, v183
s_waitcnt lgkmcnt(14)
v_mfma_f32_32x32x16_bf16 v[128:143], v[148:151], v[60:63], v[128:143]
ds_read_b64_tr_b16 v[44:45], v15 offset:49152
ds_read_b64_tr_b16 v[46:47], v15 offset:50176
v_cvt_pk_bf16_f32 v146, v184, v185
v_cvt_pk_bf16_f32 v147, v186, v187
s_waitcnt lgkmcnt(14)
v_mfma_f32_32x32x16_bf16 v[80:95], v[152:155], v[64:67], v[80:95]
ds_read_b64_tr_b16 v[48:49], v12 offset:53248
ds_read_b64_tr_b16 v[50:51], v12 offset:54272
v_pk_fma_f32 v[188:189], v[180:181], v[196:197], v[188:189] op_sel_hi:[1,0,1] neg_lo:[0,0,1] neg_hi:[0,0,1]
v_pk_fma_f32 v[190:191], v[182:183], v[196:197], v[190:191] op_sel_hi:[1,0,1] neg_lo:[0,0,1] neg_hi:[0,0,1]
s_waitcnt lgkmcnt(14)
v_mfma_f32_32x32x16_bf16 v[96:111], v[152:155], v[68:71], v[96:111]
ds_read_b64_tr_b16 v[52:53], v13 offset:53248
ds_read_b64_tr_b16 v[54:55], v13 offset:54272
v_pk_fma_f32 v[192:193], v[184:185], v[196:197], v[192:193] op_sel_hi:[1,0,1] neg_lo:[0,0,1] neg_hi:[0,0,1]
v_pk_fma_f32 v[194:195], v[186:187], v[196:197], v[194:195] op_sel_hi:[1,0,1] neg_lo:[0,0,1] neg_hi:[0,0,1]
s_waitcnt lgkmcnt(14)
v_mfma_f32_32x32x16_bf16 v[112:127], v[152:155], v[72:75], v[112:127]
ds_read_b64_tr_b16 v[56:57], v14 offset:53248
ds_read_b64_tr_b16 v[58:59], v14 offset:54272
v_cvt_pk_bf16_f32 v148, v188, v189
v_cvt_pk_bf16_f32 v149, v190, v191
s_waitcnt lgkmcnt(14)
v_mfma_f32_32x32x16_bf16 v[128:143], v[152:155], v[76:79], v[128:143]
ds_read_b64_tr_b16 v[60:61], v15 offset:53248
ds_read_b64_tr_b16 v[62:63], v15 offset:54272
v_cvt_pk_bf16_f32 v150, v192, v193
v_cvt_pk_bf16_f32 v151, v194, v195
s_waitcnt lgkmcnt(14)
v_mfma_f32_32x32x16_bf16 v[80:95], v[144:147], v[32:35], v[80:95]
ds_read_b64_tr_b16 v[64:65], v12 offset:57344
ds_read_b64_tr_b16 v[66:67], v12 offset:58368
v_pk_fma_f32 v[180:181], v[188:189], v[196:197], v[180:181] op_sel_hi:[1,0,1] neg_lo:[0,0,1] neg_hi:[0,0,1]
v_pk_fma_f32 v[182:183], v[190:191], v[196:197], v[182:183] op_sel_hi:[1,0,1] neg_lo:[0,0,1] neg_hi:[0,0,1]
s_waitcnt lgkmcnt(14)
v_mfma_f32_32x32x16_bf16 v[96:111], v[144:147], v[36:39], v[96:111]
ds_read_b64_tr_b16 v[68:69], v13 offset:57344
ds_read_b64_tr_b16 v[70:71], v13 offset:58368
v_pk_fma_f32 v[184:185], v[192:193], v[196:197], v[184:185] op_sel_hi:[1,0,1] neg_lo:[0,0,1] neg_hi:[0,0,1]
v_pk_fma_f32 v[186:187], v[194:195], v[196:197], v[186:187] op_sel_hi:[1,0,1] neg_lo:[0,0,1] neg_hi:[0,0,1]
s_waitcnt lgkmcnt(14)
v_mfma_f32_32x32x16_bf16 v[112:127], v[144:147], v[40:43], v[112:127]
ds_read_b64_tr_b16 v[72:73], v14 offset:57344
ds_read_b64_tr_b16 v[74:75], v14 offset:58368
v_cvt_pk_bf16_f32 v152, v180, v181
v_cvt_pk_bf16_f32 v153, v182, v183
s_waitcnt lgkmcnt(14)
v_mfma_f32_32x32x16_bf16 v[128:143], v[144:147], v[44:47], v[128:143]
ds_read_b64_tr_b16 v[76:77], v15 offset:57344
ds_read_b64_tr_b16 v[78:79], v15 offset:58368
v_cvt_pk_bf16_f32 v154, v184, v185
v_cvt_pk_bf16_f32 v155, v186, v187
s_waitcnt lgkmcnt(14)
v_mfma_f32_32x32x16_bf16 v[80:95], v[148:151], v[48:51], v[80:95]
ds_read_b64_tr_b16 v[32:33], v12 offset:61440
ds_read_b64_tr_b16 v[34:35], v12 offset:62464
v_pk_fma_f32 v[188:189], v[180:181], v[196:197], v[188:189] op_sel_hi:[1,0,1] neg_lo:[0,0,1] neg_hi:[0,0,1]
v_pk_fma_f32 v[190:191], v[182:183], v[196:197], v[190:191] op_sel_hi:[1,0,1] neg_lo:[0,0,1] neg_hi:[0,0,1]
s_waitcnt lgkmcnt(14)
v_mfma_f32_32x32x16_bf16 v[96:111], v[148:151], v[52:55], v[96:111]
ds_read_b64_tr_b16 v[36:37], v13 offset:61440
ds_read_b64_tr_b16 v[38:39], v13 offset:62464
v_pk_fma_f32 v[192:193], v[184:185], v[196:197], v[192:193] op_sel_hi:[1,0,1] neg_lo:[0,0,1] neg_hi:[0,0,1]
v_pk_fma_f32 v[194:195], v[186:187], v[196:197], v[194:195] op_sel_hi:[1,0,1] neg_lo:[0,0,1] neg_hi:[0,0,1]
s_waitcnt lgkmcnt(14)
v_mfma_f32_32x32x16_bf16 v[112:127], v[148:151], v[56:59], v[112:127]
ds_read_b64_tr_b16 v[40:41], v14 offset:61440
ds_read_b64_tr_b16 v[42:43], v14 offset:62464
v_cvt_pk_bf16_f32 v144, v188, v189
v_cvt_pk_bf16_f32 v145, v190, v191
s_waitcnt lgkmcnt(14)
v_mfma_f32_32x32x16_bf16 v[128:143], v[148:151], v[60:63], v[128:143]
ds_read_b64_tr_b16 v[44:45], v15 offset:61440
ds_read_b64_tr_b16 v[46:47], v15 offset:62464
v_cvt_pk_bf16_f32 v146, v192, v193
v_cvt_pk_bf16_f32 v147, v194, v195
s_waitcnt lgkmcnt(14)
v_mfma_f32_32x32x16_bf16 v[80:95], v[152:155], v[64:67], v[80:95]
s_waitcnt vmcnt(0)
s_barrier
v_add_u32 v12, 0x10000, v12
ds_read_b64_tr_b16 v[48:49], v12 offset:0
ds_read_b64_tr_b16 v[50:51], v12 offset:1024
v_pk_fma_f32 v[180:181], v[188:189], v[196:197], v[180:181] op_sel_hi:[1,0,1] neg_lo:[0,0,1] neg_hi:[0,0,1]
v_pk_fma_f32 v[182:183], v[190:191], v[196:197], v[182:183] op_sel_hi:[1,0,1] neg_lo:[0,0,1] neg_hi:[0,0,1]
s_waitcnt lgkmcnt(14)
v_mfma_f32_32x32x16_bf16 v[96:111], v[152:155], v[68:71], v[96:111]
v_add_u32 v13, 0x10000, v13
ds_read_b64_tr_b16 v[52:53], v13 offset:0
ds_read_b64_tr_b16 v[54:55], v13 offset:1024
v_pk_fma_f32 v[184:185], v[192:193], v[196:197], v[184:185] op_sel_hi:[1,0,1] neg_lo:[0,0,1] neg_hi:[0,0,1]
v_pk_fma_f32 v[186:187], v[194:195], v[196:197], v[186:187] op_sel_hi:[1,0,1] neg_lo:[0,0,1] neg_hi:[0,0,1]
s_waitcnt lgkmcnt(14)
v_mfma_f32_32x32x16_bf16 v[112:127], v[152:155], v[72:75], v[112:127]
v_add_u32 v14, 0x10000, v14
ds_read_b64_tr_b16 v[56:57], v14 offset:0
ds_read_b64_tr_b16 v[58:59], v14 offset:1024
v_cvt_pk_bf16_f32 v148, v180, v181
v_cvt_pk_bf16_f32 v149, v182, v183
s_waitcnt lgkmcnt(14)
v_mfma_f32_32x32x16_bf16 v[128:143], v[152:155], v[76:79], v[128:143]
v_add_u32 v15, 0x10000, v15
ds_read_b64_tr_b16 v[60:61], v15 offset:0
ds_read_b64_tr_b16 v[62:63], v15 offset:1024
v_cvt_pk_bf16_f32 v150, v184, v185
v_cvt_pk_bf16_f32 v151, v186, v187
s_waitcnt lgkmcnt(14)
v_mfma_f32_32x32x16_bf16 v[80:95], v[144:147], v[32:35], v[80:95]
ds_read_b64_tr_b16 v[64:65], v12 offset:4096
ds_read_b64_tr_b16 v[66:67], v12 offset:5120
v_pk_fma_f32 v[188:189], v[180:181], v[196:197], v[188:189] op_sel_hi:[1,0,1] neg_lo:[0,0,1] neg_hi:[0,0,1]
v_pk_fma_f32 v[190:191], v[182:183], v[196:197], v[190:191] op_sel_hi:[1,0,1] neg_lo:[0,0,1] neg_hi:[0,0,1]
s_waitcnt lgkmcnt(14)
v_mfma_f32_32x32x16_bf16 v[96:111], v[144:147], v[36:39], v[96:111]
ds_read_b64_tr_b16 v[68:69], v13 offset:4096
ds_read_b64_tr_b16 v[70:71], v13 offset:5120
v_pk_fma_f32 v[192:193], v[184:185], v[196:197], v[192:193] op_sel_hi:[1,0,1] neg_lo:[0,0,1] neg_hi:[0,0,1]
v_pk_fma_f32 v[194:195], v[186:187], v[196:197], v[194:195] op_sel_hi:[1,0,1] neg_lo:[0,0,1] neg_hi:[0,0,1]
s_waitcnt lgkmcnt(14)
v_mfma_f32_32x32x16_bf16 v[112:127], v[144:147], v[40:43], v[112:127]
ds_read_b64_tr_b16 v[72:73], v14 offset:4096
ds_read_b64_tr_b16 v[74:75], v14 offset:5120
v_cvt_pk_bf16_f32 v152, v188, v189
v_cvt_pk_bf16_f32 v153, v190, v191
s_waitcnt lgkmcnt(14)
v_mfma_f32_32x32x16_bf16 v[128:143], v[144:147], v[44:47], v[128:143]
ds_read_b64_tr_b16 v[76:77], v15 offset:4096
ds_read_b64_tr_b16 v[78:79], v15 offset:5120
v_cvt_pk_bf16_f32 v154, v192, v193
v_cvt_pk_bf16_f32 v155, v194, v195
s_waitcnt lgkmcnt(14)
v_mfma_f32_32x32x16_bf16 v[80:95], v[148:151], v[48:51], v[80:95]
ds_read_b64_tr_b16 v[32:33], v12 offset:8192
ds_read_b64_tr_b16 v[34:35], v12 offset:9216
v_pk_fma_f32 v[180:181], v[188:189], v[196:197], v[180:181] op_sel_hi:[1,0,1] neg_lo:[0,0,1] neg_hi:[0,0,1]
v_pk_fma_f32 v[182:183], v[190:191], v[196:197], v[182:183] op_sel_hi:[1,0,1] neg_lo:[0,0,1] neg_hi:[0,0,1]
s_waitcnt lgkmcnt(14)
v_mfma_f32_32x32x16_bf16 v[96:111], v[148:151], v[52:55], v[96:111]
ds_read_b64_tr_b16 v[36:37], v13 offset:8192
ds_read_b64_tr_b16 v[38:39], v13 offset:9216
v_pk_fma_f32 v[184:185], v[192:193], v[196:197], v[184:185] op_sel_hi:[1,0,1] neg_lo:[0,0,1] neg_hi:[0,0,1]
v_pk_fma_f32 v[186:187], v[194:195], v[196:197], v[186:187] op_sel_hi:[1,0,1] neg_lo:[0,0,1] neg_hi:[0,0,1]
s_waitcnt lgkmcnt(14)
v_mfma_f32_32x32x16_bf16 v[112:127], v[148:151], v[56:59], v[112:127]
ds_read_b64_tr_b16 v[40:41], v14 offset:8192
ds_read_b64_tr_b16 v[42:43], v14 offset:9216
v_cvt_pk_bf16_f32 v144, v180, v181
v_cvt_pk_bf16_f32 v145, v182, v183
s_waitcnt lgkmcnt(14)
v_mfma_f32_32x32x16_bf16 v[128:143], v[148:151], v[60:63], v[128:143]
ds_read_b64_tr_b16 v[44:45], v15 offset:8192
ds_read_b64_tr_b16 v[46:47], v15 offset:9216
v_cvt_pk_bf16_f32 v146, v184, v185
v_cvt_pk_bf16_f32 v147, v186, v187
s_waitcnt lgkmcnt(14)
v_mfma_f32_32x32x16_bf16 v[80:95], v[152:155], v[64:67], v[80:95]
ds_read_b64_tr_b16 v[48:49], v12 offset:12288
ds_read_b64_tr_b16 v[50:51], v12 offset:13312
v_pk_fma_f32 v[188:189], v[180:181], v[196:197], v[188:189] op_sel_hi:[1,0,1] neg_lo:[0,0,1] neg_hi:[0,0,1]
v_pk_fma_f32 v[190:191], v[182:183], v[196:197], v[190:191] op_sel_hi:[1,0,1] neg_lo:[0,0,1] neg_hi:[0,0,1]
s_waitcnt lgkmcnt(14)
v_mfma_f32_32x32x16_bf16 v[96:111], v[152:155], v[68:71], v[96:111]
ds_read_b64_tr_b16 v[52:53], v13 offset:12288
ds_read_b64_tr_b16 v[54:55], v13 offset:13312
v_pk_fma_f32 v[192:193], v[184:185], v[196:197], v[192:193] op_sel_hi:[1,0,1] neg_lo:[0,0,1] neg_hi:[0,0,1]
v_pk_fma_f32 v[194:195], v[186:187], v[196:197], v[194:195] op_sel_hi:[1,0,1] neg_lo:[0,0,1] neg_hi:[0,0,1]
s_waitcnt lgkmcnt(14)
v_mfma_f32_32x32x16_bf16 v[112:127], v[152:155], v[72:75], v[112:127]
ds_read_b64_tr_b16 v[56:57], v14 offset:12288
ds_read_b64_tr_b16 v[58:59], v14 offset:13312
v_cvt_pk_bf16_f32 v148, v188, v189
v_cvt_pk_bf16_f32 v149, v190, v191
s_waitcnt lgkmcnt(14)
v_mfma_f32_32x32x16_bf16 v[128:143], v[152:155], v[76:79], v[128:143]
ds_read_b64_tr_b16 v[60:61], v15 offset:12288
ds_read_b64_tr_b16 v[62:63], v15 offset:13312
v_cvt_pk_bf16_f32 v150, v192, v193
v_cvt_pk_bf16_f32 v151, v194, v195
s_waitcnt lgkmcnt(14)
v_mfma_f32_32x32x16_bf16 v[80:95], v[144:147], v[32:35], v[80:95]
s_waitcnt lgkmcnt(12)
v_mfma_f32_32x32x16_bf16 v[96:111], v[144:147], v[36:39], v[96:111]
s_waitcnt lgkmcnt(10)
v_mfma_f32_32x32x16_bf16 v[112:127], v[144:147], v[40:43], v[112:127]
s_waitcnt lgkmcnt(8)
v_mfma_f32_32x32x16_bf16 v[128:143], v[144:147], v[44:47], v[128:143]
s_waitcnt lgkmcnt(6)
v_mfma_f32_32x32x16_bf16 v[80:95], v[148:151], v[48:51], v[80:95]
s_waitcnt lgkmcnt(4)
v_mfma_f32_32x32x16_bf16 v[96:111], v[148:151], v[52:55], v[96:111]
s_waitcnt lgkmcnt(2)
v_mfma_f32_32x32x16_bf16 v[112:127], v[148:151], v[56:59], v[112:127]
s_waitcnt lgkmcnt(0)
v_mfma_f32_32x32x16_bf16 v[128:143], v[148:151], v[60:63], v[128:143]
s_nop 9
v_pk_add_f32 v[80:81], v[80:81], v[112:113]
v_pk_add_f32 v[82:83], v[82:83], v[114:115] neg_lo:[0,1] neg_hi:[0,1]
v_pk_add_f32 v[84:85], v[84:85], v[116:117]
v_pk_add_f32 v[86:87], v[86:87], v[118:119] neg_lo:[0,1] neg_hi:[0,1]
v_pk_add_f32 v[88:89], v[88:89], v[120:121]
v_pk_add_f32 v[90:91], v[90:91], v[122:123] neg_lo:[0,1] neg_hi:[0,1]
v_pk_add_f32 v[92:93], v[92:93], v[124:125]
v_pk_add_f32 v[94:95], v[94:95], v[126:127] neg_lo:[0,1] neg_hi:[0,1]
v_pk_mul_f32 v[80:81], v[80:81], v[178:179]
v_pk_mul_f32 v[82:83], v[82:83], v[26:27] op_sel_hi:[1,0]
v_pk_mul_f32 v[84:85], v[84:85], v[26:27] op_sel_hi:[1,0]
v_pk_mul_f32 v[86:87], v[86:87], v[26:27] op_sel_hi:[1,0]
v_pk_mul_f32 v[88:89], v[88:89], v[26:27] op_sel_hi:[1,0]
v_pk_mul_f32 v[90:91], v[90:91], v[26:27] op_sel_hi:[1,0]
v_pk_mul_f32 v[92:93], v[92:93], v[26:27] op_sel_hi:[1,0]
v_pk_mul_f32 v[94:95], v[94:95], v[26:27] op_sel_hi:[1,0]
v_cvt_pk_bf16_f32 v32, v80, v81
v_cvt_pk_bf16_f32 v33, v82, v83
v_cvt_pk_bf16_f32 v34, v84, v85
v_cvt_pk_bf16_f32 v35, v86, v87
v_cvt_pk_bf16_f32 v36, v88, v89
v_cvt_pk_bf16_f32 v37, v90, v91
v_cvt_pk_bf16_f32 v38, v92, v93
v_cvt_pk_bf16_f32 v39, v94, v95
buffer_store_dwordx4 v[32:35], v176, s[16:19], s32 offen
buffer_store_dwordx4 v[36:39], v176, s[16:19], s32 offen offset:1024
v_pk_add_f32 v[96:97], v[96:97], v[128:129]
v_pk_add_f32 v[98:99], v[98:99], v[130:131] neg_lo:[0,1] neg_hi:[0,1]
v_pk_add_f32 v[100:101], v[100:101], v[132:133]
v_pk_add_f32 v[102:103], v[102:103], v[134:135] neg_lo:[0,1] neg_hi:[0,1]
v_pk_add_f32 v[104:105], v[104:105], v[136:137]
v_pk_add_f32 v[106:107], v[106:107], v[138:139] neg_lo:[0,1] neg_hi:[0,1]
v_pk_add_f32 v[108:109], v[108:109], v[140:141]
v_pk_add_f32 v[110:111], v[110:111], v[142:143] neg_lo:[0,1] neg_hi:[0,1]
v_pk_mul_f32 v[96:97], v[96:97], v[178:179]
v_pk_mul_f32 v[98:99], v[98:99], v[26:27] op_sel_hi:[1,0]
v_pk_mul_f32 v[100:101], v[100:101], v[26:27] op_sel_hi:[1,0]
v_pk_mul_f32 v[102:103], v[102:103], v[26:27] op_sel_hi:[1,0]
v_pk_mul_f32 v[104:105], v[104:105], v[26:27] op_sel_hi:[1,0]
v_pk_mul_f32 v[106:107], v[106:107], v[26:27] op_sel_hi:[1,0]
v_pk_mul_f32 v[108:109], v[108:109], v[26:27] op_sel_hi:[1,0]
v_pk_mul_f32 v[110:111], v[110:111], v[26:27] op_sel_hi:[1,0]
v_cvt_pk_bf16_f32 v40, v96, v97
v_cvt_pk_bf16_f32 v41, v98, v99
v_cvt_pk_bf16_f32 v42, v100, v101
v_cvt_pk_bf16_f32 v43, v102, v103
v_cvt_pk_bf16_f32 v44, v104, v105
v_cvt_pk_bf16_f32 v45, v106, v107
v_cvt_pk_bf16_f32 v46, v108, v109
v_cvt_pk_bf16_f32 v47, v110, v111
buffer_store_dwordx4 v[40:43], v177, s[16:19], s32 offen
buffer_store_dwordx4 v[44:47], v177, s[16:19], s32 offen offset:1024
s_endpgm
.Lk0_role3:
s_load_dwordx4 s[4:7], s[0:1], 8
s_load_dwordx2 s[20:21], s[0:1], 64
v_lshrrev_b32 v1, 6, v0
v_and_b32 v2, 63, v0
v_readfirstlane_b32 s22, v1
s_lshr_b32 s23, s2, 4
s_bfe_u32 s24, s2, 0x20002
s_and_b32 s25, s2, 3
s_lshl_b32 s26, s23, 6
v_add_u32 v3, s26, v2
v_cmp_eq_u32 vcc, 0, v3
v_mov_b32 v5, 320
s_nop 0
v_cndmask_b32 v4, v3, v5, vcc
v_lshlrev_b32 v4, 1, v4
s_lshl_b32 s26, s25, 8
s_lshl_b32 s27, s24, 4
s_add_u32 s26, s26, s27
s_lshl_b32 s27, s22, 2
s_add_u32 s26, s26, s27
s_mul_i32 s26, s26, 642
s_waitcnt lgkmcnt(0)
s_add_u32 s8, s4, 0
s_addc_u32 s9, s5, 0
s_mov_b32 s10, 1314816
s_mov_b32 s11, 0x00020000
s_add_u32 s12, s6, 0
s_addc_u32 s13, s7, 0
s_mov_b32 s14, 1314816
s_mov_b32 s15, 0x00020000
s_add_u32 s29, s26, 0
buffer_load_ushort v8, v4, s[8:11], s29 offen offset:0
buffer_load_ushort v40, v4, s[12:15], s29 offen offset:0
buffer_load_ushort v16, v4, s[8:11], s29 offen offset:642
buffer_load_ushort v48, v4, s[12:15], s29 offen offset:642
buffer_load_ushort v24, v4, s[8:11], s29 offen offset:1284
buffer_load_ushort v56, v4, s[12:15], s29 offen offset:1284
buffer_load_ushort v32, v4, s[8:11], s29 offen offset:1926
buffer_load_ushort v64, v4, s[12:15], s29 offen offset:1926
s_add_u32 s29, s26, 41088
buffer_load_ushort v9, v4, s[8:11], s29 offen offset:0
buffer_load_ushort v41, v4, s[12:15], s29 offen offset:0
buffer_load_ushort v17, v4, s[8:11], s29 offen offset:642
buffer_load_ushort v49, v4, s[12:15], s29 offen offset:642
buffer_load_ushort v25, v4, s[8:11], s29 offen offset:1284
buffer_load_ushort v57, v4, s[12:15], s29 offen offset:1284
buffer_load_ushort v33, v4, s[8:11], s29 offen offset:1926
buffer_load_ushort v65, v4, s[12:15], s29 offen offset:1926
s_add_u32 s29, s26, 82176
buffer_load_ushort v10, v4, s[8:11], s29 offen offset:0
buffer_load_ushort v42, v4, s[12:15], s29 offen offset:0
buffer_load_ushort v18, v4, s[8:11], s29 offen offset:642
buffer_load_ushort v50, v4, s[12:15], s29 offen offset:642
buffer_load_ushort v26, v4, s[8:11], s29 offen offset:1284
buffer_load_ushort v58, v4, s[12:15], s29 offen offset:1284
buffer_load_ushort v34, v4, s[8:11], s29 offen offset:1926
buffer_load_ushort v66, v4, s[12:15], s29 offen offset:1926
s_add_u32 s29, s26, 123264
buffer_load_ushort v11, v4, s[8:11], s29 offen offset:0
buffer_load_ushort v43, v4, s[12:15], s29 offen offset:0
buffer_load_ushort v19, v4, s[8:11], s29 offen offset:642
buffer_load_ushort v51, v4, s[12:15], s29 offen offset:642
buffer_load_ushort v27, v4, s[8:11], s29 offen offset:1284
buffer_load_ushort v59, v4, s[12:15], s29 offen offset:1284
buffer_load_ushort v35, v4, s[8:11], s29 offen offset:1926
buffer_load_ushort v67, v4, s[12:15], s29 offen offset:1926
s_add_u32 s29, s26, 657408
buffer_load_ushort v12, v4, s[8:11], s29 offen offset:0
buffer_load_ushort v44, v4, s[12:15], s29 offen offset:0
buffer_load_ushort v20, v4, s[8:11], s29 offen offset:642
buffer_load_ushort v52, v4, s[12:15], s29 offen offset:642
buffer_load_ushort v28, v4, s[8:11], s29 offen offset:1284
buffer_load_ushort v60, v4, s[12:15], s29 offen offset:1284
buffer_load_ushort v36, v4, s[8:11], s29 offen offset:1926
buffer_load_ushort v68, v4, s[12:15], s29 offen offset:1926
s_add_u32 s29, s26, 698496
buffer_load_ushort v13, v4, s[8:11], s29 offen offset:0
buffer_load_ushort v45, v4, s[12:15], s29 offen offset:0
buffer_load_ushort v21, v4, s[8:11], s29 offen offset:642
buffer_load_ushort v53, v4, s[12:15], s29 offen offset:642
buffer_load_ushort v29, v4, s[8:11], s29 offen offset:1284
buffer_load_ushort v61, v4, s[12:15], s29 offen offset:1284
buffer_load_ushort v37, v4, s[8:11], s29 offen offset:1926
buffer_load_ushort v69, v4, s[12:15], s29 offen offset:1926
s_add_u32 s29, s26, 739584
buffer_load_ushort v14, v4, s[8:11], s29 offen offset:0
buffer_load_ushort v46, v4, s[12:15], s29 offen offset:0
buffer_load_ushort v22, v4, s[8:11], s29 offen offset:642
buffer_load_ushort v54, v4, s[12:15], s29 offen offset:642
buffer_load_ushort v30, v4, s[8:11], s29 offen offset:1284
buffer_load_ushort v62, v4, s[12:15], s29 offen offset:1284
buffer_load_ushort v38, v4, s[8:11], s29 offen offset:1926
buffer_load_ushort v70, v4, s[12:15], s29 offen offset:1926
s_add_u32 s29, s26, 780672
buffer_load_ushort v15, v4, s[8:11], s29 offen offset:0
buffer_load_ushort v47, v4, s[12:15], s29 offen offset:0
buffer_load_ushort v23, v4, s[8:11], s29 offen offset:642
buffer_load_ushort v55, v4, s[12:15], s29 offen offset:642
buffer_load_ushort v31, v4, s[8:11], s29 offen offset:1284
buffer_load_ushort v63, v4, s[12:15], s29 offen offset:1284
buffer_load_ushort v39, v4, s[8:11], s29 offen offset:1926
buffer_load_ushort v71, v4, s[12:15], s29 offen offset:1926
s_lshl_b32 s28, s24, 11
s_lshl_b32 s27, s25, 9
s_add_u32 s28, s28, s27
s_lshl_b32 s27, s23, 19
s_add_u32 s28, s28, s27
s_lshl_b32 s27, s22, 17
s_add_u32 s28, s28, s27
s_add_u32 s28, s28, 23068672
s_add_u32 s16, s20, 0
s_addc_u32 s17, s21, 0
s_mov_b32 s18, 44564480
s_mov_b32 s19, 0x00020000
v_and_b32 v5, 15, v2
s_lshl_b32 s27, s22, 3
v_xor_b32 v6, s27, v5
v_lshlrev_b32 v6, 4, v6
v_lshl_add_u32 v72, v2, 9, v6
v_xor_b32 v73, 16, v72
v_xor_b32 v74, 32, v72
v_xor_b32 v75, 48, v72
v_xor_b32 v76, 64, v72
v_xor_b32 v77, 80, v72
v_xor_b32 v78, 96, v72
v_xor_b32 v79, 112, v72
v_lshrrev_b32 v6, 5, v2
v_and_b32 v5, 31, v2
v_xor_b32 v7, v5, v6
v_lshlrev_b32 v7, 4, v7
v_lshl_add_u32 v7, v6, 9, v7
s_lshl_b32 s27, s22, 13
v_add_u32 v80, s27, v7
v_xor_b32 v81, 32, v80
v_xor_b32 v82, 64, v80
v_xor_b32 v83, 96, v80
v_xor_b32 v84, 128, v80
v_xor_b32 v85, 160, v80
v_xor_b32 v86, 192, v80
v_xor_b32 v87, 224, v80
v_lshlrev_b32 v3, 13, v6
v_lshl_add_u32 v3, v5, 4, v3
s_waitcnt vmcnt(32)
v_lshl_or_b32 v8, v40, 16, v8
v_lshl_or_b32 v9, v41, 16, v9
v_lshl_or_b32 v10, v42, 16, v10
v_lshl_or_b32 v11, v43, 16, v11
ds_write_b128 v72, v[8:11]
v_lshl_or_b32 v16, v48, 16, v16
v_lshl_or_b32 v17, v49, 16, v17
v_lshl_or_b32 v18, v50, 16, v18
v_lshl_or_b32 v19, v51, 16, v19
ds_write_b128 v74, v[16:19]
v_lshl_or_b32 v24, v56, 16, v24
v_lshl_or_b32 v25, v57, 16, v25
v_lshl_or_b32 v26, v58, 16, v26
v_lshl_or_b32 v27, v59, 16, v27
ds_write_b128 v76, v[24:27]
v_lshl_or_b32 v32, v64, 16, v32
v_lshl_or_b32 v33, v65, 16, v33
v_lshl_or_b32 v34, v66, 16, v34
v_lshl_or_b32 v35, v67, 16, v35
ds_write_b128 v78, v[32:35]
s_waitcnt vmcnt(0)
v_lshl_or_b32 v12, v44, 16, v12
v_lshl_or_b32 v13, v45, 16, v13
v_lshl_or_b32 v14, v46, 16, v14
v_lshl_or_b32 v15, v47, 16, v15
ds_write_b128 v73, v[12:15]
v_lshl_or_b32 v20, v52, 16, v20
v_lshl_or_b32 v21, v53, 16, v21
v_lshl_or_b32 v22, v54, 16, v22
v_lshl_or_b32 v23, v55, 16, v23
ds_write_b128 v75, v[20:23]
v_lshl_or_b32 v28, v60, 16, v28
v_lshl_or_b32 v29, v61, 16, v29
v_lshl_or_b32 v30, v62, 16, v30
v_lshl_or_b32 v31, v63, 16, v31
ds_write_b128 v77, v[28:31]
v_lshl_or_b32 v36, v68, 16, v36
v_lshl_or_b32 v37, v69, 16, v37
v_lshl_or_b32 v38, v70, 16, v38
v_lshl_or_b32 v39, v71, 16, v39
ds_write_b128 v79, v[36:39]
s_waitcnt lgkmcnt(0)
s_barrier
ds_read_b128 v[8:11], v80 offset:0
ds_read_b128 v[12:15], v81 offset:1024
ds_read_b128 v[16:19], v82 offset:2048
ds_read_b128 v[20:23], v83 offset:3072
ds_read_b128 v[24:27], v84 offset:4096
ds_read_b128 v[28:31], v85 offset:5120
ds_read_b128 v[32:35], v86 offset:6144
ds_read_b128 v[36:39], v87 offset:7168
s_waitcnt lgkmcnt(7)
buffer_store_dwordx4 v[8:11], v3, s[16:19], s28 offen sc1
s_add_u32 s28, s28, 16384
s_waitcnt lgkmcnt(6)
buffer_store_dwordx4 v[12:15], v3, s[16:19], s28 offen sc1
s_add_u32 s28, s28, 16384
s_waitcnt lgkmcnt(5)
buffer_store_dwordx4 v[16:19], v3, s[16:19], s28 offen sc1
s_add_u32 s28, s28, 16384
s_waitcnt lgkmcnt(4)
buffer_store_dwordx4 v[20:23], v3, s[16:19], s28 offen sc1
s_add_u32 s28, s28, 16384
s_waitcnt lgkmcnt(3)
buffer_store_dwordx4 v[24:27], v3, s[16:19], s28 offen sc1
s_add_u32 s28, s28, 16384
s_waitcnt lgkmcnt(2)
buffer_store_dwordx4 v[28:31], v3, s[16:19], s28 offen sc1
s_add_u32 s28, s28, 16384
s_waitcnt lgkmcnt(1)
buffer_store_dwordx4 v[32:35], v3, s[16:19], s28 offen sc1
s_add_u32 s28, s28, 16384
s_waitcnt lgkmcnt(0)
buffer_store_dwordx4 v[36:39], v3, s[16:19], s28 offen sc1
s_endpgm
.Lk0_role4:
s_load_dwordx4 s[4:7], s[0:1], 40
s_load_dwordx2 s[8:9], s[0:1], 64
s_lshr_b32 s20, s2, 3
s_and_b32 s21, s2, 7
v_lshlrev_b32 v1, 7, v0
s_getpc_b64 s[26:27]
s_add_u32 s26, s26, .Ltabcf@rel32@lo+4
s_addc_u32 s27, s27, .Ltabcf@rel32@hi+12
s_add_u32 s12, s26, 0
s_addc_u32 s13, s27, 0
s_mov_b32 s14, 20480
s_mov_b32 s15, 0x00020000
buffer_load_dword v2, v1, s[12:15], 0 offen
s_getpc_b64 s[26:27]
s_add_u32 s26, s26, .Ltab3@rel32@lo+4
s_addc_u32 s27, s27, .Ltab3@rel32@hi+12
s_add_u32 s12, s26, 0
s_addc_u32 s13, s27, 0
s_mov_b32 s14, 819200
s_mov_b32 s15, 0x00020000
v_lshlrev_b32 v3, 12, v0
buffer_load_dword v2, v3, s[12:15], 0 offen
v_lshlrev_b32 v3, 20, v0
v_min_u32 v3, 0x4000000, v3
s_mul_i32 s22, s21, 102400
s_mul_i32 s23, s20, 51200
s_add_u32 s22, s22, s23
s_waitcnt lgkmcnt(0)
s_add_u32 s12, s8, 2621440
s_addc_u32 s13, s9, 0
s_mov_b32 s14, 41943040
s_mov_b32 s15, 0x00020000
s_add_u32 s16, s6, 0
s_addc_u32 s17, s7, 0
s_mov_b32 s18, 2621440
s_mov_b32 s19, 0x00020000
buffer_load_dword v2, v3, s[12:15], 0 offen
buffer_load_dword v2, v3, s[16:19], 0 offen
s_add_u32 s12, s4, 0
s_addc_u32 s13, s5, 0
s_mov_b32 s14, 819200
s_mov_b32 s15, 0x00020000
buffer_load_dword v2, v1, s[12:15], s22 offen
s_add_u32 s22, s22, 18432
buffer_load_dword v2, v1, s[12:15], s22 offen
s_endpgm
.p2align 8
.globl k1_kernel
.type k1_kernel,@function
k1_kernel:
s_cmp_lt_u32 s2, 320
s_cbranch_scc1 .Lk1_role1
s_sub_u32 s2, s2, 320
s_cmp_lt_u32 s2, 80
s_cbranch_scc1 .Lk1_role2
s_sub_u32 s2, s2, 80
s_cmp_lt_u32 s2, 40
s_cbranch_scc1 .Lk1_role3
s_sub_u32 s2, s2, 40
s_endpgm
.Lk1_role1:
s_load_dwordx2 s[4:5], s[0:1], 64
v_lshrrev_b32 v4, 6, v0
v_and_b32 v5, 63, v0
v_readfirstlane_b32 s22, v4
v_lshlrev_b32 v1, 4, v5
v_bfe_u32 v2, v0, 4, 2
v_and_b32 v3, 15, v0
s_getpc_b64 s[26:27]
s_add_u32 s26, s26, .Ltabcf@rel32@lo+4
s_addc_u32 s27, s27, .Ltabcf@rel32@hi+12
s_add_u32 s8, s26, 0
s_addc_u32 s9, s27, 0
s_mov_b32 s10, 20480
s_mov_b32 s11, 0x00020000
s_mul_i32 s23, s22, 5120
s_mov_b32 m0, s23
s_nop 0
buffer_load_dwordx4 v1, s[8:11], m0 offen offset:0 lds
buffer_load_dwordx4 v1, s[8:11], m0 offen offset:1024 lds
buffer_load_dwordx4 v1, s[8:11], m0 offen offset:2048 lds
buffer_load_dwordx4 v1, s[8:11], m0 offen offset:3072 lds
s_add_u32 m0, s23, 4096
s_nop 0
buffer_load_dwordx4 v1, s[8:11], m0 offen lds
s_and_b32 s24, s22, 1
s_lshr_b32 s25, s22, 1
s_lshl_b32 s26, s24, 11
s_lshl_b32 s27, s25, 10
s_add_u32 s26, s26, s27
s_lshl_b32 s27, s2, 13
s_add_u32 s28, s27, s26
s_add_u32 s29, s28, 0
s_add_u32 s30, s28, 2621440
s_add_u32 s34, s29, 4096
s_add_u32 s35, s30, 4096
s_lshl_b32 s31, s26, 1
s_add_u32 s31, s31, 25690112
s_lshl_b32 s32, s22, 11
s_add_u32 s32, s32, s27
s_add_u32 s32, s32, 23068672
v_lshlrev_b32 v6, 1, v1
s_waitcnt lgkmcnt(0)
s_add_u32 s12, s4, 0
s_addc_u32 s13, s5, 0
s_mov_b32 s14, 44564480
s_mov_b32 s15, 0x00020000
buffer_load_dwordx4 v[8:11], v1, s[12:15], s29 offen
buffer_load_dwordx4 v[12:15], v1, s[12:15], s34 offen
buffer_load_dwordx4 v[16:19], v6, s[12:15], s31 offen
buffer_load_dwordx4 v[20:23], v6, s[12:15], s31 offen offset:16
buffer_load_dwordx4 v[24:27], v6, s[12:15], s32 offen
buffer_load_dwordx4 v[28:31], v6, s[12:15], s32 offen offset:16
s_lshl_b32 s33, s22, 4
v_add_u32 v4, s33, v3
v_cvt_f32_u32 v4, v4
v_mul_f32 v4, 0x3a000000, v4
v_lshlrev_b32 v5, 2, v2
v_cvt_f32_u32 v7, v5
v_mul_f32 v40, v4, v7
v_add_f32 v41, v40, v4
v_add_f32 v42, v41, v4
v_add_f32 v43, v42, v4
v_mul_f32 v4, 0x41800000, v4
v_add_f32 v44, v40, v4
v_add_f32 v45, v41, v4
v_add_f32 v46, v42, v4
v_add_f32 v47, v43, v4
v_add_u32 v5, s33, v5
v_cvt_f32_u32 v5, v5
v_cvt_f32_u32 v4, v3
v_mul_f32 v4, 0x3a000000, v4
v_add_f32 v7, 0x3c000000, v4
v_mul_f32 v56, v4, v5
v_mul_f32 v60, v7, v5
v_add_f32 v57, v56, v4
v_add_f32 v61, v60, v7
v_add_f32 v58, v57, v4
v_add_f32 v62, v61, v7
v_add_f32 v59, v58, v4
v_add_f32 v63, v62, v7
v_cos_f32 v32, v40
v_sin_f32 v40, v40
v_cos_f32 v33, v41
v_sin_f32 v41, v41
v_cos_f32 v34, v42
v_sin_f32 v42, v42
v_cos_f32 v35, v43
v_sin_f32 v43, v43
v_cos_f32 v36, v44
v_sin_f32 v44, v44
v_cos_f32 v37, v45
v_sin_f32 v45, v45
v_cos_f32 v38, v46
v_sin_f32 v46, v46
v_cos_f32 v39, v47
v_sin_f32 v47, v47
v_cos_f32 v48, v56
v_sin_f32 v56, v56
v_cos_f32 v49, v57
v_sin_f32 v57, v57
v_cos_f32 v50, v58
v_sin_f32 v58, v58
v_cos_f32 v51, v59
v_sin_f32 v59, v59
v_cos_f32 v52, v60
v_sin_f32 v60, v60
v_cos_f32 v53, v61
v_sin_f32 v61, v61
v_cos_f32 v54, v62
v_sin_f32 v62, v62
v_cos_f32 v55, v63
v_sin_f32 v63, v63
s_lshl_b32 s36, s24, 12
s_lshl_b32 s37, s25, 11
s_add_u32 s36, s36, s37
v_add_u32 v4, s36, v1
v_mov_b32 v7, 0x3727c5ac
s_waitcnt vmcnt(2)
v_fmamk_f32 v16, v16, 0x3acccccd, v7
v_fmamk_f32 v17, v17, 0x3acccccd, v7
v_fmamk_f32 v18, v18, 0x3acccccd, v7
v_fmamk_f32 v19, v19, 0x3acccccd, v7
v_fmamk_f32 v20, v20, 0x3acccccd, v7
v_fmamk_f32 v21, v21, 0x3acccccd, v7
v_fmamk_f32 v22, v22, 0x3acccccd, v7
v_fmamk_f32 v23, v23, 0x3acccccd, v7
v_rsq_f32 v16, v16
v_rsq_f32 v17, v17
v_rsq_f32 v18, v18
v_rsq_f32 v19, v19
v_rsq_f32 v20, v20
v_rsq_f32 v21, v21
v_rsq_f32 v22, v22
v_rsq_f32 v23, v23
v_lshlrev_b32 v232, 16, v8
v_and_b32 v233, 0xffff0000, v8
v_lshlrev_b32 v234, 16, v9
v_and_b32 v235, 0xffff0000, v9
v_lshlrev_b32 v236, 16, v10
v_and_b32 v237, 0xffff0000, v10
v_lshlrev_b32 v238, 16, v11
v_and_b32 v239, 0xffff0000, v11
v_fma_mixlo_f16 v224, v232, v16, 0
v_fma_mixlo_f16 v225, v234, v18, 0
v_fma_mixlo_f16 v226, v236, v20, 0
v_fma_mixlo_f16 v227, v238, v22, 0
v_fma_mixhi_f16 v224, v233, v17, 0
v_fma_mixhi_f16 v225, v235, v19, 0
v_fma_mixhi_f16 v226, v237, v21, 0
v_fma_mixhi_f16 v227, v239, v23, 0
s_nop 0
ds_write_b128 v4, v[224:227] offset:20480
v_lshlrev_b32 v232, 16, v12
v_and_b32 v233, 0xffff0000, v12
v_lshlrev_b32 v234, 16, v13
v_and_b32 v235, 0xffff0000, v13
v_lshlrev_b32 v236, 16, v14
v_and_b32 v237, 0xffff0000, v14
v_lshlrev_b32 v238, 16, v15
v_and_b32 v239, 0xffff0000, v15
v_fma_mixlo_f16 v228, v232, v16, 0
v_fma_mixlo_f16 v229, v234, v18, 0
v_fma_mixlo_f16 v230, v236, v20, 0
v_fma_mixlo_f16 v231, v238, v22, 0
v_fma_mixhi_f16 v228, v233, v17, 0
v_fma_mixhi_f16 v229, v235, v19, 0
v_fma_mixhi_f16 v230, v237, v21, 0
v_fma_mixhi_f16 v231, v239, v23, 0
s_nop 0
ds_write_b128 v4, v[228:231] offset:21504
s_waitcnt vmcnt(0)
s_and_b32 s40, s2, 1
s_mul_i32 s40, s40, 1310720
s_lshr_b32 s41, s2, 3
s_lshl_b32 s41, s41, 15
s_add_u32 s40, s40, s41
s_add_u32 s40, s40, 18350080
v_lshlrev_b32 v248, 7, v0
buffer_load_dword v249, v248, s[12:15], s40 offen
s_getpc_b64 s[44:45]
s_add_u32 s44, s44, .Ltext0@rel32@lo+4
s_addc_u32 s45, s45, .Ltext0@rel32@hi+12
s_lshr_b32 s47, s2, 3
s_lshl_b32 s47, s47, 15
v_lshl_add_u32 v248, v0, 7, s47
s_mov_b32 s46, .Ltext1-.Ltext0
s_mov_b32 s47, 0x00020000
buffer_load_dword v250, v248, s[44:47], 0 offen
v_lshlrev_b32 v232, 16, v24
v_and_b32 v233, 0xffff0000, v24
v_lshlrev_b32 v234, 16, v25
v_and_b32 v235, 0xffff0000, v25
v_lshlrev_b32 v236, 16, v26
v_and_b32 v237, 0xffff0000, v26
v_lshlrev_b32 v238, 16, v27
v_and_b32 v239, 0xffff0000, v27
v_lshlrev_b32 v240, 16, v28
v_and_b32 v241, 0xffff0000, v28
v_lshlrev_b32 v242, 16, v29
v_and_b32 v243, 0xffff0000, v29
v_lshlrev_b32 v244, 16, v30
v_and_b32 v245, 0xffff0000, v30
v_lshlrev_b32 v246, 16, v31
v_and_b32 v247, 0xffff0000, v31
v_max_f32 v5, |v232|, |v233|
v_max3_f32 v5, |v234|, |v235|, v5
v_max3_f32 v5, |v236|, |v237|, v5
v_max3_f32 v5, |v238|, |v239|, v5
v_max3_f32 v5, |v240|, |v241|, v5
v_max3_f32 v5, |v242|, |v243|, v5
v_max3_f32 v5, |v244|, |v245|, v5
v_max3_f32 v5, |v246|, |v247|, v5
s_nop 1
v_max_f32_dpp v5, v5, v5 row_ror:8 row_mask:0xf bank_mask:0xf
s_nop 1
v_max_f32_dpp v5, v5, v5 row_ror:4 row_mask:0xf bank_mask:0xf
s_nop 1
v_max_f32_dpp v5, v5, v5 row_ror:2 row_mask:0xf bank_mask:0xf
s_nop 1
v_max_f32_dpp v5, v5, v5 row_ror:1 row_mask:0xf bank_mask:0xf
s_lshl_b32 s37, s22, 4
v_lshl_add_u32 v7, v2, 2, s37
ds_write_b32 v7, v5 offset:28672
s_lshl_b32 s37, s22, 12
v_add_u32 v5, s37, v1
s_lshl_b32 s37, s25, 13
v_add_u32 v7, s37, v1
v_mov_b32 v6, 0
s_waitcnt lgkmcnt(0)
s_barrier
ds_read_b128 v[96:99], v5 offset:0
ds_read_b128 v[100:103], v5 offset:1024
ds_read_b128 v[108:111], v5 offset:2048
ds_read_b128 v[112:115], v5 offset:3072
ds_read_b128 v[64:67], v1 offset:20480
ds_read_b128 v[68:71], v1 offset:21504
ds_read_b128 v[72:75], v1 offset:22528
ds_read_b128 v[76:79], v1 offset:23552
ds_read_b128 v[80:83], v1 offset:24576
ds_read_b128 v[84:87], v1 offset:25600
ds_read_b128 v[88:91], v1 offset:26624
ds_read_b128 v[92:95], v1 offset:27648
ds_read_b128 v[208:211], v6 offset:28672
ds_read_b128 v[212:215], v6 offset:28688
ds_read_b128 v[216:219], v6 offset:28704
ds_read_b128 v[220:223], v6 offset:28720
ds_read_b128 v[168:171], v1 offset:16384
ds_read_b128 v[172:175], v1 offset:17408
ds_read_b128 v[180:183], v1 offset:18432
ds_read_b128 v[184:187], v1 offset:19456
s_waitcnt lgkmcnt(12)
v_xor_b32 v104, 0x80008000, v100
v_xor_b32 v105, 0x80008000, v101
v_xor_b32 v106, 0x80008000, v102
v_xor_b32 v107, 0x80008000, v103
v_xor_b32 v116, 0x80008000, v112
v_xor_b32 v117, 0x80008000, v113
v_xor_b32 v118, 0x80008000, v114
v_xor_b32 v119, 0x80008000, v115
v_mfma_f32_16x16x32_f16 v[192:195], v[64:67], v[96:99], 0
v_mfma_f32_16x16x32_f16 v[196:199], v[64:67], v[100:103], 0
v_mfma_f32_16x16x32_f16 v[192:195], v[68:71], v[104:107], v[192:195]
v_mfma_f32_16x16x32_f16 v[196:199], v[68:71], v[96:99], v[196:199]
v_mfma_f32_16x16x32_f16 v[192:195], v[72:75], v[108:111], v[192:195]
v_mfma_f32_16x16x32_f16 v[196:199], v[72:75], v[112:115], v[196:199]
v_mfma_f32_16x16x32_f16 v[192:195], v[76:79], v[116:119], v[192:195]
v_mfma_f32_16x16x32_f16 v[196:199], v[76:79], v[108:111], v[196:199]
s_waitcnt lgkmcnt(8)
v_mfma_f32_16x16x32_f16 v[200:203], v[80:83], v[96:99], 0
v_mfma_f32_16x16x32_f16 v[204:207], v[80:83], v[100:103], 0
v_mfma_f32_16x16x32_f16 v[200:203], v[84:87], v[104:107], v[200:203]
v_mfma_f32_16x16x32_f16 v[204:207], v[84:87], v[96:99], v[204:207]
v_mfma_f32_16x16x32_f16 v[200:203], v[88:91], v[108:111], v[200:203]
v_mfma_f32_16x16x32_f16 v[204:207], v[88:91], v[112:115], v[204:207]
v_mfma_f32_16x16x32_f16 v[200:203], v[92:95], v[116:119], v[200:203]
v_mfma_f32_16x16x32_f16 v[204:207], v[92:95], v[108:111], v[204:207]
s_waitcnt lgkmcnt(4)
v_max3_f32 v4, v208, v209, v210
v_max3_f32 v4, v211, v212, v4
v_max3_f32 v4, v213, v214, v4
v_max3_f32 v4, v215, v216, v4
v_max3_f32 v4, v217, v218, v4
v_max3_f32 v4, v219, v220, v4
v_max3_f32 v4, v221, v222, v4
v_max_f32 v4, v223, v4
v_frexp_exp_i32_f32 v4, v4
v_max_i32 v4, -100, v4
v_min_i32 v4, 100, v4
v_ldexp_f32 v6, 1.0, v4
v_sub_u32 v4, 0, v4
v_ldexp_f32 v4, 1.0, v4
v_pk_mul_f32 v[232:233], v[232:233], v[4:5] op_sel_hi:[1,0]
v_pk_mul_f32 v[234:235], v[234:235], v[4:5] op_sel_hi:[1,0]
v_pk_mul_f32 v[236:237], v[236:237], v[4:5] op_sel_hi:[1,0]
v_pk_mul_f32 v[238:239], v[238:239], v[4:5] op_sel_hi:[1,0]
v_pk_mul_f32 v[240:241], v[240:241], v[4:5] op_sel_hi:[1,0]
v_pk_mul_f32 v[242:243], v[242:243], v[4:5] op_sel_hi:[1,0]
v_pk_mul_f32 v[244:245], v[244:245], v[4:5] op_sel_hi:[1,0]
v_pk_mul_f32 v[246:247], v[246:247], v[4:5] op_sel_hi:[1,0]
ds_read_b128 v[120:123], v7 offset:0
ds_read_b128 v[124:127], v7 offset:1024
ds_read_b128 v[132:135], v7 offset:2048
ds_read_b128 v[136:139], v7 offset:3072
ds_read_b128 v[144:147], v7 offset:4096
ds_read_b128 v[148:151], v7 offset:5120
ds_read_b128 v[156:159], v7 offset:6144
ds_read_b128 v[160:163], v7 offset:7168
s_waitcnt lgkmcnt(8)
v_xor_b32 v176, 0x80008000, v172
v_xor_b32 v177, 0x80008000, v173
v_xor_b32 v178, 0x80008000, v174
v_xor_b32 v179, 0x80008000, v175
v_xor_b32 v188, 0x80008000, v184
v_xor_b32 v189, 0x80008000, v185
v_xor_b32 v190, 0x80008000, v186
v_xor_b32 v191, 0x80008000, v187
v_mul_f32 v16, v192, v32
v_mul_f32 v17, v196, v32
v_fma_mixlo_f16 v224, v196, v40, v16
v_fma_mixlo_f16 v228, -v192, v40, v17
v_mul_f32 v18, v193, v33
v_mul_f32 v19, v197, v33
v_fma_mixhi_f16 v224, v197, v41, v18
v_fma_mixhi_f16 v228, -v193, v41, v19
v_mul_f32 v20, v194, v34
v_mul_f32 v21, v198, v34
v_fma_mixlo_f16 v225, v198, v42, v20
v_fma_mixlo_f16 v229, -v194, v42, v21
v_mul_f32 v22, v195, v35
v_mul_f32 v23, v199, v35
v_fma_mixhi_f16 v225, v199, v43, v22
v_fma_mixhi_f16 v229, -v195, v43, v23
v_mul_f32 v16, v200, v36
v_mul_f32 v17, v204, v36
v_fma_mixlo_f16 v226, v204, v44, v16
v_fma_mixlo_f16 v230, -v200, v44, v17
v_mul_f32 v18, v201, v37
v_mul_f32 v19, v205, v37
v_fma_mixhi_f16 v226, v205, v45, v18
v_fma_mixhi_f16 v230, -v201, v45, v19
v_mul_f32 v20, v202, v38
v_mul_f32 v21, v206, v38
v_fma_mixlo_f16 v227, v206, v46, v20
v_fma_mixlo_f16 v231, -v202, v46, v21
v_mul_f32 v22, v203, v39
v_mul_f32 v23, v207, v39
v_fma_mixhi_f16 v227, v207, v47, v22
v_fma_mixhi_f16 v231, -v203, v47, v23
s_nop 0
v_mfma_f32_16x16x32_f16 v[208:211], v[168:171], v[224:227], 0
v_mfma_f32_16x16x32_f16 v[212:215], v[172:175], v[224:227], 0
v_mfma_f32_16x16x32_f16 v[208:211], v[176:179], v[228:231], v[208:211]
v_mfma_f32_16x16x32_f16 v[212:215], v[168:171], v[228:231], v[212:215]
v_mfma_f32_16x16x32_f16 v[216:219], v[180:183], v[224:227], 0
v_mfma_f32_16x16x32_f16 v[220:223], v[184:187], v[224:227], 0
v_mfma_f32_16x16x32_f16 v[216:219], v[188:191], v[228:231], v[216:219]
v_mfma_f32_16x16x32_f16 v[220:223], v[180:183], v[228:231], v[220:223]
s_waitcnt lgkmcnt(0)
v_xor_b32 v128, 0x80008000, v124
v_xor_b32 v129, 0x80008000, v125
v_xor_b32 v130, 0x80008000, v126
v_xor_b32 v131, 0x80008000, v127
v_xor_b32 v140, 0x80008000, v136
v_xor_b32 v141, 0x80008000, v137
v_xor_b32 v142, 0x80008000, v138
v_xor_b32 v143, 0x80008000, v139
v_xor_b32 v152, 0x80008000, v148
v_xor_b32 v153, 0x80008000, v149
v_xor_b32 v154, 0x80008000, v150
v_xor_b32 v155, 0x80008000, v151
v_xor_b32 v164, 0x80008000, v160
v_xor_b32 v165, 0x80008000, v161
v_xor_b32 v166, 0x80008000, v162
v_xor_b32 v167, 0x80008000, v163
v_mul_f32 v16, v208, v232
v_mul_f32 v17, v212, v232
v_fma_mixlo_f16 v80, -v212, v233, v16
v_fma_mixlo_f16 v84, v208, v233, v17
v_mul_f32 v18, v209, v234
v_mul_f32 v19, v213, v234
v_fma_mixhi_f16 v80, -v213, v235, v18
v_fma_mixhi_f16 v84, v209, v235, v19
v_mul_f32 v20, v210, v236
v_mul_f32 v21, v214, v236
v_fma_mixlo_f16 v81, -v214, v237, v20
v_fma_mixlo_f16 v85, v210, v237, v21
v_mul_f32 v22, v211, v238
v_mul_f32 v23, v215, v238
v_fma_mixhi_f16 v81, -v215, v239, v22
v_fma_mixhi_f16 v85, v211, v239, v23
v_mul_f32 v16, v216, v240
v_mul_f32 v17, v220, v240
v_fma_mixlo_f16 v82, -v220, v241, v16
v_fma_mixlo_f16 v86, v216, v241, v17
v_mul_f32 v18, v217, v242
v_mul_f32 v19, v221, v242
v_fma_mixhi_f16 v82, -v221, v243, v18
v_fma_mixhi_f16 v86, v217, v243, v19
v_mul_f32 v20, v218, v244
v_mul_f32 v21, v222, v244
v_fma_mixlo_f16 v83, -v222, v245, v20
v_fma_mixlo_f16 v87, v218, v245, v21
v_mul_f32 v22, v219, v246
v_mul_f32 v23, v223, v246
v_fma_mixhi_f16 v83, -v223, v247, v22
v_fma_mixhi_f16 v87, v219, v247, v23
s_nop 0
v_mfma_f32_16x16x32_f16 v[192:195], v[80:83], v[168:171], 0
v_mfma_f32_16x16x32_f16 v[196:199], v[80:83], v[176:179], 0
v_mfma_f32_16x16x32_f16 v[192:195], v[84:87], v[172:175], v[192:195]
v_mfma_f32_16x16x32_f16 v[196:199], v[84:87], v[168:171], v[196:199]
v_mfma_f32_16x16x32_f16 v[200:203], v[80:83], v[180:183], 0
v_mfma_f32_16x16x32_f16 v[204:207], v[80:83], v[188:191], 0
v_mfma_f32_16x16x32_f16 v[200:203], v[84:87], v[184:187], v[200:203]
v_mfma_f32_16x16x32_f16 v[204:207], v[84:87], v[180:183], v[204:207]
s_lshl_b32 s36, s25, 10
s_lshl_b32 s37, s24, 3
s_add_u32 s36, s36, s37
v_add_u32 v4, s36, v1
s_lshl_b32 s36, s24, 12
v_add_u32 v5, s36, v1
s_barrier
v_mul_f32 v16, v192, v48
v_mul_f32 v17, v196, v48
v_fma_mixlo_f16 v224, -v196, v56, v16
v_fma_mixlo_f16 v228, v192, v56, v17
v_mul_f32 v18, v193, v49
v_mul_f32 v19, v197, v49
v_fma_mixhi_f16 v224, -v197, v57, v18
v_fma_mixhi_f16 v228, v193, v57, v19
v_mul_f32 v20, v194, v50
v_mul_f32 v21, v198, v50
v_fma_mixlo_f16 v225, -v198, v58, v20
v_fma_mixlo_f16 v229, v194, v58, v21
v_mul_f32 v22, v195, v51
v_mul_f32 v23, v199, v51
v_fma_mixhi_f16 v225, -v199, v59, v22
v_fma_mixhi_f16 v229, v195, v59, v23
ds_write_b64 v4, v[224:225] offset:28672
ds_write_b64 v4, v[228:229] offset:30720
v_mul_f32 v16, v200, v52
v_mul_f32 v17, v204, v52
v_fma_mixlo_f16 v226, -v204, v60, v16
v_fma_mixlo_f16 v230, v200, v60, v17
v_mul_f32 v18, v201, v53
v_mul_f32 v19, v205, v53
v_fma_mixhi_f16 v226, -v205, v61, v18
v_fma_mixhi_f16 v230, v201, v61, v19
v_mul_f32 v20, v202, v54
v_mul_f32 v21, v206, v54
v_fma_mixlo_f16 v227, -v206, v62, v20
v_fma_mixlo_f16 v231, v202, v62, v21
v_mul_f32 v22, v203, v55
v_mul_f32 v23, v207, v55
v_fma_mixhi_f16 v227, -v207, v63, v22
v_fma_mixhi_f16 v231, v203, v63, v23
ds_write_b64 v4, v[226:227] offset:32768
ds_write_b64 v4, v[230:231] offset:34816
v_lshlrev_b32 v232, 16, v8
v_and_b32 v233, 0xffff0000, v8
v_lshlrev_b32 v234, 16, v9
v_and_b32 v235, 0xffff0000, v9
v_lshlrev_b32 v236, 16, v10
v_and_b32 v237, 0xffff0000, v10
v_lshlrev_b32 v238, 16, v11
v_and_b32 v239, 0xffff0000, v11
v_lshlrev_b32 v240, 16, v12
v_and_b32 v241, 0xffff0000, v12
v_lshlrev_b32 v242, 16, v13
v_and_b32 v243, 0xffff0000, v13
v_lshlrev_b32 v244, 16, v14
v_and_b32 v245, 0xffff0000, v14
v_lshlrev_b32 v246, 16, v15
v_and_b32 v247, 0xffff0000, v15
s_cmp_eq_u32 s2, 0
s_cselect_b32 s36, 0, 1.0
v_mul_f32 v7, s36, v6
s_waitcnt lgkmcnt(0)
s_barrier
ds_read_b128 v[64:67], v5 offset:28672
ds_read_b128 v[68:71], v5 offset:30720
ds_read_b128 v[72:75], v5 offset:29696
ds_read_b128 v[76:79], v5 offset:31744
s_waitcnt lgkmcnt(2)
v_mfma_f32_16x16x32_f16 v[208:211], v[120:123], v[64:67], 0
v_mfma_f32_16x16x32_f16 v[212:215], v[120:123], v[68:71], 0
v_mfma_f32_16x16x32_f16 v[208:211], v[124:127], v[68:71], v[208:211]
v_mfma_f32_16x16x32_f16 v[212:215], v[128:131], v[64:67], v[212:215]
v_mfma_f32_16x16x32_f16 v[216:219], v[144:147], v[64:67], 0
v_mfma_f32_16x16x32_f16 v[220:223], v[144:147], v[68:71], 0
v_mfma_f32_16x16x32_f16 v[216:219], v[148:151], v[68:71], v[216:219]
v_mfma_f32_16x16x32_f16 v[220:223], v[152:155], v[64:67], v[220:223]
s_waitcnt lgkmcnt(0)
v_mfma_f32_16x16x32_f16 v[208:211], v[132:135], v[72:75], v[208:211]
v_mfma_f32_16x16x32_f16 v[212:215], v[132:135], v[76:79], v[212:215]
v_mfma_f32_16x16x32_f16 v[208:211], v[136:139], v[76:79], v[208:211]
v_mfma_f32_16x16x32_f16 v[212:215], v[140:143], v[72:75], v[212:215]
v_mfma_f32_16x16x32_f16 v[216:219], v[156:159], v[72:75], v[216:219]
v_mfma_f32_16x16x32_f16 v[220:223], v[156:159], v[76:79], v[220:223]
v_mfma_f32_16x16x32_f16 v[216:219], v[160:163], v[76:79], v[216:219]
v_mfma_f32_16x16x32_f16 v[220:223], v[164:167], v[72:75], v[220:223]
s_nop 2
v_fmac_f32 v232, v208, v6
v_fmac_f32 v233, v209, v6
v_fmac_f32 v234, v210, v6
v_fmac_f32 v235, v211, v6
v_fmac_f32 v236, v216, v6
v_fmac_f32 v237, v217, v6
v_fmac_f32 v238, v218, v6
v_fmac_f32 v239, v219, v6
v_cvt_pk_bf16_f32 v224, v232, v233
v_cvt_pk_bf16_f32 v225, v234, v235
v_cvt_pk_bf16_f32 v226, v236, v237
v_cvt_pk_bf16_f32 v227, v238, v239
buffer_store_dwordx4 v[224:227], v1, s[12:15], s30 offen sc1
v_fmac_f32 v240, v212, v7
v_fmac_f32 v241, v213, v7
v_fmac_f32 v242, v214, v7
v_fmac_f32 v243, v215, v7
v_fmac_f32 v244, v220, v7
v_fmac_f32 v245, v221, v7
v_fmac_f32 v246, v222, v7
v_fmac_f32 v247, v223, v7
v_cvt_pk_bf16_f32 v228, v240, v241
v_cvt_pk_bf16_f32 v229, v242, v243
v_cvt_pk_bf16_f32 v230, v244, v245
v_cvt_pk_bf16_f32 v231, v246, v247
buffer_store_dwordx4 v[228:231], v1, s[12:15], s35 offen sc1
s_cmp_ge_u32 s2, 2
s_cbranch_scc1 .Lk1_z4
v_mov_b32 v8, 0
v_mov_b32 v9, 0
v_mov_b32 v10, 0
v_mov_b32 v11, 0
v_lshlrev_b32 v4, 4, v0
s_lshl_b32 s36, s2, 12
s_add_u32 s36, s36, 25698304
buffer_store_dwordx4 v[8:11], v4, s[12:15], s36 offen sc1
.Lk1_z4:
s_endpgm
.Lk1_role2:
s_load_dwordx2 s[4:5], s[0:1], 40
s_load_dwordx2 s[6:7], s[0:1], 64
s_and_b32 s24, s2, 7
s_lshr_b32 s25, s2, 3
s_cmp_lt_u32 s25, 8
s_cselect_b32 s20, s24, s25
s_cselect_b32 s21, s25, s24
v_lshrrev_b32 v1, 6, v0
v_and_b32 v2, 63, v0
v_readfirstlane_b32 s22, v1
v_and_b32 v3, 15, v0
v_bfe_u32 v4, v0, 4, 2
v_lshlrev_b32 v5, 4, v2
s_sub_u32 s37, s21, 5
s_cmp_lt_u32 s21, 5
s_cselect_b32 s37, s21, s37
s_lshl_b32 s27, s37, 7
s_add_u32 s36, s27, 640
s_lshl_b32 s25, s20, 6
s_lshl_b32 s26, s22, 4
s_add_u32 s25, s25, s26
v_lshrrev_b32 v1, 3, v2
v_xor_b32 v11, v1, v2
v_and_b32 v11, 7, v11
v_lshlrev_b32 v11, 4, v11
v_add_u32 v6, s25, v1
v_lshrrev_b32 v8, 4, v6
v_mul_u32_u24 v8, 20, v8
v_and_b32 v9, 3, v6
v_add_u32 v8, v8, v9
v_bfe_u32 v10, v6, 3, 1
v_lshl_add_u32 v8, v10, 2, v8
v_bfe_u32 v10, v6, 2, 1
v_lshl_add_u32 v8, v10, 3, v8
v_subrev_u32 v10, 512, v6
v_lshrrev_b32 v10, 2, v10
v_mul_u32_u24 v10, 20, v10
v_add3_u32 v10, v10, v9, 16
v_cmp_gt_u32 vcc, 512, v6
s_nop 1
v_cndmask_b32 v7, v10, v8, vcc
v_mul_u32_u24 v7, 1280, v7
v_add_u32 v7, v7, v11
s_movk_i32 s24, 4096
s_cmp_lt_u32 s25, 512
s_cselect_b32 s24, s24, 50176
v_add_u32 v12, s24, v7
s_mul_i32 s23, s22, 6144
s_add_u32 s23, s23, 51200
s_waitcnt lgkmcnt(0)
s_add_u32 s12, s4, 0
s_addc_u32 s13, s5, 0
s_mov_b32 s14, 819200
s_mov_b32 s15, 0x00020000
s_add_u32 m0, s23, 0
s_nop 0
buffer_load_dwordx4 v7, s[12:15], s27 offen lds
buffer_load_dwordx4 v12, s[12:15], s27 offen offset:1024 lds
s_add_u32 m0, s23, 2048
s_nop 0
buffer_load_dwordx4 v7, s[12:15], s36 offen lds
buffer_load_dwordx4 v12, s[12:15], s36 offen offset:1024 lds
s_add_u32 s27, s27, 128
s_cmp_eq_u32 s27, 1280
s_cselect_b32 s27, 0, s27
s_add_u32 m0, s23, 4096
s_nop 0
buffer_load_dwordx4 v7, s[12:15], s27 offen lds
buffer_load_dwordx4 v12, s[12:15], s27 offen offset:1024 lds
v_lshlrev_b32 v8, 3, v4
v_cvt_f32_u32 v8, v8
s_mul_i32 s24, s21, 80
s_add_u32 s26, s24, s26
v_add_u32 v9, s26, v3
v_lshrrev_b32 v96, 1, v9
v_and_b32 v97, 1, v9
v_cmp_eq_u32 vcc, 0, v9
v_mov_b32 v98, 320
s_nop 0
v_cndmask_b32 v96, v96, v98, vcc
v_cmp_eq_u32 vcc, 1, v9
s_nop 1
v_cndmask_b32 v97, v97, 0, vcc
v_cvt_f32_u32 v96, v96
v_cvt_f32_u32 v97, v97
v_mul_f32 v96, 0x3acccccd, v96
v_mul_f32 v97, 0x3e800000, v97
v_fmac_f32 v97, v96, v8
v_mov_b32 v98, 0
v_mov_b32 v99, v96
v_mul_f32 v100, 0x40000000, v96
v_mul_f32 v101, 0x40400000, v96
v_mul_f32 v102, 0x40800000, v96
v_mul_f32 v103, 0x40a00000, v96
v_mul_f32 v104, 0x40c00000, v96
v_mul_f32 v105, 0x40e00000, v96
s_add_u32 s24, s24, 64
v_add_u32 v9, s24, v3
v_lshrrev_b32 v106, 1, v9
v_and_b32 v107, 1, v9
v_cvt_f32_u32 v106, v106
v_cvt_f32_u32 v107, v107
v_mul_f32 v106, 0x3acccccd, v106
v_mul_f32 v107, 0x3e800000, v107
v_fmac_f32 v107, v106, v8
v_mov_b32 v108, 0
v_mov_b32 v109, v106
v_mul_f32 v110, 0x40000000, v106
v_mul_f32 v111, 0x40400000, v106
v_mul_f32 v112, 0x40800000, v106
v_mul_f32 v113, 0x40a00000, v106
v_mul_f32 v114, 0x40c00000, v106
v_mul_f32 v115, 0x40e00000, v106
s_lshl_b32 s38, s37, 6
s_add_u32 s39, s38, 32
s_lshl_b32 s26, s22, 10
v_add_u32 v11, s26, v5
v_cvt_f32_u32 v116, s38
v_fma_f32 v116, v96, v116, v97
v_pk_add_f32 v[136:137], v[98:99], v[116:117] op_sel_hi:[1,0]
v_pk_add_f32 v[138:139], v[100:101], v[116:117] op_sel_hi:[1,0]
v_pk_add_f32 v[140:141], v[102:103], v[116:117] op_sel_hi:[1,0]
v_pk_add_f32 v[142:143], v[104:105], v[116:117] op_sel_hi:[1,0]
v_cos_f32 v136, v136
v_cos_f32 v137, v137
v_cos_f32 v138, v138
v_cos_f32 v139, v139
v_cos_f32 v140, v140
v_cos_f32 v141, v141
v_cos_f32 v142, v142
v_cos_f32 v143, v143
v_cvt_f32_u32 v118, s39
v_fma_f32 v118, v96, v118, v97
v_pk_add_f32 v[144:145], v[98:99], v[118:119] op_sel_hi:[1,0]
v_pk_add_f32 v[146:147], v[100:101], v[118:119] op_sel_hi:[1,0]
v_pk_add_f32 v[148:149], v[102:103], v[118:119] op_sel_hi:[1,0]
v_pk_add_f32 v[150:151], v[104:105], v[118:119] op_sel_hi:[1,0]
v_cos_f32 v144, v144
v_cos_f32 v145, v145
v_cos_f32 v146, v146
v_cos_f32 v147, v147
v_cos_f32 v148, v148
v_cos_f32 v149, v149
v_cos_f32 v150, v150
v_cos_f32 v151, v151
v_mul_f32 v152, 0x42000000, v96
v_cos_f32 v152, v152
s_nop 0
v_add_f32 v152, v152, v152
v_cvt_pk_bf16_f32 v128, v136, v137
v_cvt_pk_bf16_f32 v129, v138, v139
v_cvt_pk_bf16_f32 v130, v140, v141
v_cvt_pk_bf16_f32 v131, v142, v143
ds_write_b128 v11, v[128:131] offset:0
v_cvt_pk_bf16_f32 v132, v144, v145
v_cvt_pk_bf16_f32 v133, v146, v147
v_cvt_pk_bf16_f32 v134, v148, v149
v_cvt_pk_bf16_f32 v135, v150, v151
ds_write_b128 v11, v[132:135] offset:5120
v_pk_fma_f32 v[136:137], v[144:145], v[152:153], v[136:137] op_sel_hi:[1,0,1] neg_lo:[0,0,1] neg_hi:[0,0,1]
v_pk_fma_f32 v[138:139], v[146:147], v[152:153], v[138:139] op_sel_hi:[1,0,1] neg_lo:[0,0,1] neg_hi:[0,0,1]
v_pk_fma_f32 v[140:141], v[148:149], v[152:153], v[140:141] op_sel_hi:[1,0,1] neg_lo:[0,0,1] neg_hi:[0,0,1]
v_pk_fma_f32 v[142:143], v[150:151], v[152:153], v[142:143] op_sel_hi:[1,0,1] neg_lo:[0,0,1] neg_hi:[0,0,1]
v_cvt_pk_bf16_f32 v128, v136, v137
v_cvt_pk_bf16_f32 v129, v138, v139
v_cvt_pk_bf16_f32 v130, v140, v141
v_cvt_pk_bf16_f32 v131, v142, v143
ds_write_b128 v11, v[128:131] offset:10240
v_pk_fma_f32 v[144:145], v[136:137], v[152:153], v[144:145] op_sel_hi:[1,0,1] neg_lo:[0,0,1] neg_hi:[0,0,1]
v_pk_fma_f32 v[146:147], v[138:139], v[152:153], v[146:147] op_sel_hi:[1,0,1] neg_lo:[0,0,1] neg_hi:[0,0,1]
v_pk_fma_f32 v[148:149], v[140:141], v[152:153], v[148:149] op_sel_hi:[1,0,1] neg_lo:[0,0,1] neg_hi:[0,0,1]
v_pk_fma_f32 v[150:151], v[142:143], v[152:153], v[150:151] op_sel_hi:[1,0,1] neg_lo:[0,0,1] neg_hi:[0,0,1]
v_cvt_pk_bf16_f32 v132, v144, v145
v_cvt_pk_bf16_f32 v133, v146, v147
v_cvt_pk_bf16_f32 v134, v148, v149
v_cvt_pk_bf16_f32 v135, v150, v151
ds_write_b128 v11, v[132:135] offset:15360
v_pk_fma_f32 v[136:137], v[144:145], v[152:153], v[136:137] op_sel_hi:[1,0,1] neg_lo:[0,0,1] neg_hi:[0,0,1]
v_pk_fma_f32 v[138:139], v[146:147], v[152:153], v[138:139] op_sel_hi:[1,0,1] neg_lo:[0,0,1] neg_hi:[0,0,1]
v_pk_fma_f32 v[140:141], v[148:149], v[152:153], v[140:141] op_sel_hi:[1,0,1] neg_lo:[0,0,1] neg_hi:[0,0,1]
v_pk_fma_f32 v[142:143], v[150:151], v[152:153], v[142:143] op_sel_hi:[1,0,1] neg_lo:[0,0,1] neg_hi:[0,0,1]
v_cvt_pk_bf16_f32 v128, v136, v137
v_cvt_pk_bf16_f32 v129, v138, v139
v_cvt_pk_bf16_f32 v130, v140, v141
v_cvt_pk_bf16_f32 v131, v142, v143
ds_write_b128 v11, v[128:131] offset:20480
v_pk_fma_f32 v[144:145], v[136:137], v[152:153], v[144:145] op_sel_hi:[1,0,1] neg_lo:[0,0,1] neg_hi:[0,0,1]
v_pk_fma_f32 v[146:147], v[138:139], v[152:153], v[146:147] op_sel_hi:[1,0,1] neg_lo:[0,0,1] neg_hi:[0,0,1]
v_pk_fma_f32 v[148:149], v[140:141], v[152:153], v[148:149] op_sel_hi:[1,0,1] neg_lo:[0,0,1] neg_hi:[0,0,1]
v_pk_fma_f32 v[150:151], v[142:143], v[152:153], v[150:151] op_sel_hi:[1,0,1] neg_lo:[0,0,1] neg_hi:[0,0,1]
v_cvt_pk_bf16_f32 v132, v144, v145
v_cvt_pk_bf16_f32 v133, v146, v147
v_cvt_pk_bf16_f32 v134, v148, v149
v_cvt_pk_bf16_f32 v135, v150, v151
ds_write_b128 v11, v[132:135] offset:25600
v_pk_fma_f32 v[136:137], v[144:145], v[152:153], v[136:137] op_sel_hi:[1,0,1] neg_lo:[0,0,1] neg_hi:[0,0,1]
v_pk_fma_f32 v[138:139], v[146:147], v[152:153], v[138:139] op_sel_hi:[1,0,1] neg_lo:[0,0,1] neg_hi:[0,0,1]
v_pk_fma_f32 v[140:141], v[148:149], v[152:153], v[140:141] op_sel_hi:[1,0,1] neg_lo:[0,0,1] neg_hi:[0,0,1]
v_pk_fma_f32 v[142:143], v[150:151], v[152:153], v[142:143] op_sel_hi:[1,0,1] neg_lo:[0,0,1] neg_hi:[0,0,1]
v_cvt_pk_bf16_f32 v128, v136, v137
v_cvt_pk_bf16_f32 v129, v138, v139
v_cvt_pk_bf16_f32 v130, v140, v141
v_cvt_pk_bf16_f32 v131, v142, v143
ds_write_b128 v11, v[128:131] offset:30720
v_pk_fma_f32 v[144:145], v[136:137], v[152:153], v[144:145] op_sel_hi:[1,0,1] neg_lo:[0,0,1] neg_hi:[0,0,1]
v_pk_fma_f32 v[146:147], v[138:139], v[152:153], v[146:147] op_sel_hi:[1,0,1] neg_lo:[0,0,1] neg_hi:[0,0,1]
v_pk_fma_f32 v[148:149], v[140:141], v[152:153], v[148:149] op_sel_hi:[1,0,1] neg_lo:[0,0,1] neg_hi:[0,0,1]
v_pk_fma_f32 v[150:151], v[142:143], v[152:153], v[150:151] op_sel_hi:[1,0,1] neg_lo:[0,0,1] neg_hi:[0,0,1]
v_cvt_pk_bf16_f32 v132, v144, v145
v_cvt_pk_bf16_f32 v133, v146, v147
v_cvt_pk_bf16_f32 v134, v148, v149
v_cvt_pk_bf16_f32 v135, v150, v151
ds_write_b128 v11, v[132:135] offset:35840
v_pk_fma_f32 v[136:137], v[144:145], v[152:153], v[136:137] op_sel_hi:[1,0,1] neg_lo:[0,0,1] neg_hi:[0,0,1]
v_pk_fma_f32 v[138:139], v[146:147], v[152:153], v[138:139] op_sel_hi:[1,0,1] neg_lo:[0,0,1] neg_hi:[0,0,1]
v_pk_fma_f32 v[140:141], v[148:149], v[152:153], v[140:141] op_sel_hi:[1,0,1] neg_lo:[0,0,1] neg_hi:[0,0,1]
v_pk_fma_f32 v[142:143], v[150:151], v[152:153], v[142:143] op_sel_hi:[1,0,1] neg_lo:[0,0,1] neg_hi:[0,0,1]
v_cvt_pk_bf16_f32 v128, v136, v137
v_cvt_pk_bf16_f32 v129, v138, v139
v_cvt_pk_bf16_f32 v130, v140, v141
v_cvt_pk_bf16_f32 v131, v142, v143
ds_write_b128 v11, v[128:131] offset:40960
v_pk_fma_f32 v[144:145], v[136:137], v[152:153], v[144:145] op_sel_hi:[1,0,1] neg_lo:[0,0,1] neg_hi:[0,0,1]
v_pk_fma_f32 v[146:147], v[138:139], v[152:153], v[146:147] op_sel_hi:[1,0,1] neg_lo:[0,0,1] neg_hi:[0,0,1]
v_pk_fma_f32 v[148:149], v[140:141], v[152:153], v[148:149] op_sel_hi:[1,0,1] neg_lo:[0,0,1] neg_hi:[0,0,1]
v_pk_fma_f32 v[150:151], v[142:143], v[152:153], v[150:151] op_sel_hi:[1,0,1] neg_lo:[0,0,1] neg_hi:[0,0,1]
v_cvt_pk_bf16_f32 v132, v144, v145
v_cvt_pk_bf16_f32 v133, v146, v147
v_cvt_pk_bf16_f32 v134, v148, v149
v_cvt_pk_bf16_f32 v135, v150, v151
ds_write_b128 v11, v[132:135] offset:46080
s_mov_b32 s39, s22
.Lk1_g5:
s_min_u32 s40, s39, 9
s_mul_i32 s41, s40, 5120
v_add_u32 v11, s41, v5
s_lshl_b32 s40, s40, 5
s_add_u32 s40, s40, s38
v_cvt_f32_u32 v124, s40
v_fma_f32 v124, v106, v124, v107
v_fract_f32 v124, v124
v_pk_add_f32 v[116:117], v[108:109], v[124:125] op_sel_hi:[1,0]
v_pk_add_f32 v[118:119], v[110:111], v[124:125] op_sel_hi:[1,0]
v_pk_add_f32 v[120:121], v[112:113], v[124:125] op_sel_hi:[1,0]
v_pk_add_f32 v[122:123], v[114:115], v[124:125] op_sel_hi:[1,0]
v_cos_f32 v116, v116
v_cos_f32 v117, v117
v_cos_f32 v118, v118
v_cos_f32 v119, v119
v_cos_f32 v120, v120
v_cvt_pk_bf16_f32 v128, v116, v117
v_cos_f32 v121, v121
v_cos_f32 v122, v122
v_cvt_pk_bf16_f32 v129, v118, v119
v_cos_f32 v123, v123
v_cvt_pk_bf16_f32 v130, v120, v121
v_cvt_pk_bf16_f32 v131, v122, v123
ds_write_b128 v11, v[128:131] offset:4096
s_add_u32 s39, s39, 4
s_cmp_lt_u32 s39, 12
s_cbranch_scc1 .Lk1_g5
v_xor_b32 v8, v4, v3
v_and_b32 v8, 7, v8
v_lshl_add_u32 v8, v3, 3, v8
v_lshl_add_u32 v8, v8, 4, s23
v_xor_b32 v9, 64, v8
v_add_u32 v6, s25, v3
v_mov_b32 v200, 0x3d64f92e
v_lshlrev_b32 v204, 30, v3
v_and_b32 v204, 0x80000000, v204
v_xor_b32 v204, v200, v204
s_cmp_eq_u32 s21, 0
s_cselect_b32 s30, 0, 99
s_cselect_b32 s31, 1, 99
v_mov_b32 v1, 0x3d21e89b
v_cmp_eq_u32 vcc, s30, v3
s_nop 1
v_cndmask_b32 v202, v200, v1, vcc
v_cndmask_b32 v14, v204, v1, vcc
v_mov_b32 v1, 0x3acccccd
v_cmp_eq_u32 vcc, s31, v3
s_nop 1
v_cndmask_b32 v202, v202, v1, vcc
v_cndmask_b32 v14, v14, v1, vcc
s_lshr_b32 s28, s25, 5
s_mul_i32 s28, s28, 5120
s_mul_i32 s29, s21, 102400
s_add_u32 s28, s28, s29
s_and_b32 s29, s22, 1
s_lshl_b32 s29, s29, 9
s_add_u32 s28, s28, s29
s_add_u32 s28, s28, 20971520
v_lshrrev_b32 v10, 1, v4
v_lshlrev_b32 v10, 8, v10
v_lshl_add_u32 v10, v3, 4, v10
v_and_b32 v1, 1, v4
v_lshl_add_u32 v10, v1, 3, v10
s_add_u32 s16, s6, 0
s_addc_u32 s17, s7, 0
s_mov_b32 s18, 44564480
s_mov_b32 s19, 0x00020000
s_waitcnt lgkmcnt(0)
s_barrier
ds_read_b128 v[96:99], v5 offset:0
ds_read_b128 v[100:103], v5 offset:1024
ds_read_b128 v[104:107], v5 offset:2048
ds_read_b128 v[108:111], v5 offset:3072
ds_read_b128 v[112:115], v5 offset:4096
s_waitcnt vmcnt(4)
ds_read_b128 v[16:19], v8 offset:0
ds_read_b128 v[24:27], v9 offset:0
s_waitcnt vmcnt(2)
ds_read_b128 v[20:23], v8 offset:2048
ds_read_b128 v[28:31], v9 offset:2048
s_waitcnt lgkmcnt(2)
s_add_u32 s36, s36, 128
s_cmp_eq_u32 s36, 1280
s_cselect_b32 s36, 0, s36
s_add_u32 m0, s23, 0
s_nop 0
buffer_load_dwordx4 v7, s[12:15], s36 offen lds
buffer_load_dwordx4 v12, s[12:15], s36 offen offset:1024 lds
s_waitcnt lgkmcnt(0)
s_add_u32 s27, s27, 128
s_cmp_eq_u32 s27, 1280
s_cselect_b32 s27, 0, s27
s_add_u32 m0, s23, 2048
s_nop 0
buffer_load_dwordx4 v7, s[12:15], s27 offen lds
buffer_load_dwordx4 v12, s[12:15], s27 offen offset:1024 lds
ds_read_b128 v[116:119], v5 offset:5120
ds_read_b128 v[120:123], v5 offset:6144
ds_read_b128 v[124:127], v5 offset:7168
ds_read_b128 v[128:131], v5 offset:8192
ds_read_b128 v[132:135], v5 offset:9216
s_waitcnt lgkmcnt(5)
v_mfma_f32_16x16x32_bf16 v[156:159], v[16:19], v[96:99], 0
ds_read_b128 v[136:139], v5 offset:10240
v_mfma_f32_16x16x32_bf16 v[176:179], v[20:23], v[96:99], 0
s_waitcnt lgkmcnt(6)
v_mfma_f32_16x16x32_bf16 v[160:163], v[16:19], v[100:103], 0
ds_read_b128 v[140:143], v5 offset:11264
v_mfma_f32_16x16x32_bf16 v[180:183], v[20:23], v[100:103], 0
s_waitcnt vmcnt(4)
ds_read_b128 v[32:35], v8 offset:4096
ds_read_b128 v[40:43], v9 offset:4096
s_waitcnt lgkmcnt(9)
v_mfma_f32_16x16x32_bf16 v[164:167], v[16:19], v[104:107], 0
ds_read_b128 v[144:147], v5 offset:12288
v_mfma_f32_16x16x32_bf16 v[184:187], v[20:23], v[104:107], 0
s_waitcnt lgkmcnt(10)
v_mfma_f32_16x16x32_bf16 v[168:171], v[16:19], v[108:111], 0
ds_read_b128 v[148:151], v5 offset:13312
v_mfma_f32_16x16x32_bf16 v[188:191], v[20:23], v[108:111], 0
s_waitcnt lgkmcnt(2)
s_add_u32 s36, s36, 128
s_cmp_eq_u32 s36, 1280
s_cselect_b32 s36, 0, s36
s_add_u32 m0, s23, 4096
s_nop 0
buffer_load_dwordx4 v7, s[12:15], s36 offen lds
buffer_load_dwordx4 v12, s[12:15], s36 offen offset:1024 lds
s_waitcnt lgkmcnt(11)
v_mfma_f32_16x16x32_bf16 v[172:175], v[16:19], v[112:115], 0
ds_read_b128 v[152:155], v5 offset:14336
v_mfma_f32_16x16x32_bf16 v[192:195], v[20:23], v[112:115], 0
s_waitcnt lgkmcnt(11)
v_mfma_f32_16x16x32_bf16 v[156:159], v[24:27], v[116:119], v[156:159]
ds_read_b128 v[96:99], v5 offset:15360
v_mfma_f32_16x16x32_bf16 v[176:179], v[28:31], v[116:119], v[176:179]
s_waitcnt lgkmcnt(11)
v_mfma_f32_16x16x32_bf16 v[160:163], v[24:27], v[120:123], v[160:163]
ds_read_b128 v[100:103], v5 offset:16384
v_mfma_f32_16x16x32_bf16 v[180:183], v[28:31], v[120:123], v[180:183]
s_waitcnt vmcnt(4)
ds_read_b128 v[36:39], v8 offset:0
ds_read_b128 v[44:47], v9 offset:0
s_waitcnt lgkmcnt(13)
v_mfma_f32_16x16x32_bf16 v[164:167], v[24:27], v[124:127], v[164:167]
ds_read_b128 v[104:107], v5 offset:17408
v_mfma_f32_16x16x32_bf16 v[184:187], v[28:31], v[124:127], v[184:187]
s_waitcnt lgkmcnt(13)
v_mfma_f32_16x16x32_bf16 v[168:171], v[24:27], v[128:131], v[168:171]
ds_read_b128 v[108:111], v5 offset:18432
v_mfma_f32_16x16x32_bf16 v[188:191], v[28:31], v[128:131], v[188:191]
s_waitcnt lgkmcnt(2)
s_add_u32 s27, s27, 128
s_cmp_eq_u32 s27, 1280
s_cselect_b32 s27, 0, s27
s_add_u32 m0, s23, 0
s_nop 0
buffer_load_dwordx4 v7, s[12:15], s27 offen lds
buffer_load_dwordx4 v12, s[12:15], s27 offen offset:1024 lds
s_waitcnt lgkmcnt(13)
v_mfma_f32_16x16x32_bf16 v[172:175], v[24:27], v[132:135], v[172:175]
ds_read_b128 v[112:115], v5 offset:19456
v_mfma_f32_16x16x32_bf16 v[192:195], v[28:31], v[132:135], v[192:195]
s_waitcnt lgkmcnt(3)
v_mfma_f32_16x16x32_bf16 v[156:159], v[32:35], v[136:139], v[156:159]
ds_read_b128 v[116:119], v5 offset:20480
v_mfma_f32_16x16x32_bf16 v[176:179], v[36:39], v[136:139], v[176:179]
s_waitcnt lgkmcnt(4)
v_mfma_f32_16x16x32_bf16 v[160:163], v[32:35], v[140:143], v[160:163]
ds_read_b128 v[120:123], v5 offset:21504
v_mfma_f32_16x16x32_bf16 v[180:183], v[36:39], v[140:143], v[180:183]
s_waitcnt vmcnt(4)
ds_read_b128 v[48:51], v8 offset:2048
ds_read_b128 v[56:59], v9 offset:2048
s_waitcnt lgkmcnt(7)
v_mfma_f32_16x16x32_bf16 v[164:167], v[32:35], v[144:147], v[164:167]
ds_read_b128 v[124:127], v5 offset:22528
v_mfma_f32_16x16x32_bf16 v[184:187], v[36:39], v[144:147], v[184:187]
s_waitcnt lgkmcnt(8)
v_mfma_f32_16x16x32_bf16 v[168:171], v[32:35], v[148:151], v[168:171]
ds_read_b128 v[128:131], v5 offset:23552
v_mfma_f32_16x16x32_bf16 v[188:191], v[36:39], v[148:151], v[188:191]
s_waitcnt lgkmcnt(2)
s_add_u32 s36, s36, 128
s_cmp_eq_u32 s36, 1280
s_cselect_b32 s36, 0, s36
s_add_u32 m0, s23, 2048
s_nop 0
buffer_load_dwordx4 v7, s[12:15], s36 offen lds
buffer_load_dwordx4 v12, s[12:15], s36 offen offset:1024 lds
s_waitcnt lgkmcnt(9)
v_mfma_f32_16x16x32_bf16 v[172:175], v[32:35], v[152:155], v[172:175]
ds_read_b128 v[132:135], v5 offset:24576
v_mfma_f32_16x16x32_bf16 v[192:195], v[36:39], v[152:155], v[192:195]
s_waitcnt lgkmcnt(10)
v_mfma_f32_16x16x32_bf16 v[156:159], v[40:43], v[96:99], v[156:159]
ds_read_b128 v[136:139], v5 offset:25600
v_mfma_f32_16x16x32_bf16 v[176:179], v[44:47], v[96:99], v[176:179]
s_waitcnt lgkmcnt(11)
v_mfma_f32_16x16x32_bf16 v[160:163], v[40:43], v[100:103], v[160:163]
ds_read_b128 v[140:143], v5 offset:26624
v_mfma_f32_16x16x32_bf16 v[180:183], v[44:47], v[100:103], v[180:183]
s_waitcnt vmcnt(4)
ds_read_b128 v[52:55], v8 offset:4096
ds_read_b128 v[60:63], v9 offset:4096
s_waitcnt lgkmcnt(13)
v_mfma_f32_16x16x32_bf16 v[164:167], v[40:43], v[104:107], v[164:167]
ds_read_b128 v[144:147], v5 offset:27648
v_mfma_f32_16x16x32_bf16 v[184:187], v[44:47], v[104:107], v[184:187]
s_waitcnt lgkmcnt(13)
v_mfma_f32_16x16x32_bf16 v[168:171], v[40:43], v[108:111], v[168:171]
ds_read_b128 v[148:151], v5 offset:28672
v_mfma_f32_16x16x32_bf16 v[188:191], v[44:47], v[108:111], v[188:191]
s_waitcnt lgkmcnt(2)
s_add_u32 s27, s27, 128
s_cmp_eq_u32 s27, 1280
s_cselect_b32 s27, 0, s27
s_add_u32 m0, s23, 4096
s_nop 0
buffer_load_dwordx4 v7, s[12:15], s27 offen lds
buffer_load_dwordx4 v12, s[12:15], s27 offen offset:1024 lds
s_waitcnt lgkmcnt(13)
v_mfma_f32_16x16x32_bf16 v[172:175], v[40:43], v[112:115], v[172:175]
ds_read_b128 v[152:155], v5 offset:29696
v_mfma_f32_16x16x32_bf16 v[192:195], v[44:47], v[112:115], v[192:195]
s_waitcnt lgkmcnt(3)
v_mfma_f32_16x16x32_bf16 v[156:159], v[48:51], v[116:119], v[156:159]
ds_read_b128 v[96:99], v5 offset:30720
v_mfma_f32_16x16x32_bf16 v[176:179], v[52:55], v[116:119], v[176:179]
s_waitcnt lgkmcnt(4)
v_mfma_f32_16x16x32_bf16 v[160:163], v[48:51], v[120:123], v[160:163]
ds_read_b128 v[100:103], v5 offset:31744
v_mfma_f32_16x16x32_bf16 v[180:183], v[52:55], v[120:123], v[180:183]
s_waitcnt vmcnt(4)
ds_read_b128 v[64:67], v8 offset:0
ds_read_b128 v[72:75], v9 offset:0
s_waitcnt lgkmcnt(7)
v_mfma_f32_16x16x32_bf16 v[164:167], v[48:51], v[124:127], v[164:167]
ds_read_b128 v[104:107], v5 offset:32768
v_mfma_f32_16x16x32_bf16 v[184:187], v[52:55], v[124:127], v[184:187]
s_waitcnt lgkmcnt(8)
v_mfma_f32_16x16x32_bf16 v[168:171], v[48:51], v[128:131], v[168:171]
ds_read_b128 v[108:111], v5 offset:33792
v_mfma_f32_16x16x32_bf16 v[188:191], v[52:55], v[128:131], v[188:191]
s_waitcnt lgkmcnt(2)
s_add_u32 s36, s36, 128
s_cmp_eq_u32 s36, 1280
s_cselect_b32 s36, 0, s36
s_add_u32 m0, s23, 0
s_nop 0
buffer_load_dwordx4 v7, s[12:15], s36 offen lds
buffer_load_dwordx4 v12, s[12:15], s36 offen offset:1024 lds
s_waitcnt lgkmcnt(9)
v_mfma_f32_16x16x32_bf16 v[172:175], v[48:51], v[132:135], v[172:175]
ds_read_b128 v[112:115], v5 offset:34816
v_mfma_f32_16x16x32_bf16 v[192:195], v[52:55], v[132:135], v[192:195]
s_waitcnt lgkmcnt(10)
v_mfma_f32_16x16x32_bf16 v[156:159], v[56:59], v[136:139], v[156:159]
ds_read_b128 v[116:119], v5 offset:35840
v_mfma_f32_16x16x32_bf16 v[176:179], v[60:63], v[136:139], v[176:179]
s_waitcnt lgkmcnt(11)
v_mfma_f32_16x16x32_bf16 v[160:163], v[56:59], v[140:143], v[160:163]
ds_read_b128 v[120:123], v5 offset:36864
v_mfma_f32_16x16x32_bf16 v[180:183], v[60:63], v[140:143], v[180:183]
s_waitcnt vmcnt(4)
ds_read_b128 v[68:71], v8 offset:2048
ds_read_b128 v[76:79], v9 offset:2048
s_waitcnt lgkmcnt(13)
v_mfma_f32_16x16x32_bf16 v[164:167], v[56:59], v[144:147], v[164:167]
ds_read_b128 v[124:127], v5 offset:37888
v_mfma_f32_16x16x32_bf16 v[184:187], v[60:63], v[144:147], v[184:187]
s_waitcnt lgkmcnt(13)
v_mfma_f32_16x16x32_bf16 v[168:171], v[56:59], v[148:151], v[168:171]
ds_read_b128 v[128:131], v5 offset:38912
v_mfma_f32_16x16x32_bf16 v[188:191], v[60:63], v[148:151], v[188:191]
s_waitcnt lgkmcnt(13)
v_mfma_f32_16x16x32_bf16 v[172:175], v[56:59], v[152:155], v[172:175]
ds_read_b128 v[132:135], v5 offset:39936
v_mfma_f32_16x16x32_bf16 v[192:195], v[60:63], v[152:155], v[192:195]
s_waitcnt lgkmcnt(3)
v_mfma_f32_16x16x32_bf16 v[156:159], v[64:67], v[96:99], v[156:159]
ds_read_b128 v[136:139], v5 offset:40960
v_mfma_f32_16x16x32_bf16 v[176:179], v[68:71], v[96:99], v[176:179]
s_waitcnt lgkmcnt(4)
v_mfma_f32_16x16x32_bf16 v[160:163], v[64:67], v[100:103], v[160:163]
ds_read_b128 v[140:143], v5 offset:41984
v_mfma_f32_16x16x32_bf16 v[180:183], v[68:71], v[100:103], v[180:183]
s_waitcnt vmcnt(2)
ds_read_b128 v[80:83], v8 offset:4096
ds_read_b128 v[88:91], v9 offset:4096
s_waitcnt lgkmcnt(7)
v_mfma_f32_16x16x32_bf16 v[164:167], v[64:67], v[104:107], v[164:167]
ds_read_b128 v[144:147], v5 offset:43008
v_mfma_f32_16x16x32_bf16 v[184:187], v[68:71], v[104:107], v[184:187]
s_waitcnt lgkmcnt(8)
v_mfma_f32_16x16x32_bf16 v[168:171], v[64:67], v[108:111], v[168:171]
ds_read_b128 v[148:151], v5 offset:44032
v_mfma_f32_16x16x32_bf16 v[188:191], v[68:71], v[108:111], v[188:191]
s_waitcnt lgkmcnt(9)
v_mfma_f32_16x16x32_bf16 v[172:175], v[64:67], v[112:115], v[172:175]
ds_read_b128 v[152:155], v5 offset:45056
v_mfma_f32_16x16x32_bf16 v[192:195], v[68:71], v[112:115], v[192:195]
s_waitcnt lgkmcnt(10)
v_mfma_f32_16x16x32_bf16 v[156:159], v[72:75], v[116:119], v[156:159]
ds_read_b128 v[96:99], v5 offset:46080
v_mfma_f32_16x16x32_bf16 v[176:179], v[76:79], v[116:119], v[176:179]
s_waitcnt lgkmcnt(11)
v_mfma_f32_16x16x32_bf16 v[160:163], v[72:75], v[120:123], v[160:163]
ds_read_b128 v[100:103], v5 offset:47104
v_mfma_f32_16x16x32_bf16 v[180:183], v[76:79], v[120:123], v[180:183]
s_waitcnt vmcnt(0)
ds_read_b128 v[84:87], v8 offset:0
ds_read_b128 v[92:95], v9 offset:0
s_waitcnt lgkmcnt(13)
v_mfma_f32_16x16x32_bf16 v[164:167], v[72:75], v[124:127], v[164:167]
ds_read_b128 v[104:107], v5 offset:48128
v_mfma_f32_16x16x32_bf16 v[184:187], v[76:79], v[124:127], v[184:187]
s_waitcnt lgkmcnt(13)
v_mfma_f32_16x16x32_bf16 v[168:171], v[72:75], v[128:131], v[168:171]
ds_read_b128 v[108:111], v5 offset:49152
v_mfma_f32_16x16x32_bf16 v[188:191], v[76:79], v[128:131], v[188:191]
s_waitcnt lgkmcnt(13)
v_mfma_f32_16x16x32_bf16 v[172:175], v[72:75], v[132:135], v[172:175]
ds_read_b128 v[112:115], v5 offset:50176
v_mfma_f32_16x16x32_bf16 v[192:195], v[76:79], v[132:135], v[192:195]
s_waitcnt lgkmcnt(3)
v_mfma_f32_16x16x32_bf16 v[156:159], v[80:83], v[136:139], v[156:159]
v_mfma_f32_16x16x32_bf16 v[176:179], v[84:87], v[136:139], v[176:179]
s_waitcnt lgkmcnt(3)
v_mfma_f32_16x16x32_bf16 v[160:163], v[80:83], v[140:143], v[160:163]
v_mfma_f32_16x16x32_bf16 v[180:183], v[84:87], v[140:143], v[180:183]
s_waitcnt lgkmcnt(3)
v_mfma_f32_16x16x32_bf16 v[164:167], v[80:83], v[144:147], v[164:167]
v_mfma_f32_16x16x32_bf16 v[184:187], v[84:87], v[144:147], v[184:187]
s_waitcnt lgkmcnt(3)
v_mfma_f32_16x16x32_bf16 v[168:171], v[80:83], v[148:151], v[168:171]
v_mfma_f32_16x16x32_bf16 v[188:191], v[84:87], v[148:151], v[188:191]
s_waitcnt lgkmcnt(3)
v_mfma_f32_16x16x32_bf16 v[172:175], v[80:83], v[152:155], v[172:175]
v_mfma_f32_16x16x32_bf16 v[192:195], v[84:87], v[152:155], v[192:195]
s_waitcnt lgkmcnt(3)
v_mfma_f32_16x16x32_bf16 v[156:159], v[88:91], v[96:99], v[156:159]
v_mfma_f32_16x16x32_bf16 v[176:179], v[92:95], v[96:99], v[176:179]
s_waitcnt lgkmcnt(3)
v_mfma_f32_16x16x32_bf16 v[160:163], v[88:91], v[100:103], v[160:163]
v_mfma_f32_16x16x32_bf16 v[180:183], v[92:95], v[100:103], v[180:183]
s_waitcnt lgkmcnt(2)
v_mfma_f32_16x16x32_bf16 v[164:167], v[88:91], v[104:107], v[164:167]
v_mfma_f32_16x16x32_bf16 v[184:187], v[92:95], v[104:107], v[184:187]
s_waitcnt lgkmcnt(1)
v_mfma_f32_16x16x32_bf16 v[168:171], v[88:91], v[108:111], v[168:171]
v_mfma_f32_16x16x32_bf16 v[188:191], v[92:95], v[108:111], v[188:191]
s_waitcnt lgkmcnt(0)
v_mfma_f32_16x16x32_bf16 v[172:175], v[88:91], v[112:115], v[172:175]
v_mfma_f32_16x16x32_bf16 v[192:195], v[92:95], v[112:115], v[192:195]
v_pk_mul_f32 v[156:157], v[156:157], v[202:203] op_sel_hi:[1,0]
v_pk_mul_f32 v[158:159], v[158:159], v[202:203] op_sel_hi:[1,0]
v_pk_mul_f32 v[160:161], v[160:161], v[200:201] op_sel_hi:[1,0]
v_pk_mul_f32 v[162:163], v[162:163], v[200:201] op_sel_hi:[1,0]
v_pk_mul_f32 v[164:165], v[164:165], v[200:201] op_sel_hi:[1,0]
v_pk_mul_f32 v[166:167], v[166:167], v[200:201] op_sel_hi:[1,0]
v_pk_mul_f32 v[168:169], v[168:169], v[200:201] op_sel_hi:[1,0]
v_pk_mul_f32 v[170:171], v[170:171], v[200:201] op_sel_hi:[1,0]
v_pk_mul_f32 v[172:173], v[172:173], v[200:201] op_sel_hi:[1,0]
v_pk_mul_f32 v[174:175], v[174:175], v[200:201] op_sel_hi:[1,0]
v_pk_fma_f32 v[156:157], v[176:177], v[14:15], v[156:157] op_sel_hi:[1,0,1]
v_pk_fma_f32 v[158:159], v[178:179], v[14:15], v[158:159] op_sel_hi:[1,0,1]
v_pk_fma_f32 v[160:161], v[180:181], v[204:205], v[160:161] op_sel_hi:[1,0,1]
v_pk_fma_f32 v[162:163], v[182:183], v[204:205], v[162:163] op_sel_hi:[1,0,1]
v_pk_fma_f32 v[164:165], v[184:185], v[204:205], v[164:165] op_sel_hi:[1,0,1]
v_pk_fma_f32 v[166:167], v[186:187], v[204:205], v[166:167] op_sel_hi:[1,0,1]
v_pk_fma_f32 v[168:169], v[188:189], v[204:205], v[168:169] op_sel_hi:[1,0,1]
v_pk_fma_f32 v[170:171], v[190:191], v[204:205], v[170:171] op_sel_hi:[1,0,1]
v_pk_fma_f32 v[172:173], v[192:193], v[204:205], v[172:173] op_sel_hi:[1,0,1]
v_pk_fma_f32 v[174:175], v[194:195], v[204:205], v[174:175] op_sel_hi:[1,0,1]
v_cvt_pk_bf16_f32 v16, v156, v157
v_cvt_pk_bf16_f32 v17, v158, v159
buffer_store_dwordx2 v[16:17], v10, s[16:19], s28 offen offset:0 sc1
v_cvt_pk_bf16_f32 v18, v160, v161
v_cvt_pk_bf16_f32 v19, v162, v163
buffer_store_dwordx2 v[18:19], v10, s[16:19], s28 offen offset:1024 sc1
v_cvt_pk_bf16_f32 v20, v164, v165
v_cvt_pk_bf16_f32 v21, v166, v167
buffer_store_dwordx2 v[20:21], v10, s[16:19], s28 offen offset:2048 sc1
v_cvt_pk_bf16_f32 v22, v168, v169
v_cvt_pk_bf16_f32 v23, v170, v171
buffer_store_dwordx2 v[22:23], v10, s[16:19], s28 offen offset:3072 sc1
v_cvt_pk_bf16_f32 v24, v172, v173
v_cvt_pk_bf16_f32 v25, v174, v175
s_add_u32 s28, s28, 4096
buffer_store_dwordx2 v[24:25], v10, s[16:19], s28 offen offset:0 sc1
.Lk1_end6:
s_endpgm
.Lk1_role3:
s_load_dwordx2 s[4:5], s[0:1], 40
s_load_dwordx2 s[6:7], s[0:1], 64
v_lshrrev_b32 v1, 6, v0
v_and_b32 v2, 63, v0
v_readfirstlane_b32 s22, v1
s_lshl_b32 s20, s2, 2
s_add_u32 s20, s20, s22
s_mul_i32 s21, s20, 3277
s_lshr_b32 s21, s21, 16
s_mul_i32 s23, s21, 20
s_sub_u32 s23, s20, s23
s_mul_i32 s24, s23, 40
s_mul_i32 s25, s23, 160
s_sub_u32 s25, s25, 2544
s_cmp_lt_u32 s23, 16
s_cselect_b32 s24, s24, s25
s_cselect_b32 s26, 20, 80
s_cselect_b32 s27, 4, 40
s_cselect_b32 s28, 8, 20
s_mul_i32 s24, s24, 1280
s_mul_i32 s25, s21, 160
s_add_u32 s24, s24, s25
s_mul_i32 s28, s28, 1280
v_and_b32 v3, 15, v2
v_lshrrev_b32 v4, 5, v2
v_bfe_u32 v5, v2, 4, 1
v_mul_lo_u32 v4, v4, s26
v_mul_lo_u32 v5, v5, s27
v_add_u32 v4, v4, v5
v_mul_u32_u24 v4, 1280, v4
v_lshl_add_u32 v6, v3, 1, v4
v_lshrrev_b32 v5, 2, v3
v_lshl_add_u32 v4, v5, 4, v4
v_and_b32 v5, 3, v3
v_lshl_add_u32 v4, v5, 1, v4
v_lshlrev_b32 v7, 4, v2
s_mul_i32 s30, s20, 5120
s_add_u32 s30, s30, 22020096
s_waitcnt lgkmcnt(0)
s_add_u32 s8, s4, 0
s_addc_u32 s9, s5, 0
s_mov_b32 s10, 819200
s_mov_b32 s11, 0x00020000
s_add_u32 s12, s6, 0
s_addc_u32 s13, s7, 0
s_mov_b32 s14, 44564480
s_mov_b32 s15, 0x00020000
s_add_u32 s29, s24, 0
buffer_load_ushort v8, v4, s[8:11], s29 offen offset:0
buffer_load_ushort v16, v4, s[8:11], s29 offen offset:8
buffer_load_ushort v24, v4, s[8:11], s29 offen offset:64
buffer_load_ushort v32, v4, s[8:11], s29 offen offset:72
buffer_load_ushort v40, v6, s[8:11], s29 offen offset:128
s_add_u32 s29, s24, 1280
buffer_load_ushort v9, v4, s[8:11], s29 offen offset:0
buffer_load_ushort v17, v4, s[8:11], s29 offen offset:8
buffer_load_ushort v25, v4, s[8:11], s29 offen offset:64
buffer_load_ushort v33, v4, s[8:11], s29 offen offset:72
buffer_load_ushort v41, v6, s[8:11], s29 offen offset:128
s_add_u32 s29, s24, 2560
buffer_load_ushort v10, v4, s[8:11], s29 offen offset:0
buffer_load_ushort v18, v4, s[8:11], s29 offen offset:8
buffer_load_ushort v26, v4, s[8:11], s29 offen offset:64
buffer_load_ushort v34, v4, s[8:11], s29 offen offset:72
buffer_load_ushort v42, v6, s[8:11], s29 offen offset:128
s_add_u32 s29, s24, 3840
buffer_load_ushort v11, v4, s[8:11], s29 offen offset:0
buffer_load_ushort v19, v4, s[8:11], s29 offen offset:8
buffer_load_ushort v27, v4, s[8:11], s29 offen offset:64
buffer_load_ushort v35, v4, s[8:11], s29 offen offset:72
buffer_load_ushort v43, v6, s[8:11], s29 offen offset:128
s_add_u32 s24, s24, s28
s_add_u32 s29, s24, 0
buffer_load_ushort v12, v4, s[8:11], s29 offen offset:0
buffer_load_ushort v20, v4, s[8:11], s29 offen offset:8
buffer_load_ushort v28, v4, s[8:11], s29 offen offset:64
buffer_load_ushort v36, v4, s[8:11], s29 offen offset:72
buffer_load_ushort v44, v6, s[8:11], s29 offen offset:128
s_add_u32 s29, s24, 1280
buffer_load_ushort v13, v4, s[8:11], s29 offen offset:0
buffer_load_ushort v21, v4, s[8:11], s29 offen offset:8
buffer_load_ushort v29, v4, s[8:11], s29 offen offset:64
buffer_load_ushort v37, v4, s[8:11], s29 offen offset:72
buffer_load_ushort v45, v6, s[8:11], s29 offen offset:128
s_add_u32 s29, s24, 2560
buffer_load_ushort v14, v4, s[8:11], s29 offen offset:0
buffer_load_ushort v22, v4, s[8:11], s29 offen offset:8
buffer_load_ushort v30, v4, s[8:11], s29 offen offset:64
buffer_load_ushort v38, v4, s[8:11], s29 offen offset:72
buffer_load_ushort v46, v6, s[8:11], s29 offen offset:128
s_add_u32 s29, s24, 3840
buffer_load_ushort v15, v4, s[8:11], s29 offen offset:0
buffer_load_ushort v23, v4, s[8:11], s29 offen offset:8
buffer_load_ushort v31, v4, s[8:11], s29 offen offset:64
buffer_load_ushort v39, v4, s[8:11], s29 offen offset:72
buffer_load_ushort v47, v6, s[8:11], s29 offen offset:128
s_waitcnt vmcnt(30)
v_lshl_or_b32 v48, v9, 16, v8
v_lshl_or_b32 v52, v17, 16, v16
v_lshl_or_b32 v56, v25, 16, v24
v_lshl_or_b32 v60, v33, 16, v32
v_lshl_or_b32 v64, v41, 16, v40
s_waitcnt vmcnt(20)
v_lshl_or_b32 v49, v11, 16, v10
v_lshl_or_b32 v53, v19, 16, v18
v_lshl_or_b32 v57, v27, 16, v26
v_lshl_or_b32 v61, v35, 16, v34
v_lshl_or_b32 v65, v43, 16, v42
s_waitcnt vmcnt(10)
v_lshl_or_b32 v50, v13, 16, v12
v_lshl_or_b32 v54, v21, 16, v20
v_lshl_or_b32 v58, v29, 16, v28
v_lshl_or_b32 v62, v37, 16, v36
v_lshl_or_b32 v66, v45, 16, v44
s_waitcnt vmcnt(0)
v_lshl_or_b32 v51, v15, 16, v14
v_lshl_or_b32 v55, v23, 16, v22
v_lshl_or_b32 v59, v31, 16, v30
v_lshl_or_b32 v63, v39, 16, v38
v_lshl_or_b32 v67, v47, 16, v46
buffer_store_dwordx4 v[48:51], v7, s[12:15], s30 offen offset:0 sc1
buffer_store_dwordx4 v[52:55], v7, s[12:15], s30 offen offset:1024 sc1
buffer_store_dwordx4 v[56:59], v7, s[12:15], s30 offen offset:2048 sc1
buffer_store_dwordx4 v[60:63], v7, s[12:15], s30 offen offset:3072 sc1
s_add_u32 s30, s30, 4096
buffer_store_dwordx4 v[64:67], v7, s[12:15], s30 offen offset:0 sc1
s_endpgm
.p2align 8
.globl qkv_kernel
.type qkv_kernel,@function
qkv_kernel:
s_mov_b32 s46, 0
.Lq_common:
s_cmp_lt_u32 s2, 256
s_cbranch_scc1 .Lqkv_role1
s_sub_u32 s2, s2, 256
s_endpgm
.Lqkv_role1:
s_load_dwordx2 s[4:5], s[0:1], 64
v_lshrrev_b32 v1, 6, v0
v_and_b32 v2, 63, v0
v_readfirstlane_b32 s22, v1
s_bfe_u32 s20, s2, 0x20001
s_lshl_b32 s20, s20, 2
s_bfe_u32 s21, s2, 0x20003
s_add_u32 s20, s20, s21
s_and_b32 s21, s2, 1
s_lshl_b32 s21, s21, 3
s_lshr_b32 s23, s2, 5
s_add_u32 s21, s21, s23
s_lshl_b32 s23, s21, 2
s_add_u32 s23, s23, s22
v_lshlrev_b32 v3, 4, v2
v_lshrrev_b32 v4, 4, v2
v_and_b32 v5, 15, v2
v_lshlrev_b32 v6, 2, v4
v_xor_b32 v6, v6, v5
v_lshlrev_b32 v6, 4, v6
v_mul_u32_u24 v7, 4096, v4
v_add_u32 v8, v6, v7
v_add_u32 v9, 15360, v8
v_add_u32 v10, 15360, v9
v_add_u32 v11, 15360, v10
v_lshrrev_b32 v6, 2, v5
v_lshrrev_b32 v7, 5, v2
v_lshl_add_u32 v1, v7, 2, v6
v_lshlrev_b32 v1, 8, v1
v_and_b32 v21, 3, v5
v_lshl_add_u32 v1, v21, 3, v1
v_and_b32 v21, 1, v4
v_lshl_add_u32 v1, v21, 5, v1
s_add_u32 s24, s22, 0
s_and_b32 s24, s24, 3
s_mov_b32 s40, s24
v_xor_b32 v21, s24, v6
v_lshl_add_u32 v12, v21, 6, v1
s_add_u32 s24, s22, 1
s_and_b32 s24, s24, 3
s_mov_b32 s41, s24
v_xor_b32 v21, s24, v6
v_lshl_add_u32 v13, v21, 6, v1
s_add_u32 s24, s22, 2
s_and_b32 s24, s24, 3
s_mov_b32 s42, s24
v_xor_b32 v21, s24, v6
v_lshl_add_u32 v14, v21, 6, v1
s_add_u32 s24, s22, 3
s_and_b32 s24, s24, 3
s_mov_b32 s43, s24
v_xor_b32 v21, s24, v6
v_lshl_add_u32 v15, v21, 6, v1
s_mul_i32 s25, s23, 40960
s_add_u32 s25, s25, 18350080
v_mov_b32 v24, 0
v_mov_b32 v25, 0
v_mov_b32 v26, 0
v_mov_b32 v27, 0
v_mov_b32 v28, 0
v_mov_b32 v29, 0
v_mov_b32 v30, 0
v_mov_b32 v31, 0
s_lshl_b32 s24, s20, 8
s_mul_i32 s26, s22, 65536
s_add_u32 s24, s24, s26
s_add_u32 s24, s24, 2621440
s_lshl_b32 s26, s22, 12
s_waitcnt lgkmcnt(0)
s_add_u32 s16, s4, s46
s_addc_u32 s17, s5, 0
s_mov_b32 s18, 18350080
s_mov_b32 s19, 0x00020000
s_add_u32 s12, s4, 0
s_addc_u32 s13, s5, 0
s_mov_b32 s14, 26214400
s_mov_b32 s15, 0x00020000
s_cmp_lg_u32 s21, 15
s_cbranch_scc1 .Lqkv_notr2
s_cmp_lg_u32 s46, 0
s_cbranch_scc1 .Lqkv_r23
s_endpgm
.Lqkv_r23:
s_lshl_b32 s29, s20, 2
s_add_u32 s29, s29, s40
s_mul_i32 s29, s29, 40960
s_lshl_b32 s30, s22, 10
s_add_u32 s29, s29, s30
s_add_u32 s48, s29, 7864320
v_add_u32 v12, s26, v12
s_lshl_b32 s29, s20, 2
s_add_u32 s29, s29, s41
s_mul_i32 s29, s29, 40960
s_lshl_b32 s30, s22, 10
s_add_u32 s29, s29, s30
s_add_u32 s49, s29, 7864320
v_add_u32 v13, s26, v13
s_lshl_b32 s29, s20, 2
s_add_u32 s29, s29, s42
s_mul_i32 s29, s29, 40960
s_lshl_b32 s30, s22, 10
s_add_u32 s29, s29, s30
s_add_u32 s50, s29, 7864320
v_add_u32 v14, s26, v14
s_lshl_b32 s29, s20, 2
s_add_u32 s29, s29, s43
s_mul_i32 s29, s29, 40960
s_lshl_b32 s30, s22, 10
s_add_u32 s29, s29, s30
s_add_u32 s51, s29, 7864320
v_add_u32 v15, s26, v15
s_add_u32 s27, s24, 0
s_add_u32 m0, s26, 0
s_nop 0
buffer_load_dwordx4 v8, s[16:19], s27 offen lds
buffer_load_dwordx4 v9, s[16:19], s27 offen offset:1024 lds
buffer_load_dwordx4 v10, s[16:19], s27 offen offset:2048 lds
buffer_load_dwordx4 v11, s[16:19], s27 offen offset:3072 lds
s_add_u32 s27, s24, 262144
s_add_u32 m0, s26, 16384
s_nop 0
buffer_load_dwordx4 v8, s[16:19], s27 offen lds
buffer_load_dwordx4 v9, s[16:19], s27 offen offset:1024 lds
buffer_load_dwordx4 v10, s[16:19], s27 offen offset:2048 lds
buffer_load_dwordx4 v11, s[16:19], s27 offen offset:3072 lds
s_add_u32 s27, s24, 524288
s_add_u32 m0, s26, 32768
s_nop 0
buffer_load_dwordx4 v8, s[16:19], s27 offen lds
buffer_load_dwordx4 v9, s[16:19], s27 offen offset:1024 lds
buffer_load_dwordx4 v10, s[16:19], s27 offen offset:2048 lds
buffer_load_dwordx4 v11, s[16:19], s27 offen offset:3072 lds
s_add_u32 s27, s24, 786432
s_add_u32 m0, s26, 49152
s_nop 0
buffer_load_dwordx4 v8, s[16:19], s27 offen lds
buffer_load_dwordx4 v9, s[16:19], s27 offen offset:1024 lds
buffer_load_dwordx4 v10, s[16:19], s27 offen offset:2048 lds
buffer_load_dwordx4 v11, s[16:19], s27 offen offset:3072 lds
s_waitcnt vmcnt(12)
ds_read_b64_tr_b16 v[32:33], v12 offset:0
ds_read_b64_tr_b16 v[34:35], v12 offset:2048
ds_read_b64_tr_b16 v[36:37], v13 offset:0
ds_read_b64_tr_b16 v[38:39], v13 offset:2048
ds_read_b64_tr_b16 v[40:41], v14 offset:0
ds_read_b64_tr_b16 v[42:43], v14 offset:2048
ds_read_b64_tr_b16 v[44:45], v15 offset:0
ds_read_b64_tr_b16 v[46:47], v15 offset:2048
s_waitcnt lgkmcnt(0)
s_add_u32 s27, s24, 1048576
s_add_u32 m0, s26, 0
s_nop 0
buffer_load_dwordx4 v8, s[16:19], s27 offen lds
buffer_load_dwordx4 v9, s[16:19], s27 offen offset:1024 lds
buffer_load_dwordx4 v10, s[16:19], s27 offen offset:2048 lds
buffer_load_dwordx4 v11, s[16:19], s27 offen offset:3072 lds
s_waitcnt vmcnt(12)
ds_read_b64_tr_b16 v[48:49], v12 offset:16384
ds_read_b64_tr_b16 v[50:51], v12 offset:18432
ds_read_b64_tr_b16 v[52:53], v13 offset:16384
ds_read_b64_tr_b16 v[54:55], v13 offset:18432
ds_read_b64_tr_b16 v[56:57], v14 offset:16384
ds_read_b64_tr_b16 v[58:59], v14 offset:18432
ds_read_b64_tr_b16 v[60:61], v15 offset:16384
ds_read_b64_tr_b16 v[62:63], v15 offset:18432
s_waitcnt lgkmcnt(0)
s_add_u32 s27, s24, 1310720
s_add_u32 m0, s26, 16384
s_nop 0
buffer_load_dwordx4 v8, s[16:19], s27 offen lds
buffer_load_dwordx4 v9, s[16:19], s27 offen offset:1024 lds
buffer_load_dwordx4 v10, s[16:19], s27 offen offset:2048 lds
buffer_load_dwordx4 v11, s[16:19], s27 offen offset:3072 lds
s_waitcnt vmcnt(12)
ds_read_b64_tr_b16 v[64:65], v12 offset:32768
ds_read_b64_tr_b16 v[66:67], v12 offset:34816
ds_read_b64_tr_b16 v[68:69], v13 offset:32768
ds_read_b64_tr_b16 v[70:71], v13 offset:34816
ds_read_b64_tr_b16 v[72:73], v14 offset:32768
ds_read_b64_tr_b16 v[74:75], v14 offset:34816
ds_read_b64_tr_b16 v[76:77], v15 offset:32768
ds_read_b64_tr_b16 v[78:79], v15 offset:34816
s_waitcnt lgkmcnt(0)
s_add_u32 s27, s24, 1572864
s_add_u32 m0, s26, 32768
s_nop 0
buffer_load_dwordx4 v8, s[16:19], s27 offen lds
buffer_load_dwordx4 v9, s[16:19], s27 offen offset:1024 lds
buffer_load_dwordx4 v10, s[16:19], s27 offen offset:2048 lds
buffer_load_dwordx4 v11, s[16:19], s27 offen offset:3072 lds
s_waitcnt vmcnt(12)
ds_read_b64_tr_b16 v[80:81], v12 offset:49152
ds_read_b64_tr_b16 v[82:83], v12 offset:51200
ds_read_b64_tr_b16 v[84:85], v13 offset:49152
ds_read_b64_tr_b16 v[86:87], v13 offset:51200
ds_read_b64_tr_b16 v[88:89], v14 offset:49152
ds_read_b64_tr_b16 v[90:91], v14 offset:51200
ds_read_b64_tr_b16 v[92:93], v15 offset:49152
ds_read_b64_tr_b16 v[94:95], v15 offset:51200
s_waitcnt lgkmcnt(0)
s_add_u32 s27, s24, 1835008
s_add_u32 m0, s26, 49152
s_nop 0
buffer_load_dwordx4 v8, s[16:19], s27 offen lds
buffer_load_dwordx4 v9, s[16:19], s27 offen offset:1024 lds
buffer_load_dwordx4 v10, s[16:19], s27 offen offset:2048 lds
buffer_load_dwordx4 v11, s[16:19], s27 offen offset:3072 lds
s_waitcnt vmcnt(12)
ds_read_b64_tr_b16 v[96:97], v12 offset:0
ds_read_b64_tr_b16 v[98:99], v12 offset:2048
ds_read_b64_tr_b16 v[100:101], v13 offset:0
ds_read_b64_tr_b16 v[102:103], v13 offset:2048
ds_read_b64_tr_b16 v[104:105], v14 offset:0
ds_read_b64_tr_b16 v[106:107], v14 offset:2048
ds_read_b64_tr_b16 v[108:109], v15 offset:0
ds_read_b64_tr_b16 v[110:111], v15 offset:2048
s_waitcnt lgkmcnt(0)
s_add_u32 s27, s24, 2097152
s_add_u32 m0, s26, 0
s_nop 0
buffer_load_dwordx4 v8, s[16:19], s27 offen lds
buffer_load_dwordx4 v9, s[16:19], s27 offen offset:1024 lds
buffer_load_dwordx4 v10, s[16:19], s27 offen offset:2048 lds
buffer_load_dwordx4 v11, s[16:19], s27 offen offset:3072 lds
s_waitcnt vmcnt(12)
ds_read_b64_tr_b16 v[112:113], v12 offset:16384
ds_read_b64_tr_b16 v[114:115], v12 offset:18432
ds_read_b64_tr_b16 v[116:117], v13 offset:16384
ds_read_b64_tr_b16 v[118:119], v13 offset:18432
ds_read_b64_tr_b16 v[120:121], v14 offset:16384
ds_read_b64_tr_b16 v[122:123], v14 offset:18432
ds_read_b64_tr_b16 v[124:125], v15 offset:16384
ds_read_b64_tr_b16 v[126:127], v15 offset:18432
s_waitcnt lgkmcnt(0)
s_add_u32 s27, s24, 2359296
s_add_u32 m0, s26, 16384
s_nop 0
buffer_load_dwordx4 v8, s[16:19], s27 offen lds
buffer_load_dwordx4 v9, s[16:19], s27 offen offset:1024 lds
buffer_load_dwordx4 v10, s[16:19], s27 offen offset:2048 lds
buffer_load_dwordx4 v11, s[16:19], s27 offen offset:3072 lds
s_waitcnt vmcnt(12)
ds_read_b64_tr_b16 v[128:129], v12 offset:32768
ds_read_b64_tr_b16 v[130:131], v12 offset:34816
ds_read_b64_tr_b16 v[132:133], v13 offset:32768
ds_read_b64_tr_b16 v[134:135], v13 offset:34816
ds_read_b64_tr_b16 v[136:137], v14 offset:32768
ds_read_b64_tr_b16 v[138:139], v14 offset:34816
ds_read_b64_tr_b16 v[140:141], v15 offset:32768
ds_read_b64_tr_b16 v[142:143], v15 offset:34816
s_waitcnt vmcnt(8)
ds_read_b64_tr_b16 v[144:145], v12 offset:49152
ds_read_b64_tr_b16 v[146:147], v12 offset:51200
ds_read_b64_tr_b16 v[148:149], v13 offset:49152
ds_read_b64_tr_b16 v[150:151], v13 offset:51200
ds_read_b64_tr_b16 v[152:153], v14 offset:49152
ds_read_b64_tr_b16 v[154:155], v14 offset:51200
ds_read_b64_tr_b16 v[156:157], v15 offset:49152
ds_read_b64_tr_b16 v[158:159], v15 offset:51200
s_waitcnt vmcnt(4)
ds_read_b64_tr_b16 v[160:161], v12 offset:0
ds_read_b64_tr_b16 v[162:163], v12 offset:2048
ds_read_b64_tr_b16 v[164:165], v13 offset:0
ds_read_b64_tr_b16 v[166:167], v13 offset:2048
ds_read_b64_tr_b16 v[168:169], v14 offset:0
ds_read_b64_tr_b16 v[170:171], v14 offset:2048
ds_read_b64_tr_b16 v[172:173], v15 offset:0
ds_read_b64_tr_b16 v[174:175], v15 offset:2048
s_waitcnt vmcnt(0)
ds_read_b64_tr_b16 v[176:177], v12 offset:16384
ds_read_b64_tr_b16 v[178:179], v12 offset:18432
ds_read_b64_tr_b16 v[180:181], v13 offset:16384
ds_read_b64_tr_b16 v[182:183], v13 offset:18432
ds_read_b64_tr_b16 v[184:185], v14 offset:16384
ds_read_b64_tr_b16 v[186:187], v14 offset:18432
ds_read_b64_tr_b16 v[188:189], v15 offset:16384
ds_read_b64_tr_b16 v[190:191], v15 offset:18432
buffer_store_dwordx4 v[32:35], v3, s[16:19], s48 offen sc1
s_add_u32 s48, s48, 4096
buffer_store_dwordx4 v[36:39], v3, s[16:19], s49 offen sc1
s_add_u32 s49, s49, 4096
buffer_store_dwordx4 v[40:43], v3, s[16:19], s50 offen sc1
s_add_u32 s50, s50, 4096
buffer_store_dwordx4 v[44:47], v3, s[16:19], s51 offen sc1
s_add_u32 s51, s51, 4096
buffer_store_dwordx4 v[48:51], v3, s[16:19], s48 offen sc1
s_add_u32 s48, s48, 4096
buffer_store_dwordx4 v[52:55], v3, s[16:19], s49 offen sc1
s_add_u32 s49, s49, 4096
buffer_store_dwordx4 v[56:59], v3, s[16:19], s50 offen sc1
s_add_u32 s50, s50, 4096
buffer_store_dwordx4 v[60:63], v3, s[16:19], s51 offen sc1
s_add_u32 s51, s51, 4096
buffer_store_dwordx4 v[64:67], v3, s[16:19], s48 offen sc1
s_add_u32 s48, s48, 4096
buffer_store_dwordx4 v[68:71], v3, s[16:19], s49 offen sc1
s_add_u32 s49, s49, 4096
buffer_store_dwordx4 v[72:75], v3, s[16:19], s50 offen sc1
s_add_u32 s50, s50, 4096
buffer_store_dwordx4 v[76:79], v3, s[16:19], s51 offen sc1
s_add_u32 s51, s51, 4096
buffer_store_dwordx4 v[80:83], v3, s[16:19], s48 offen sc1
s_add_u32 s48, s48, 4096
buffer_store_dwordx4 v[84:87], v3, s[16:19], s49 offen sc1
s_add_u32 s49, s49, 4096
buffer_store_dwordx4 v[88:91], v3, s[16:19], s50 offen sc1
s_add_u32 s50, s50, 4096
buffer_store_dwordx4 v[92:95], v3, s[16:19], s51 offen sc1
s_add_u32 s51, s51, 4096
buffer_store_dwordx4 v[96:99], v3, s[16:19], s48 offen sc1
s_add_u32 s48, s48, 4096
buffer_store_dwordx4 v[100:103], v3, s[16:19], s49 offen sc1
s_add_u32 s49, s49, 4096
buffer_store_dwordx4 v[104:107], v3, s[16:19], s50 offen sc1
s_add_u32 s50, s50, 4096
buffer_store_dwordx4 v[108:111], v3, s[16:19], s51 offen sc1
s_add_u32 s51, s51, 4096
buffer_store_dwordx4 v[112:115], v3, s[16:19], s48 offen sc1
s_add_u32 s48, s48, 4096
buffer_store_dwordx4 v[116:119], v3, s[16:19], s49 offen sc1
s_add_u32 s49, s49, 4096
buffer_store_dwordx4 v[120:123], v3, s[16:19], s50 offen sc1
s_add_u32 s50, s50, 4096
buffer_store_dwordx4 v[124:127], v3, s[16:19], s51 offen sc1
s_add_u32 s51, s51, 4096
s_waitcnt lgkmcnt(15)
buffer_store_dwordx4 v[128:131], v3, s[16:19], s48 offen sc1
s_add_u32 s48, s48, 4096
buffer_store_dwordx4 v[132:135], v3, s[16:19], s49 offen sc1
s_add_u32 s49, s49, 4096
buffer_store_dwordx4 v[136:139], v3, s[16:19], s50 offen sc1
s_add_u32 s50, s50, 4096
buffer_store_dwordx4 v[140:143], v3, s[16:19], s51 offen sc1
s_add_u32 s51, s51, 4096
s_waitcnt lgkmcnt(15)
buffer_store_dwordx4 v[144:147], v3, s[16:19], s48 offen sc1
s_add_u32 s48, s48, 4096
buffer_store_dwordx4 v[148:151], v3, s[16:19], s49 offen sc1
s_add_u32 s49, s49, 4096
buffer_store_dwordx4 v[152:155], v3, s[16:19], s50 offen sc1
s_add_u32 s50, s50, 4096
buffer_store_dwordx4 v[156:159], v3, s[16:19], s51 offen sc1
s_add_u32 s51, s51, 4096
s_waitcnt lgkmcnt(8)
buffer_store_dwordx4 v[160:163], v3, s[16:19], s48 offen sc1
s_add_u32 s48, s48, 4096
buffer_store_dwordx4 v[164:167], v3, s[16:19], s49 offen sc1
s_add_u32 s49, s49, 4096
buffer_store_dwordx4 v[168:171], v3, s[16:19], s50 offen sc1
s_add_u32 s50, s50, 4096
buffer_store_dwordx4 v[172:175], v3, s[16:19], s51 offen sc1
s_add_u32 s51, s51, 4096
s_waitcnt lgkmcnt(0)
buffer_store_dwordx4 v[176:179], v3, s[16:19], s48 offen sc1
s_add_u32 s48, s48, 4096
buffer_store_dwordx4 v[180:183], v3, s[16:19], s49 offen sc1
s_add_u32 s49, s49, 4096
buffer_store_dwordx4 v[184:187], v3, s[16:19], s50 offen sc1
s_add_u32 s50, s50, 4096
buffer_store_dwordx4 v[188:191], v3, s[16:19], s51 offen sc1
s_add_u32 s51, s51, 4096
s_endpgm
.Lqkv_notr2:
s_add_u32 s27, s24, 0
s_add_u32 m0, s26, 0
s_nop 0
buffer_load_dwordx4 v8, s[16:19], s27 offen lds
buffer_load_dwordx4 v9, s[16:19], s27 offen offset:1024 lds
buffer_load_dwordx4 v10, s[16:19], s27 offen offset:2048 lds
buffer_load_dwordx4 v11, s[16:19], s27 offen offset:3072 lds
s_add_u32 s28, s25, 0
buffer_load_dwordx4 a[0:3], v3, s[12:15], s28 offen offset:0
buffer_load_dwordx4 a[4:7], v3, s[12:15], s28 offen offset:1024
buffer_load_dwordx4 a[8:11], v3, s[12:15], s28 offen offset:2048
buffer_load_dwordx4 a[12:15], v3, s[12:15], s28 offen offset:3072
s_add_u32 s27, s24, 262144
s_add_u32 m0, s26, 16384
s_nop 0
buffer_load_dwordx4 v8, s[16:19], s27 offen lds
buffer_load_dwordx4 v9, s[16:19], s27 offen offset:1024 lds
buffer_load_dwordx4 v10, s[16:19], s27 offen offset:2048 lds
buffer_load_dwordx4 v11, s[16:19], s27 offen offset:3072 lds
s_add_u32 s28, s25, 4096
buffer_load_dwordx4 a[16:19], v3, s[12:15], s28 offen offset:0
buffer_load_dwordx4 a[20:23], v3, s[12:15], s28 offen offset:1024
buffer_load_dwordx4 a[24:27], v3, s[12:15], s28 offen offset:2048
buffer_load_dwordx4 a[28:31], v3, s[12:15], s28 offen offset:3072
v_add_u32 v144, 0x10000, v12
v_add_u32 v145, 0x10000, v13
v_add_u32 v146, 0x10000, v14
v_add_u32 v147, 0x10000, v15
v_and_b32 v23, 3, v2
v_and_b32 v21, 31, v2
v_lshlrev_b32 v21, 2, v21
s_lshl_b32 s27, s22, 7
s_add_u32 s27, s27, 131072
v_add_u32 v22, s27, v21
s_cmp_ge_u32 s21, 10
s_cbranch_scc1 .Lqkv_v4
s_cmp_ge_u32 s21, 5
s_cselect_b32 s30, 1, 0
s_mul_i32 s31, s30, 20
s_sub_u32 s31, s23, s31
s_lshl_b32 s38, s31, 1
s_sub_u32 s39, s31, 16
s_lshl_b32 s39, s39, 3
s_cmp_ge_u32 s31, 16
s_cselect_b32 s38, s39, s38
s_mov_b32 s32, 65536
s_cselect_b32 s32, 16384, s32
s_mov_b32 s33, 10485760
s_cselect_b32 s33, 12582912, s33
s_movk_i32 s35, 2048
s_cselect_b32 s35, 512, s35
s_movk_i32 s34, 1024
s_cselect_b32 s34, 256, s34
s_mov_b32 s39, 13107200
s_cselect_b32 s39, 13109248, s39
s_cmp_eq_u32 s30, 1
s_cselect_b32 s32, 163840, s32
s_cselect_b32 s33, s39, s33
s_cselect_b32 s35, 5120, s35
s_mul_i32 s38, s38, s32
s_add_u32 s33, s33, s38
s_lshl_b32 s36, s20, 1
s_lshr_b32 s37, s40, 1
s_add_u32 s36, s36, s37
s_mul_i32 s36, s36, s35
s_and_b32 s37, s40, 1
s_mul_i32 s37, s37, s34
s_add_u32 s36, s36, s37
s_add_u32 s48, s36, s33
s_lshl_b32 s36, s20, 1
s_lshr_b32 s37, s41, 1
s_add_u32 s36, s36, s37
s_mul_i32 s36, s36, s35
s_and_b32 s37, s41, 1
s_mul_i32 s37, s37, s34
s_add_u32 s36, s36, s37
s_add_u32 s49, s36, s33
s_lshl_b32 s36, s20, 1
s_lshr_b32 s37, s42, 1
s_add_u32 s36, s36, s37
s_mul_i32 s36, s36, s35
s_and_b32 s37, s42, 1
s_mul_i32 s37, s37, s34
s_add_u32 s36, s36, s37
s_add_u32 s50, s36, s33
s_lshl_b32 s36, s20, 1
s_lshr_b32 s37, s43, 1
s_add_u32 s36, s36, s37
s_mul_i32 s36, s36, s35
s_and_b32 s37, s43, 1
s_mul_i32 s37, s37, s34
s_add_u32 s36, s36, s37
s_add_u32 s51, s36, s33
v_mul_lo_u32 v16, v7, s32
v_lshl_add_u32 v16, v21, 1, v16
s_lshl_b32 s33, s32, 1
s_lshl_b32 s27, s40, 7
s_add_u32 s27, s27, 131072
v_add_u32 v148, s27, v21
s_lshl_b32 s27, s41, 7
s_add_u32 s27, s27, 131072
v_add_u32 v149, s27, v21
s_lshl_b32 s27, s42, 7
s_add_u32 s27, s27, 131072
v_add_u32 v150, s27, v21
s_lshl_b32 s27, s43, 7
s_add_u32 s27, s27, 131072
v_add_u32 v151, s27, v21
s_waitcnt vmcnt(12)
s_barrier
ds_read_b64_tr_b16 v[32:33], v12 offset:0
ds_read_b64_tr_b16 v[34:35], v12 offset:2048
ds_read_b64_tr_b16 v[36:37], v13 offset:0
ds_read_b64_tr_b16 v[38:39], v13 offset:2048
ds_read_b64_tr_b16 v[40:41], v14 offset:0
ds_read_b64_tr_b16 v[42:43], v14 offset:2048
ds_read_b64_tr_b16 v[44:45], v15 offset:0
ds_read_b64_tr_b16 v[46:47], v15 offset:2048
ds_read_b64_tr_b16 v[48:49], v12 offset:4096
ds_read_b64_tr_b16 v[50:51], v12 offset:6144
ds_read_b64_tr_b16 v[52:53], v13 offset:4096
ds_read_b64_tr_b16 v[54:55], v13 offset:6144
ds_read_b64_tr_b16 v[56:57], v14 offset:4096
ds_read_b64_tr_b16 v[58:59], v14 offset:6144
ds_read_b64_tr_b16 v[60:61], v15 offset:4096
ds_read_b64_tr_b16 v[62:63], v15 offset:6144
s_waitcnt vmcnt(11) lgkmcnt(14)
v_mfma_f32_32x32x16_bf16 v[80:95], a[0:3], v[32:35], 0
ds_read_b64_tr_b16 v[64:65], v12 offset:8192
ds_read_b64_tr_b16 v[66:67], v12 offset:10240
v_mfma_f32_4x4x4_16b_bf16 v[24:27], v[32:33], v[32:33], v[24:27]
s_waitcnt lgkmcnt(14)
v_mfma_f32_32x32x16_bf16 v[96:111], a[0:3], v[36:39], 0
ds_read_b64_tr_b16 v[68:69], v13 offset:8192
ds_read_b64_tr_b16 v[70:71], v13 offset:10240
s_add_u32 s27, s24, 524288
s_add_u32 m0, s26, 32768
s_nop 0
buffer_load_dwordx4 v8, s[16:19], s27 offen lds
s_waitcnt lgkmcnt(14)
v_mfma_f32_32x32x16_bf16 v[112:127], a[0:3], v[40:43], 0
ds_read_b64_tr_b16 v[72:73], v14 offset:8192
ds_read_b64_tr_b16 v[74:75], v14 offset:10240
v_mfma_f32_4x4x4_16b_bf16 v[28:31], v[34:35], v[34:35], v[28:31]
s_waitcnt lgkmcnt(14)
v_mfma_f32_32x32x16_bf16 v[128:143], a[0:3], v[44:47], 0
ds_read_b64_tr_b16 v[76:77], v15 offset:8192
ds_read_b64_tr_b16 v[78:79], v15 offset:10240
buffer_load_dwordx4 v9, s[16:19], s27 offen offset:1024 lds
s_waitcnt vmcnt(12) lgkmcnt(14)
v_mfma_f32_32x32x16_bf16 v[80:95], a[4:7], v[48:51], v[80:95]
ds_read_b64_tr_b16 v[32:33], v12 offset:12288
ds_read_b64_tr_b16 v[34:35], v12 offset:14336
v_mfma_f32_4x4x4_16b_bf16 v[24:27], v[48:49], v[48:49], v[24:27]
buffer_load_dwordx4 v10, s[16:19], s27 offen offset:2048 lds
s_waitcnt lgkmcnt(14)
v_mfma_f32_32x32x16_bf16 v[96:111], a[4:7], v[52:55], v[96:111]
ds_read_b64_tr_b16 v[36:37], v13 offset:12288
ds_read_b64_tr_b16 v[38:39], v13 offset:14336
s_waitcnt lgkmcnt(14)
v_mfma_f32_32x32x16_bf16 v[112:127], a[4:7], v[56:59], v[112:127]
ds_read_b64_tr_b16 v[40:41], v14 offset:12288
ds_read_b64_tr_b16 v[42:43], v14 offset:14336
v_mfma_f32_4x4x4_16b_bf16 v[28:31], v[50:51], v[50:51], v[28:31]
buffer_load_dwordx4 v11, s[16:19], s27 offen offset:3072 lds
s_waitcnt lgkmcnt(14)
v_mfma_f32_32x32x16_bf16 v[128:143], a[4:7], v[60:63], v[128:143]
ds_read_b64_tr_b16 v[44:45], v15 offset:12288
ds_read_b64_tr_b16 v[46:47], v15 offset:14336
s_add_u32 s28, s25, 8192
buffer_load_dwordx4 a[32:35], v3, s[12:15], s28 offen offset:0
s_waitcnt vmcnt(14) lgkmcnt(14)
v_mfma_f32_32x32x16_bf16 v[80:95], a[8:11], v[64:67], v[80:95]
s_waitcnt vmcnt(9)
s_barrier
ds_read_b64_tr_b16 v[48:49], v12 offset:16384
ds_read_b64_tr_b16 v[50:51], v12 offset:18432
v_mfma_f32_4x4x4_16b_bf16 v[24:27], v[64:65], v[64:65], v[24:27]
s_waitcnt lgkmcnt(14)
v_mfma_f32_32x32x16_bf16 v[96:111], a[8:11], v[68:71], v[96:111]
ds_read_b64_tr_b16 v[52:53], v13 offset:16384
ds_read_b64_tr_b16 v[54:55], v13 offset:18432
buffer_load_dwordx4 a[36:39], v3, s[12:15], s28 offen offset:1024
s_waitcnt lgkmcnt(14)
v_mfma_f32_32x32x16_bf16 v[112:127], a[8:11], v[72:75], v[112:127]
ds_read_b64_tr_b16 v[56:57], v14 offset:16384
ds_read_b64_tr_b16 v[58:59], v14 offset:18432
v_mfma_f32_4x4x4_16b_bf16 v[28:31], v[66:67], v[66:67], v[28:31]
s_waitcnt lgkmcnt(14)
v_mfma_f32_32x32x16_bf16 v[128:143], a[8:11], v[76:79], v[128:143]
ds_read_b64_tr_b16 v[60:61], v15 offset:16384
ds_read_b64_tr_b16 v[62:63], v15 offset:18432
buffer_load_dwordx4 a[40:43], v3, s[12:15], s28 offen offset:2048
s_waitcnt lgkmcnt(14)
v_mfma_f32_32x32x16_bf16 v[80:95], a[12:15], v[32:35], v[80:95]
ds_read_b64_tr_b16 v[64:65], v12 offset:20480
ds_read_b64_tr_b16 v[66:67], v12 offset:22528
v_mfma_f32_4x4x4_16b_bf16 v[24:27], v[32:33], v[32:33], v[24:27]
buffer_load_dwordx4 a[44:47], v3, s[12:15], s28 offen offset:3072
s_waitcnt lgkmcnt(14)
v_mfma_f32_32x32x16_bf16 v[96:111], a[12:15], v[36:39], v[96:111]
ds_read_b64_tr_b16 v[68:69], v13 offset:20480
ds_read_b64_tr_b16 v[70:71], v13 offset:22528
s_waitcnt lgkmcnt(14)
v_mfma_f32_32x32x16_bf16 v[112:127], a[12:15], v[40:43], v[112:127]
ds_read_b64_tr_b16 v[72:73], v14 offset:20480
ds_read_b64_tr_b16 v[74:75], v14 offset:22528
v_mfma_f32_4x4x4_16b_bf16 v[28:31], v[34:35], v[34:35], v[28:31]
s_add_u32 s27, s24, 786432
s_add_u32 m0, s26, 49152
s_nop 0
buffer_load_dwordx4 v8, s[16:19], s27 offen lds
s_waitcnt lgkmcnt(14)
v_mfma_f32_32x32x16_bf16 v[128:143], a[12:15], v[44:47], v[128:143]
ds_read_b64_tr_b16 v[76:77], v15 offset:20480
ds_read_b64_tr_b16 v[78:79], v15 offset:22528
buffer_load_dwordx4 v9, s[16:19], s27 offen offset:1024 lds
s_waitcnt vmcnt(13) lgkmcnt(14)
v_mfma_f32_32x32x16_bf16 v[80:95], a[16:19], v[48:51], v[80:95]
ds_read_b64_tr_b16 v[32:33], v12 offset:24576
ds_read_b64_tr_b16 v[34:35], v12 offset:26624
v_mfma_f32_4x4x4_16b_bf16 v[24:27], v[48:49], v[48:49], v[24:27]
s_waitcnt lgkmcnt(14)
v_mfma_f32_32x32x16_bf16 v[96:111], a[16:19], v[52:55], v[96:111]
ds_read_b64_tr_b16 v[36:37], v13 offset:24576
ds_read_b64_tr_b16 v[38:39], v13 offset:26624
buffer_load_dwordx4 v10, s[16:19], s27 offen offset:2048 lds
s_waitcnt lgkmcnt(14)
v_mfma_f32_32x32x16_bf16 v[112:127], a[16:19], v[56:59], v[112:127]
ds_read_b64_tr_b16 v[40:41], v14 offset:24576
ds_read_b64_tr_b16 v[42:43], v14 offset:26624
v_mfma_f32_4x4x4_16b_bf16 v[28:31], v[50:51], v[50:51], v[28:31]
s_waitcnt lgkmcnt(14)
v_mfma_f32_32x32x16_bf16 v[128:143], a[16:19], v[60:63], v[128:143]
ds_read_b64_tr_b16 v[44:45], v15 offset:24576
ds_read_b64_tr_b16 v[46:47], v15 offset:26624
buffer_load_dwordx4 v11, s[16:19], s27 offen offset:3072 lds
s_waitcnt vmcnt(14) lgkmcnt(14)
v_mfma_f32_32x32x16_bf16 v[80:95], a[20:23], v[64:67], v[80:95]
ds_read_b64_tr_b16 v[48:49], v12 offset:28672
ds_read_b64_tr_b16 v[50:51], v12 offset:30720
v_mfma_f32_4x4x4_16b_bf16 v[24:27], v[64:65], v[64:65], v[24:27]
s_add_u32 s28, s25, 12288
buffer_load_dwordx4 a[48:51], v3, s[12:15], s28 offen offset:0
s_waitcnt lgkmcnt(14)
v_mfma_f32_32x32x16_bf16 v[96:111], a[20:23], v[68:71], v[96:111]
ds_read_b64_tr_b16 v[52:53], v13 offset:28672
ds_read_b64_tr_b16 v[54:55], v13 offset:30720
s_waitcnt lgkmcnt(14)
v_mfma_f32_32x32x16_bf16 v[112:127], a[20:23], v[72:75], v[112:127]
ds_read_b64_tr_b16 v[56:57], v14 offset:28672
ds_read_b64_tr_b16 v[58:59], v14 offset:30720
v_mfma_f32_4x4x4_16b_bf16 v[28:31], v[66:67], v[66:67], v[28:31]
buffer_load_dwordx4 a[52:55], v3, s[12:15], s28 offen offset:1024
s_waitcnt lgkmcnt(14)
v_mfma_f32_32x32x16_bf16 v[128:143], a[20:23], v[76:79], v[128:143]
ds_read_b64_tr_b16 v[60:61], v15 offset:28672
ds_read_b64_tr_b16 v[62:63], v15 offset:30720
buffer_load_dwordx4 a[56:59], v3, s[12:15], s28 offen offset:2048
s_waitcnt vmcnt(16) lgkmcnt(14)
v_mfma_f32_32x32x16_bf16 v[80:95], a[24:27], v[32:35], v[80:95]
s_waitcnt vmcnt(11)
s_barrier
ds_read_b64_tr_b16 v[64:65], v12 offset:32768
ds_read_b64_tr_b16 v[66:67], v12 offset:34816
v_mfma_f32_4x4x4_16b_bf16 v[24:27], v[32:33], v[32:33], v[24:27]
s_waitcnt lgkmcnt(14)
v_mfma_f32_32x32x16_bf16 v[96:111], a[24:27], v[36:39], v[96:111]
ds_read_b64_tr_b16 v[68:69], v13 offset:32768
ds_read_b64_tr_b16 v[70:71], v13 offset:34816
buffer_load_dwordx4 a[60:63], v3, s[12:15], s28 offen offset:3072
s_waitcnt lgkmcnt(14)
v_mfma_f32_32x32x16_bf16 v[112:127], a[24:27], v[40:43], v[112:127]
ds_read_b64_tr_b16 v[72:73], v14 offset:32768
ds_read_b64_tr_b16 v[74:75], v14 offset:34816
v_mfma_f32_4x4x4_16b_bf16 v[28:31], v[34:35], v[34:35], v[28:31]
s_waitcnt lgkmcnt(14)
v_mfma_f32_32x32x16_bf16 v[128:143], a[24:27], v[44:47], v[128:143]
ds_read_b64_tr_b16 v[76:77], v15 offset:32768
ds_read_b64_tr_b16 v[78:79], v15 offset:34816
s_add_u32 s27, s24, 1048576
s_add_u32 m0, s26, 65536
s_nop 0
buffer_load_dwordx4 v8, s[16:19], s27 offen lds
s_waitcnt lgkmcnt(14)
v_mfma_f32_32x32x16_bf16 v[80:95], a[28:31], v[48:51], v[80:95]
ds_read_b64_tr_b16 v[32:33], v12 offset:36864
ds_read_b64_tr_b16 v[34:35], v12 offset:38912
v_mfma_f32_4x4x4_16b_bf16 v[24:27], v[48:49], v[48:49], v[24:27]
buffer_load_dwordx4 v9, s[16:19], s27 offen offset:1024 lds
s_waitcnt lgkmcnt(14)
v_mfma_f32_32x32x16_bf16 v[96:111], a[28:31], v[52:55], v[96:111]
ds_read_b64_tr_b16 v[36:37], v13 offset:36864
ds_read_b64_tr_b16 v[38:39], v13 offset:38912
s_waitcnt lgkmcnt(14)
v_mfma_f32_32x32x16_bf16 v[112:127], a[28:31], v[56:59], v[112:127]
ds_read_b64_tr_b16 v[40:41], v14 offset:36864
ds_read_b64_tr_b16 v[42:43], v14 offset:38912
v_mfma_f32_4x4x4_16b_bf16 v[28:31], v[50:51], v[50:51], v[28:31]
buffer_load_dwordx4 v10, s[16:19], s27 offen offset:2048 lds
s_waitcnt lgkmcnt(14)
v_mfma_f32_32x32x16_bf16 v[128:143], a[28:31], v[60:63], v[128:143]
ds_read_b64_tr_b16 v[44:45], v15 offset:36864
ds_read_b64_tr_b16 v[46:47], v15 offset:38912
buffer_load_dwordx4 v11, s[16:19], s27 offen offset:3072 lds
s_waitcnt vmcnt(15) lgkmcnt(14)
v_mfma_f32_32x32x16_bf16 v[80:95], a[32:35], v[64:67], v[80:95]
ds_read_b64_tr_b16 v[48:49], v12 offset:40960
ds_read_b64_tr_b16 v[50:51], v12 offset:43008
v_mfma_f32_4x4x4_16b_bf16 v[24:27], v[64:65], v[64:65], v[24:27]
s_waitcnt lgkmcnt(14)
v_mfma_f32_32x32x16_bf16 v[96:111], a[32:35], v[68:71], v[96:111]
ds_read_b64_tr_b16 v[52:53], v13 offset:40960
ds_read_b64_tr_b16 v[54:55], v13 offset:43008
s_add_u32 s28, s25, 16384
buffer_load_dwordx4 a[64:67], v3, s[12:15], s28 offen offset:0
s_waitcnt lgkmcnt(14)
v_mfma_f32_32x32x16_bf16 v[112:127], a[32:35], v[72:75], v[112:127]
ds_read_b64_tr_b16 v[56:57], v14 offset:40960
ds_read_b64_tr_b16 v[58:59], v14 offset:43008
v_mfma_f32_4x4x4_16b_bf16 v[28:31], v[66:67], v[66:67], v[28:31]
s_waitcnt lgkmcnt(14)
v_mfma_f32_32x32x16_bf16 v[128:143], a[32:35], v[76:79], v[128:143]
ds_read_b64_tr_b16 v[60:61], v15 offset:40960
ds_read_b64_tr_b16 v[62:63], v15 offset:43008
buffer_load_dwordx4 a[68:71], v3, s[12:15], s28 offen offset:1024
s_waitcnt vmcnt(16) lgkmcnt(14)
v_mfma_f32_32x32x16_bf16 v[80:95], a[36:39], v[32:35], v[80:95]
ds_read_b64_tr_b16 v[64:65], v12 offset:45056
ds_read_b64_tr_b16 v[66:67], v12 offset:47104
v_mfma_f32_4x4x4_16b_bf16 v[24:27], v[32:33], v[32:33], v[24:27]
buffer_load_dwordx4 a[72:75], v3, s[12:15], s28 offen offset:2048
s_waitcnt lgkmcnt(14)
v_mfma_f32_32x32x16_bf16 v[96:111], a[36:39], v[36:39], v[96:111]
ds_read_b64_tr_b16 v[68:69], v13 offset:45056
ds_read_b64_tr_b16 v[70:71], v13 offset:47104
s_waitcnt lgkmcnt(14)
v_mfma_f32_32x32x16_bf16 v[112:127], a[36:39], v[40:43], v[112:127]
ds_read_b64_tr_b16 v[72:73], v14 offset:45056
ds_read_b64_tr_b16 v[74:75], v14 offset:47104
v_mfma_f32_4x4x4_16b_bf16 v[28:31], v[34:35], v[34:35], v[28:31]
buffer_load_dwordx4 a[76:79], v3, s[12:15], s28 offen offset:3072
s_waitcnt lgkmcnt(14)
v_mfma_f32_32x32x16_bf16 v[128:143], a[36:39], v[44:47], v[128:143]
ds_read_b64_tr_b16 v[76:77], v15 offset:45056
ds_read_b64_tr_b16 v[78:79], v15 offset:47104
s_add_u32 s27, s24, 1310720
s_add_u32 m0, s26, 81920
s_nop 0
buffer_load_dwordx4 v8, s[16:19], s27 offen lds
s_waitcnt vmcnt(18) lgkmcnt(14)
v_mfma_f32_32x32x16_bf16 v[80:95], a[40:43], v[48:51], v[80:95]
s_waitcnt vmcnt(13)
s_barrier
ds_read_b64_tr_b16 v[32:33], v12 offset:49152
ds_read_b64_tr_b16 v[34:35], v12 offset:51200
v_mfma_f32_4x4x4_16b_bf16 v[24:27], v[48:49], v[48:49], v[24:27]
s_waitcnt lgkmcnt(14)
v_mfma_f32_32x32x16_bf16 v[96:111], a[40:43], v[52:55], v[96:111]
ds_read_b64_tr_b16 v[36:37], v13 offset:49152
ds_read_b64_tr_b16 v[38:39], v13 offset:51200
buffer_load_dwordx4 v9, s[16:19], s27 offen offset:1024 lds
s_waitcnt lgkmcnt(14)
v_mfma_f32_32x32x16_bf16 v[112:127], a[40:43], v[56:59], v[112:127]
ds_read_b64_tr_b16 v[40:41], v14 offset:49152
ds_read_b64_tr_b16 v[42:43], v14 offset:51200
v_mfma_f32_4x4x4_16b_bf16 v[28:31], v[50:51], v[50:51], v[28:31]
s_waitcnt lgkmcnt(14)
v_mfma_f32_32x32x16_bf16 v[128:143], a[40:43], v[60:63], v[128:143]
ds_read_b64_tr_b16 v[44:45], v15 offset:49152
ds_read_b64_tr_b16 v[46:47], v15 offset:51200
buffer_load_dwordx4 v10, s[16:19], s27 offen offset:2048 lds
s_waitcnt lgkmcnt(14)
v_mfma_f32_32x32x16_bf16 v[80:95], a[44:47], v[64:67], v[80:95]
ds_read_b64_tr_b16 v[48:49], v12 offset:53248
ds_read_b64_tr_b16 v[50:51], v12 offset:55296
v_mfma_f32_4x4x4_16b_bf16 v[24:27], v[64:65], v[64:65], v[24:27]
buffer_load_dwordx4 v11, s[16:19], s27 offen offset:3072 lds
s_waitcnt lgkmcnt(14)
v_mfma_f32_32x32x16_bf16 v[96:111], a[44:47], v[68:71], v[96:111]
ds_read_b64_tr_b16 v[52:53], v13 offset:53248
ds_read_b64_tr_b16 v[54:55], v13 offset:55296
s_waitcnt lgkmcnt(14)
v_mfma_f32_32x32x16_bf16 v[112:127], a[44:47], v[72:75], v[112:127]
ds_read_b64_tr_b16 v[56:57], v14 offset:53248
ds_read_b64_tr_b16 v[58:59], v14 offset:55296
v_mfma_f32_4x4x4_16b_bf16 v[28:31], v[66:67], v[66:67], v[28:31]
s_add_u32 s28, s25, 20480
buffer_load_dwordx4 a[80:83], v3, s[12:15], s28 offen offset:0
s_waitcnt lgkmcnt(14)
v_mfma_f32_32x32x16_bf16 v[128:143], a[44:47], v[76:79], v[128:143]
ds_read_b64_tr_b16 v[60:61], v15 offset:53248
ds_read_b64_tr_b16 v[62:63], v15 offset:55296
buffer_load_dwordx4 a[84:87], v3, s[12:15], s28 offen offset:1024
s_waitcnt vmcnt(17) lgkmcnt(14)
v_mfma_f32_32x32x16_bf16 v[80:95], a[48:51], v[32:35], v[80:95]
ds_read_b64_tr_b16 v[64:65], v12 offset:57344
ds_read_b64_tr_b16 v[66:67], v12 offset:59392
v_mfma_f32_4x4x4_16b_bf16 v[24:27], v[32:33], v[32:33], v[24:27]
s_waitcnt lgkmcnt(14)
v_mfma_f32_32x32x16_bf16 v[96:111], a[48:51], v[36:39], v[96:111]
ds_read_b64_tr_b16 v[68:69], v13 offset:57344
ds_read_b64_tr_b16 v[70:71], v13 offset:59392
buffer_load_dwordx4 a[88:91], v3, s[12:15], s28 offen offset:2048
s_waitcnt lgkmcnt(14)
v_mfma_f32_32x32x16_bf16 v[112:127], a[48:51], v[40:43], v[112:127]
ds_read_b64_tr_b16 v[72:73], v14 offset:57344
ds_read_b64_tr_b16 v[74:75], v14 offset:59392
v_mfma_f32_4x4x4_16b_bf16 v[28:31], v[34:35], v[34:35], v[28:31]
s_waitcnt lgkmcnt(14)
v_mfma_f32_32x32x16_bf16 v[128:143], a[48:51], v[44:47], v[128:143]
ds_read_b64_tr_b16 v[76:77], v15 offset:57344
ds_read_b64_tr_b16 v[78:79], v15 offset:59392
buffer_load_dwordx4 a[92:95], v3, s[12:15], s28 offen offset:3072
s_waitcnt vmcnt(18) lgkmcnt(14)
v_mfma_f32_32x32x16_bf16 v[80:95], a[52:55], v[48:51], v[80:95]
ds_read_b64_tr_b16 v[32:33], v12 offset:61440
ds_read_b64_tr_b16 v[34:35], v12 offset:63488
v_mfma_f32_4x4x4_16b_bf16 v[24:27], v[48:49], v[48:49], v[24:27]
s_add_u32 s27, s24, 1572864
s_add_u32 m0, s26, 98304
s_nop 0
buffer_load_dwordx4 v8, s[16:19], s27 offen lds
s_waitcnt lgkmcnt(14)
v_mfma_f32_32x32x16_bf16 v[96:111], a[52:55], v[52:55], v[96:111]
ds_read_b64_tr_b16 v[36:37], v13 offset:61440
ds_read_b64_tr_b16 v[38:39], v13 offset:63488
s_waitcnt lgkmcnt(14)
v_mfma_f32_32x32x16_bf16 v[112:127], a[52:55], v[56:59], v[112:127]
ds_read_b64_tr_b16 v[40:41], v14 offset:61440
ds_read_b64_tr_b16 v[42:43], v14 offset:63488
v_mfma_f32_4x4x4_16b_bf16 v[28:31], v[50:51], v[50:51], v[28:31]
buffer_load_dwordx4 v9, s[16:19], s27 offen offset:1024 lds
s_waitcnt lgkmcnt(14)
v_mfma_f32_32x32x16_bf16 v[128:143], a[52:55], v[60:63], v[128:143]
ds_read_b64_tr_b16 v[44:45], v15 offset:61440
ds_read_b64_tr_b16 v[46:47], v15 offset:63488
buffer_load_dwordx4 v10, s[16:19], s27 offen offset:2048 lds
s_waitcnt vmcnt(20) lgkmcnt(14)
v_mfma_f32_32x32x16_bf16 v[80:95], a[56:59], v[64:67], v[80:95]
s_waitcnt vmcnt(15)
s_barrier
ds_read_b64_tr_b16 v[48:49], v144 offset:0
ds_read_b64_tr_b16 v[50:51], v144 offset:2048
v_mfma_f32_4x4x4_16b_bf16 v[24:27], v[64:65], v[64:65], v[24:27]
s_waitcnt lgkmcnt(14)
v_mfma_f32_32x32x16_bf16 v[96:111], a[56:59], v[68:71], v[96:111]
ds_read_b64_tr_b16 v[52:53], v145 offset:0
ds_read_b64_tr_b16 v[54:55], v145 offset:2048
buffer_load_dwordx4 v11, s[16:19], s27 offen offset:3072 lds
s_waitcnt lgkmcnt(14)
v_mfma_f32_32x32x16_bf16 v[112:127], a[56:59], v[72:75], v[112:127]
ds_read_b64_tr_b16 v[56:57], v146 offset:0
ds_read_b64_tr_b16 v[58:59], v146 offset:2048
v_mfma_f32_4x4x4_16b_bf16 v[28:31], v[66:67], v[66:67], v[28:31]
s_waitcnt lgkmcnt(14)
v_mfma_f32_32x32x16_bf16 v[128:143], a[56:59], v[76:79], v[128:143]
ds_read_b64_tr_b16 v[60:61], v147 offset:0
ds_read_b64_tr_b16 v[62:63], v147 offset:2048
s_add_u32 s28, s25, 24576
buffer_load_dwordx4 a[96:99], v3, s[12:15], s28 offen offset:0
s_waitcnt lgkmcnt(14)
v_mfma_f32_32x32x16_bf16 v[80:95], a[60:63], v[32:35], v[80:95]
ds_read_b64_tr_b16 v[64:65], v144 offset:4096
ds_read_b64_tr_b16 v[66:67], v144 offset:6144
v_mfma_f32_4x4x4_16b_bf16 v[24:27], v[32:33], v[32:33], v[24:27]
buffer_load_dwordx4 a[100:103], v3, s[12:15], s28 offen offset:1024
s_waitcnt lgkmcnt(14)
v_mfma_f32_32x32x16_bf16 v[96:111], a[60:63], v[36:39], v[96:111]
ds_read_b64_tr_b16 v[68:69], v145 offset:4096
ds_read_b64_tr_b16 v[70:71], v145 offset:6144
s_waitcnt lgkmcnt(14)
v_mfma_f32_32x32x16_bf16 v[112:127], a[60:63], v[40:43], v[112:127]
ds_read_b64_tr_b16 v[72:73], v146 offset:4096
ds_read_b64_tr_b16 v[74:75], v146 offset:6144
v_mfma_f32_4x4x4_16b_bf16 v[28:31], v[34:35], v[34:35], v[28:31]
buffer_load_dwordx4 a[104:107], v3, s[12:15], s28 offen offset:2048
s_waitcnt lgkmcnt(14)
v_mfma_f32_32x32x16_bf16 v[128:143], a[60:63], v[44:47], v[128:143]
ds_read_b64_tr_b16 v[76:77], v147 offset:4096
ds_read_b64_tr_b16 v[78:79], v147 offset:6144
buffer_load_dwordx4 a[108:111], v3, s[12:15], s28 offen offset:3072
s_waitcnt vmcnt(19) lgkmcnt(14)
v_mfma_f32_32x32x16_bf16 v[80:95], a[64:67], v[48:51], v[80:95]
ds_read_b64_tr_b16 v[32:33], v144 offset:8192
ds_read_b64_tr_b16 v[34:35], v144 offset:10240
v_mfma_f32_4x4x4_16b_bf16 v[24:27], v[48:49], v[48:49], v[24:27]
s_waitcnt lgkmcnt(14)
v_mfma_f32_32x32x16_bf16 v[96:111], a[64:67], v[52:55], v[96:111]
ds_read_b64_tr_b16 v[36:37], v145 offset:8192
ds_read_b64_tr_b16 v[38:39], v145 offset:10240
s_add_u32 s27, s24, 1835008
s_add_u32 m0, s26, 114688
s_nop 0
buffer_load_dwordx4 v8, s[16:19], s27 offen lds
s_waitcnt lgkmcnt(14)
v_mfma_f32_32x32x16_bf16 v[112:127], a[64:67], v[56:59], v[112:127]
ds_read_b64_tr_b16 v[40:41], v146 offset:8192
ds_read_b64_tr_b16 v[42:43], v146 offset:10240
v_mfma_f32_4x4x4_16b_bf16 v[28:31], v[50:51], v[50:51], v[28:31]
s_waitcnt lgkmcnt(14)
v_mfma_f32_32x32x16_bf16 v[128:143], a[64:67], v[60:63], v[128:143]
ds_read_b64_tr_b16 v[44:45], v147 offset:8192
ds_read_b64_tr_b16 v[46:47], v147 offset:10240
buffer_load_dwordx4 v9, s[16:19], s27 offen offset:1024 lds
s_waitcnt vmcnt(20) lgkmcnt(14)
v_mfma_f32_32x32x16_bf16 v[80:95], a[68:71], v[64:67], v[80:95]
ds_read_b64_tr_b16 v[48:49], v144 offset:12288
ds_read_b64_tr_b16 v[50:51], v144 offset:14336
v_mfma_f32_4x4x4_16b_bf16 v[24:27], v[64:65], v[64:65], v[24:27]
buffer_load_dwordx4 v10, s[16:19], s27 offen offset:2048 lds
s_waitcnt lgkmcnt(14)
v_mfma_f32_32x32x16_bf16 v[96:111], a[68:71], v[68:71], v[96:111]
ds_read_b64_tr_b16 v[52:53], v145 offset:12288
ds_read_b64_tr_b16 v[54:55], v145 offset:14336
s_waitcnt lgkmcnt(14)
v_mfma_f32_32x32x16_bf16 v[112:127], a[68:71], v[72:75], v[112:127]
ds_read_b64_tr_b16 v[56:57], v146 offset:12288
ds_read_b64_tr_b16 v[58:59], v146 offset:14336
v_mfma_f32_4x4x4_16b_bf16 v[28:31], v[66:67], v[66:67], v[28:31]
buffer_load_dwordx4 v11, s[16:19], s27 offen offset:3072 lds
s_waitcnt lgkmcnt(14)
v_mfma_f32_32x32x16_bf16 v[128:143], a[68:71], v[76:79], v[128:143]
ds_read_b64_tr_b16 v[60:61], v147 offset:12288
ds_read_b64_tr_b16 v[62:63], v147 offset:14336
s_add_u32 s28, s25, 28672
buffer_load_dwordx4 a[112:115], v3, s[12:15], s28 offen offset:0
s_waitcnt vmcnt(22) lgkmcnt(14)
v_mfma_f32_32x32x16_bf16 v[80:95], a[72:75], v[32:35], v[80:95]
s_waitcnt vmcnt(17)
s_barrier
ds_read_b64_tr_b16 v[64:65], v144 offset:16384
ds_read_b64_tr_b16 v[66:67], v144 offset:18432
v_mfma_f32_4x4x4_16b_bf16 v[24:27], v[32:33], v[32:33], v[24:27]
s_waitcnt lgkmcnt(14)
v_mfma_f32_32x32x16_bf16 v[96:111], a[72:75], v[36:39], v[96:111]
ds_read_b64_tr_b16 v[68:69], v145 offset:16384
ds_read_b64_tr_b16 v[70:71], v145 offset:18432
buffer_load_dwordx4 a[116:119], v3, s[12:15], s28 offen offset:1024
s_waitcnt lgkmcnt(14)
v_mfma_f32_32x32x16_bf16 v[112:127], a[72:75], v[40:43], v[112:127]
ds_read_b64_tr_b16 v[72:73], v146 offset:16384
ds_read_b64_tr_b16 v[74:75], v146 offset:18432
v_mfma_f32_4x4x4_16b_bf16 v[28:31], v[34:35], v[34:35], v[28:31]
s_waitcnt lgkmcnt(14)
v_mfma_f32_32x32x16_bf16 v[128:143], a[72:75], v[44:47], v[128:143]
ds_read_b64_tr_b16 v[76:77], v147 offset:16384
ds_read_b64_tr_b16 v[78:79], v147 offset:18432
buffer_load_dwordx4 a[120:123], v3, s[12:15], s28 offen offset:2048
s_waitcnt lgkmcnt(14)
v_mfma_f32_32x32x16_bf16 v[80:95], a[76:79], v[48:51], v[80:95]
ds_read_b64_tr_b16 v[32:33], v144 offset:20480
ds_read_b64_tr_b16 v[34:35], v144 offset:22528
v_mfma_f32_4x4x4_16b_bf16 v[24:27], v[48:49], v[48:49], v[24:27]
buffer_load_dwordx4 a[124:127], v3, s[12:15], s28 offen offset:3072
s_waitcnt lgkmcnt(14)
v_mfma_f32_32x32x16_bf16 v[96:111], a[76:79], v[52:55], v[96:111]
ds_read_b64_tr_b16 v[36:37], v145 offset:20480
ds_read_b64_tr_b16 v[38:39], v145 offset:22528
s_waitcnt lgkmcnt(14)
v_mfma_f32_32x32x16_bf16 v[112:127], a[76:79], v[56:59], v[112:127]
ds_read_b64_tr_b16 v[40:41], v146 offset:20480
ds_read_b64_tr_b16 v[42:43], v146 offset:22528
v_mfma_f32_4x4x4_16b_bf16 v[28:31], v[50:51], v[50:51], v[28:31]
s_add_u32 s27, s24, 2097152
s_add_u32 m0, s26, 0
s_nop 0
buffer_load_dwordx4 v8, s[16:19], s27 offen lds
s_waitcnt lgkmcnt(14)
v_mfma_f32_32x32x16_bf16 v[128:143], a[76:79], v[60:63], v[128:143]
ds_read_b64_tr_b16 v[44:45], v147 offset:20480
ds_read_b64_tr_b16 v[46:47], v147 offset:22528
buffer_load_dwordx4 v9, s[16:19], s27 offen offset:1024 lds
s_waitcnt vmcnt(21) lgkmcnt(14)
v_mfma_f32_32x32x16_bf16 v[80:95], a[80:83], v[64:67], v[80:95]
ds_read_b64_tr_b16 v[48:49], v144 offset:24576
ds_read_b64_tr_b16 v[50:51], v144 offset:26624
v_mfma_f32_4x4x4_16b_bf16 v[24:27], v[64:65], v[64:65], v[24:27]
s_waitcnt lgkmcnt(14)
v_mfma_f32_32x32x16_bf16 v[96:111], a[80:83], v[68:71], v[96:111]
ds_read_b64_tr_b16 v[52:53], v145 offset:24576
ds_read_b64_tr_b16 v[54:55], v145 offset:26624
buffer_load_dwordx4 v10, s[16:19], s27 offen offset:2048 lds
s_waitcnt lgkmcnt(14)
v_mfma_f32_32x32x16_bf16 v[112:127], a[80:83], v[72:75], v[112:127]
ds_read_b64_tr_b16 v[56:57], v146 offset:24576
ds_read_b64_tr_b16 v[58:59], v146 offset:26624
v_mfma_f32_4x4x4_16b_bf16 v[28:31], v[66:67], v[66:67], v[28:31]
s_waitcnt lgkmcnt(14)
v_mfma_f32_32x32x16_bf16 v[128:143], a[80:83], v[76:79], v[128:143]
ds_read_b64_tr_b16 v[60:61], v147 offset:24576
ds_read_b64_tr_b16 v[62:63], v147 offset:26624
buffer_load_dwordx4 v11, s[16:19], s27 offen offset:3072 lds
s_waitcnt vmcnt(22) lgkmcnt(14)
v_mfma_f32_32x32x16_bf16 v[80:95], a[84:87], v[32:35], v[80:95]
ds_read_b64_tr_b16 v[64:65], v144 offset:28672
ds_read_b64_tr_b16 v[66:67], v144 offset:30720
v_mfma_f32_4x4x4_16b_bf16 v[24:27], v[32:33], v[32:33], v[24:27]
s_add_u32 s28, s25, 32768
buffer_load_dwordx4 a[128:131], v3, s[12:15], s28 offen offset:0
s_waitcnt lgkmcnt(14)
v_mfma_f32_32x32x16_bf16 v[96:111], a[84:87], v[36:39], v[96:111]
ds_read_b64_tr_b16 v[68:69], v145 offset:28672
ds_read_b64_tr_b16 v[70:71], v145 offset:30720
s_waitcnt lgkmcnt(14)
v_mfma_f32_32x32x16_bf16 v[112:127], a[84:87], v[40:43], v[112:127]
ds_read_b64_tr_b16 v[72:73], v146 offset:28672
ds_read_b64_tr_b16 v[74:75], v146 offset:30720
v_mfma_f32_4x4x4_16b_bf16 v[28:31], v[34:35], v[34:35], v[28:31]
buffer_load_dwordx4 a[132:135], v3, s[12:15], s28 offen offset:1024
s_waitcnt lgkmcnt(14)
v_mfma_f32_32x32x16_bf16 v[128:143], a[84:87], v[44:47], v[128:143]
ds_read_b64_tr_b16 v[76:77], v147 offset:28672
ds_read_b64_tr_b16 v[78:79], v147 offset:30720
buffer_load_dwordx4 a[136:139], v3, s[12:15], s28 offen offset:2048
s_waitcnt vmcnt(24) lgkmcnt(14)
v_mfma_f32_32x32x16_bf16 v[80:95], a[88:91], v[48:51], v[80:95]
s_waitcnt vmcnt(19)
s_barrier
ds_read_b64_tr_b16 v[32:33], v144 offset:32768
ds_read_b64_tr_b16 v[34:35], v144 offset:34816
v_mfma_f32_4x4x4_16b_bf16 v[24:27], v[48:49], v[48:49], v[24:27]
s_waitcnt lgkmcnt(14)
v_mfma_f32_32x32x16_bf16 v[96:111], a[88:91], v[52:55], v[96:111]
ds_read_b64_tr_b16 v[36:37], v145 offset:32768
ds_read_b64_tr_b16 v[38:39], v145 offset:34816
buffer_load_dwordx4 a[140:143], v3, s[12:15], s28 offen offset:3072
s_waitcnt lgkmcnt(14)
v_mfma_f32_32x32x16_bf16 v[112:127], a[88:91], v[56:59], v[112:127]
ds_read_b64_tr_b16 v[40:41], v146 offset:32768
ds_read_b64_tr_b16 v[42:43], v146 offset:34816
v_mfma_f32_4x4x4_16b_bf16 v[28:31], v[50:51], v[50:51], v[28:31]
s_waitcnt lgkmcnt(14)
v_mfma_f32_32x32x16_bf16 v[128:143], a[88:91], v[60:63], v[128:143]
ds_read_b64_tr_b16 v[44:45], v147 offset:32768
ds_read_b64_tr_b16 v[46:47], v147 offset:34816
s_add_u32 s27, s24, 2359296
s_add_u32 m0, s26, 16384
s_nop 0
buffer_load_dwordx4 v8, s[16:19], s27 offen lds
s_waitcnt lgkmcnt(14)
v_mfma_f32_32x32x16_bf16 v[80:95], a[92:95], v[64:67], v[80:95]
ds_read_b64_tr_b16 v[48:49], v144 offset:36864
ds_read_b64_tr_b16 v[50:51], v144 offset:38912
v_mfma_f32_4x4x4_16b_bf16 v[24:27], v[64:65], v[64:65], v[24:27]
buffer_load_dwordx4 v9, s[16:19], s27 offen offset:1024 lds
s_waitcnt lgkmcnt(14)
v_mfma_f32_32x32x16_bf16 v[96:111], a[92:95], v[68:71], v[96:111]
ds_read_b64_tr_b16 v[52:53], v145 offset:36864
ds_read_b64_tr_b16 v[54:55], v145 offset:38912
s_waitcnt lgkmcnt(14)
v_mfma_f32_32x32x16_bf16 v[112:127], a[92:95], v[72:75], v[112:127]
ds_read_b64_tr_b16 v[56:57], v146 offset:36864
ds_read_b64_tr_b16 v[58:59], v146 offset:38912
v_mfma_f32_4x4x4_16b_bf16 v[28:31], v[66:67], v[66:67], v[28:31]
buffer_load_dwordx4 v10, s[16:19], s27 offen offset:2048 lds
s_waitcnt lgkmcnt(14)
v_mfma_f32_32x32x16_bf16 v[128:143], a[92:95], v[76:79], v[128:143]
ds_read_b64_tr_b16 v[60:61], v147 offset:36864
ds_read_b64_tr_b16 v[62:63], v147 offset:38912
buffer_load_dwordx4 v11, s[16:19], s27 offen offset:3072 lds
s_waitcnt vmcnt(23) lgkmcnt(14)
v_mfma_f32_32x32x16_bf16 v[80:95], a[96:99], v[32:35], v[80:95]
ds_read_b64_tr_b16 v[64:65], v144 offset:40960
ds_read_b64_tr_b16 v[66:67], v144 offset:43008
v_mfma_f32_4x4x4_16b_bf16 v[24:27], v[32:33], v[32:33], v[24:27]
s_waitcnt lgkmcnt(14)
v_mfma_f32_32x32x16_bf16 v[96:111], a[96:99], v[36:39], v[96:111]
ds_read_b64_tr_b16 v[68:69], v145 offset:40960
ds_read_b64_tr_b16 v[70:71], v145 offset:43008
s_add_u32 s28, s25, 36864
buffer_load_dwordx4 a[144:147], v3, s[12:15], s28 offen offset:0
s_waitcnt lgkmcnt(14)
v_mfma_f32_32x32x16_bf16 v[112:127], a[96:99], v[40:43], v[112:127]
ds_read_b64_tr_b16 v[72:73], v146 offset:40960
ds_read_b64_tr_b16 v[74:75], v146 offset:43008
v_mfma_f32_4x4x4_16b_bf16 v[28:31], v[34:35], v[34:35], v[28:31]
s_waitcnt lgkmcnt(14)
v_mfma_f32_32x32x16_bf16 v[128:143], a[96:99], v[44:47], v[128:143]
ds_read_b64_tr_b16 v[76:77], v147 offset:40960
ds_read_b64_tr_b16 v[78:79], v147 offset:43008
buffer_load_dwordx4 a[148:151], v3, s[12:15], s28 offen offset:1024
s_waitcnt vmcnt(24) lgkmcnt(14)
v_mfma_f32_32x32x16_bf16 v[80:95], a[100:103], v[48:51], v[80:95]
ds_read_b64_tr_b16 v[32:33], v144 offset:45056
ds_read_b64_tr_b16 v[34:35], v144 offset:47104
v_mfma_f32_4x4x4_16b_bf16 v[24:27], v[48:49], v[48:49], v[24:27]
buffer_load_dwordx4 a[152:155], v3, s[12:15], s28 offen offset:2048
s_waitcnt lgkmcnt(14)
v_mfma_f32_32x32x16_bf16 v[96:111], a[100:103], v[52:55], v[96:111]
ds_read_b64_tr_b16 v[36:37], v145 offset:45056
ds_read_b64_tr_b16 v[38:39], v145 offset:47104
s_waitcnt lgkmcnt(14)
v_mfma_f32_32x32x16_bf16 v[112:127], a[100:103], v[56:59], v[112:127]
ds_read_b64_tr_b16 v[40:41], v146 offset:45056
ds_read_b64_tr_b16 v[42:43], v146 offset:47104
v_mfma_f32_4x4x4_16b_bf16 v[28:31], v[50:51], v[50:51], v[28:31]
buffer_load_dwordx4 a[156:159], v3, s[12:15], s28 offen offset:3072
s_waitcnt lgkmcnt(14)
v_mfma_f32_32x32x16_bf16 v[128:143], a[100:103], v[60:63], v[128:143]
ds_read_b64_tr_b16 v[44:45], v147 offset:45056
ds_read_b64_tr_b16 v[46:47], v147 offset:47104
s_getpc_b64 s[52:53]
s_add_u32 s52, s52, .Ltext0@rel32@lo+4
s_addc_u32 s53, s53, .Ltext0@rel32@hi+12
s_lshr_b32 s55, s2, 3
s_lshl_b32 s55, s55, 15
v_lshl_add_u32 v17, v0, 7, s55
s_mov_b32 s54, .Ltext1-.Ltext0
s_mov_b32 s55, 0x00020000
buffer_load_dword v18, v17, s[52:55], 0 offen
s_waitcnt vmcnt(26) lgkmcnt(14)
v_mfma_f32_32x32x16_bf16 v[80:95], a[104:107], v[64:67], v[80:95]
s_waitcnt vmcnt(21)
s_barrier
ds_read_b64_tr_b16 v[48:49], v144 offset:49152
ds_read_b64_tr_b16 v[50:51], v144 offset:51200
v_mfma_f32_4x4x4_16b_bf16 v[24:27], v[64:65], v[64:65], v[24:27]
s_waitcnt lgkmcnt(14)
v_mfma_f32_32x32x16_bf16 v[96:111], a[104:107], v[68:71], v[96:111]
ds_read_b64_tr_b16 v[52:53], v144 offset:53248
ds_read_b64_tr_b16 v[54:55], v144 offset:55296
s_waitcnt lgkmcnt(14)
v_mfma_f32_32x32x16_bf16 v[112:127], a[104:107], v[72:75], v[112:127]
ds_read_b64_tr_b16 v[56:57], v144 offset:57344
ds_read_b64_tr_b16 v[58:59], v144 offset:59392
v_mfma_f32_4x4x4_16b_bf16 v[28:31], v[66:67], v[66:67], v[28:31]
s_waitcnt lgkmcnt(14)
v_mfma_f32_32x32x16_bf16 v[128:143], a[104:107], v[76:79], v[128:143]
ds_read_b64_tr_b16 v[60:61], v144 offset:61440
ds_read_b64_tr_b16 v[62:63], v144 offset:63488
s_waitcnt lgkmcnt(14)
v_mfma_f32_32x32x16_bf16 v[80:95], a[108:111], v[32:35], v[80:95]
s_waitcnt vmcnt(13)
s_barrier
ds_read_b64_tr_b16 v[64:65], v12 offset:0
ds_read_b64_tr_b16 v[66:67], v12 offset:2048
v_mfma_f32_4x4x4_16b_bf16 v[24:27], v[32:33], v[32:33], v[24:27]
s_waitcnt lgkmcnt(14)
v_mfma_f32_32x32x16_bf16 v[96:111], a[108:111], v[36:39], v[96:111]
ds_read_b64_tr_b16 v[68:69], v12 offset:4096
ds_read_b64_tr_b16 v[70:71], v12 offset:6144
s_waitcnt lgkmcnt(14)
v_mfma_f32_32x32x16_bf16 v[112:127], a[108:111], v[40:43], v[112:127]
ds_read_b64_tr_b16 v[72:73], v12 offset:8192
ds_read_b64_tr_b16 v[74:75], v12 offset:10240
v_mfma_f32_4x4x4_16b_bf16 v[28:31], v[34:35], v[34:35], v[28:31]
s_waitcnt lgkmcnt(14)
v_mfma_f32_32x32x16_bf16 v[128:143], a[108:111], v[44:47], v[128:143]
ds_read_b64_tr_b16 v[76:77], v12 offset:12288
ds_read_b64_tr_b16 v[78:79], v12 offset:14336
s_waitcnt lgkmcnt(14)
v_mfma_f32_32x32x16_bf16 v[80:95], a[112:115], v[48:51], v[80:95]
s_waitcnt vmcnt(5)
s_barrier
ds_read_b64_tr_b16 v[32:33], v12 offset:16384
ds_read_b64_tr_b16 v[34:35], v12 offset:18432
v_mfma_f32_4x4x4_16b_bf16 v[24:27], v[48:49], v[48:49], v[24:27]
v_mfma_f32_4x4x4_16b_bf16 v[28:31], v[50:51], v[50:51], v[28:31]
s_waitcnt lgkmcnt(14)
v_mfma_f32_32x32x16_bf16 v[80:95], a[116:119], v[52:55], v[80:95]
ds_read_b64_tr_b16 v[36:37], v12 offset:20480
ds_read_b64_tr_b16 v[38:39], v12 offset:22528
v_mfma_f32_4x4x4_16b_bf16 v[24:27], v[52:53], v[52:53], v[24:27]
v_mfma_f32_4x4x4_16b_bf16 v[28:31], v[54:55], v[54:55], v[28:31]
s_waitcnt lgkmcnt(14)
v_mfma_f32_32x32x16_bf16 v[80:95], a[120:123], v[56:59], v[80:95]
ds_read_b64_tr_b16 v[40:41], v12 offset:24576
ds_read_b64_tr_b16 v[42:43], v12 offset:26624
v_mfma_f32_4x4x4_16b_bf16 v[24:27], v[56:57], v[56:57], v[24:27]
v_mfma_f32_4x4x4_16b_bf16 v[28:31], v[58:59], v[58:59], v[28:31]
s_waitcnt lgkmcnt(14)
v_mfma_f32_32x32x16_bf16 v[80:95], a[124:127], v[60:63], v[80:95]
ds_read_b64_tr_b16 v[44:45], v12 offset:28672
ds_read_b64_tr_b16 v[46:47], v12 offset:30720
v_mfma_f32_4x4x4_16b_bf16 v[24:27], v[60:61], v[60:61], v[24:27]
v_mfma_f32_4x4x4_16b_bf16 v[28:31], v[62:63], v[62:63], v[28:31]
s_waitcnt lgkmcnt(14)
v_mfma_f32_32x32x16_bf16 v[80:95], a[128:131], v[64:67], v[80:95]
ds_read_b64_tr_b16 v[48:49], v145 offset:49152
ds_read_b64_tr_b16 v[50:51], v145 offset:51200
v_mfma_f32_4x4x4_16b_bf16 v[24:27], v[64:65], v[64:65], v[24:27]
v_mfma_f32_4x4x4_16b_bf16 v[28:31], v[66:67], v[66:67], v[28:31]
s_waitcnt lgkmcnt(14)
v_mfma_f32_32x32x16_bf16 v[80:95], a[132:135], v[68:71], v[80:95]
ds_read_b64_tr_b16 v[52:53], v146 offset:49152
ds_read_b64_tr_b16 v[54:55], v146 offset:51200
v_mfma_f32_4x4x4_16b_bf16 v[24:27], v[68:69], v[68:69], v[24:27]
v_mfma_f32_4x4x4_16b_bf16 v[28:31], v[70:71], v[70:71], v[28:31]
s_waitcnt lgkmcnt(14)
v_mfma_f32_32x32x16_bf16 v[80:95], a[136:139], v[72:75], v[80:95]
ds_read_b64_tr_b16 v[56:57], v145 offset:53248
ds_read_b64_tr_b16 v[58:59], v145 offset:55296
v_mfma_f32_4x4x4_16b_bf16 v[24:27], v[72:73], v[72:73], v[24:27]
v_mfma_f32_4x4x4_16b_bf16 v[28:31], v[74:75], v[74:75], v[28:31]
s_waitcnt lgkmcnt(14)
v_mfma_f32_32x32x16_bf16 v[80:95], a[140:143], v[76:79], v[80:95]
ds_read_b64_tr_b16 v[60:61], v146 offset:53248
ds_read_b64_tr_b16 v[62:63], v146 offset:55296
v_mfma_f32_4x4x4_16b_bf16 v[24:27], v[76:77], v[76:77], v[24:27]
v_mfma_f32_4x4x4_16b_bf16 v[28:31], v[78:79], v[78:79], v[28:31]
s_waitcnt vmcnt(4) lgkmcnt(14)
v_mfma_f32_32x32x16_bf16 v[80:95], a[144:147], v[32:35], v[80:95]
ds_read_b64_tr_b16 v[64:65], v145 offset:57344
ds_read_b64_tr_b16 v[66:67], v145 offset:59392
v_mfma_f32_4x4x4_16b_bf16 v[24:27], v[32:33], v[32:33], v[24:27]
v_mfma_f32_4x4x4_16b_bf16 v[28:31], v[34:35], v[34:35], v[28:31]
s_waitcnt vmcnt(3) lgkmcnt(14)
v_mfma_f32_32x32x16_bf16 v[80:95], a[148:151], v[36:39], v[80:95]
ds_read_b64_tr_b16 v[68:69], v146 offset:57344
ds_read_b64_tr_b16 v[70:71], v146 offset:59392
v_mfma_f32_4x4x4_16b_bf16 v[24:27], v[36:37], v[36:37], v[24:27]
v_mfma_f32_4x4x4_16b_bf16 v[28:31], v[38:39], v[38:39], v[28:31]
s_waitcnt vmcnt(2) lgkmcnt(14)
v_mfma_f32_32x32x16_bf16 v[80:95], a[152:155], v[40:43], v[80:95]
ds_read_b64_tr_b16 v[72:73], v145 offset:61440
ds_read_b64_tr_b16 v[74:75], v145 offset:63488
v_mfma_f32_4x4x4_16b_bf16 v[24:27], v[40:41], v[40:41], v[24:27]
v_mfma_f32_4x4x4_16b_bf16 v[28:31], v[42:43], v[42:43], v[28:31]
s_waitcnt vmcnt(1) lgkmcnt(14)
v_mfma_f32_32x32x16_bf16 v[80:95], a[156:159], v[44:47], v[80:95]
ds_read_b64_tr_b16 v[76:77], v146 offset:61440
ds_read_b64_tr_b16 v[78:79], v146 offset:63488
v_mfma_f32_4x4x4_16b_bf16 v[24:27], v[44:45], v[44:45], v[24:27]
v_mfma_f32_4x4x4_16b_bf16 v[28:31], v[46:47], v[46:47], v[28:31]
s_waitcnt lgkmcnt(14)
v_mfma_f32_32x32x16_bf16 v[96:111], a[112:115], v[48:51], v[96:111]
ds_read_b64_tr_b16 v[32:33], v13 offset:0
ds_read_b64_tr_b16 v[34:35], v13 offset:2048
s_waitcnt lgkmcnt(14)
v_mfma_f32_32x32x16_bf16 v[112:127], a[112:115], v[52:55], v[112:127]
ds_read_b64_tr_b16 v[36:37], v14 offset:0
ds_read_b64_tr_b16 v[38:39], v14 offset:2048
v_add_f32 v24, v24, v28
v_add_f32 v25, v25, v29
v_add_f32 v26, v26, v30
v_add_f32 v27, v27, v31
v_cmp_eq_u32 vcc, 1, v23
s_nop 1
v_cndmask_b32 v24, v24, v25, vcc
v_cmp_eq_u32 vcc, 2, v23
s_nop 1
v_cndmask_b32 v24, v24, v26, vcc
v_cmp_eq_u32 vcc, 3, v23
s_nop 1
v_cndmask_b32 v24, v24, v27, vcc
s_waitcnt lgkmcnt(14)
v_mfma_f32_32x32x16_bf16 v[96:111], a[116:119], v[56:59], v[96:111]
ds_read_b64_tr_b16 v[40:41], v13 offset:4096
ds_read_b64_tr_b16 v[42:43], v13 offset:6144
v_mov_b32 v25, v24
s_nop 1
v_permlane32_swap_b32 v24, v25
v_add_f32 v24, v24, v25
v_mov_b32 v25, 0x3727c5ac
v_fmamk_f32 v24, v24, 0x3acccccd, v25
v_rsq_f32 v24, v24
s_nop 0
ds_write_b32 v22, v24
s_waitcnt lgkmcnt(15)
v_mfma_f32_32x32x16_bf16 v[112:127], a[116:119], v[60:63], v[112:127]
ds_read_b64_tr_b16 v[44:45], v14 offset:4096
ds_read_b64_tr_b16 v[46:47], v14 offset:6144
s_waitcnt lgkmcnt(15)
v_mfma_f32_32x32x16_bf16 v[96:111], a[120:123], v[64:67], v[96:111]
ds_read_b64_tr_b16 v[48:49], v13 offset:8192
ds_read_b64_tr_b16 v[50:51], v13 offset:10240
s_waitcnt vmcnt(0) lgkmcnt(4)
s_barrier
ds_read_b32 v192, v148
ds_read_b32 v194, v149
ds_read_b32 v196, v150
ds_read_b32 v198, v151
v_mfma_f32_32x32x16_bf16 v[112:127], a[120:123], v[68:71], v[112:127]
ds_read_b64_tr_b16 v[52:53], v14 offset:8192
ds_read_b64_tr_b16 v[54:55], v14 offset:10240
v_mfma_f32_32x32x16_bf16 v[96:111], a[124:127], v[72:75], v[96:111]
ds_read_b64_tr_b16 v[56:57], v13 offset:12288
ds_read_b64_tr_b16 v[58:59], v13 offset:14336
v_mfma_f32_32x32x16_bf16 v[112:127], a[124:127], v[76:79], v[112:127]
ds_read_b64_tr_b16 v[60:61], v14 offset:12288
ds_read_b64_tr_b16 v[62:63], v14 offset:14336
s_waitcnt lgkmcnt(9)
v_pk_mul_f32 v[80:81], v[80:81], v[192:193] op_sel_hi:[1,0]
v_pk_mul_f32 v[82:83], v[82:83], v[192:193] op_sel_hi:[1,0]
v_mfma_f32_32x32x16_bf16 v[96:111], a[128:131], v[32:35], v[96:111]
ds_read_b64_tr_b16 v[64:65], v13 offset:16384
ds_read_b64_tr_b16 v[66:67], v13 offset:18432
v_pk_mul_f32 v[84:85], v[84:85], v[192:193] op_sel_hi:[1,0]
v_pk_mul_f32 v[86:87], v[86:87], v[192:193] op_sel_hi:[1,0]
v_pk_mul_f32 v[88:89], v[88:89], v[192:193] op_sel_hi:[1,0]
v_mfma_f32_32x32x16_bf16 v[112:127], a[128:131], v[36:39], v[112:127]
ds_read_b64_tr_b16 v[68:69], v14 offset:16384
ds_read_b64_tr_b16 v[70:71], v14 offset:18432
v_pk_mul_f32 v[90:91], v[90:91], v[192:193] op_sel_hi:[1,0]
v_pk_mul_f32 v[92:93], v[92:93], v[192:193] op_sel_hi:[1,0]
v_pk_mul_f32 v[94:95], v[94:95], v[192:193] op_sel_hi:[1,0]
v_mfma_f32_32x32x16_bf16 v[96:111], a[132:135], v[40:43], v[96:111]
ds_read_b64_tr_b16 v[72:73], v13 offset:20480
ds_read_b64_tr_b16 v[74:75], v13 offset:22528
v_cvt_pk_bf16_f32 v152, v80, v81
v_cvt_pk_bf16_f32 v153, v82, v83
v_cvt_pk_bf16_f32 v154, v84, v85
v_mfma_f32_32x32x16_bf16 v[112:127], a[132:135], v[44:47], v[112:127]
ds_read_b64_tr_b16 v[76:77], v147 offset:49152
ds_read_b64_tr_b16 v[78:79], v147 offset:51200
v_cvt_pk_bf16_f32 v155, v86, v87
v_cvt_pk_bf16_f32 v156, v88, v89
v_cvt_pk_bf16_f32 v157, v90, v91
s_waitcnt lgkmcnt(15)
v_mfma_f32_32x32x16_bf16 v[96:111], a[136:139], v[48:51], v[96:111]
ds_read_b64_tr_b16 v[32:33], v13 offset:24576
ds_read_b64_tr_b16 v[34:35], v13 offset:26624
v_cvt_pk_bf16_f32 v158, v92, v93
v_cvt_pk_bf16_f32 v159, v94, v95
s_cmp_ge_u32 s31, 16
s_cbranch_scc1 .Lqkv_four5
buffer_store_dwordx4 v[152:155], v3, s[16:19], s48 offen sc1
s_add_u32 s36, s48, s32
buffer_store_dwordx4 v[156:159], v3, s[16:19], s36 offen sc1
s_cmp_eq_u32 s31, s31
s_cbranch_scc1 .Lqkv_j6
.Lqkv_four5:
buffer_store_dwordx2 v[152:153], v16, s[16:19], s48 offen sc1
s_add_u32 s48, s48, s33
buffer_store_dwordx2 v[154:155], v16, s[16:19], s48 offen sc1
s_add_u32 s48, s48, s33
buffer_store_dwordx2 v[156:157], v16, s[16:19], s48 offen sc1
s_add_u32 s48, s48, s33
buffer_store_dwordx2 v[158:159], v16, s[16:19], s48 offen sc1
.Lqkv_j6:
s_waitcnt lgkmcnt(14)
v_mfma_f32_32x32x16_bf16 v[112:127], a[136:139], v[52:55], v[112:127]
ds_read_b64_tr_b16 v[36:37], v147 offset:53248
ds_read_b64_tr_b16 v[38:39], v147 offset:55296
s_waitcnt lgkmcnt(14)
v_mfma_f32_32x32x16_bf16 v[96:111], a[140:143], v[56:59], v[96:111]
ds_read_b64_tr_b16 v[40:41], v13 offset:28672
ds_read_b64_tr_b16 v[42:43], v13 offset:30720
s_waitcnt lgkmcnt(14)
v_mfma_f32_32x32x16_bf16 v[112:127], a[140:143], v[60:63], v[112:127]
ds_read_b64_tr_b16 v[44:45], v147 offset:57344
ds_read_b64_tr_b16 v[46:47], v147 offset:59392
s_waitcnt lgkmcnt(14)
v_mfma_f32_32x32x16_bf16 v[96:111], a[144:147], v[64:67], v[96:111]
ds_read_b64_tr_b16 v[48:49], v14 offset:20480
ds_read_b64_tr_b16 v[50:51], v14 offset:22528
s_waitcnt lgkmcnt(14)
v_mfma_f32_32x32x16_bf16 v[112:127], a[144:147], v[68:71], v[112:127]
ds_read_b64_tr_b16 v[52:53], v147 offset:61440
ds_read_b64_tr_b16 v[54:55], v147 offset:63488
s_waitcnt lgkmcnt(14)
v_mfma_f32_32x32x16_bf16 v[96:111], a[148:151], v[72:75], v[96:111]
ds_read_b64_tr_b16 v[56:57], v14 offset:24576
ds_read_b64_tr_b16 v[58:59], v14 offset:26624
s_waitcnt lgkmcnt(14)
v_mfma_f32_32x32x16_bf16 v[128:143], a[112:115], v[76:79], v[128:143]
ds_read_b64_tr_b16 v[60:61], v15 offset:0
ds_read_b64_tr_b16 v[62:63], v15 offset:2048
s_waitcnt lgkmcnt(14)
v_mfma_f32_32x32x16_bf16 v[96:111], a[152:155], v[32:35], v[96:111]
ds_read_b64_tr_b16 v[64:65], v14 offset:28672
ds_read_b64_tr_b16 v[66:67], v14 offset:30720
s_waitcnt lgkmcnt(14)
v_mfma_f32_32x32x16_bf16 v[128:143], a[116:119], v[36:39], v[128:143]
ds_read_b64_tr_b16 v[68:69], v15 offset:4096
ds_read_b64_tr_b16 v[70:71], v15 offset:6144
s_waitcnt lgkmcnt(14)
v_mfma_f32_32x32x16_bf16 v[96:111], a[156:159], v[40:43], v[96:111]
ds_read_b64_tr_b16 v[72:73], v15 offset:8192
ds_read_b64_tr_b16 v[74:75], v15 offset:10240
s_waitcnt lgkmcnt(14)
v_mfma_f32_32x32x16_bf16 v[128:143], a[120:123], v[44:47], v[128:143]
ds_read_b64_tr_b16 v[76:77], v15 offset:12288
ds_read_b64_tr_b16 v[78:79], v15 offset:14336
s_waitcnt lgkmcnt(14)
v_mfma_f32_32x32x16_bf16 v[112:127], a[148:151], v[48:51], v[112:127]
ds_read_b64_tr_b16 v[32:33], v15 offset:16384
ds_read_b64_tr_b16 v[34:35], v15 offset:18432
s_waitcnt lgkmcnt(14)
v_mfma_f32_32x32x16_bf16 v[128:143], a[124:127], v[52:55], v[128:143]
ds_read_b64_tr_b16 v[36:37], v15 offset:20480
ds_read_b64_tr_b16 v[38:39], v15 offset:22528
s_waitcnt lgkmcnt(15)
v_pk_mul_f32 v[96:97], v[96:97], v[194:195] op_sel_hi:[1,0]
v_pk_mul_f32 v[98:99], v[98:99], v[194:195] op_sel_hi:[1,0]
s_waitcnt lgkmcnt(14)
v_mfma_f32_32x32x16_bf16 v[112:127], a[152:155], v[56:59], v[112:127]
ds_read_b64_tr_b16 v[40:41], v15 offset:24576
ds_read_b64_tr_b16 v[42:43], v15 offset:26624
v_pk_mul_f32 v[100:101], v[100:101], v[194:195] op_sel_hi:[1,0]
v_pk_mul_f32 v[102:103], v[102:103], v[194:195] op_sel_hi:[1,0]
v_pk_mul_f32 v[104:105], v[104:105], v[194:195] op_sel_hi:[1,0]
s_waitcnt lgkmcnt(14)
v_mfma_f32_32x32x16_bf16 v[128:143], a[128:131], v[60:63], v[128:143]
ds_read_b64_tr_b16 v[44:45], v15 offset:28672
ds_read_b64_tr_b16 v[46:47], v15 offset:30720
v_pk_mul_f32 v[106:107], v[106:107], v[194:195] op_sel_hi:[1,0]
v_pk_mul_f32 v[108:109], v[108:109], v[194:195] op_sel_hi:[1,0]
v_pk_mul_f32 v[110:111], v[110:111], v[194:195] op_sel_hi:[1,0]
s_waitcnt lgkmcnt(14)
v_mfma_f32_32x32x16_bf16 v[112:127], a[156:159], v[64:67], v[112:127]
v_cvt_pk_bf16_f32 v160, v96, v97
v_cvt_pk_bf16_f32 v161, v98, v99
v_cvt_pk_bf16_f32 v162, v100, v101
s_waitcnt lgkmcnt(12)
v_mfma_f32_32x32x16_bf16 v[128:143], a[132:135], v[68:71], v[128:143]
v_cvt_pk_bf16_f32 v163, v102, v103
v_cvt_pk_bf16_f32 v164, v104, v105
v_cvt_pk_bf16_f32 v165, v106, v107
s_waitcnt lgkmcnt(10)
v_mfma_f32_32x32x16_bf16 v[128:143], a[136:139], v[72:75], v[128:143]
v_cvt_pk_bf16_f32 v166, v108, v109
v_cvt_pk_bf16_f32 v167, v110, v111
s_cmp_ge_u32 s31, 16
s_cbranch_scc1 .Lqkv_four7
buffer_store_dwordx4 v[160:163], v3, s[16:19], s49 offen sc1
s_add_u32 s36, s49, s32
buffer_store_dwordx4 v[164:167], v3, s[16:19], s36 offen sc1
s_cmp_eq_u32 s31, s31
s_cbranch_scc1 .Lqkv_j8
.Lqkv_four7:
buffer_store_dwordx2 v[160:161], v16, s[16:19], s49 offen sc1
s_add_u32 s49, s49, s33
buffer_store_dwordx2 v[162:163], v16, s[16:19], s49 offen sc1
s_add_u32 s49, s49, s33
buffer_store_dwordx2 v[164:165], v16, s[16:19], s49 offen sc1
s_add_u32 s49, s49, s33
buffer_store_dwordx2 v[166:167], v16, s[16:19], s49 offen sc1
.Lqkv_j8:
s_waitcnt lgkmcnt(8)
v_mfma_f32_32x32x16_bf16 v[128:143], a[140:143], v[76:79], v[128:143]
v_pk_mul_f32 v[112:113], v[112:113], v[196:197] op_sel_hi:[1,0]
v_pk_mul_f32 v[114:115], v[114:115], v[196:197] op_sel_hi:[1,0]
s_waitcnt lgkmcnt(6)
v_mfma_f32_32x32x16_bf16 v[128:143], a[144:147], v[32:35], v[128:143]
v_pk_mul_f32 v[116:117], v[116:117], v[196:197] op_sel_hi:[1,0]
v_pk_mul_f32 v[118:119], v[118:119], v[196:197] op_sel_hi:[1,0]
v_pk_mul_f32 v[120:121], v[120:121], v[196:197] op_sel_hi:[1,0]
s_waitcnt lgkmcnt(4)
v_mfma_f32_32x32x16_bf16 v[128:143], a[148:151], v[36:39], v[128:143]
v_pk_mul_f32 v[122:123], v[122:123], v[196:197] op_sel_hi:[1,0]
v_pk_mul_f32 v[124:125], v[124:125], v[196:197] op_sel_hi:[1,0]
v_pk_mul_f32 v[126:127], v[126:127], v[196:197] op_sel_hi:[1,0]
s_waitcnt lgkmcnt(2)
v_mfma_f32_32x32x16_bf16 v[128:143], a[152:155], v[40:43], v[128:143]
v_cvt_pk_bf16_f32 v168, v112, v113
v_cvt_pk_bf16_f32 v169, v114, v115
v_cvt_pk_bf16_f32 v170, v116, v117
s_waitcnt lgkmcnt(0)
v_mfma_f32_32x32x16_bf16 v[128:143], a[156:159], v[44:47], v[128:143]
v_cvt_pk_bf16_f32 v171, v118, v119
v_cvt_pk_bf16_f32 v172, v120, v121
v_cvt_pk_bf16_f32 v173, v122, v123
v_cvt_pk_bf16_f32 v174, v124, v125
v_cvt_pk_bf16_f32 v175, v126, v127
s_cmp_ge_u32 s31, 16
s_cbranch_scc1 .Lqkv_four9
buffer_store_dwordx4 v[168:171], v3, s[16:19], s50 offen sc1
s_add_u32 s36, s50, s32
buffer_store_dwordx4 v[172:175], v3, s[16:19], s36 offen sc1
s_cmp_eq_u32 s31, s31
s_cbranch_scc1 .Lqkv_j10
.Lqkv_four9:
buffer_store_dwordx2 v[168:169], v16, s[16:19], s50 offen sc1
s_add_u32 s50, s50, s33
buffer_store_dwordx2 v[170:171], v16, s[16:19], s50 offen sc1
s_add_u32 s50, s50, s33
buffer_store_dwordx2 v[172:173], v16, s[16:19], s50 offen sc1
s_add_u32 s50, s50, s33
buffer_store_dwordx2 v[174:175], v16, s[16:19], s50 offen sc1
.Lqkv_j10:
v_pk_mul_f32 v[128:129], v[128:129], v[198:199] op_sel_hi:[1,0]
v_pk_mul_f32 v[130:131], v[130:131], v[198:199] op_sel_hi:[1,0]
v_pk_mul_f32 v[132:133], v[132:133], v[198:199] op_sel_hi:[1,0]
v_pk_mul_f32 v[134:135], v[134:135], v[198:199] op_sel_hi:[1,0]
v_pk_mul_f32 v[136:137], v[136:137], v[198:199] op_sel_hi:[1,0]
v_pk_mul_f32 v[138:139], v[138:139], v[198:199] op_sel_hi:[1,0]
v_pk_mul_f32 v[140:141], v[140:141], v[198:199] op_sel_hi:[1,0]
v_pk_mul_f32 v[142:143], v[142:143], v[198:199] op_sel_hi:[1,0]
v_cvt_pk_bf16_f32 v176, v128, v129
v_cvt_pk_bf16_f32 v177, v130, v131
v_cvt_pk_bf16_f32 v178, v132, v133
v_cvt_pk_bf16_f32 v179, v134, v135
v_cvt_pk_bf16_f32 v180, v136, v137
v_cvt_pk_bf16_f32 v181, v138, v139
v_cvt_pk_bf16_f32 v182, v140, v141
v_cvt_pk_bf16_f32 v183, v142, v143
s_cmp_ge_u32 s31, 16
s_cbranch_scc1 .Lqkv_four11
buffer_store_dwordx4 v[176:179], v3, s[16:19], s51 offen sc1
s_add_u32 s36, s51, s32
buffer_store_dwordx4 v[180:183], v3, s[16:19], s36 offen sc1
s_cmp_eq_u32 s31, s31
s_cbranch_scc1 .Lqkv_j12
.Lqkv_four11:
buffer_store_dwordx2 v[176:177], v16, s[16:19], s51 offen sc1
s_add_u32 s51, s51, s33
buffer_store_dwordx2 v[178:179], v16, s[16:19], s51 offen sc1
s_add_u32 s51, s51, s33
buffer_store_dwordx2 v[180:181], v16, s[16:19], s51 offen sc1
s_add_u32 s51, s51, s33
buffer_store_dwordx2 v[182:183], v16, s[16:19], s51 offen sc1
.Lqkv_j12:
s_endpgm
.Lqkv_v4:
s_sub_u32 s31, s23, 40
s_lshl_b32 s31, s31, 5
v_and_b32 v16, 31, v2
v_add_u32 v16, s31, v16
v_mul_u32_u24 v17, 3277, v16
v_lshrrev_b32 v17, 16, v17
v_mul_u32_u24 v18, 20, v17
v_sub_u32 v18, v16, v18
v_mul_u32_u24 v17, 163840, v17
v_mad_u32_u24 v18, v7, 20, v18
v_lshl_add_u32 v16, v18, 4, v17
s_mov_b32 s33, 13109760
s_movk_i32 s35, 5120
s_movk_i32 s34, 1280
s_lshl_b32 s36, s20, 1
s_lshr_b32 s37, s40, 1
s_add_u32 s36, s36, s37
s_mul_i32 s36, s36, s35
s_and_b32 s37, s40, 1
s_mul_i32 s37, s37, s34
s_add_u32 s36, s36, s37
s_add_u32 s48, s36, s33
s_lshl_b32 s36, s20, 1
s_lshr_b32 s37, s41, 1
s_add_u32 s36, s36, s37
s_mul_i32 s36, s36, s35
s_and_b32 s37, s41, 1
s_mul_i32 s37, s37, s34
s_add_u32 s36, s36, s37
s_add_u32 s49, s36, s33
s_lshl_b32 s36, s20, 1
s_lshr_b32 s37, s42, 1
s_add_u32 s36, s36, s37
s_mul_i32 s36, s36, s35
s_and_b32 s37, s42, 1
s_mul_i32 s37, s37, s34
s_add_u32 s36, s36, s37
s_add_u32 s50, s36, s33
s_lshl_b32 s36, s20, 1
s_lshr_b32 s37, s43, 1
s_add_u32 s36, s36, s37
s_mul_i32 s36, s36, s35
s_and_b32 s37, s43, 1
s_mul_i32 s37, s37, s34
s_add_u32 s36, s36, s37
s_add_u32 s51, s36, s33
s_lshl_b32 s27, s40, 7
s_add_u32 s27, s27, 131072
v_lshl_add_u32 v148, v7, 4, s27
s_lshl_b32 s27, s41, 7
s_add_u32 s27, s27, 131072
v_lshl_add_u32 v149, v7, 4, s27
s_lshl_b32 s27, s42, 7
s_add_u32 s27, s27, 131072
v_lshl_add_u32 v150, v7, 4, s27
s_lshl_b32 s27, s43, 7
s_add_u32 s27, s27, 131072
v_lshl_add_u32 v151, v7, 4, s27
s_waitcnt vmcnt(12)
s_barrier
ds_read_b64_tr_b16 v[32:33], v12 offset:0
ds_read_b64_tr_b16 v[34:35], v12 offset:2048
ds_read_b64_tr_b16 v[36:37], v13 offset:0
ds_read_b64_tr_b16 v[38:39], v13 offset:2048
ds_read_b64_tr_b16 v[40:41], v14 offset:0
ds_read_b64_tr_b16 v[42:43], v14 offset:2048
ds_read_b64_tr_b16 v[44:45], v15 offset:0
ds_read_b64_tr_b16 v[46:47], v15 offset:2048
ds_read_b64_tr_b16 v[48:49], v12 offset:4096
ds_read_b64_tr_b16 v[50:51], v12 offset:6144
ds_read_b64_tr_b16 v[52:53], v13 offset:4096
ds_read_b64_tr_b16 v[54:55], v13 offset:6144
ds_read_b64_tr_b16 v[56:57], v14 offset:4096
ds_read_b64_tr_b16 v[58:59], v14 offset:6144
ds_read_b64_tr_b16 v[60:61], v15 offset:4096
ds_read_b64_tr_b16 v[62:63], v15 offset:6144
s_waitcnt vmcnt(11) lgkmcnt(14)
v_mfma_f32_32x32x16_bf16 v[80:95], v[32:35], a[0:3], 0
ds_read_b64_tr_b16 v[64:65], v12 offset:8192
ds_read_b64_tr_b16 v[66:67], v12 offset:10240
v_mfma_f32_4x4x4_16b_bf16 v[24:27], v[32:33], v[32:33], v[24:27]
s_waitcnt lgkmcnt(14)
v_mfma_f32_32x32x16_bf16 v[96:111], v[36:39], a[0:3], 0
ds_read_b64_tr_b16 v[68:69], v13 offset:8192
ds_read_b64_tr_b16 v[70:71], v13 offset:10240
s_add_u32 s27, s24, 524288
s_add_u32 m0, s26, 32768
s_nop 0
buffer_load_dwordx4 v8, s[16:19], s27 offen lds
s_waitcnt lgkmcnt(14)
v_mfma_f32_32x32x16_bf16 v[112:127], v[40:43], a[0:3], 0
ds_read_b64_tr_b16 v[72:73], v14 offset:8192
ds_read_b64_tr_b16 v[74:75], v14 offset:10240
v_mfma_f32_4x4x4_16b_bf16 v[28:31], v[34:35], v[34:35], v[28:31]
s_waitcnt lgkmcnt(14)
v_mfma_f32_32x32x16_bf16 v[128:143], v[44:47], a[0:3], 0
ds_read_b64_tr_b16 v[76:77], v15 offset:8192
ds_read_b64_tr_b16 v[78:79], v15 offset:10240
buffer_load_dwordx4 v9, s[16:19], s27 offen offset:1024 lds
s_waitcnt vmcnt(12) lgkmcnt(14)
v_mfma_f32_32x32x16_bf16 v[80:95], v[48:51], a[4:7], v[80:95]
ds_read_b64_tr_b16 v[32:33], v12 offset:12288
ds_read_b64_tr_b16 v[34:35], v12 offset:14336
v_mfma_f32_4x4x4_16b_bf16 v[24:27], v[48:49], v[48:49], v[24:27]
buffer_load_dwordx4 v10, s[16:19], s27 offen offset:2048 lds
s_waitcnt lgkmcnt(14)
v_mfma_f32_32x32x16_bf16 v[96:111], v[52:55], a[4:7], v[96:111]
ds_read_b64_tr_b16 v[36:37], v13 offset:12288
ds_read_b64_tr_b16 v[38:39], v13 offset:14336
s_waitcnt lgkmcnt(14)
v_mfma_f32_32x32x16_bf16 v[112:127], v[56:59], a[4:7], v[112:127]
ds_read_b64_tr_b16 v[40:41], v14 offset:12288
ds_read_b64_tr_b16 v[42:43], v14 offset:14336
v_mfma_f32_4x4x4_16b_bf16 v[28:31], v[50:51], v[50:51], v[28:31]
buffer_load_dwordx4 v11, s[16:19], s27 offen offset:3072 lds
s_waitcnt lgkmcnt(14)
v_mfma_f32_32x32x16_bf16 v[128:143], v[60:63], a[4:7], v[128:143]
ds_read_b64_tr_b16 v[44:45], v15 offset:12288
ds_read_b64_tr_b16 v[46:47], v15 offset:14336
s_add_u32 s28, s25, 8192
buffer_load_dwordx4 a[32:35], v3, s[12:15], s28 offen offset:0
s_waitcnt vmcnt(14) lgkmcnt(14)
v_mfma_f32_32x32x16_bf16 v[80:95], v[64:67], a[8:11], v[80:95]
s_waitcnt vmcnt(9)
s_barrier
ds_read_b64_tr_b16 v[48:49], v12 offset:16384
ds_read_b64_tr_b16 v[50:51], v12 offset:18432
v_mfma_f32_4x4x4_16b_bf16 v[24:27], v[64:65], v[64:65], v[24:27]
s_waitcnt lgkmcnt(14)
v_mfma_f32_32x32x16_bf16 v[96:111], v[68:71], a[8:11], v[96:111]
ds_read_b64_tr_b16 v[52:53], v13 offset:16384
ds_read_b64_tr_b16 v[54:55], v13 offset:18432
buffer_load_dwordx4 a[36:39], v3, s[12:15], s28 offen offset:1024
s_waitcnt lgkmcnt(14)
v_mfma_f32_32x32x16_bf16 v[112:127], v[72:75], a[8:11], v[112:127]
ds_read_b64_tr_b16 v[56:57], v14 offset:16384
ds_read_b64_tr_b16 v[58:59], v14 offset:18432
v_mfma_f32_4x4x4_16b_bf16 v[28:31], v[66:67], v[66:67], v[28:31]
s_waitcnt lgkmcnt(14)
v_mfma_f32_32x32x16_bf16 v[128:143], v[76:79], a[8:11], v[128:143]
ds_read_b64_tr_b16 v[60:61], v15 offset:16384
ds_read_b64_tr_b16 v[62:63], v15 offset:18432
buffer_load_dwordx4 a[40:43], v3, s[12:15], s28 offen offset:2048
s_waitcnt lgkmcnt(14)
v_mfma_f32_32x32x16_bf16 v[80:95], v[32:35], a[12:15], v[80:95]
ds_read_b64_tr_b16 v[64:65], v12 offset:20480
ds_read_b64_tr_b16 v[66:67], v12 offset:22528
v_mfma_f32_4x4x4_16b_bf16 v[24:27], v[32:33], v[32:33], v[24:27]
buffer_load_dwordx4 a[44:47], v3, s[12:15], s28 offen offset:3072
s_waitcnt lgkmcnt(14)
v_mfma_f32_32x32x16_bf16 v[96:111], v[36:39], a[12:15], v[96:111]
ds_read_b64_tr_b16 v[68:69], v13 offset:20480
ds_read_b64_tr_b16 v[70:71], v13 offset:22528
s_waitcnt lgkmcnt(14)
v_mfma_f32_32x32x16_bf16 v[112:127], v[40:43], a[12:15], v[112:127]
ds_read_b64_tr_b16 v[72:73], v14 offset:20480
ds_read_b64_tr_b16 v[74:75], v14 offset:22528
v_mfma_f32_4x4x4_16b_bf16 v[28:31], v[34:35], v[34:35], v[28:31]
s_add_u32 s27, s24, 786432
s_add_u32 m0, s26, 49152
s_nop 0
buffer_load_dwordx4 v8, s[16:19], s27 offen lds
s_waitcnt lgkmcnt(14)
v_mfma_f32_32x32x16_bf16 v[128:143], v[44:47], a[12:15], v[128:143]
ds_read_b64_tr_b16 v[76:77], v15 offset:20480
ds_read_b64_tr_b16 v[78:79], v15 offset:22528
buffer_load_dwordx4 v9, s[16:19], s27 offen offset:1024 lds
s_waitcnt vmcnt(13) lgkmcnt(14)
v_mfma_f32_32x32x16_bf16 v[80:95], v[48:51], a[16:19], v[80:95]
ds_read_b64_tr_b16 v[32:33], v12 offset:24576
ds_read_b64_tr_b16 v[34:35], v12 offset:26624
v_mfma_f32_4x4x4_16b_bf16 v[24:27], v[48:49], v[48:49], v[24:27]
s_waitcnt lgkmcnt(14)
v_mfma_f32_32x32x16_bf16 v[96:111], v[52:55], a[16:19], v[96:111]
ds_read_b64_tr_b16 v[36:37], v13 offset:24576
ds_read_b64_tr_b16 v[38:39], v13 offset:26624
buffer_load_dwordx4 v10, s[16:19], s27 offen offset:2048 lds
s_waitcnt lgkmcnt(14)
v_mfma_f32_32x32x16_bf16 v[112:127], v[56:59], a[16:19], v[112:127]
ds_read_b64_tr_b16 v[40:41], v14 offset:24576
ds_read_b64_tr_b16 v[42:43], v14 offset:26624
v_mfma_f32_4x4x4_16b_bf16 v[28:31], v[50:51], v[50:51], v[28:31]
s_waitcnt lgkmcnt(14)
v_mfma_f32_32x32x16_bf16 v[128:143], v[60:63], a[16:19], v[128:143]
ds_read_b64_tr_b16 v[44:45], v15 offset:24576
ds_read_b64_tr_b16 v[46:47], v15 offset:26624
buffer_load_dwordx4 v11, s[16:19], s27 offen offset:3072 lds
s_waitcnt vmcnt(14) lgkmcnt(14)
v_mfma_f32_32x32x16_bf16 v[80:95], v[64:67], a[20:23], v[80:95]
ds_read_b64_tr_b16 v[48:49], v12 offset:28672
ds_read_b64_tr_b16 v[50:51], v12 offset:30720
v_mfma_f32_4x4x4_16b_bf16 v[24:27], v[64:65], v[64:65], v[24:27]
s_add_u32 s28, s25, 12288
buffer_load_dwordx4 a[48:51], v3, s[12:15], s28 offen offset:0
s_waitcnt lgkmcnt(14)
v_mfma_f32_32x32x16_bf16 v[96:111], v[68:71], a[20:23], v[96:111]
ds_read_b64_tr_b16 v[52:53], v13 offset:28672
ds_read_b64_tr_b16 v[54:55], v13 offset:30720
s_waitcnt lgkmcnt(14)
v_mfma_f32_32x32x16_bf16 v[112:127], v[72:75], a[20:23], v[112:127]
ds_read_b64_tr_b16 v[56:57], v14 offset:28672
ds_read_b64_tr_b16 v[58:59], v14 offset:30720
v_mfma_f32_4x4x4_16b_bf16 v[28:31], v[66:67], v[66:67], v[28:31]
buffer_load_dwordx4 a[52:55], v3, s[12:15], s28 offen offset:1024
s_waitcnt lgkmcnt(14)
v_mfma_f32_32x32x16_bf16 v[128:143], v[76:79], a[20:23], v[128:143]
ds_read_b64_tr_b16 v[60:61], v15 offset:28672
ds_read_b64_tr_b16 v[62:63], v15 offset:30720
buffer_load_dwordx4 a[56:59], v3, s[12:15], s28 offen offset:2048
s_waitcnt vmcnt(16) lgkmcnt(14)
v_mfma_f32_32x32x16_bf16 v[80:95], v[32:35], a[24:27], v[80:95]
s_waitcnt vmcnt(11)
s_barrier
ds_read_b64_tr_b16 v[64:65], v12 offset:32768
ds_read_b64_tr_b16 v[66:67], v12 offset:34816
v_mfma_f32_4x4x4_16b_bf16 v[24:27], v[32:33], v[32:33], v[24:27]
s_waitcnt lgkmcnt(14)
v_mfma_f32_32x32x16_bf16 v[96:111], v[36:39], a[24:27], v[96:111]
ds_read_b64_tr_b16 v[68:69], v13 offset:32768
ds_read_b64_tr_b16 v[70:71], v13 offset:34816
buffer_load_dwordx4 a[60:63], v3, s[12:15], s28 offen offset:3072
s_waitcnt lgkmcnt(14)
v_mfma_f32_32x32x16_bf16 v[112:127], v[40:43], a[24:27], v[112:127]
ds_read_b64_tr_b16 v[72:73], v14 offset:32768
ds_read_b64_tr_b16 v[74:75], v14 offset:34816
v_mfma_f32_4x4x4_16b_bf16 v[28:31], v[34:35], v[34:35], v[28:31]
s_waitcnt lgkmcnt(14)
v_mfma_f32_32x32x16_bf16 v[128:143], v[44:47], a[24:27], v[128:143]
ds_read_b64_tr_b16 v[76:77], v15 offset:32768
ds_read_b64_tr_b16 v[78:79], v15 offset:34816
s_add_u32 s27, s24, 1048576
s_add_u32 m0, s26, 65536
s_nop 0
buffer_load_dwordx4 v8, s[16:19], s27 offen lds
s_waitcnt lgkmcnt(14)
v_mfma_f32_32x32x16_bf16 v[80:95], v[48:51], a[28:31], v[80:95]
ds_read_b64_tr_b16 v[32:33], v12 offset:36864
ds_read_b64_tr_b16 v[34:35], v12 offset:38912
v_mfma_f32_4x4x4_16b_bf16 v[24:27], v[48:49], v[48:49], v[24:27]
buffer_load_dwordx4 v9, s[16:19], s27 offen offset:1024 lds
s_waitcnt lgkmcnt(14)
v_mfma_f32_32x32x16_bf16 v[96:111], v[52:55], a[28:31], v[96:111]
ds_read_b64_tr_b16 v[36:37], v13 offset:36864
ds_read_b64_tr_b16 v[38:39], v13 offset:38912
s_waitcnt lgkmcnt(14)
v_mfma_f32_32x32x16_bf16 v[112:127], v[56:59], a[28:31], v[112:127]
ds_read_b64_tr_b16 v[40:41], v14 offset:36864
ds_read_b64_tr_b16 v[42:43], v14 offset:38912
v_mfma_f32_4x4x4_16b_bf16 v[28:31], v[50:51], v[50:51], v[28:31]
buffer_load_dwordx4 v10, s[16:19], s27 offen offset:2048 lds
s_waitcnt lgkmcnt(14)
v_mfma_f32_32x32x16_bf16 v[128:143], v[60:63], a[28:31], v[128:143]
ds_read_b64_tr_b16 v[44:45], v15 offset:36864
ds_read_b64_tr_b16 v[46:47], v15 offset:38912
buffer_load_dwordx4 v11, s[16:19], s27 offen offset:3072 lds
s_waitcnt vmcnt(15) lgkmcnt(14)
v_mfma_f32_32x32x16_bf16 v[80:95], v[64:67], a[32:35], v[80:95]
ds_read_b64_tr_b16 v[48:49], v12 offset:40960
ds_read_b64_tr_b16 v[50:51], v12 offset:43008
v_mfma_f32_4x4x4_16b_bf16 v[24:27], v[64:65], v[64:65], v[24:27]
s_waitcnt lgkmcnt(14)
v_mfma_f32_32x32x16_bf16 v[96:111], v[68:71], a[32:35], v[96:111]
ds_read_b64_tr_b16 v[52:53], v13 offset:40960
ds_read_b64_tr_b16 v[54:55], v13 offset:43008
s_add_u32 s28, s25, 16384
buffer_load_dwordx4 a[64:67], v3, s[12:15], s28 offen offset:0
s_waitcnt lgkmcnt(14)
v_mfma_f32_32x32x16_bf16 v[112:127], v[72:75], a[32:35], v[112:127]
ds_read_b64_tr_b16 v[56:57], v14 offset:40960
ds_read_b64_tr_b16 v[58:59], v14 offset:43008
v_mfma_f32_4x4x4_16b_bf16 v[28:31], v[66:67], v[66:67], v[28:31]
s_waitcnt lgkmcnt(14)
v_mfma_f32_32x32x16_bf16 v[128:143], v[76:79], a[32:35], v[128:143]
ds_read_b64_tr_b16 v[60:61], v15 offset:40960
ds_read_b64_tr_b16 v[62:63], v15 offset:43008
buffer_load_dwordx4 a[68:71], v3, s[12:15], s28 offen offset:1024
s_waitcnt vmcnt(16) lgkmcnt(14)
v_mfma_f32_32x32x16_bf16 v[80:95], v[32:35], a[36:39], v[80:95]
ds_read_b64_tr_b16 v[64:65], v12 offset:45056
ds_read_b64_tr_b16 v[66:67], v12 offset:47104
v_mfma_f32_4x4x4_16b_bf16 v[24:27], v[32:33], v[32:33], v[24:27]
buffer_load_dwordx4 a[72:75], v3, s[12:15], s28 offen offset:2048
s_waitcnt lgkmcnt(14)
v_mfma_f32_32x32x16_bf16 v[96:111], v[36:39], a[36:39], v[96:111]
ds_read_b64_tr_b16 v[68:69], v13 offset:45056
ds_read_b64_tr_b16 v[70:71], v13 offset:47104
s_waitcnt lgkmcnt(14)
v_mfma_f32_32x32x16_bf16 v[112:127], v[40:43], a[36:39], v[112:127]
ds_read_b64_tr_b16 v[72:73], v14 offset:45056
ds_read_b64_tr_b16 v[74:75], v14 offset:47104
v_mfma_f32_4x4x4_16b_bf16 v[28:31], v[34:35], v[34:35], v[28:31]
buffer_load_dwordx4 a[76:79], v3, s[12:15], s28 offen offset:3072
s_waitcnt lgkmcnt(14)
v_mfma_f32_32x32x16_bf16 v[128:143], v[44:47], a[36:39], v[128:143]
ds_read_b64_tr_b16 v[76:77], v15 offset:45056
ds_read_b64_tr_b16 v[78:79], v15 offset:47104
s_add_u32 s27, s24, 1310720
s_add_u32 m0, s26, 81920
s_nop 0
buffer_load_dwordx4 v8, s[16:19], s27 offen lds
s_waitcnt vmcnt(18) lgkmcnt(14)
v_mfma_f32_32x32x16_bf16 v[80:95], v[48:51], a[40:43], v[80:95]
s_waitcnt vmcnt(13)
s_barrier
ds_read_b64_tr_b16 v[32:33], v12 offset:49152
ds_read_b64_tr_b16 v[34:35], v12 offset:51200
v_mfma_f32_4x4x4_16b_bf16 v[24:27], v[48:49], v[48:49], v[24:27]
s_waitcnt lgkmcnt(14)
v_mfma_f32_32x32x16_bf16 v[96:111], v[52:55], a[40:43], v[96:111]
ds_read_b64_tr_b16 v[36:37], v13 offset:49152
ds_read_b64_tr_b16 v[38:39], v13 offset:51200
buffer_load_dwordx4 v9, s[16:19], s27 offen offset:1024 lds
s_waitcnt lgkmcnt(14)
v_mfma_f32_32x32x16_bf16 v[112:127], v[56:59], a[40:43], v[112:127]
ds_read_b64_tr_b16 v[40:41], v14 offset:49152
ds_read_b64_tr_b16 v[42:43], v14 offset:51200
v_mfma_f32_4x4x4_16b_bf16 v[28:31], v[50:51], v[50:51], v[28:31]
s_waitcnt lgkmcnt(14)
v_mfma_f32_32x32x16_bf16 v[128:143], v[60:63], a[40:43], v[128:143]
ds_read_b64_tr_b16 v[44:45], v15 offset:49152
ds_read_b64_tr_b16 v[46:47], v15 offset:51200
buffer_load_dwordx4 v10, s[16:19], s27 offen offset:2048 lds
s_waitcnt lgkmcnt(14)
v_mfma_f32_32x32x16_bf16 v[80:95], v[64:67], a[44:47], v[80:95]
ds_read_b64_tr_b16 v[48:49], v12 offset:53248
ds_read_b64_tr_b16 v[50:51], v12 offset:55296
v_mfma_f32_4x4x4_16b_bf16 v[24:27], v[64:65], v[64:65], v[24:27]
buffer_load_dwordx4 v11, s[16:19], s27 offen offset:3072 lds
s_waitcnt lgkmcnt(14)
v_mfma_f32_32x32x16_bf16 v[96:111], v[68:71], a[44:47], v[96:111]
ds_read_b64_tr_b16 v[52:53], v13 offset:53248
ds_read_b64_tr_b16 v[54:55], v13 offset:55296
s_waitcnt lgkmcnt(14)
v_mfma_f32_32x32x16_bf16 v[112:127], v[72:75], a[44:47], v[112:127]
ds_read_b64_tr_b16 v[56:57], v14 offset:53248
ds_read_b64_tr_b16 v[58:59], v14 offset:55296
v_mfma_f32_4x4x4_16b_bf16 v[28:31], v[66:67], v[66:67], v[28:31]
s_add_u32 s28, s25, 20480
buffer_load_dwordx4 a[80:83], v3, s[12:15], s28 offen offset:0
s_waitcnt lgkmcnt(14)
v_mfma_f32_32x32x16_bf16 v[128:143], v[76:79], a[44:47], v[128:143]
ds_read_b64_tr_b16 v[60:61], v15 offset:53248
ds_read_b64_tr_b16 v[62:63], v15 offset:55296
buffer_load_dwordx4 a[84:87], v3, s[12:15], s28 offen offset:1024
s_waitcnt vmcnt(17) lgkmcnt(14)
v_mfma_f32_32x32x16_bf16 v[80:95], v[32:35], a[48:51], v[80:95]
ds_read_b64_tr_b16 v[64:65], v12 offset:57344
ds_read_b64_tr_b16 v[66:67], v12 offset:59392
v_mfma_f32_4x4x4_16b_bf16 v[24:27], v[32:33], v[32:33], v[24:27]
s_waitcnt lgkmcnt(14)
v_mfma_f32_32x32x16_bf16 v[96:111], v[36:39], a[48:51], v[96:111]
ds_read_b64_tr_b16 v[68:69], v13 offset:57344
ds_read_b64_tr_b16 v[70:71], v13 offset:59392
buffer_load_dwordx4 a[88:91], v3, s[12:15], s28 offen offset:2048
s_waitcnt lgkmcnt(14)
v_mfma_f32_32x32x16_bf16 v[112:127], v[40:43], a[48:51], v[112:127]
ds_read_b64_tr_b16 v[72:73], v14 offset:57344
ds_read_b64_tr_b16 v[74:75], v14 offset:59392
v_mfma_f32_4x4x4_16b_bf16 v[28:31], v[34:35], v[34:35], v[28:31]
s_waitcnt lgkmcnt(14)
v_mfma_f32_32x32x16_bf16 v[128:143], v[44:47], a[48:51], v[128:143]
ds_read_b64_tr_b16 v[76:77], v15 offset:57344
ds_read_b64_tr_b16 v[78:79], v15 offset:59392
buffer_load_dwordx4 a[92:95], v3, s[12:15], s28 offen offset:3072
s_waitcnt vmcnt(18) lgkmcnt(14)
v_mfma_f32_32x32x16_bf16 v[80:95], v[48:51], a[52:55], v[80:95]
ds_read_b64_tr_b16 v[32:33], v12 offset:61440
ds_read_b64_tr_b16 v[34:35], v12 offset:63488
v_mfma_f32_4x4x4_16b_bf16 v[24:27], v[48:49], v[48:49], v[24:27]
s_add_u32 s27, s24, 1572864
s_add_u32 m0, s26, 98304
s_nop 0
buffer_load_dwordx4 v8, s[16:19], s27 offen lds
s_waitcnt lgkmcnt(14)
v_mfma_f32_32x32x16_bf16 v[96:111], v[52:55], a[52:55], v[96:111]
ds_read_b64_tr_b16 v[36:37], v13 offset:61440
ds_read_b64_tr_b16 v[38:39], v13 offset:63488
s_waitcnt lgkmcnt(14)
v_mfma_f32_32x32x16_bf16 v[112:127], v[56:59], a[52:55], v[112:127]
ds_read_b64_tr_b16 v[40:41], v14 offset:61440
ds_read_b64_tr_b16 v[42:43], v14 offset:63488
v_mfma_f32_4x4x4_16b_bf16 v[28:31], v[50:51], v[50:51], v[28:31]
buffer_load_dwordx4 v9, s[16:19], s27 offen offset:1024 lds
s_waitcnt lgkmcnt(14)
v_mfma_f32_32x32x16_bf16 v[128:143], v[60:63], a[52:55], v[128:143]
ds_read_b64_tr_b16 v[44:45], v15 offset:61440
ds_read_b64_tr_b16 v[46:47], v15 offset:63488
buffer_load_dwordx4 v10, s[16:19], s27 offen offset:2048 lds
s_waitcnt vmcnt(20) lgkmcnt(14)
v_mfma_f32_32x32x16_bf16 v[80:95], v[64:67], a[56:59], v[80:95]
s_waitcnt vmcnt(15)
s_barrier
ds_read_b64_tr_b16 v[48:49], v144 offset:0
ds_read_b64_tr_b16 v[50:51], v144 offset:2048
v_mfma_f32_4x4x4_16b_bf16 v[24:27], v[64:65], v[64:65], v[24:27]
s_waitcnt lgkmcnt(14)
v_mfma_f32_32x32x16_bf16 v[96:111], v[68:71], a[56:59], v[96:111]
ds_read_b64_tr_b16 v[52:53], v145 offset:0
ds_read_b64_tr_b16 v[54:55], v145 offset:2048
buffer_load_dwordx4 v11, s[16:19], s27 offen offset:3072 lds
s_waitcnt lgkmcnt(14)
v_mfma_f32_32x32x16_bf16 v[112:127], v[72:75], a[56:59], v[112:127]
ds_read_b64_tr_b16 v[56:57], v146 offset:0
ds_read_b64_tr_b16 v[58:59], v146 offset:2048
v_mfma_f32_4x4x4_16b_bf16 v[28:31], v[66:67], v[66:67], v[28:31]
s_waitcnt lgkmcnt(14)
v_mfma_f32_32x32x16_bf16 v[128:143], v[76:79], a[56:59], v[128:143]
ds_read_b64_tr_b16 v[60:61], v147 offset:0
ds_read_b64_tr_b16 v[62:63], v147 offset:2048
s_add_u32 s28, s25, 24576
buffer_load_dwordx4 a[96:99], v3, s[12:15], s28 offen offset:0
s_waitcnt lgkmcnt(14)
v_mfma_f32_32x32x16_bf16 v[80:95], v[32:35], a[60:63], v[80:95]
ds_read_b64_tr_b16 v[64:65], v144 offset:4096
ds_read_b64_tr_b16 v[66:67], v144 offset:6144
v_mfma_f32_4x4x4_16b_bf16 v[24:27], v[32:33], v[32:33], v[24:27]
buffer_load_dwordx4 a[100:103], v3, s[12:15], s28 offen offset:1024
s_waitcnt lgkmcnt(14)
v_mfma_f32_32x32x16_bf16 v[96:111], v[36:39], a[60:63], v[96:111]
ds_read_b64_tr_b16 v[68:69], v145 offset:4096
ds_read_b64_tr_b16 v[70:71], v145 offset:6144
s_waitcnt lgkmcnt(14)
v_mfma_f32_32x32x16_bf16 v[112:127], v[40:43], a[60:63], v[112:127]
ds_read_b64_tr_b16 v[72:73], v146 offset:4096
ds_read_b64_tr_b16 v[74:75], v146 offset:6144
v_mfma_f32_4x4x4_16b_bf16 v[28:31], v[34:35], v[34:35], v[28:31]
buffer_load_dwordx4 a[104:107], v3, s[12:15], s28 offen offset:2048
s_waitcnt lgkmcnt(14)
v_mfma_f32_32x32x16_bf16 v[128:143], v[44:47], a[60:63], v[128:143]
ds_read_b64_tr_b16 v[76:77], v147 offset:4096
ds_read_b64_tr_b16 v[78:79], v147 offset:6144
buffer_load_dwordx4 a[108:111], v3, s[12:15], s28 offen offset:3072
s_waitcnt vmcnt(19) lgkmcnt(14)
v_mfma_f32_32x32x16_bf16 v[80:95], v[48:51], a[64:67], v[80:95]
ds_read_b64_tr_b16 v[32:33], v144 offset:8192
ds_read_b64_tr_b16 v[34:35], v144 offset:10240
v_mfma_f32_4x4x4_16b_bf16 v[24:27], v[48:49], v[48:49], v[24:27]
s_waitcnt lgkmcnt(14)
v_mfma_f32_32x32x16_bf16 v[96:111], v[52:55], a[64:67], v[96:111]
ds_read_b64_tr_b16 v[36:37], v145 offset:8192
ds_read_b64_tr_b16 v[38:39], v145 offset:10240
s_add_u32 s27, s24, 1835008
s_add_u32 m0, s26, 114688
s_nop 0
buffer_load_dwordx4 v8, s[16:19], s27 offen lds
s_waitcnt lgkmcnt(14)
v_mfma_f32_32x32x16_bf16 v[112:127], v[56:59], a[64:67], v[112:127]
ds_read_b64_tr_b16 v[40:41], v146 offset:8192
ds_read_b64_tr_b16 v[42:43], v146 offset:10240
v_mfma_f32_4x4x4_16b_bf16 v[28:31], v[50:51], v[50:51], v[28:31]
s_waitcnt lgkmcnt(14)
v_mfma_f32_32x32x16_bf16 v[128:143], v[60:63], a[64:67], v[128:143]
ds_read_b64_tr_b16 v[44:45], v147 offset:8192
ds_read_b64_tr_b16 v[46:47], v147 offset:10240
buffer_load_dwordx4 v9, s[16:19], s27 offen offset:1024 lds
s_waitcnt vmcnt(20) lgkmcnt(14)
v_mfma_f32_32x32x16_bf16 v[80:95], v[64:67], a[68:71], v[80:95]
ds_read_b64_tr_b16 v[48:49], v144 offset:12288
ds_read_b64_tr_b16 v[50:51], v144 offset:14336
v_mfma_f32_4x4x4_16b_bf16 v[24:27], v[64:65], v[64:65], v[24:27]
buffer_load_dwordx4 v10, s[16:19], s27 offen offset:2048 lds
s_waitcnt lgkmcnt(14)
v_mfma_f32_32x32x16_bf16 v[96:111], v[68:71], a[68:71], v[96:111]
ds_read_b64_tr_b16 v[52:53], v145 offset:12288
ds_read_b64_tr_b16 v[54:55], v145 offset:14336
s_waitcnt lgkmcnt(14)
v_mfma_f32_32x32x16_bf16 v[112:127], v[72:75], a[68:71], v[112:127]
ds_read_b64_tr_b16 v[56:57], v146 offset:12288
ds_read_b64_tr_b16 v[58:59], v146 offset:14336
v_mfma_f32_4x4x4_16b_bf16 v[28:31], v[66:67], v[66:67], v[28:31]
buffer_load_dwordx4 v11, s[16:19], s27 offen offset:3072 lds
s_waitcnt lgkmcnt(14)
v_mfma_f32_32x32x16_bf16 v[128:143], v[76:79], a[68:71], v[128:143]
ds_read_b64_tr_b16 v[60:61], v147 offset:12288
ds_read_b64_tr_b16 v[62:63], v147 offset:14336
s_add_u32 s28, s25, 28672
buffer_load_dwordx4 a[112:115], v3, s[12:15], s28 offen offset:0
s_waitcnt vmcnt(22) lgkmcnt(14)
v_mfma_f32_32x32x16_bf16 v[80:95], v[32:35], a[72:75], v[80:95]
s_waitcnt vmcnt(17)
s_barrier
ds_read_b64_tr_b16 v[64:65], v144 offset:16384
ds_read_b64_tr_b16 v[66:67], v144 offset:18432
v_mfma_f32_4x4x4_16b_bf16 v[24:27], v[32:33], v[32:33], v[24:27]
s_waitcnt lgkmcnt(14)
v_mfma_f32_32x32x16_bf16 v[96:111], v[36:39], a[72:75], v[96:111]
ds_read_b64_tr_b16 v[68:69], v145 offset:16384
ds_read_b64_tr_b16 v[70:71], v145 offset:18432
buffer_load_dwordx4 a[116:119], v3, s[12:15], s28 offen offset:1024
s_waitcnt lgkmcnt(14)
v_mfma_f32_32x32x16_bf16 v[112:127], v[40:43], a[72:75], v[112:127]
ds_read_b64_tr_b16 v[72:73], v146 offset:16384
ds_read_b64_tr_b16 v[74:75], v146 offset:18432
v_mfma_f32_4x4x4_16b_bf16 v[28:31], v[34:35], v[34:35], v[28:31]
s_waitcnt lgkmcnt(14)
v_mfma_f32_32x32x16_bf16 v[128:143], v[44:47], a[72:75], v[128:143]
ds_read_b64_tr_b16 v[76:77], v147 offset:16384
ds_read_b64_tr_b16 v[78:79], v147 offset:18432
buffer_load_dwordx4 a[120:123], v3, s[12:15], s28 offen offset:2048
s_waitcnt lgkmcnt(14)
v_mfma_f32_32x32x16_bf16 v[80:95], v[48:51], a[76:79], v[80:95]
ds_read_b64_tr_b16 v[32:33], v144 offset:20480
ds_read_b64_tr_b16 v[34:35], v144 offset:22528
v_mfma_f32_4x4x4_16b_bf16 v[24:27], v[48:49], v[48:49], v[24:27]
buffer_load_dwordx4 a[124:127], v3, s[12:15], s28 offen offset:3072
s_waitcnt lgkmcnt(14)
v_mfma_f32_32x32x16_bf16 v[96:111], v[52:55], a[76:79], v[96:111]
ds_read_b64_tr_b16 v[36:37], v145 offset:20480
ds_read_b64_tr_b16 v[38:39], v145 offset:22528
s_waitcnt lgkmcnt(14)
v_mfma_f32_32x32x16_bf16 v[112:127], v[56:59], a[76:79], v[112:127]
ds_read_b64_tr_b16 v[40:41], v146 offset:20480
ds_read_b64_tr_b16 v[42:43], v146 offset:22528
v_mfma_f32_4x4x4_16b_bf16 v[28:31], v[50:51], v[50:51], v[28:31]
s_add_u32 s27, s24, 2097152
s_add_u32 m0, s26, 0
s_nop 0
buffer_load_dwordx4 v8, s[16:19], s27 offen lds
s_waitcnt lgkmcnt(14)
v_mfma_f32_32x32x16_bf16 v[128:143], v[60:63], a[76:79], v[128:143]
ds_read_b64_tr_b16 v[44:45], v147 offset:20480
ds_read_b64_tr_b16 v[46:47], v147 offset:22528
buffer_load_dwordx4 v9, s[16:19], s27 offen offset:1024 lds
s_waitcnt vmcnt(21) lgkmcnt(14)
v_mfma_f32_32x32x16_bf16 v[80:95], v[64:67], a[80:83], v[80:95]
ds_read_b64_tr_b16 v[48:49], v144 offset:24576
ds_read_b64_tr_b16 v[50:51], v144 offset:26624
v_mfma_f32_4x4x4_16b_bf16 v[24:27], v[64:65], v[64:65], v[24:27]
s_waitcnt lgkmcnt(14)
v_mfma_f32_32x32x16_bf16 v[96:111], v[68:71], a[80:83], v[96:111]
ds_read_b64_tr_b16 v[52:53], v145 offset:24576
ds_read_b64_tr_b16 v[54:55], v145 offset:26624
buffer_load_dwordx4 v10, s[16:19], s27 offen offset:2048 lds
s_waitcnt lgkmcnt(14)
v_mfma_f32_32x32x16_bf16 v[112:127], v[72:75], a[80:83], v[112:127]
ds_read_b64_tr_b16 v[56:57], v146 offset:24576
ds_read_b64_tr_b16 v[58:59], v146 offset:26624
v_mfma_f32_4x4x4_16b_bf16 v[28:31], v[66:67], v[66:67], v[28:31]
s_waitcnt lgkmcnt(14)
v_mfma_f32_32x32x16_bf16 v[128:143], v[76:79], a[80:83], v[128:143]
ds_read_b64_tr_b16 v[60:61], v147 offset:24576
ds_read_b64_tr_b16 v[62:63], v147 offset:26624
buffer_load_dwordx4 v11, s[16:19], s27 offen offset:3072 lds
s_waitcnt vmcnt(22) lgkmcnt(14)
v_mfma_f32_32x32x16_bf16 v[80:95], v[32:35], a[84:87], v[80:95]
ds_read_b64_tr_b16 v[64:65], v144 offset:28672
ds_read_b64_tr_b16 v[66:67], v144 offset:30720
v_mfma_f32_4x4x4_16b_bf16 v[24:27], v[32:33], v[32:33], v[24:27]
s_add_u32 s28, s25, 32768
buffer_load_dwordx4 a[128:131], v3, s[12:15], s28 offen offset:0
s_waitcnt lgkmcnt(14)
v_mfma_f32_32x32x16_bf16 v[96:111], v[36:39], a[84:87], v[96:111]
ds_read_b64_tr_b16 v[68:69], v145 offset:28672
ds_read_b64_tr_b16 v[70:71], v145 offset:30720
s_waitcnt lgkmcnt(14)
v_mfma_f32_32x32x16_bf16 v[112:127], v[40:43], a[84:87], v[112:127]
ds_read_b64_tr_b16 v[72:73], v146 offset:28672
ds_read_b64_tr_b16 v[74:75], v146 offset:30720
v_mfma_f32_4x4x4_16b_bf16 v[28:31], v[34:35], v[34:35], v[28:31]
buffer_load_dwordx4 a[132:135], v3, s[12:15], s28 offen offset:1024
s_waitcnt lgkmcnt(14)
v_mfma_f32_32x32x16_bf16 v[128:143], v[44:47], a[84:87], v[128:143]
ds_read_b64_tr_b16 v[76:77], v147 offset:28672
ds_read_b64_tr_b16 v[78:79], v147 offset:30720
buffer_load_dwordx4 a[136:139], v3, s[12:15], s28 offen offset:2048
s_waitcnt vmcnt(24) lgkmcnt(14)
v_mfma_f32_32x32x16_bf16 v[80:95], v[48:51], a[88:91], v[80:95]
s_waitcnt vmcnt(19)
s_barrier
ds_read_b64_tr_b16 v[32:33], v144 offset:32768
ds_read_b64_tr_b16 v[34:35], v144 offset:34816
v_mfma_f32_4x4x4_16b_bf16 v[24:27], v[48:49], v[48:49], v[24:27]
s_waitcnt lgkmcnt(14)
v_mfma_f32_32x32x16_bf16 v[96:111], v[52:55], a[88:91], v[96:111]
ds_read_b64_tr_b16 v[36:37], v145 offset:32768
ds_read_b64_tr_b16 v[38:39], v145 offset:34816
buffer_load_dwordx4 a[140:143], v3, s[12:15], s28 offen offset:3072
s_waitcnt lgkmcnt(14)
v_mfma_f32_32x32x16_bf16 v[112:127], v[56:59], a[88:91], v[112:127]
ds_read_b64_tr_b16 v[40:41], v146 offset:32768
ds_read_b64_tr_b16 v[42:43], v146 offset:34816
v_mfma_f32_4x4x4_16b_bf16 v[28:31], v[50:51], v[50:51], v[28:31]
s_waitcnt lgkmcnt(14)
v_mfma_f32_32x32x16_bf16 v[128:143], v[60:63], a[88:91], v[128:143]
ds_read_b64_tr_b16 v[44:45], v147 offset:32768
ds_read_b64_tr_b16 v[46:47], v147 offset:34816
s_add_u32 s27, s24, 2359296
s_add_u32 m0, s26, 16384
s_nop 0
buffer_load_dwordx4 v8, s[16:19], s27 offen lds
s_waitcnt lgkmcnt(14)
v_mfma_f32_32x32x16_bf16 v[80:95], v[64:67], a[92:95], v[80:95]
ds_read_b64_tr_b16 v[48:49], v144 offset:36864
ds_read_b64_tr_b16 v[50:51], v144 offset:38912
v_mfma_f32_4x4x4_16b_bf16 v[24:27], v[64:65], v[64:65], v[24:27]
buffer_load_dwordx4 v9, s[16:19], s27 offen offset:1024 lds
s_waitcnt lgkmcnt(14)
v_mfma_f32_32x32x16_bf16 v[96:111], v[68:71], a[92:95], v[96:111]
ds_read_b64_tr_b16 v[52:53], v145 offset:36864
ds_read_b64_tr_b16 v[54:55], v145 offset:38912
s_waitcnt lgkmcnt(14)
v_mfma_f32_32x32x16_bf16 v[112:127], v[72:75], a[92:95], v[112:127]
ds_read_b64_tr_b16 v[56:57], v146 offset:36864
ds_read_b64_tr_b16 v[58:59], v146 offset:38912
v_mfma_f32_4x4x4_16b_bf16 v[28:31], v[66:67], v[66:67], v[28:31]
buffer_load_dwordx4 v10, s[16:19], s27 offen offset:2048 lds
s_waitcnt lgkmcnt(14)
v_mfma_f32_32x32x16_bf16 v[128:143], v[76:79], a[92:95], v[128:143]
ds_read_b64_tr_b16 v[60:61], v147 offset:36864
ds_read_b64_tr_b16 v[62:63], v147 offset:38912
buffer_load_dwordx4 v11, s[16:19], s27 offen offset:3072 lds
s_waitcnt vmcnt(23) lgkmcnt(14)
v_mfma_f32_32x32x16_bf16 v[80:95], v[32:35], a[96:99], v[80:95]
ds_read_b64_tr_b16 v[64:65], v144 offset:40960
ds_read_b64_tr_b16 v[66:67], v144 offset:43008
v_mfma_f32_4x4x4_16b_bf16 v[24:27], v[32:33], v[32:33], v[24:27]
s_waitcnt lgkmcnt(14)
v_mfma_f32_32x32x16_bf16 v[96:111], v[36:39], a[96:99], v[96:111]
ds_read_b64_tr_b16 v[68:69], v145 offset:40960
ds_read_b64_tr_b16 v[70:71], v145 offset:43008
s_add_u32 s28, s25, 36864
buffer_load_dwordx4 a[144:147], v3, s[12:15], s28 offen offset:0
s_waitcnt lgkmcnt(14)
v_mfma_f32_32x32x16_bf16 v[112:127], v[40:43], a[96:99], v[112:127]
ds_read_b64_tr_b16 v[72:73], v146 offset:40960
ds_read_b64_tr_b16 v[74:75], v146 offset:43008
v_mfma_f32_4x4x4_16b_bf16 v[28:31], v[34:35], v[34:35], v[28:31]
s_waitcnt lgkmcnt(14)
v_mfma_f32_32x32x16_bf16 v[128:143], v[44:47], a[96:99], v[128:143]
ds_read_b64_tr_b16 v[76:77], v147 offset:40960
ds_read_b64_tr_b16 v[78:79], v147 offset:43008
buffer_load_dwordx4 a[148:151], v3, s[12:15], s28 offen offset:1024
s_waitcnt vmcnt(24) lgkmcnt(14)
v_mfma_f32_32x32x16_bf16 v[80:95], v[48:51], a[100:103], v[80:95]
ds_read_b64_tr_b16 v[32:33], v144 offset:45056
ds_read_b64_tr_b16 v[34:35], v144 offset:47104
v_mfma_f32_4x4x4_16b_bf16 v[24:27], v[48:49], v[48:49], v[24:27]
buffer_load_dwordx4 a[152:155], v3, s[12:15], s28 offen offset:2048
s_waitcnt lgkmcnt(14)
v_mfma_f32_32x32x16_bf16 v[96:111], v[52:55], a[100:103], v[96:111]
ds_read_b64_tr_b16 v[36:37], v145 offset:45056
ds_read_b64_tr_b16 v[38:39], v145 offset:47104
s_waitcnt lgkmcnt(14)
v_mfma_f32_32x32x16_bf16 v[112:127], v[56:59], a[100:103], v[112:127]
ds_read_b64_tr_b16 v[40:41], v146 offset:45056
ds_read_b64_tr_b16 v[42:43], v146 offset:47104
v_mfma_f32_4x4x4_16b_bf16 v[28:31], v[50:51], v[50:51], v[28:31]
buffer_load_dwordx4 a[156:159], v3, s[12:15], s28 offen offset:3072
s_waitcnt lgkmcnt(14)
v_mfma_f32_32x32x16_bf16 v[128:143], v[60:63], a[100:103], v[128:143]
ds_read_b64_tr_b16 v[44:45], v147 offset:45056
ds_read_b64_tr_b16 v[46:47], v147 offset:47104
s_getpc_b64 s[52:53]
s_add_u32 s52, s52, .Ltext0@rel32@lo+4
s_addc_u32 s53, s53, .Ltext0@rel32@hi+12
s_lshr_b32 s55, s2, 3
s_lshl_b32 s55, s55, 15
v_lshl_add_u32 v17, v0, 7, s55
s_mov_b32 s54, .Ltext1-.Ltext0
s_mov_b32 s55, 0x00020000
buffer_load_dword v18, v17, s[52:55], 0 offen
s_waitcnt vmcnt(26) lgkmcnt(14)
v_mfma_f32_32x32x16_bf16 v[80:95], v[64:67], a[104:107], v[80:95]
s_waitcnt vmcnt(21)
s_barrier
ds_read_b64_tr_b16 v[48:49], v144 offset:49152
ds_read_b64_tr_b16 v[50:51], v144 offset:51200
v_mfma_f32_4x4x4_16b_bf16 v[24:27], v[64:65], v[64:65], v[24:27]
s_waitcnt lgkmcnt(14)
v_mfma_f32_32x32x16_bf16 v[96:111], v[68:71], a[104:107], v[96:111]
ds_read_b64_tr_b16 v[52:53], v144 offset:53248
ds_read_b64_tr_b16 v[54:55], v144 offset:55296
s_waitcnt lgkmcnt(14)
v_mfma_f32_32x32x16_bf16 v[112:127], v[72:75], a[104:107], v[112:127]
ds_read_b64_tr_b16 v[56:57], v144 offset:57344
ds_read_b64_tr_b16 v[58:59], v144 offset:59392
v_mfma_f32_4x4x4_16b_bf16 v[28:31], v[66:67], v[66:67], v[28:31]
s_waitcnt lgkmcnt(14)
v_mfma_f32_32x32x16_bf16 v[128:143], v[76:79], a[104:107], v[128:143]
ds_read_b64_tr_b16 v[60:61], v144 offset:61440
ds_read_b64_tr_b16 v[62:63], v144 offset:63488
s_waitcnt lgkmcnt(14)
v_mfma_f32_32x32x16_bf16 v[80:95], v[32:35], a[108:111], v[80:95]
s_waitcnt vmcnt(13)
s_barrier
ds_read_b64_tr_b16 v[64:65], v12 offset:0
ds_read_b64_tr_b16 v[66:67], v12 offset:2048
v_mfma_f32_4x4x4_16b_bf16 v[24:27], v[32:33], v[32:33], v[24:27]
s_waitcnt lgkmcnt(14)
v_mfma_f32_32x32x16_bf16 v[96:111], v[36:39], a[108:111], v[96:111]
ds_read_b64_tr_b16 v[68:69], v12 offset:4096
ds_read_b64_tr_b16 v[70:71], v12 offset:6144
s_waitcnt lgkmcnt(14)
v_mfma_f32_32x32x16_bf16 v[112:127], v[40:43], a[108:111], v[112:127]
ds_read_b64_tr_b16 v[72:73], v12 offset:8192
ds_read_b64_tr_b16 v[74:75], v12 offset:10240
v_mfma_f32_4x4x4_16b_bf16 v[28:31], v[34:35], v[34:35], v[28:31]
s_waitcnt lgkmcnt(14)
v_mfma_f32_32x32x16_bf16 v[128:143], v[44:47], a[108:111], v[128:143]
ds_read_b64_tr_b16 v[76:77], v12 offset:12288
ds_read_b64_tr_b16 v[78:79], v12 offset:14336
s_waitcnt lgkmcnt(14)
v_mfma_f32_32x32x16_bf16 v[80:95], v[48:51], a[112:115], v[80:95]
s_waitcnt vmcnt(5)
s_barrier
ds_read_b64_tr_b16 v[32:33], v12 offset:16384
ds_read_b64_tr_b16 v[34:35], v12 offset:18432
v_mfma_f32_4x4x4_16b_bf16 v[24:27], v[48:49], v[48:49], v[24:27]
v_mfma_f32_4x4x4_16b_bf16 v[28:31], v[50:51], v[50:51], v[28:31]
s_waitcnt lgkmcnt(14)
v_mfma_f32_32x32x16_bf16 v[80:95], v[52:55], a[116:119], v[80:95]
ds_read_b64_tr_b16 v[36:37], v12 offset:20480
ds_read_b64_tr_b16 v[38:39], v12 offset:22528
v_mfma_f32_4x4x4_16b_bf16 v[24:27], v[52:53], v[52:53], v[24:27]
v_mfma_f32_4x4x4_16b_bf16 v[28:31], v[54:55], v[54:55], v[28:31]
s_waitcnt lgkmcnt(14)
v_mfma_f32_32x32x16_bf16 v[80:95], v[56:59], a[120:123], v[80:95]
ds_read_b64_tr_b16 v[40:41], v12 offset:24576
ds_read_b64_tr_b16 v[42:43], v12 offset:26624
v_mfma_f32_4x4x4_16b_bf16 v[24:27], v[56:57], v[56:57], v[24:27]
v_mfma_f32_4x4x4_16b_bf16 v[28:31], v[58:59], v[58:59], v[28:31]
s_waitcnt lgkmcnt(14)
v_mfma_f32_32x32x16_bf16 v[80:95], v[60:63], a[124:127], v[80:95]
ds_read_b64_tr_b16 v[44:45], v12 offset:28672
ds_read_b64_tr_b16 v[46:47], v12 offset:30720
v_mfma_f32_4x4x4_16b_bf16 v[24:27], v[60:61], v[60:61], v[24:27]
v_mfma_f32_4x4x4_16b_bf16 v[28:31], v[62:63], v[62:63], v[28:31]
s_waitcnt lgkmcnt(14)
v_mfma_f32_32x32x16_bf16 v[80:95], v[64:67], a[128:131], v[80:95]
ds_read_b64_tr_b16 v[48:49], v145 offset:49152
ds_read_b64_tr_b16 v[50:51], v145 offset:51200
v_mfma_f32_4x4x4_16b_bf16 v[24:27], v[64:65], v[64:65], v[24:27]
v_mfma_f32_4x4x4_16b_bf16 v[28:31], v[66:67], v[66:67], v[28:31]
s_waitcnt lgkmcnt(14)
v_mfma_f32_32x32x16_bf16 v[80:95], v[68:71], a[132:135], v[80:95]
ds_read_b64_tr_b16 v[52:53], v146 offset:49152
ds_read_b64_tr_b16 v[54:55], v146 offset:51200
v_mfma_f32_4x4x4_16b_bf16 v[24:27], v[68:69], v[68:69], v[24:27]
v_mfma_f32_4x4x4_16b_bf16 v[28:31], v[70:71], v[70:71], v[28:31]
s_waitcnt lgkmcnt(14)
v_mfma_f32_32x32x16_bf16 v[80:95], v[72:75], a[136:139], v[80:95]
ds_read_b64_tr_b16 v[56:57], v145 offset:53248
ds_read_b64_tr_b16 v[58:59], v145 offset:55296
v_mfma_f32_4x4x4_16b_bf16 v[24:27], v[72:73], v[72:73], v[24:27]
v_mfma_f32_4x4x4_16b_bf16 v[28:31], v[74:75], v[74:75], v[28:31]
s_waitcnt lgkmcnt(14)
v_mfma_f32_32x32x16_bf16 v[80:95], v[76:79], a[140:143], v[80:95]
ds_read_b64_tr_b16 v[60:61], v146 offset:53248
ds_read_b64_tr_b16 v[62:63], v146 offset:55296
v_mfma_f32_4x4x4_16b_bf16 v[24:27], v[76:77], v[76:77], v[24:27]
v_mfma_f32_4x4x4_16b_bf16 v[28:31], v[78:79], v[78:79], v[28:31]
s_waitcnt vmcnt(4) lgkmcnt(14)
v_mfma_f32_32x32x16_bf16 v[80:95], v[32:35], a[144:147], v[80:95]
ds_read_b64_tr_b16 v[64:65], v145 offset:57344
ds_read_b64_tr_b16 v[66:67], v145 offset:59392
v_mfma_f32_4x4x4_16b_bf16 v[24:27], v[32:33], v[32:33], v[24:27]
v_mfma_f32_4x4x4_16b_bf16 v[28:31], v[34:35], v[34:35], v[28:31]
s_waitcnt vmcnt(3) lgkmcnt(14)
v_mfma_f32_32x32x16_bf16 v[80:95], v[36:39], a[148:151], v[80:95]
ds_read_b64_tr_b16 v[68:69], v146 offset:57344
ds_read_b64_tr_b16 v[70:71], v146 offset:59392
v_mfma_f32_4x4x4_16b_bf16 v[24:27], v[36:37], v[36:37], v[24:27]
v_mfma_f32_4x4x4_16b_bf16 v[28:31], v[38:39], v[38:39], v[28:31]
s_waitcnt vmcnt(2) lgkmcnt(14)
v_mfma_f32_32x32x16_bf16 v[80:95], v[40:43], a[152:155], v[80:95]
ds_read_b64_tr_b16 v[72:73], v145 offset:61440
ds_read_b64_tr_b16 v[74:75], v145 offset:63488
v_mfma_f32_4x4x4_16b_bf16 v[24:27], v[40:41], v[40:41], v[24:27]
v_mfma_f32_4x4x4_16b_bf16 v[28:31], v[42:43], v[42:43], v[28:31]
s_waitcnt vmcnt(1) lgkmcnt(14)
v_mfma_f32_32x32x16_bf16 v[80:95], v[44:47], a[156:159], v[80:95]
ds_read_b64_tr_b16 v[76:77], v146 offset:61440
ds_read_b64_tr_b16 v[78:79], v146 offset:63488
v_mfma_f32_4x4x4_16b_bf16 v[24:27], v[44:45], v[44:45], v[24:27]
v_mfma_f32_4x4x4_16b_bf16 v[28:31], v[46:47], v[46:47], v[28:31]
s_waitcnt lgkmcnt(14)
v_mfma_f32_32x32x16_bf16 v[96:111], v[48:51], a[112:115], v[96:111]
ds_read_b64_tr_b16 v[32:33], v13 offset:0
ds_read_b64_tr_b16 v[34:35], v13 offset:2048
s_waitcnt lgkmcnt(14)
v_mfma_f32_32x32x16_bf16 v[112:127], v[52:55], a[112:115], v[112:127]
ds_read_b64_tr_b16 v[36:37], v14 offset:0
ds_read_b64_tr_b16 v[38:39], v14 offset:2048
v_add_f32 v24, v24, v28
v_add_f32 v25, v25, v29
v_add_f32 v26, v26, v30
v_add_f32 v27, v27, v31
v_cmp_eq_u32 vcc, 1, v23
s_nop 1
v_cndmask_b32 v24, v24, v25, vcc
v_cmp_eq_u32 vcc, 2, v23
s_nop 1
v_cndmask_b32 v24, v24, v26, vcc
v_cmp_eq_u32 vcc, 3, v23
s_nop 1
v_cndmask_b32 v24, v24, v27, vcc
s_waitcnt lgkmcnt(14)
v_mfma_f32_32x32x16_bf16 v[96:111], v[56:59], a[116:119], v[96:111]
ds_read_b64_tr_b16 v[40:41], v13 offset:4096
ds_read_b64_tr_b16 v[42:43], v13 offset:6144
v_mov_b32 v25, v24
s_nop 1
v_permlane32_swap_b32 v24, v25
v_add_f32 v24, v24, v25
v_mov_b32 v25, 0x3727c5ac
v_fmamk_f32 v24, v24, 0x3acccccd, v25
v_rsq_f32 v24, v24
s_nop 0
ds_write_b32 v22, v24
s_waitcnt lgkmcnt(15)
v_mfma_f32_32x32x16_bf16 v[112:127], v[60:63], a[116:119], v[112:127]
ds_read_b64_tr_b16 v[44:45], v14 offset:4096
ds_read_b64_tr_b16 v[46:47], v14 offset:6144
s_waitcnt lgkmcnt(15)
v_mfma_f32_32x32x16_bf16 v[96:111], v[64:67], a[120:123], v[96:111]
ds_read_b64_tr_b16 v[48:49], v13 offset:8192
ds_read_b64_tr_b16 v[50:51], v13 offset:10240
s_waitcnt vmcnt(0) lgkmcnt(4)
s_barrier
ds_read_b128 v[192:195], v148 offset:0
ds_read_b128 v[196:199], v148 offset:32
ds_read_b128 v[200:203], v148 offset:64
ds_read_b128 v[204:207], v148 offset:96
v_mfma_f32_32x32x16_bf16 v[112:127], v[68:71], a[120:123], v[112:127]
ds_read_b64_tr_b16 v[52:53], v14 offset:8192
ds_read_b64_tr_b16 v[54:55], v14 offset:10240
ds_read_b128 v[208:211], v149 offset:0
ds_read_b128 v[212:215], v149 offset:32
ds_read_b128 v[216:219], v149 offset:64
ds_read_b128 v[220:223], v149 offset:96
v_mfma_f32_32x32x16_bf16 v[96:111], v[72:75], a[124:127], v[96:111]
ds_read_b64_tr_b16 v[56:57], v13 offset:12288
ds_read_b64_tr_b16 v[58:59], v13 offset:14336
ds_read_b128 v[224:227], v150 offset:0
ds_read_b128 v[228:231], v150 offset:32
ds_read_b128 v[232:235], v150 offset:64
ds_read_b128 v[236:239], v150 offset:96
s_waitcnt lgkmcnt(15)
v_mfma_f32_32x32x16_bf16 v[112:127], v[76:79], a[124:127], v[112:127]
ds_read_b64_tr_b16 v[60:61], v14 offset:12288
ds_read_b64_tr_b16 v[62:63], v14 offset:14336
ds_read_b128 v[240:243], v151 offset:0
ds_read_b128 v[244:247], v151 offset:32
ds_read_b128 v[248:251], v151 offset:64
ds_read_b128 v[252:255], v151 offset:96
s_waitcnt lgkmcnt(15)
v_pk_mul_f32 v[80:81], v[80:81], v[192:193]
v_pk_mul_f32 v[82:83], v[82:83], v[194:195]
v_mfma_f32_32x32x16_bf16 v[96:111], v[32:35], a[128:131], v[96:111]
ds_read_b64_tr_b16 v[64:65], v13 offset:16384
ds_read_b64_tr_b16 v[66:67], v13 offset:18432
v_pk_mul_f32 v[84:85], v[84:85], v[196:197]
v_pk_mul_f32 v[86:87], v[86:87], v[198:199]
v_pk_mul_f32 v[88:89], v[88:89], v[200:201]
s_waitcnt lgkmcnt(15)
v_mfma_f32_32x32x16_bf16 v[112:127], v[36:39], a[128:131], v[112:127]
ds_read_b64_tr_b16 v[68:69], v14 offset:16384
ds_read_b64_tr_b16 v[70:71], v14 offset:18432
v_pk_mul_f32 v[90:91], v[90:91], v[202:203]
v_pk_mul_f32 v[92:93], v[92:93], v[204:205]
v_pk_mul_f32 v[94:95], v[94:95], v[206:207]
s_waitcnt lgkmcnt(15)
v_mfma_f32_32x32x16_bf16 v[96:111], v[40:43], a[132:135], v[96:111]
ds_read_b64_tr_b16 v[72:73], v13 offset:20480
ds_read_b64_tr_b16 v[74:75], v13 offset:22528
v_cvt_pk_bf16_f32 v152, v80, v81
v_cvt_pk_bf16_f32 v153, v82, v83
v_cvt_pk_bf16_f32 v154, v84, v85
s_waitcnt lgkmcnt(15)
v_mfma_f32_32x32x16_bf16 v[112:127], v[44:47], a[132:135], v[112:127]
ds_read_b64_tr_b16 v[76:77], v147 offset:49152
ds_read_b64_tr_b16 v[78:79], v147 offset:51200
v_cvt_pk_bf16_f32 v155, v86, v87
v_cvt_pk_bf16_f32 v156, v88, v89
v_cvt_pk_bf16_f32 v157, v90, v91
s_waitcnt lgkmcnt(15)
v_mfma_f32_32x32x16_bf16 v[96:111], v[48:51], a[136:139], v[96:111]
ds_read_b64_tr_b16 v[32:33], v13 offset:24576
ds_read_b64_tr_b16 v[34:35], v13 offset:26624
v_cvt_pk_bf16_f32 v158, v92, v93
v_cvt_pk_bf16_f32 v159, v94, v95
buffer_store_dwordx4 v[152:155], v16, s[16:19], s48 offen sc1
buffer_store_dwordx4 v[156:159], v16, s[16:19], s48 offen offset:640 sc1
s_waitcnt lgkmcnt(15)
v_mfma_f32_32x32x16_bf16 v[112:127], v[52:55], a[136:139], v[112:127]
ds_read_b64_tr_b16 v[36:37], v147 offset:53248
ds_read_b64_tr_b16 v[38:39], v147 offset:55296
s_waitcnt lgkmcnt(15)
v_mfma_f32_32x32x16_bf16 v[96:111], v[56:59], a[140:143], v[96:111]
ds_read_b64_tr_b16 v[40:41], v13 offset:28672
ds_read_b64_tr_b16 v[42:43], v13 offset:30720
s_waitcnt lgkmcnt(15)
v_mfma_f32_32x32x16_bf16 v[112:127], v[60:63], a[140:143], v[112:127]
ds_read_b64_tr_b16 v[44:45], v147 offset:57344
ds_read_b64_tr_b16 v[46:47], v147 offset:59392
s_waitcnt lgkmcnt(14)
v_mfma_f32_32x32x16_bf16 v[96:111], v[64:67], a[144:147], v[96:111]
ds_read_b64_tr_b16 v[48:49], v14 offset:20480
ds_read_b64_tr_b16 v[50:51], v14 offset:22528
s_waitcnt lgkmcnt(14)
v_mfma_f32_32x32x16_bf16 v[112:127], v[68:71], a[144:147], v[112:127]
ds_read_b64_tr_b16 v[52:53], v147 offset:61440
ds_read_b64_tr_b16 v[54:55], v147 offset:63488
s_waitcnt lgkmcnt(14)
v_mfma_f32_32x32x16_bf16 v[96:111], v[72:75], a[148:151], v[96:111]
ds_read_b64_tr_b16 v[56:57], v14 offset:24576
ds_read_b64_tr_b16 v[58:59], v14 offset:26624
s_waitcnt lgkmcnt(14)
v_mfma_f32_32x32x16_bf16 v[128:143], v[76:79], a[112:115], v[128:143]
ds_read_b64_tr_b16 v[60:61], v15 offset:0
ds_read_b64_tr_b16 v[62:63], v15 offset:2048
s_waitcnt lgkmcnt(14)
v_mfma_f32_32x32x16_bf16 v[96:111], v[32:35], a[152:155], v[96:111]
ds_read_b64_tr_b16 v[64:65], v14 offset:28672
ds_read_b64_tr_b16 v[66:67], v14 offset:30720
s_waitcnt lgkmcnt(14)
v_mfma_f32_32x32x16_bf16 v[128:143], v[36:39], a[116:119], v[128:143]
ds_read_b64_tr_b16 v[68:69], v15 offset:4096
ds_read_b64_tr_b16 v[70:71], v15 offset:6144
s_waitcnt lgkmcnt(14)
v_mfma_f32_32x32x16_bf16 v[96:111], v[40:43], a[156:159], v[96:111]
ds_read_b64_tr_b16 v[72:73], v15 offset:8192
ds_read_b64_tr_b16 v[74:75], v15 offset:10240
s_waitcnt lgkmcnt(14)
v_mfma_f32_32x32x16_bf16 v[128:143], v[44:47], a[120:123], v[128:143]
ds_read_b64_tr_b16 v[76:77], v15 offset:12288
ds_read_b64_tr_b16 v[78:79], v15 offset:14336
s_waitcnt lgkmcnt(14)
v_mfma_f32_32x32x16_bf16 v[112:127], v[48:51], a[148:151], v[112:127]
ds_read_b64_tr_b16 v[32:33], v15 offset:16384
ds_read_b64_tr_b16 v[34:35], v15 offset:18432
s_waitcnt lgkmcnt(14)
v_mfma_f32_32x32x16_bf16 v[128:143], v[52:55], a[124:127], v[128:143]
ds_read_b64_tr_b16 v[36:37], v15 offset:20480
ds_read_b64_tr_b16 v[38:39], v15 offset:22528
s_waitcnt lgkmcnt(15)
v_pk_mul_f32 v[96:97], v[96:97], v[208:209]
v_pk_mul_f32 v[98:99], v[98:99], v[210:211]
s_waitcnt lgkmcnt(14)
v_mfma_f32_32x32x16_bf16 v[112:127], v[56:59], a[152:155], v[112:127]
ds_read_b64_tr_b16 v[40:41], v15 offset:24576
ds_read_b64_tr_b16 v[42:43], v15 offset:26624
v_pk_mul_f32 v[100:101], v[100:101], v[212:213]
v_pk_mul_f32 v[102:103], v[102:103], v[214:215]
v_pk_mul_f32 v[104:105], v[104:105], v[216:217]
s_waitcnt lgkmcnt(14)
v_mfma_f32_32x32x16_bf16 v[128:143], v[60:63], a[128:131], v[128:143]
ds_read_b64_tr_b16 v[44:45], v15 offset:28672
ds_read_b64_tr_b16 v[46:47], v15 offset:30720
v_pk_mul_f32 v[106:107], v[106:107], v[218:219]
v_pk_mul_f32 v[108:109], v[108:109], v[220:221]
v_pk_mul_f32 v[110:111], v[110:111], v[222:223]
s_waitcnt lgkmcnt(14)
v_mfma_f32_32x32x16_bf16 v[112:127], v[64:67], a[156:159], v[112:127]
v_cvt_pk_bf16_f32 v160, v96, v97
v_cvt_pk_bf16_f32 v161, v98, v99
v_cvt_pk_bf16_f32 v162, v100, v101
s_waitcnt lgkmcnt(12)
v_mfma_f32_32x32x16_bf16 v[128:143], v[68:71], a[132:135], v[128:143]
v_cvt_pk_bf16_f32 v163, v102, v103
v_cvt_pk_bf16_f32 v164, v104, v105
v_cvt_pk_bf16_f32 v165, v106, v107
s_waitcnt lgkmcnt(10)
v_mfma_f32_32x32x16_bf16 v[128:143], v[72:75], a[136:139], v[128:143]
v_cvt_pk_bf16_f32 v166, v108, v109
v_cvt_pk_bf16_f32 v167, v110, v111
buffer_store_dwordx4 v[160:163], v16, s[16:19], s49 offen sc1
buffer_store_dwordx4 v[164:167], v16, s[16:19], s49 offen offset:640 sc1
s_waitcnt lgkmcnt(8)
v_mfma_f32_32x32x16_bf16 v[128:143], v[76:79], a[140:143], v[128:143]
v_pk_mul_f32 v[112:113], v[112:113], v[224:225]
v_pk_mul_f32 v[114:115], v[114:115], v[226:227]
s_waitcnt lgkmcnt(6)
v_mfma_f32_32x32x16_bf16 v[128:143], v[32:35], a[144:147], v[128:143]
v_pk_mul_f32 v[116:117], v[116:117], v[228:229]
v_pk_mul_f32 v[118:119], v[118:119], v[230:231]
v_pk_mul_f32 v[120:121], v[120:121], v[232:233]
s_waitcnt lgkmcnt(4)
v_mfma_f32_32x32x16_bf16 v[128:143], v[36:39], a[148:151], v[128:143]
v_pk_mul_f32 v[122:123], v[122:123], v[234:235]
v_pk_mul_f32 v[124:125], v[124:125], v[236:237]
v_pk_mul_f32 v[126:127], v[126:127], v[238:239]
s_waitcnt lgkmcnt(2)
v_mfma_f32_32x32x16_bf16 v[128:143], v[40:43], a[152:155], v[128:143]
v_cvt_pk_bf16_f32 v168, v112, v113
v_cvt_pk_bf16_f32 v169, v114, v115
v_cvt_pk_bf16_f32 v170, v116, v117
s_waitcnt lgkmcnt(0)
v_mfma_f32_32x32x16_bf16 v[128:143], v[44:47], a[156:159], v[128:143]
v_cvt_pk_bf16_f32 v171, v118, v119
v_cvt_pk_bf16_f32 v172, v120, v121
v_cvt_pk_bf16_f32 v173, v122, v123
v_cvt_pk_bf16_f32 v174, v124, v125
v_cvt_pk_bf16_f32 v175, v126, v127
buffer_store_dwordx4 v[168:171], v16, s[16:19], s50 offen sc1
buffer_store_dwordx4 v[172:175], v16, s[16:19], s50 offen offset:640 sc1
s_nop 4
v_pk_mul_f32 v[128:129], v[128:129], v[240:241]
v_pk_mul_f32 v[130:131], v[130:131], v[242:243]
v_pk_mul_f32 v[132:133], v[132:133], v[244:245]
v_pk_mul_f32 v[134:135], v[134:135], v[246:247]
v_pk_mul_f32 v[136:137], v[136:137], v[248:249]
v_pk_mul_f32 v[138:139], v[138:139], v[250:251]
v_pk_mul_f32 v[140:141], v[140:141], v[252:253]
v_pk_mul_f32 v[142:143], v[142:143], v[254:255]
v_cvt_pk_bf16_f32 v176, v128, v129
v_cvt_pk_bf16_f32 v177, v130, v131
v_cvt_pk_bf16_f32 v178, v132, v133
v_cvt_pk_bf16_f32 v179, v134, v135
v_cvt_pk_bf16_f32 v180, v136, v137
v_cvt_pk_bf16_f32 v181, v138, v139
v_cvt_pk_bf16_f32 v182, v140, v141
v_cvt_pk_bf16_f32 v183, v142, v143
buffer_store_dwordx4 v[176:179], v16, s[16:19], s51 offen sc1
buffer_store_dwordx4 v[180:183], v16, s[16:19], s51 offen offset:640 sc1
s_endpgm
.p2align 8
.globl at_kernel
.type at_kernel,@function
at_kernel:
s_mov_b32 s42, 0
.Lat_common:
s_cmp_lt_u32 s2, 256
s_cbranch_scc1 .Lat_role1
s_sub_u32 s2, s2, 256
s_endpgm
.Lat_role1:
s_load_dwordx2 s[4:5], s[0:1], 64
v_lshrrev_b32 v1, 6, v0
v_and_b32 v2, 63, v0
v_readfirstlane_b32 s22, v1
s_and_b32 s20, s2, 7
s_lshl_b32 s20, s20, 2
s_bfe_u32 s21, s2, 0x20003
s_add_u32 s20, s20, s21
s_lshr_b32 s21, s2, 5
s_and_b32 s23, s22, 3
s_lshr_b32 s24, s22, 2
v_lshlrev_b32 v3, 4, v2
v_and_b32 v4, 31, v2
v_lshrrev_b32 v5, 5, v2
v_lshlrev_b32 v6, 3, v4
s_lshl_b32 s25, s21, 3
s_lshl_b32 s26, s23, 1
s_add_u32 s25, s25, s26
s_add_u32 s26, s25, s24
s_xor_b32 s27, s26, 1
s_lshl_b32 s28, s20, 6
s_add_u32 s29, s28, s26
s_lshl_b32 s30, s29, 10
s_add_u32 s30, s30, 10485760
s_lshl_b32 s32, s29, 8
s_add_u32 s32, s32, 12582912
s_add_u32 s29, s28, s27
s_lshl_b32 s31, s29, 10
s_add_u32 s31, s31, 10485760
s_lshl_b32 s33, s29, 8
s_add_u32 s33, s33, 12582912
s_mul_i32 s29, s20, 163840
s_add_u32 s29, s29, 13107200
s_add_u32 s29, s29, s42
s_lshl_b32 s34, s22, 10
s_mov_b32 s36, 0x000fffff
s_mov_b32 s37, 0x000fffff
s_mov_b32 s38, 0
s_mul_i32 s35, s24, 5120
v_add_u32 v188, s35, v3
v_lshl_add_u32 v189, v2, 3, s35
v_mad_u32_u24 v7, v5, 20, v4
v_lshl_add_u32 v190, v7, 4, s35
v_add_u32 v191, 61440, v188
v_add_u32 v192, 61440, v189
v_add_u32 v193, 61440, v190
v_add_u32 v194, 61440, v191
v_add_u32 v195, 61440, v192
v_add_u32 v196, 61440, v193
v_cmp_eq_u32 vcc, 20, v4
v_cmp_eq_u32 s[40:41], 24, v4
s_or_b64 vcc, vcc, s[40:41]
v_mov_b32 v7, 0x3f803f80
v_cndmask_b32 v140, 0, v7, vcc
v_mov_b32 v141, v140
v_mov_b32 v142, v140
v_mov_b32 v143, v140
v_mov_b32 v144, v140
v_mov_b32 v145, v140
v_mov_b32 v146, v140
v_mov_b32 v147, v140
v_mov_b32 v148, v140
v_mov_b32 v149, v140
v_mov_b32 v150, v140
v_mov_b32 v151, v140
v_mov_b32 v152, v140
v_mov_b32 v153, v140
v_mov_b32 v154, v140
v_mov_b32 v155, v140
v_mov_b32 v156, v140
v_mov_b32 v157, v140
v_mov_b32 v158, v140
v_mov_b32 v159, v140
v_mov_b32 v160, v140
v_mov_b32 v161, v140
v_mov_b32 v162, v140
v_mov_b32 v163, v140
v_mov_b32 v164, v140
v_mov_b32 v165, v140
v_mov_b32 v166, v140
v_mov_b32 v167, v140
v_mov_b32 v168, v140
v_mov_b32 v169, v140
v_mov_b32 v170, v140
v_mov_b32 v171, v140
s_waitcnt lgkmcnt(0)
s_add_u32 s8, s4, s29
s_addc_u32 s9, s5, 0
s_mov_b32 s10, 163840
s_mov_b32 s11, 0x00020000
s_add_u32 s16, s4, s42
s_addc_u32 s17, s5, 0
s_mov_b32 s18, 18350080
s_mov_b32 s19, 0x00020000
buffer_load_dwordx4 v[172:175], v3, s[16:19], s30 offen
buffer_load_dwordx2 v[176:177], v6, s[16:19], s32 offen
buffer_load_dwordx4 v[180:183], v3, s[16:19], s31 offen
buffer_load_dwordx2 v[184:185], v6, s[16:19], s33 offen
s_add_u32 m0, s34, 0
s_nop 0
buffer_load_dwordx4 v3, s[8:11], m0 offen lds
s_add_u32 m0, s34, 8192
s_nop 0
buffer_load_dwordx4 v3, s[8:11], m0 offen lds
s_add_u32 m0, s34, 16384
s_nop 0
buffer_load_dwordx4 v3, s[8:11], m0 offen lds
s_add_u32 m0, s34, 24576
s_nop 0
buffer_load_dwordx4 v3, s[8:11], m0 offen lds
s_add_u32 m0, s34, 32768
s_nop 0
buffer_load_dwordx4 v3, s[8:11], m0 offen lds
s_mul_i32 s35, s23, 20480
v_add_u32 v9, s35, v3
s_lshl_b32 s29, s20, 10
s_add_u32 s29, s29, 5242880
s_lshr_b32 s28, s20, 1
s_lshl_b32 s28, s28, 9
s_and_b32 s35, s20, 1
s_lshl_b32 s35, s35, 3
s_add_u32 s28, s28, s35
s_lshl_b32 s28, s20, 8
s_add_u32 s28, s28, 5275648
s_mul_i32 s35, s26, 40960
s_add_u32 s30, s35, s29
s_add_u32 s32, s35, s28
s_mul_i32 s35, s27, 40960
s_add_u32 s31, s35, s29
s_add_u32 s33, s35, s28
v_cmp_eq_u32 vcc, 0, v5
s_waitcnt vmcnt(5)
s_nop 0
v_cndmask_b32 v178, v176, 0, vcc
v_cndmask_b32 v176, 0, v176, vcc
v_cndmask_b32 v179, v177, 0, vcc
v_cndmask_b32 v177, 0, v177, vcc
v_cndmask_b32 v186, v184, 0, vcc
v_cndmask_b32 v184, 0, v184, vcc
v_cndmask_b32 v187, v185, 0, vcc
v_cndmask_b32 v185, 0, v185, vcc
s_waitcnt vmcnt(3)
s_barrier
ds_read_b128 v[120:123], v188 offset:0
ds_read_b64 v[128:129], v189 offset:2048
ds_read_b128 v[124:127], v188 offset:1024
s_mov_b64 exec, s[36:37]
ds_read_b128 v[140:143], v190 offset:2560
ds_read_b128 v[144:147], v190 offset:3200
ds_read_b128 v[148:151], v190 offset:3840
ds_read_b128 v[152:155], v190 offset:4480
s_mov_b64 exec, -1
s_waitcnt lgkmcnt(5)
v_mfma_f32_32x32x16_bf16 v[16:31], v[120:123], v[172:175], 0
v_mfma_f32_32x32x16_bf16 v[32:47], v[120:123], v[180:183], 0
v_mfma_f32_32x32x8bf16_1k v[16:31], v[128:129], v[176:177], v[16:31]
v_mfma_f32_32x32x8bf16_1k v[32:47], v[128:129], v[184:185], v[32:47]
s_nop 10
v_max_f32 v200, v16, v17
v_max3_f32 v200, v18, v19, v200
v_max3_f32 v200, v20, v21, v200
v_max3_f32 v200, v22, v23, v200
v_max3_f32 v200, v24, v25, v200
v_max3_f32 v200, v26, v27, v200
v_max3_f32 v200, v28, v29, v200
v_max3_f32 v200, v30, v31, v200
v_max_f32 v201, v32, v33
v_max3_f32 v201, v34, v35, v201
v_max3_f32 v201, v36, v37, v201
v_max3_f32 v201, v38, v39, v201
v_max3_f32 v201, v40, v41, v201
v_max3_f32 v201, v42, v43, v201
v_max3_f32 v201, v44, v45, v201
v_max3_f32 v201, v46, v47, v201
s_nop 1
v_permlane32_swap_b32 v200, v201
v_max_f32 v200, v200, v201
v_mov_b32 v201, v200
s_nop 1
v_permlane32_swap_b32 v200, v201
v_sub_f32 v56, 0, v200
v_sub_f32 v57, 0, v200
v_sub_f32 v72, 0, v201
v_sub_f32 v73, 0, v201
v_mov_b64 v[58:59], v[56:57]
v_mov_b64 v[74:75], v[72:73]
v_mov_b64 v[60:61], v[56:57]
v_mov_b64 v[76:77], v[72:73]
v_mov_b64 v[62:63], v[56:57]
v_mov_b64 v[78:79], v[72:73]
v_mov_b64 v[64:65], v[56:57]
v_mov_b64 v[80:81], v[72:73]
v_mov_b64 v[66:67], v[56:57]
v_mov_b64 v[82:83], v[72:73]
v_mov_b64 v[68:69], v[56:57]
v_mov_b64 v[84:85], v[72:73]
v_mov_b64 v[70:71], v[56:57]
v_mov_b64 v[86:87], v[72:73]
.Lat_main2:
s_nop 0
v_mfma_f32_32x32x16_bf16 v[16:31], v[120:123], v[172:175], v[56:71]
v_mfma_f32_32x32x8bf16_1k v[16:31], v[128:129], v[176:177], v[16:31]
v_mfma_f32_32x32x16_bf16 v[32:47], v[120:123], v[180:183], v[72:87]
s_nop 10
v_exp_f32 v16, v16
v_exp_f32 v17, v17
v_exp_f32 v18, v18
v_exp_f32 v19, v19
v_exp_f32 v20, v20
v_mfma_f32_32x32x8bf16_1k v[32:47], v[128:129], v[184:185], v[32:47]
v_exp_f32 v21, v21
v_cvt_pk_bf16_f32 v48, v16, v17
v_exp_f32 v22, v22
v_cvt_pk_bf16_f32 v49, v18, v19
v_exp_f32 v23, v23
v_cvt_pk_bf16_f32 v50, v20, v21
v_cvt_pk_bf16_f32 v51, v22, v23
s_cmp_lg_u32 s38, 0
s_cbranch_scc1 .Lat_nb3
s_waitcnt vmcnt(2)
s_barrier
.Lat_nb3:
s_setprio 1
ds_read_b128 v[130:133], v188 offset:10240
ds_read_b64 v[138:139], v189 offset:12288
ds_read_b128 v[134:137], v188 offset:11264
s_mov_b64 exec, s[36:37]
ds_read_b128 v[156:159], v190 offset:12800
ds_read_b128 v[160:163], v190 offset:13440
ds_read_b128 v[164:167], v190 offset:14080
ds_read_b128 v[168:171], v190 offset:14720
s_mov_b64 exec, -1
v_exp_f32 v24, v24
s_add_u32 m0, s34, 40960
s_nop 0
buffer_load_dwordx4 v3, s[8:11], m0 offen lds
v_exp_f32 v25, v25
v_exp_f32 v26, v26
v_exp_f32 v27, v27
v_exp_f32 v28, v28
s_waitcnt lgkmcnt(7)
v_mfma_f32_32x32x16_bf16 v[88:103], v[140:143], v[48:51], 0
v_exp_f32 v29, v29
v_cvt_pk_bf16_f32 v52, v24, v25
v_exp_f32 v30, v30
v_cvt_pk_bf16_f32 v53, v26, v27
v_exp_f32 v31, v31
v_cvt_pk_bf16_f32 v54, v28, v29
v_cvt_pk_bf16_f32 v55, v30, v31
s_waitcnt lgkmcnt(7)
v_mfma_f32_32x32x16_bf16 v[16:31], v[124:127], v[172:175], v[56:71]
v_exp_f32 v32, v32
v_exp_f32 v33, v33
v_exp_f32 v34, v34
v_exp_f32 v35, v35
v_exp_f32 v36, v36
v_mfma_f32_32x32x8bf16_1k v[16:31], v[128:129], v[178:179], v[16:31]
v_exp_f32 v37, v37
v_cvt_pk_bf16_f32 v48, v32, v33
v_exp_f32 v38, v38
v_cvt_pk_bf16_f32 v49, v34, v35
v_exp_f32 v39, v39
v_cvt_pk_bf16_f32 v50, v36, v37
v_cvt_pk_bf16_f32 v51, v38, v39
v_mfma_f32_32x32x16_bf16 v[88:103], v[144:147], v[52:55], v[88:103]
v_exp_f32 v40, v40
s_add_u32 m0, s34, 49152
s_nop 0
buffer_load_dwordx4 v3, s[8:11], m0 offen lds
v_exp_f32 v41, v41
v_exp_f32 v42, v42
v_exp_f32 v43, v43
v_exp_f32 v44, v44
v_mfma_f32_32x32x16_bf16 v[104:119], v[140:143], v[48:51], 0
v_exp_f32 v45, v45
v_cvt_pk_bf16_f32 v52, v40, v41
v_exp_f32 v46, v46
v_cvt_pk_bf16_f32 v53, v42, v43
v_exp_f32 v47, v47
v_cvt_pk_bf16_f32 v54, v44, v45
v_cvt_pk_bf16_f32 v55, v46, v47
v_mfma_f32_32x32x16_bf16 v[32:47], v[124:127], v[180:183], v[72:87]
v_exp_f32 v16, v16
v_exp_f32 v17, v17
v_exp_f32 v18, v18
v_exp_f32 v19, v19
v_exp_f32 v20, v20
v_mfma_f32_32x32x8bf16_1k v[32:47], v[128:129], v[186:187], v[32:47]
v_exp_f32 v21, v21
v_cvt_pk_bf16_f32 v48, v16, v17
v_exp_f32 v22, v22
v_cvt_pk_bf16_f32 v49, v18, v19
v_exp_f32 v23, v23
v_cvt_pk_bf16_f32 v50, v20, v21
v_cvt_pk_bf16_f32 v51, v22, v23
v_mfma_f32_32x32x16_bf16 v[104:119], v[144:147], v[52:55], v[104:119]
v_exp_f32 v24, v24
s_add_u32 m0, s34, 57344
s_nop 0
buffer_load_dwordx4 v3, s[8:11], m0 offen lds
v_exp_f32 v25, v25
v_exp_f32 v26, v26
v_exp_f32 v27, v27
v_exp_f32 v28, v28
v_mfma_f32_32x32x16_bf16 v[88:103], v[148:151], v[48:51], v[88:103]
v_exp_f32 v29, v29
v_cvt_pk_bf16_f32 v52, v24, v25
v_exp_f32 v30, v30
v_cvt_pk_bf16_f32 v53, v26, v27
v_exp_f32 v31, v31
v_cvt_pk_bf16_f32 v54, v28, v29
v_cvt_pk_bf16_f32 v55, v30, v31
s_waitcnt lgkmcnt(0)
v_mfma_f32_32x32x16_bf16 v[16:31], v[130:133], v[172:175], v[56:71]
v_exp_f32 v32, v32
v_exp_f32 v33, v33
v_exp_f32 v34, v34
v_exp_f32 v35, v35
v_exp_f32 v36, v36
v_mfma_f32_32x32x8bf16_1k v[16:31], v[138:139], v[176:177], v[16:31]
v_exp_f32 v37, v37
v_cvt_pk_bf16_f32 v48, v32, v33
v_exp_f32 v38, v38
v_cvt_pk_bf16_f32 v49, v34, v35
v_exp_f32 v39, v39
v_cvt_pk_bf16_f32 v50, v36, v37
v_cvt_pk_bf16_f32 v51, v38, v39
v_mfma_f32_32x32x16_bf16 v[88:103], v[152:155], v[52:55], v[88:103]
v_exp_f32 v40, v40
s_add_u32 m0, s34, 65536
s_nop 0
buffer_load_dwordx4 v3, s[8:11], m0 offen lds
v_exp_f32 v41, v41
v_exp_f32 v42, v42
v_exp_f32 v43, v43
v_exp_f32 v44, v44
v_mfma_f32_32x32x16_bf16 v[104:119], v[148:151], v[48:51], v[104:119]
v_exp_f32 v45, v45
v_cvt_pk_bf16_f32 v52, v40, v41
v_exp_f32 v46, v46
v_cvt_pk_bf16_f32 v53, v42, v43
v_exp_f32 v47, v47
v_cvt_pk_bf16_f32 v54, v44, v45
v_cvt_pk_bf16_f32 v55, v46, v47
s_setprio 0
v_mfma_f32_32x32x16_bf16 v[32:47], v[130:133], v[180:183], v[72:87]
v_exp_f32 v16, v16
v_exp_f32 v17, v17
v_exp_f32 v18, v18
v_exp_f32 v19, v19
v_exp_f32 v20, v20
v_mfma_f32_32x32x8bf16_1k v[32:47], v[138:139], v[184:185], v[32:47]
v_exp_f32 v21, v21
v_cvt_pk_bf16_f32 v48, v16, v17
v_exp_f32 v22, v22
v_cvt_pk_bf16_f32 v49, v18, v19
v_exp_f32 v23, v23
v_cvt_pk_bf16_f32 v50, v20, v21
v_cvt_pk_bf16_f32 v51, v22, v23
v_mfma_f32_32x32x16_bf16 v[104:119], v[152:155], v[52:55], v[104:119]
s_cmp_lg_u32 s38, 0
s_cbranch_scc1 .Lat_nb4
s_waitcnt vmcnt(4)
s_barrier
.Lat_nb4:
s_setprio 1
ds_read_b128 v[120:123], v188 offset:20480
ds_read_b64 v[128:129], v189 offset:22528
ds_read_b128 v[124:127], v188 offset:21504
s_mov_b64 exec, s[36:37]
ds_read_b128 v[140:143], v190 offset:23040
ds_read_b128 v[144:147], v190 offset:23680
ds_read_b128 v[148:151], v190 offset:24320
ds_read_b128 v[152:155], v190 offset:24960
s_mov_b64 exec, -1
v_exp_f32 v24, v24
s_add_u32 m0, s34, 73728
s_nop 0
buffer_load_dwordx4 v3, s[8:11], m0 offen lds
v_exp_f32 v25, v25
v_exp_f32 v26, v26
v_exp_f32 v27, v27
v_exp_f32 v28, v28
v_mfma_f32_32x32x16_bf16 v[88:103], v[156:159], v[48:51], v[88:103]
v_exp_f32 v29, v29
v_cvt_pk_bf16_f32 v52, v24, v25
v_exp_f32 v30, v30
v_cvt_pk_bf16_f32 v53, v26, v27
v_exp_f32 v31, v31
v_cvt_pk_bf16_f32 v54, v28, v29
v_cvt_pk_bf16_f32 v55, v30, v31
v_mfma_f32_32x32x16_bf16 v[16:31], v[134:137], v[172:175], v[56:71]
v_exp_f32 v32, v32
v_exp_f32 v33, v33
v_exp_f32 v34, v34
v_exp_f32 v35, v35
v_exp_f32 v36, v36
v_mfma_f32_32x32x8bf16_1k v[16:31], v[138:139], v[178:179], v[16:31]
v_exp_f32 v37, v37
v_cvt_pk_bf16_f32 v48, v32, v33
v_exp_f32 v38, v38
v_cvt_pk_bf16_f32 v49, v34, v35
v_exp_f32 v39, v39
v_cvt_pk_bf16_f32 v50, v36, v37
v_cvt_pk_bf16_f32 v51, v38, v39
v_mfma_f32_32x32x16_bf16 v[88:103], v[160:163], v[52:55], v[88:103]
v_exp_f32 v40, v40
s_add_u32 m0, s34, 81920
s_nop 0
buffer_load_dwordx4 v3, s[8:11], m0 offen lds
v_exp_f32 v41, v41
v_exp_f32 v42, v42
v_exp_f32 v43, v43
v_exp_f32 v44, v44
v_mfma_f32_32x32x16_bf16 v[104:119], v[156:159], v[48:51], v[104:119]
v_exp_f32 v45, v45
v_cvt_pk_bf16_f32 v52, v40, v41
v_exp_f32 v46, v46
v_cvt_pk_bf16_f32 v53, v42, v43
v_exp_f32 v47, v47
v_cvt_pk_bf16_f32 v54, v44, v45
v_cvt_pk_bf16_f32 v55, v46, v47
v_mfma_f32_32x32x16_bf16 v[32:47], v[134:137], v[180:183], v[72:87]
v_exp_f32 v16, v16
v_exp_f32 v17, v17
v_exp_f32 v18, v18
v_exp_f32 v19, v19
v_exp_f32 v20, v20
v_mfma_f32_32x32x8bf16_1k v[32:47], v[138:139], v[186:187], v[32:47]
v_exp_f32 v21, v21
v_cvt_pk_bf16_f32 v48, v16, v17
v_exp_f32 v22, v22
v_cvt_pk_bf16_f32 v49, v18, v19
v_exp_f32 v23, v23
v_cvt_pk_bf16_f32 v50, v20, v21
v_cvt_pk_bf16_f32 v51, v22, v23
v_mfma_f32_32x32x16_bf16 v[104:119], v[160:163], v[52:55], v[104:119]
v_exp_f32 v24, v24
s_add_u32 m0, s34, 90112
s_nop 0
buffer_load_dwordx4 v3, s[8:11], m0 offen lds
v_exp_f32 v25, v25
v_exp_f32 v26, v26
v_exp_f32 v27, v27
v_exp_f32 v28, v28
v_mfma_f32_32x32x16_bf16 v[88:103], v[164:167], v[48:51], v[88:103]
v_exp_f32 v29, v29
v_cvt_pk_bf16_f32 v52, v24, v25
v_exp_f32 v30, v30
v_cvt_pk_bf16_f32 v53, v26, v27
v_exp_f32 v31, v31
v_cvt_pk_bf16_f32 v54, v28, v29
v_cvt_pk_bf16_f32 v55, v30, v31
s_waitcnt lgkmcnt(0)
v_mfma_f32_32x32x16_bf16 v[16:31], v[120:123], v[172:175], v[56:71]
v_exp_f32 v32, v32
v_exp_f32 v33, v33
v_exp_f32 v34, v34
v_exp_f32 v35, v35
v_exp_f32 v36, v36
v_mfma_f32_32x32x8bf16_1k v[16:31], v[128:129], v[176:177], v[16:31]
v_exp_f32 v37, v37
v_cvt_pk_bf16_f32 v48, v32, v33
v_exp_f32 v38, v38
v_cvt_pk_bf16_f32 v49, v34, v35
v_exp_f32 v39, v39
v_cvt_pk_bf16_f32 v50, v36, v37
v_cvt_pk_bf16_f32 v51, v38, v39
v_mfma_f32_32x32x16_bf16 v[88:103], v[168:171], v[52:55], v[88:103]
v_exp_f32 v40, v40
s_add_u32 m0, s34, 98304
s_nop 0
buffer_load_dwordx4 v3, s[8:11], m0 offen lds
v_exp_f32 v41, v41
v_exp_f32 v42, v42
v_exp_f32 v43, v43
v_exp_f32 v44, v44
v_mfma_f32_32x32x16_bf16 v[104:119], v[164:167], v[48:51], v[104:119]
v_exp_f32 v45, v45
v_cvt_pk_bf16_f32 v52, v40, v41
v_exp_f32 v46, v46
v_cvt_pk_bf16_f32 v53, v42, v43
v_exp_f32 v47, v47
v_cvt_pk_bf16_f32 v54, v44, v45
v_cvt_pk_bf16_f32 v55, v46, v47
v_mfma_f32_32x32x16_bf16 v[32:47], v[120:123], v[180:183], v[72:87]
v_exp_f32 v16, v16
v_exp_f32 v17, v17
v_exp_f32 v18, v18
v_exp_f32 v19, v19
v_exp_f32 v20, v20
v_mfma_f32_32x32x8bf16_1k v[32:47], v[128:129], v[184:185], v[32:47]
v_exp_f32 v21, v21
v_cvt_pk_bf16_f32 v48, v16, v17
v_exp_f32 v22, v22
v_cvt_pk_bf16_f32 v49, v18, v19
v_exp_f32 v23, v23
v_cvt_pk_bf16_f32 v50, v20, v21
v_cvt_pk_bf16_f32 v51, v22, v23
v_mfma_f32_32x32x16_bf16 v[104:119], v[168:171], v[52:55], v[104:119]
ds_read_b128 v[130:133], v188 offset:30720
ds_read_b64 v[138:139], v189 offset:32768
ds_read_b128 v[134:137], v188 offset:31744
s_mov_b64 exec, s[36:37]
ds_read_b128 v[156:159], v190 offset:33280
ds_read_b128 v[160:163], v190 offset:33920
ds_read_b128 v[164:167], v190 offset:34560
ds_read_b128 v[168:171], v190 offset:35200
s_mov_b64 exec, -1
v_exp_f32 v24, v24
s_add_u32 m0, s34, 106496
s_nop 0
buffer_load_dwordx4 v3, s[8:11], m0 offen lds
v_exp_f32 v25, v25
v_exp_f32 v26, v26
v_exp_f32 v27, v27
v_exp_f32 v28, v28
v_mfma_f32_32x32x16_bf16 v[88:103], v[140:143], v[48:51], v[88:103]
v_exp_f32 v29, v29
v_cvt_pk_bf16_f32 v52, v24, v25
v_exp_f32 v30, v30
v_cvt_pk_bf16_f32 v53, v26, v27
v_exp_f32 v31, v31
v_cvt_pk_bf16_f32 v54, v28, v29
v_cvt_pk_bf16_f32 v55, v30, v31
v_mfma_f32_32x32x16_bf16 v[16:31], v[124:127], v[172:175], v[56:71]
v_exp_f32 v32, v32
v_exp_f32 v33, v33
v_exp_f32 v34, v34
v_exp_f32 v35, v35
v_exp_f32 v36, v36
v_mfma_f32_32x32x8bf16_1k v[16:31], v[128:129], v[178:179], v[16:31]
v_exp_f32 v37, v37
v_cvt_pk_bf16_f32 v48, v32, v33
v_exp_f32 v38, v38
v_cvt_pk_bf16_f32 v49, v34, v35
v_exp_f32 v39, v39
v_cvt_pk_bf16_f32 v50, v36, v37
v_cvt_pk_bf16_f32 v51, v38, v39
v_mfma_f32_32x32x16_bf16 v[88:103], v[144:147], v[52:55], v[88:103]
v_exp_f32 v40, v40
s_add_u32 m0, s34, 114688
s_nop 0
buffer_load_dwordx4 v3, s[8:11], m0 offen lds
v_exp_f32 v41, v41
v_exp_f32 v42, v42
v_exp_f32 v43, v43
v_exp_f32 v44, v44
v_mfma_f32_32x32x16_bf16 v[104:119], v[140:143], v[48:51], v[104:119]
v_exp_f32 v45, v45
v_cvt_pk_bf16_f32 v52, v40, v41
v_exp_f32 v46, v46
v_cvt_pk_bf16_f32 v53, v42, v43
v_exp_f32 v47, v47
v_cvt_pk_bf16_f32 v54, v44, v45
v_cvt_pk_bf16_f32 v55, v46, v47
v_mfma_f32_32x32x16_bf16 v[32:47], v[124:127], v[180:183], v[72:87]
v_exp_f32 v16, v16
v_exp_f32 v17, v17
v_exp_f32 v18, v18
v_exp_f32 v19, v19
v_exp_f32 v20, v20
v_mfma_f32_32x32x8bf16_1k v[32:47], v[128:129], v[186:187], v[32:47]
v_exp_f32 v21, v21
v_cvt_pk_bf16_f32 v48, v16, v17
v_exp_f32 v22, v22
v_cvt_pk_bf16_f32 v49, v18, v19
v_exp_f32 v23, v23
v_cvt_pk_bf16_f32 v50, v20, v21
v_cvt_pk_bf16_f32 v51, v22, v23
v_mfma_f32_32x32x16_bf16 v[104:119], v[144:147], v[52:55], v[104:119]
v_exp_f32 v24, v24
s_add_u32 m0, s34, 122880
s_nop 0
buffer_load_dwordx4 v3, s[8:11], m0 offen lds
v_exp_f32 v25, v25
v_exp_f32 v26, v26
v_exp_f32 v27, v27
v_exp_f32 v28, v28
v_mfma_f32_32x32x16_bf16 v[88:103], v[148:151], v[48:51], v[88:103]
v_exp_f32 v29, v29
v_cvt_pk_bf16_f32 v52, v24, v25
v_exp_f32 v30, v30
v_cvt_pk_bf16_f32 v53, v26, v27
v_exp_f32 v31, v31
v_cvt_pk_bf16_f32 v54, v28, v29
v_cvt_pk_bf16_f32 v55, v30, v31
s_waitcnt lgkmcnt(0)
v_mfma_f32_32x32x16_bf16 v[16:31], v[130:133], v[172:175], v[56:71]
v_exp_f32 v32, v32
v_exp_f32 v33, v33
v_exp_f32 v34, v34
v_exp_f32 v35, v35
v_exp_f32 v36, v36
v_mfma_f32_32x32x8bf16_1k v[16:31], v[138:139], v[176:177], v[16:31]
v_exp_f32 v37, v37
v_cvt_pk_bf16_f32 v48, v32, v33
v_exp_f32 v38, v38
v_cvt_pk_bf16_f32 v49, v34, v35
v_exp_f32 v39, v39
v_cvt_pk_bf16_f32 v50, v36, v37
v_cvt_pk_bf16_f32 v51, v38, v39
v_mfma_f32_32x32x16_bf16 v[88:103], v[152:155], v[52:55], v[88:103]
s_setprio 0
v_exp_f32 v40, v40
s_add_u32 m0, s34, 131072
s_nop 0
buffer_load_dwordx4 v3, s[8:11], m0 offen lds
v_exp_f32 v41, v41
v_exp_f32 v42, v42
v_exp_f32 v43, v43
v_exp_f32 v44, v44
v_mfma_f32_32x32x16_bf16 v[104:119], v[148:151], v[48:51], v[104:119]
v_exp_f32 v45, v45
v_cvt_pk_bf16_f32 v52, v40, v41
v_exp_f32 v46, v46
v_cvt_pk_bf16_f32 v53, v42, v43
v_exp_f32 v47, v47
v_cvt_pk_bf16_f32 v54, v44, v45
v_cvt_pk_bf16_f32 v55, v46, v47
v_mfma_f32_32x32x16_bf16 v[32:47], v[130:133], v[180:183], v[72:87]
v_exp_f32 v16, v16
v_exp_f32 v17, v17
v_exp_f32 v18, v18
v_exp_f32 v19, v19
v_exp_f32 v20, v20
v_mfma_f32_32x32x8bf16_1k v[32:47], v[138:139], v[184:185], v[32:47]
v_exp_f32 v21, v21
v_cvt_pk_bf16_f32 v48, v16, v17
v_exp_f32 v22, v22
v_cvt_pk_bf16_f32 v49, v18, v19
v_exp_f32 v23, v23
v_cvt_pk_bf16_f32 v50, v20, v21
v_cvt_pk_bf16_f32 v51, v22, v23
v_mfma_f32_32x32x16_bf16 v[104:119], v[152:155], v[52:55], v[104:119]
s_cmp_lg_u32 s38, 0
s_cbranch_scc1 .Lat_nb5
s_waitcnt vmcnt(5)
s_barrier
.Lat_nb5:
s_setprio 1
ds_read_b128 v[120:123], v188 offset:40960
ds_read_b64 v[128:129], v189 offset:43008
ds_read_b128 v[124:127], v188 offset:41984
s_mov_b64 exec, s[36:37]
ds_read_b128 v[140:143], v190 offset:43520
ds_read_b128 v[144:147], v190 offset:44160
ds_read_b128 v[148:151], v190 offset:44800
ds_read_b128 v[152:155], v190 offset:45440
s_mov_b64 exec, -1
v_exp_f32 v24, v24
s_add_u32 m0, s34, 139264
s_nop 0
buffer_load_dwordx4 v3, s[8:11], m0 offen lds
v_exp_f32 v25, v25
v_exp_f32 v26, v26
v_exp_f32 v27, v27
v_exp_f32 v28, v28
v_mfma_f32_32x32x16_bf16 v[88:103], v[156:159], v[48:51], v[88:103]
v_exp_f32 v29, v29
v_cvt_pk_bf16_f32 v52, v24, v25
v_exp_f32 v30, v30
v_cvt_pk_bf16_f32 v53, v26, v27
v_exp_f32 v31, v31
v_cvt_pk_bf16_f32 v54, v28, v29
v_cvt_pk_bf16_f32 v55, v30, v31
v_mfma_f32_32x32x16_bf16 v[16:31], v[134:137], v[172:175], v[56:71]
v_exp_f32 v32, v32
v_exp_f32 v33, v33
v_exp_f32 v34, v34
v_exp_f32 v35, v35
v_exp_f32 v36, v36
v_mfma_f32_32x32x8bf16_1k v[16:31], v[138:139], v[178:179], v[16:31]
v_exp_f32 v37, v37
v_cvt_pk_bf16_f32 v48, v32, v33
v_exp_f32 v38, v38
v_cvt_pk_bf16_f32 v49, v34, v35
v_exp_f32 v39, v39
v_cvt_pk_bf16_f32 v50, v36, v37
v_cvt_pk_bf16_f32 v51, v38, v39
v_mfma_f32_32x32x16_bf16 v[88:103], v[160:163], v[52:55], v[88:103]
v_exp_f32 v40, v40
s_add_u32 m0, s34, 147456
s_nop 0
buffer_load_dwordx4 v3, s[8:11], m0 offen lds
v_exp_f32 v41, v41
v_exp_f32 v42, v42
v_exp_f32 v43, v43
v_exp_f32 v44, v44
v_mfma_f32_32x32x16_bf16 v[104:119], v[156:159], v[48:51], v[104:119]
v_exp_f32 v45, v45
v_cvt_pk_bf16_f32 v52, v40, v41
v_exp_f32 v46, v46
v_cvt_pk_bf16_f32 v53, v42, v43
v_exp_f32 v47, v47
v_cvt_pk_bf16_f32 v54, v44, v45
v_cvt_pk_bf16_f32 v55, v46, v47
v_mfma_f32_32x32x16_bf16 v[32:47], v[134:137], v[180:183], v[72:87]
v_exp_f32 v16, v16
v_exp_f32 v17, v17
v_exp_f32 v18, v18
v_exp_f32 v19, v19
v_exp_f32 v20, v20
v_mfma_f32_32x32x8bf16_1k v[32:47], v[138:139], v[186:187], v[32:47]
v_exp_f32 v21, v21
v_cvt_pk_bf16_f32 v48, v16, v17
v_exp_f32 v22, v22
v_cvt_pk_bf16_f32 v49, v18, v19
v_exp_f32 v23, v23
v_cvt_pk_bf16_f32 v50, v20, v21
v_cvt_pk_bf16_f32 v51, v22, v23
v_mfma_f32_32x32x16_bf16 v[104:119], v[160:163], v[52:55], v[104:119]
v_exp_f32 v24, v24
s_add_u32 m0, s34, 155648
s_nop 0
buffer_load_dwordx4 v3, s[8:11], m0 offen lds
v_exp_f32 v25, v25
v_exp_f32 v26, v26
v_exp_f32 v27, v27
v_exp_f32 v28, v28
v_mfma_f32_32x32x16_bf16 v[88:103], v[164:167], v[48:51], v[88:103]
v_exp_f32 v29, v29
v_cvt_pk_bf16_f32 v52, v24, v25
v_exp_f32 v30, v30
v_cvt_pk_bf16_f32 v53, v26, v27
v_exp_f32 v31, v31
v_cvt_pk_bf16_f32 v54, v28, v29
v_cvt_pk_bf16_f32 v55, v30, v31
s_waitcnt lgkmcnt(0)
v_mfma_f32_32x32x16_bf16 v[16:31], v[120:123], v[172:175], v[56:71]
v_exp_f32 v32, v32
v_exp_f32 v33, v33
v_exp_f32 v34, v34
v_exp_f32 v35, v35
v_exp_f32 v36, v36
v_mfma_f32_32x32x8bf16_1k v[16:31], v[128:129], v[176:177], v[16:31]
v_exp_f32 v37, v37
v_cvt_pk_bf16_f32 v48, v32, v33
v_exp_f32 v38, v38
v_cvt_pk_bf16_f32 v49, v34, v35
v_exp_f32 v39, v39
v_cvt_pk_bf16_f32 v50, v36, v37
v_cvt_pk_bf16_f32 v51, v38, v39
v_mfma_f32_32x32x16_bf16 v[88:103], v[168:171], v[52:55], v[88:103]
v_exp_f32 v40, v40
v_exp_f32 v41, v41
v_exp_f32 v42, v42
v_exp_f32 v43, v43
v_exp_f32 v44, v44
v_mfma_f32_32x32x16_bf16 v[104:119], v[164:167], v[48:51], v[104:119]
v_exp_f32 v45, v45
v_cvt_pk_bf16_f32 v52, v40, v41
v_exp_f32 v46, v46
v_cvt_pk_bf16_f32 v53, v42, v43
v_exp_f32 v47, v47
v_cvt_pk_bf16_f32 v54, v44, v45
v_cvt_pk_bf16_f32 v55, v46, v47
v_mfma_f32_32x32x16_bf16 v[32:47], v[120:123], v[180:183], v[72:87]
v_exp_f32 v16, v16
v_exp_f32 v17, v17
v_exp_f32 v18, v18
v_exp_f32 v19, v19
v_exp_f32 v20, v20
v_mfma_f32_32x32x8bf16_1k v[32:47], v[128:129], v[184:185], v[32:47]
v_exp_f32 v21, v21
v_cvt_pk_bf16_f32 v48, v16, v17
v_exp_f32 v22, v22
v_cvt_pk_bf16_f32 v49, v18, v19
v_exp_f32 v23, v23
v_cvt_pk_bf16_f32 v50, v20, v21
v_cvt_pk_bf16_f32 v51, v22, v23
v_mfma_f32_32x32x16_bf16 v[104:119], v[168:171], v[52:55], v[104:119]
ds_read_b128 v[130:133], v188 offset:51200
ds_read_b64 v[138:139], v189 offset:53248
ds_read_b128 v[134:137], v188 offset:52224
s_mov_b64 exec, s[36:37]
ds_read_b128 v[156:159], v190 offset:53760
ds_read_b128 v[160:163], v190 offset:54400
ds_read_b128 v[164:167], v190 offset:55040
ds_read_b128 v[168:171], v190 offset:55680
s_mov_b64 exec, -1
v_exp_f32 v24, v24
v_exp_f32 v25, v25
v_exp_f32 v26, v26
v_exp_f32 v27, v27
v_exp_f32 v28, v28
v_mfma_f32_32x32x16_bf16 v[88:103], v[140:143], v[48:51], v[88:103]
v_exp_f32 v29, v29
v_cvt_pk_bf16_f32 v52, v24, v25
v_exp_f32 v30, v30
v_cvt_pk_bf16_f32 v53, v26, v27
v_exp_f32 v31, v31
v_cvt_pk_bf16_f32 v54, v28, v29
v_cvt_pk_bf16_f32 v55, v30, v31
v_mfma_f32_32x32x16_bf16 v[16:31], v[124:127], v[172:175], v[56:71]
v_exp_f32 v32, v32
v_exp_f32 v33, v33
v_exp_f32 v34, v34
v_exp_f32 v35, v35
v_exp_f32 v36, v36
v_mfma_f32_32x32x8bf16_1k v[16:31], v[128:129], v[178:179], v[16:31]
v_exp_f32 v37, v37
v_cvt_pk_bf16_f32 v48, v32, v33
v_exp_f32 v38, v38
v_cvt_pk_bf16_f32 v49, v34, v35
v_exp_f32 v39, v39
v_cvt_pk_bf16_f32 v50, v36, v37
v_cvt_pk_bf16_f32 v51, v38, v39
v_mfma_f32_32x32x16_bf16 v[88:103], v[144:147], v[52:55], v[88:103]
v_exp_f32 v40, v40
v_exp_f32 v41, v41
v_exp_f32 v42, v42
v_exp_f32 v43, v43
v_exp_f32 v44, v44
v_mfma_f32_32x32x16_bf16 v[104:119], v[140:143], v[48:51], v[104:119]
v_exp_f32 v45, v45
v_cvt_pk_bf16_f32 v52, v40, v41
v_exp_f32 v46, v46
v_cvt_pk_bf16_f32 v53, v42, v43
v_exp_f32 v47, v47
v_cvt_pk_bf16_f32 v54, v44, v45
v_cvt_pk_bf16_f32 v55, v46, v47
v_mfma_f32_32x32x16_bf16 v[32:47], v[124:127], v[180:183], v[72:87]
v_exp_f32 v16, v16
v_exp_f32 v17, v17
v_exp_f32 v18, v18
v_exp_f32 v19, v19
v_exp_f32 v20, v20
v_mfma_f32_32x32x8bf16_1k v[32:47], v[128:129], v[186:187], v[32:47]
v_exp_f32 v21, v21
v_cvt_pk_bf16_f32 v48, v16, v17
v_exp_f32 v22, v22
v_cvt_pk_bf16_f32 v49, v18, v19
v_exp_f32 v23, v23
v_cvt_pk_bf16_f32 v50, v20, v21
v_cvt_pk_bf16_f32 v51, v22, v23
v_mfma_f32_32x32x16_bf16 v[104:119], v[144:147], v[52:55], v[104:119]
v_exp_f32 v24, v24
v_exp_f32 v25, v25
v_exp_f32 v26, v26
v_exp_f32 v27, v27
v_exp_f32 v28, v28
v_mfma_f32_32x32x16_bf16 v[88:103], v[148:151], v[48:51], v[88:103]
v_exp_f32 v29, v29
v_cvt_pk_bf16_f32 v52, v24, v25
v_exp_f32 v30, v30
v_cvt_pk_bf16_f32 v53, v26, v27
v_exp_f32 v31, v31
v_cvt_pk_bf16_f32 v54, v28, v29
v_cvt_pk_bf16_f32 v55, v30, v31
s_waitcnt lgkmcnt(0)
v_mfma_f32_32x32x16_bf16 v[16:31], v[130:133], v[172:175], v[56:71]
v_exp_f32 v32, v32
v_exp_f32 v33, v33
v_exp_f32 v34, v34
v_exp_f32 v35, v35
v_exp_f32 v36, v36
v_mfma_f32_32x32x8bf16_1k v[16:31], v[138:139], v[176:177], v[16:31]
v_exp_f32 v37, v37
v_cvt_pk_bf16_f32 v48, v32, v33
v_exp_f32 v38, v38
v_cvt_pk_bf16_f32 v49, v34, v35
v_exp_f32 v39, v39
v_cvt_pk_bf16_f32 v50, v36, v37
v_cvt_pk_bf16_f32 v51, v38, v39
v_mfma_f32_32x32x16_bf16 v[88:103], v[152:155], v[52:55], v[88:103]
v_exp_f32 v40, v40
v_exp_f32 v41, v41
v_exp_f32 v42, v42
v_exp_f32 v43, v43
v_exp_f32 v44, v44
v_mfma_f32_32x32x16_bf16 v[104:119], v[148:151], v[48:51], v[104:119]
v_exp_f32 v45, v45
v_cvt_pk_bf16_f32 v52, v40, v41
v_exp_f32 v46, v46
v_cvt_pk_bf16_f32 v53, v42, v43
v_exp_f32 v47, v47
v_cvt_pk_bf16_f32 v54, v44, v45
v_cvt_pk_bf16_f32 v55, v46, v47
v_mfma_f32_32x32x16_bf16 v[32:47], v[130:133], v[180:183], v[72:87]
v_exp_f32 v16, v16
v_exp_f32 v17, v17
v_exp_f32 v18, v18
v_exp_f32 v19, v19
v_exp_f32 v20, v20
v_mfma_f32_32x32x8bf16_1k v[32:47], v[138:139], v[184:185], v[32:47]
v_exp_f32 v21, v21
v_cvt_pk_bf16_f32 v48, v16, v17
v_exp_f32 v22, v22
v_cvt_pk_bf16_f32 v49, v18, v19
v_exp_f32 v23, v23
v_cvt_pk_bf16_f32 v50, v20, v21
v_cvt_pk_bf16_f32 v51, v22, v23
v_mfma_f32_32x32x16_bf16 v[104:119], v[152:155], v[52:55], v[104:119]
ds_read_b128 v[120:123], v191 offset:0
ds_read_b64 v[128:129], v192 offset:2048
ds_read_b128 v[124:127], v191 offset:1024
s_mov_b64 exec, s[36:37]
ds_read_b128 v[140:143], v193 offset:2560
ds_read_b128 v[144:147], v193 offset:3200
ds_read_b128 v[148:151], v193 offset:3840
ds_read_b128 v[152:155], v193 offset:4480
s_mov_b64 exec, -1
v_exp_f32 v24, v24
v_exp_f32 v25, v25
v_exp_f32 v26, v26
v_exp_f32 v27, v27
v_exp_f32 v28, v28
v_mfma_f32_32x32x16_bf16 v[88:103], v[156:159], v[48:51], v[88:103]
v_exp_f32 v29, v29
v_cvt_pk_bf16_f32 v52, v24, v25
v_exp_f32 v30, v30
v_cvt_pk_bf16_f32 v53, v26, v27
v_exp_f32 v31, v31
v_cvt_pk_bf16_f32 v54, v28, v29
v_cvt_pk_bf16_f32 v55, v30, v31
v_mfma_f32_32x32x16_bf16 v[16:31], v[134:137], v[172:175], v[56:71]
v_exp_f32 v32, v32
v_exp_f32 v33, v33
v_exp_f32 v34, v34
v_exp_f32 v35, v35
v_exp_f32 v36, v36
v_mfma_f32_32x32x8bf16_1k v[16:31], v[138:139], v[178:179], v[16:31]
v_exp_f32 v37, v37
v_cvt_pk_bf16_f32 v48, v32, v33
v_exp_f32 v38, v38
v_cvt_pk_bf16_f32 v49, v34, v35
v_exp_f32 v39, v39
v_cvt_pk_bf16_f32 v50, v36, v37
v_cvt_pk_bf16_f32 v51, v38, v39
v_mfma_f32_32x32x16_bf16 v[88:103], v[160:163], v[52:55], v[88:103]
v_exp_f32 v40, v40
v_exp_f32 v41, v41
v_exp_f32 v42, v42
v_exp_f32 v43, v43
v_exp_f32 v44, v44
v_mfma_f32_32x32x16_bf16 v[104:119], v[156:159], v[48:51], v[104:119]
v_exp_f32 v45, v45
v_cvt_pk_bf16_f32 v52, v40, v41
v_exp_f32 v46, v46
v_cvt_pk_bf16_f32 v53, v42, v43
v_exp_f32 v47, v47
v_cvt_pk_bf16_f32 v54, v44, v45
v_cvt_pk_bf16_f32 v55, v46, v47
v_mfma_f32_32x32x16_bf16 v[32:47], v[134:137], v[180:183], v[72:87]
v_exp_f32 v16, v16
v_exp_f32 v17, v17
v_exp_f32 v18, v18
v_exp_f32 v19, v19
v_exp_f32 v20, v20
v_mfma_f32_32x32x8bf16_1k v[32:47], v[138:139], v[186:187], v[32:47]
v_exp_f32 v21, v21
v_cvt_pk_bf16_f32 v48, v16, v17
v_exp_f32 v22, v22
v_cvt_pk_bf16_f32 v49, v18, v19
v_exp_f32 v23, v23
v_cvt_pk_bf16_f32 v50, v20, v21
v_cvt_pk_bf16_f32 v51, v22, v23
v_mfma_f32_32x32x16_bf16 v[104:119], v[160:163], v[52:55], v[104:119]
v_exp_f32 v24, v24
v_exp_f32 v25, v25
v_exp_f32 v26, v26
v_exp_f32 v27, v27
v_exp_f32 v28, v28
v_mfma_f32_32x32x16_bf16 v[88:103], v[164:167], v[48:51], v[88:103]
v_exp_f32 v29, v29
v_cvt_pk_bf16_f32 v52, v24, v25
v_exp_f32 v30, v30
v_cvt_pk_bf16_f32 v53, v26, v27
v_exp_f32 v31, v31
v_cvt_pk_bf16_f32 v54, v28, v29
v_cvt_pk_bf16_f32 v55, v30, v31
s_waitcnt lgkmcnt(0)
v_mfma_f32_32x32x16_bf16 v[16:31], v[120:123], v[172:175], v[56:71]
v_exp_f32 v32, v32
v_exp_f32 v33, v33
v_exp_f32 v34, v34
v_exp_f32 v35, v35
v_exp_f32 v36, v36
v_mfma_f32_32x32x8bf16_1k v[16:31], v[128:129], v[176:177], v[16:31]
v_exp_f32 v37, v37
v_cvt_pk_bf16_f32 v48, v32, v33
v_exp_f32 v38, v38
v_cvt_pk_bf16_f32 v49, v34, v35
v_exp_f32 v39, v39
v_cvt_pk_bf16_f32 v50, v36, v37
v_cvt_pk_bf16_f32 v51, v38, v39
v_mfma_f32_32x32x16_bf16 v[88:103], v[168:171], v[52:55], v[88:103]
v_exp_f32 v40, v40
v_exp_f32 v41, v41
v_exp_f32 v42, v42
v_exp_f32 v43, v43
v_exp_f32 v44, v44
v_mfma_f32_32x32x16_bf16 v[104:119], v[164:167], v[48:51], v[104:119]
v_exp_f32 v45, v45
v_cvt_pk_bf16_f32 v52, v40, v41
v_exp_f32 v46, v46
v_cvt_pk_bf16_f32 v53, v42, v43
v_exp_f32 v47, v47
v_cvt_pk_bf16_f32 v54, v44, v45
v_cvt_pk_bf16_f32 v55, v46, v47
v_mfma_f32_32x32x16_bf16 v[32:47], v[120:123], v[180:183], v[72:87]
v_exp_f32 v16, v16
v_exp_f32 v17, v17
v_exp_f32 v18, v18
v_exp_f32 v19, v19
v_exp_f32 v20, v20
v_mfma_f32_32x32x8bf16_1k v[32:47], v[128:129], v[184:185], v[32:47]
v_exp_f32 v21, v21
v_cvt_pk_bf16_f32 v48, v16, v17
v_exp_f32 v22, v22
v_cvt_pk_bf16_f32 v49, v18, v19
v_exp_f32 v23, v23
v_cvt_pk_bf16_f32 v50, v20, v21
v_cvt_pk_bf16_f32 v51, v22, v23
v_mfma_f32_32x32x16_bf16 v[104:119], v[168:171], v[52:55], v[104:119]
ds_read_b128 v[130:133], v191 offset:10240
ds_read_b64 v[138:139], v192 offset:12288
ds_read_b128 v[134:137], v191 offset:11264
s_mov_b64 exec, s[36:37]
ds_read_b128 v[156:159], v193 offset:12800
ds_read_b128 v[160:163], v193 offset:13440
ds_read_b128 v[164:167], v193 offset:14080
ds_read_b128 v[168:171], v193 offset:14720
s_mov_b64 exec, -1
v_exp_f32 v24, v24
v_exp_f32 v25, v25
v_exp_f32 v26, v26
v_exp_f32 v27, v27
v_exp_f32 v28, v28
v_mfma_f32_32x32x16_bf16 v[88:103], v[140:143], v[48:51], v[88:103]
v_exp_f32 v29, v29
v_cvt_pk_bf16_f32 v52, v24, v25
v_exp_f32 v30, v30
v_cvt_pk_bf16_f32 v53, v26, v27
v_exp_f32 v31, v31
v_cvt_pk_bf16_f32 v54, v28, v29
v_cvt_pk_bf16_f32 v55, v30, v31
v_mfma_f32_32x32x16_bf16 v[16:31], v[124:127], v[172:175], v[56:71]
v_exp_f32 v32, v32
v_exp_f32 v33, v33
v_exp_f32 v34, v34
v_exp_f32 v35, v35
v_exp_f32 v36, v36
v_mfma_f32_32x32x8bf16_1k v[16:31], v[128:129], v[178:179], v[16:31]
v_exp_f32 v37, v37
v_cvt_pk_bf16_f32 v48, v32, v33
v_exp_f32 v38, v38
v_cvt_pk_bf16_f32 v49, v34, v35
v_exp_f32 v39, v39
v_cvt_pk_bf16_f32 v50, v36, v37
v_cvt_pk_bf16_f32 v51, v38, v39
v_mfma_f32_32x32x16_bf16 v[88:103], v[144:147], v[52:55], v[88:103]
v_exp_f32 v40, v40
v_exp_f32 v41, v41
v_exp_f32 v42, v42
v_exp_f32 v43, v43
v_exp_f32 v44, v44
v_mfma_f32_32x32x16_bf16 v[104:119], v[140:143], v[48:51], v[104:119]
v_exp_f32 v45, v45
v_cvt_pk_bf16_f32 v52, v40, v41
v_exp_f32 v46, v46
v_cvt_pk_bf16_f32 v53, v42, v43
v_exp_f32 v47, v47
v_cvt_pk_bf16_f32 v54, v44, v45
v_cvt_pk_bf16_f32 v55, v46, v47
v_mfma_f32_32x32x16_bf16 v[32:47], v[124:127], v[180:183], v[72:87]
v_exp_f32 v16, v16
v_exp_f32 v17, v17
v_exp_f32 v18, v18
v_exp_f32 v19, v19
v_exp_f32 v20, v20
v_mfma_f32_32x32x8bf16_1k v[32:47], v[128:129], v[186:187], v[32:47]
v_exp_f32 v21, v21
v_cvt_pk_bf16_f32 v48, v16, v17
v_exp_f32 v22, v22
v_cvt_pk_bf16_f32 v49, v18, v19
v_exp_f32 v23, v23
v_cvt_pk_bf16_f32 v50, v20, v21
v_cvt_pk_bf16_f32 v51, v22, v23
v_mfma_f32_32x32x16_bf16 v[104:119], v[144:147], v[52:55], v[104:119]
v_exp_f32 v24, v24
v_exp_f32 v25, v25
v_exp_f32 v26, v26
v_exp_f32 v27, v27
v_exp_f32 v28, v28
v_mfma_f32_32x32x16_bf16 v[88:103], v[148:151], v[48:51], v[88:103]
v_exp_f32 v29, v29
v_cvt_pk_bf16_f32 v52, v24, v25
v_exp_f32 v30, v30
v_cvt_pk_bf16_f32 v53, v26, v27
v_exp_f32 v31, v31
v_cvt_pk_bf16_f32 v54, v28, v29
v_cvt_pk_bf16_f32 v55, v30, v31
s_waitcnt lgkmcnt(0)
v_mfma_f32_32x32x16_bf16 v[16:31], v[130:133], v[172:175], v[56:71]
v_exp_f32 v32, v32
v_exp_f32 v33, v33
v_exp_f32 v34, v34
v_exp_f32 v35, v35
v_exp_f32 v36, v36
v_mfma_f32_32x32x8bf16_1k v[16:31], v[138:139], v[176:177], v[16:31]
v_exp_f32 v37, v37
v_cvt_pk_bf16_f32 v48, v32, v33
v_exp_f32 v38, v38
v_cvt_pk_bf16_f32 v49, v34, v35
v_exp_f32 v39, v39
v_cvt_pk_bf16_f32 v50, v36, v37
v_cvt_pk_bf16_f32 v51, v38, v39
v_mfma_f32_32x32x16_bf16 v[88:103], v[152:155], v[52:55], v[88:103]
v_exp_f32 v40, v40
v_exp_f32 v41, v41
v_exp_f32 v42, v42
v_exp_f32 v43, v43
v_exp_f32 v44, v44
v_mfma_f32_32x32x16_bf16 v[104:119], v[148:151], v[48:51], v[104:119]
v_exp_f32 v45, v45
v_cvt_pk_bf16_f32 v52, v40, v41
v_exp_f32 v46, v46
v_cvt_pk_bf16_f32 v53, v42, v43
v_exp_f32 v47, v47
v_cvt_pk_bf16_f32 v54, v44, v45
v_cvt_pk_bf16_f32 v55, v46, v47
v_mfma_f32_32x32x16_bf16 v[32:47], v[130:133], v[180:183], v[72:87]
v_exp_f32 v16, v16
v_exp_f32 v17, v17
v_exp_f32 v18, v18
v_exp_f32 v19, v19
v_exp_f32 v20, v20
v_mfma_f32_32x32x8bf16_1k v[32:47], v[138:139], v[184:185], v[32:47]
v_exp_f32 v21, v21
v_cvt_pk_bf16_f32 v48, v16, v17
v_exp_f32 v22, v22
v_cvt_pk_bf16_f32 v49, v18, v19
v_exp_f32 v23, v23
v_cvt_pk_bf16_f32 v50, v20, v21
v_cvt_pk_bf16_f32 v51, v22, v23
v_mfma_f32_32x32x16_bf16 v[104:119], v[152:155], v[52:55], v[104:119]
ds_read_b128 v[120:123], v191 offset:20480
ds_read_b64 v[128:129], v192 offset:22528
ds_read_b128 v[124:127], v191 offset:21504
s_mov_b64 exec, s[36:37]
ds_read_b128 v[140:143], v193 offset:23040
ds_read_b128 v[144:147], v193 offset:23680
ds_read_b128 v[148:151], v193 offset:24320
ds_read_b128 v[152:155], v193 offset:24960
s_mov_b64 exec, -1
v_exp_f32 v24, v24
v_exp_f32 v25, v25
v_exp_f32 v26, v26
v_exp_f32 v27, v27
v_exp_f32 v28, v28
v_mfma_f32_32x32x16_bf16 v[88:103], v[156:159], v[48:51], v[88:103]
v_exp_f32 v29, v29
v_cvt_pk_bf16_f32 v52, v24, v25
v_exp_f32 v30, v30
v_cvt_pk_bf16_f32 v53, v26, v27
v_exp_f32 v31, v31
v_cvt_pk_bf16_f32 v54, v28, v29
v_cvt_pk_bf16_f32 v55, v30, v31
v_mfma_f32_32x32x16_bf16 v[16:31], v[134:137], v[172:175], v[56:71]
v_exp_f32 v32, v32
v_exp_f32 v33, v33
v_exp_f32 v34, v34
v_exp_f32 v35, v35
v_exp_f32 v36, v36
v_mfma_f32_32x32x8bf16_1k v[16:31], v[138:139], v[178:179], v[16:31]
v_exp_f32 v37, v37
v_cvt_pk_bf16_f32 v48, v32, v33
v_exp_f32 v38, v38
v_cvt_pk_bf16_f32 v49, v34, v35
v_exp_f32 v39, v39
v_cvt_pk_bf16_f32 v50, v36, v37
v_cvt_pk_bf16_f32 v51, v38, v39
v_mfma_f32_32x32x16_bf16 v[88:103], v[160:163], v[52:55], v[88:103]
v_exp_f32 v40, v40
v_exp_f32 v41, v41
v_exp_f32 v42, v42
v_exp_f32 v43, v43
v_exp_f32 v44, v44
v_mfma_f32_32x32x16_bf16 v[104:119], v[156:159], v[48:51], v[104:119]
v_exp_f32 v45, v45
v_cvt_pk_bf16_f32 v52, v40, v41
v_exp_f32 v46, v46
v_cvt_pk_bf16_f32 v53, v42, v43
v_exp_f32 v47, v47
v_cvt_pk_bf16_f32 v54, v44, v45
v_cvt_pk_bf16_f32 v55, v46, v47
v_mfma_f32_32x32x16_bf16 v[32:47], v[134:137], v[180:183], v[72:87]
v_exp_f32 v16, v16
v_exp_f32 v17, v17
v_exp_f32 v18, v18
v_exp_f32 v19, v19
v_exp_f32 v20, v20
v_mfma_f32_32x32x8bf16_1k v[32:47], v[138:139], v[186:187], v[32:47]
v_exp_f32 v21, v21
v_cvt_pk_bf16_f32 v48, v16, v17
v_exp_f32 v22, v22
v_cvt_pk_bf16_f32 v49, v18, v19
v_exp_f32 v23, v23
v_cvt_pk_bf16_f32 v50, v20, v21
v_cvt_pk_bf16_f32 v51, v22, v23
v_mfma_f32_32x32x16_bf16 v[104:119], v[160:163], v[52:55], v[104:119]
s_setprio 0
v_exp_f32 v24, v24
v_exp_f32 v25, v25
v_exp_f32 v26, v26
v_exp_f32 v27, v27
v_exp_f32 v28, v28
v_mfma_f32_32x32x16_bf16 v[88:103], v[164:167], v[48:51], v[88:103]
v_exp_f32 v29, v29
v_cvt_pk_bf16_f32 v52, v24, v25
v_exp_f32 v30, v30
v_cvt_pk_bf16_f32 v53, v26, v27
v_exp_f32 v31, v31
v_cvt_pk_bf16_f32 v54, v28, v29
v_cvt_pk_bf16_f32 v55, v30, v31
s_waitcnt lgkmcnt(0)
v_mfma_f32_32x32x16_bf16 v[16:31], v[120:123], v[172:175], v[56:71]
v_exp_f32 v32, v32
v_exp_f32 v33, v33
v_exp_f32 v34, v34
v_exp_f32 v35, v35
v_exp_f32 v36, v36
v_mfma_f32_32x32x8bf16_1k v[16:31], v[128:129], v[176:177], v[16:31]
v_exp_f32 v37, v37
v_cvt_pk_bf16_f32 v48, v32, v33
v_exp_f32 v38, v38
v_cvt_pk_bf16_f32 v49, v34, v35
v_exp_f32 v39, v39
v_cvt_pk_bf16_f32 v50, v36, v37
v_cvt_pk_bf16_f32 v51, v38, v39
v_mfma_f32_32x32x16_bf16 v[88:103], v[168:171], v[52:55], v[88:103]
v_exp_f32 v40, v40
v_exp_f32 v41, v41
v_exp_f32 v42, v42
v_exp_f32 v43, v43
v_exp_f32 v44, v44
v_mfma_f32_32x32x16_bf16 v[104:119], v[164:167], v[48:51], v[104:119]
v_exp_f32 v45, v45
v_cvt_pk_bf16_f32 v52, v40, v41
v_exp_f32 v46, v46
v_cvt_pk_bf16_f32 v53, v42, v43
v_exp_f32 v47, v47
v_cvt_pk_bf16_f32 v54, v44, v45
v_cvt_pk_bf16_f32 v55, v46, v47
v_mfma_f32_32x32x16_bf16 v[32:47], v[120:123], v[180:183], v[72:87]
v_exp_f32 v16, v16
v_exp_f32 v17, v17
v_exp_f32 v18, v18
v_exp_f32 v19, v19
v_exp_f32 v20, v20
v_mfma_f32_32x32x8bf16_1k v[32:47], v[128:129], v[184:185], v[32:47]
v_exp_f32 v21, v21
v_cvt_pk_bf16_f32 v48, v16, v17
v_exp_f32 v22, v22
v_cvt_pk_bf16_f32 v49, v18, v19
v_exp_f32 v23, v23
v_cvt_pk_bf16_f32 v50, v20, v21
v_cvt_pk_bf16_f32 v51, v22, v23
v_mfma_f32_32x32x16_bf16 v[104:119], v[168:171], v[52:55], v[104:119]
s_cmp_lg_u32 s38, 0
s_cbranch_scc1 .Lat_nb6
s_waitcnt vmcnt(0)
s_barrier
.Lat_nb6:
s_setprio 1
ds_read_b128 v[130:133], v191 offset:30720
ds_read_b64 v[138:139], v192 offset:32768
ds_read_b128 v[134:137], v191 offset:31744
s_mov_b64 exec, s[36:37]
ds_read_b128 v[156:159], v193 offset:33280
ds_read_b128 v[160:163], v193 offset:33920
ds_read_b128 v[164:167], v193 offset:34560
ds_read_b128 v[168:171], v193 offset:35200
s_mov_b64 exec, -1
v_exp_f32 v24, v24
v_exp_f32 v25, v25
v_exp_f32 v26, v26
v_exp_f32 v27, v27
v_exp_f32 v28, v28
v_mfma_f32_32x32x16_bf16 v[88:103], v[140:143], v[48:51], v[88:103]
v_exp_f32 v29, v29
v_cvt_pk_bf16_f32 v52, v24, v25
v_exp_f32 v30, v30
v_cvt_pk_bf16_f32 v53, v26, v27
v_exp_f32 v31, v31
v_cvt_pk_bf16_f32 v54, v28, v29
v_cvt_pk_bf16_f32 v55, v30, v31
v_mfma_f32_32x32x16_bf16 v[16:31], v[124:127], v[172:175], v[56:71]
v_exp_f32 v32, v32
v_exp_f32 v33, v33
v_exp_f32 v34, v34
v_exp_f32 v35, v35
v_exp_f32 v36, v36
v_mfma_f32_32x32x8bf16_1k v[16:31], v[128:129], v[178:179], v[16:31]
v_exp_f32 v37, v37
v_cvt_pk_bf16_f32 v48, v32, v33
v_exp_f32 v38, v38
v_cvt_pk_bf16_f32 v49, v34, v35
v_exp_f32 v39, v39
v_cvt_pk_bf16_f32 v50, v36, v37
v_cvt_pk_bf16_f32 v51, v38, v39
v_mfma_f32_32x32x16_bf16 v[88:103], v[144:147], v[52:55], v[88:103]
v_exp_f32 v40, v40
v_exp_f32 v41, v41
v_exp_f32 v42, v42
v_exp_f32 v43, v43
v_exp_f32 v44, v44
v_mfma_f32_32x32x16_bf16 v[104:119], v[140:143], v[48:51], v[104:119]
v_exp_f32 v45, v45
v_cvt_pk_bf16_f32 v52, v40, v41
v_exp_f32 v46, v46
v_cvt_pk_bf16_f32 v53, v42, v43
v_exp_f32 v47, v47
v_cvt_pk_bf16_f32 v54, v44, v45
v_cvt_pk_bf16_f32 v55, v46, v47
v_mfma_f32_32x32x16_bf16 v[32:47], v[124:127], v[180:183], v[72:87]
v_exp_f32 v16, v16
v_exp_f32 v17, v17
v_exp_f32 v18, v18
v_exp_f32 v19, v19
v_exp_f32 v20, v20
v_mfma_f32_32x32x8bf16_1k v[32:47], v[128:129], v[186:187], v[32:47]
v_exp_f32 v21, v21
v_cvt_pk_bf16_f32 v48, v16, v17
v_exp_f32 v22, v22
v_cvt_pk_bf16_f32 v49, v18, v19
v_exp_f32 v23, v23
v_cvt_pk_bf16_f32 v50, v20, v21
v_cvt_pk_bf16_f32 v51, v22, v23
v_mfma_f32_32x32x16_bf16 v[104:119], v[144:147], v[52:55], v[104:119]
v_exp_f32 v24, v24
v_exp_f32 v25, v25
v_exp_f32 v26, v26
v_exp_f32 v27, v27
v_exp_f32 v28, v28
v_mfma_f32_32x32x16_bf16 v[88:103], v[148:151], v[48:51], v[88:103]
v_exp_f32 v29, v29
v_cvt_pk_bf16_f32 v52, v24, v25
v_exp_f32 v30, v30
v_cvt_pk_bf16_f32 v53, v26, v27
v_exp_f32 v31, v31
v_cvt_pk_bf16_f32 v54, v28, v29
v_cvt_pk_bf16_f32 v55, v30, v31
s_waitcnt lgkmcnt(0)
v_mfma_f32_32x32x16_bf16 v[16:31], v[130:133], v[172:175], v[56:71]
v_exp_f32 v32, v32
v_exp_f32 v33, v33
v_exp_f32 v34, v34
v_exp_f32 v35, v35
v_exp_f32 v36, v36
v_mfma_f32_32x32x8bf16_1k v[16:31], v[138:139], v[176:177], v[16:31]
v_exp_f32 v37, v37
v_cvt_pk_bf16_f32 v48, v32, v33
v_exp_f32 v38, v38
v_cvt_pk_bf16_f32 v49, v34, v35
v_exp_f32 v39, v39
v_cvt_pk_bf16_f32 v50, v36, v37
v_cvt_pk_bf16_f32 v51, v38, v39
v_mfma_f32_32x32x16_bf16 v[88:103], v[152:155], v[52:55], v[88:103]
v_exp_f32 v40, v40
v_exp_f32 v41, v41
v_exp_f32 v42, v42
v_exp_f32 v43, v43
v_exp_f32 v44, v44
v_mfma_f32_32x32x16_bf16 v[104:119], v[148:151], v[48:51], v[104:119]
v_exp_f32 v45, v45
v_cvt_pk_bf16_f32 v52, v40, v41
v_exp_f32 v46, v46
v_cvt_pk_bf16_f32 v53, v42, v43
v_exp_f32 v47, v47
v_cvt_pk_bf16_f32 v54, v44, v45
v_cvt_pk_bf16_f32 v55, v46, v47
v_mfma_f32_32x32x16_bf16 v[32:47], v[130:133], v[180:183], v[72:87]
v_exp_f32 v16, v16
v_exp_f32 v17, v17
v_exp_f32 v18, v18
v_exp_f32 v19, v19
v_exp_f32 v20, v20
v_mfma_f32_32x32x8bf16_1k v[32:47], v[138:139], v[184:185], v[32:47]
v_exp_f32 v21, v21
v_cvt_pk_bf16_f32 v48, v16, v17
v_exp_f32 v22, v22
v_cvt_pk_bf16_f32 v49, v18, v19
v_exp_f32 v23, v23
v_cvt_pk_bf16_f32 v50, v20, v21
v_cvt_pk_bf16_f32 v51, v22, v23
v_mfma_f32_32x32x16_bf16 v[104:119], v[152:155], v[52:55], v[104:119]
ds_read_b128 v[120:123], v191 offset:40960
ds_read_b64 v[128:129], v192 offset:43008
ds_read_b128 v[124:127], v191 offset:41984
s_mov_b64 exec, s[36:37]
ds_read_b128 v[140:143], v193 offset:43520
ds_read_b128 v[144:147], v193 offset:44160
ds_read_b128 v[148:151], v193 offset:44800
ds_read_b128 v[152:155], v193 offset:45440
s_mov_b64 exec, -1
v_exp_f32 v24, v24
v_exp_f32 v25, v25
v_exp_f32 v26, v26
v_exp_f32 v27, v27
v_exp_f32 v28, v28
v_mfma_f32_32x32x16_bf16 v[88:103], v[156:159], v[48:51], v[88:103]
v_exp_f32 v29, v29
v_cvt_pk_bf16_f32 v52, v24, v25
v_exp_f32 v30, v30
v_cvt_pk_bf16_f32 v53, v26, v27
v_exp_f32 v31, v31
v_cvt_pk_bf16_f32 v54, v28, v29
v_cvt_pk_bf16_f32 v55, v30, v31
v_mfma_f32_32x32x16_bf16 v[16:31], v[134:137], v[172:175], v[56:71]
v_exp_f32 v32, v32
v_exp_f32 v33, v33
v_exp_f32 v34, v34
v_exp_f32 v35, v35
v_exp_f32 v36, v36
v_mfma_f32_32x32x8bf16_1k v[16:31], v[138:139], v[178:179], v[16:31]
v_exp_f32 v37, v37
v_cvt_pk_bf16_f32 v48, v32, v33
v_exp_f32 v38, v38
v_cvt_pk_bf16_f32 v49, v34, v35
v_exp_f32 v39, v39
v_cvt_pk_bf16_f32 v50, v36, v37
v_cvt_pk_bf16_f32 v51, v38, v39
v_mfma_f32_32x32x16_bf16 v[88:103], v[160:163], v[52:55], v[88:103]
v_exp_f32 v40, v40
v_exp_f32 v41, v41
v_exp_f32 v42, v42
v_exp_f32 v43, v43
v_exp_f32 v44, v44
v_mfma_f32_32x32x16_bf16 v[104:119], v[156:159], v[48:51], v[104:119]
v_exp_f32 v45, v45
v_cvt_pk_bf16_f32 v52, v40, v41
v_exp_f32 v46, v46
v_cvt_pk_bf16_f32 v53, v42, v43
v_exp_f32 v47, v47
v_cvt_pk_bf16_f32 v54, v44, v45
v_cvt_pk_bf16_f32 v55, v46, v47
v_mfma_f32_32x32x16_bf16 v[32:47], v[134:137], v[180:183], v[72:87]
v_exp_f32 v16, v16
v_exp_f32 v17, v17
v_exp_f32 v18, v18
v_exp_f32 v19, v19
v_exp_f32 v20, v20
v_mfma_f32_32x32x8bf16_1k v[32:47], v[138:139], v[186:187], v[32:47]
v_exp_f32 v21, v21
v_cvt_pk_bf16_f32 v48, v16, v17
v_exp_f32 v22, v22
v_cvt_pk_bf16_f32 v49, v18, v19
v_exp_f32 v23, v23
v_cvt_pk_bf16_f32 v50, v20, v21
v_cvt_pk_bf16_f32 v51, v22, v23
v_mfma_f32_32x32x16_bf16 v[104:119], v[160:163], v[52:55], v[104:119]
v_exp_f32 v24, v24
v_exp_f32 v25, v25
v_exp_f32 v26, v26
v_exp_f32 v27, v27
v_exp_f32 v28, v28
v_mfma_f32_32x32x16_bf16 v[88:103], v[164:167], v[48:51], v[88:103]
v_exp_f32 v29, v29
v_cvt_pk_bf16_f32 v52, v24, v25
v_exp_f32 v30, v30
v_cvt_pk_bf16_f32 v53, v26, v27
v_exp_f32 v31, v31
v_cvt_pk_bf16_f32 v54, v28, v29
v_cvt_pk_bf16_f32 v55, v30, v31
s_waitcnt lgkmcnt(0)
v_mfma_f32_32x32x16_bf16 v[16:31], v[120:123], v[172:175], v[56:71]
v_exp_f32 v32, v32
v_exp_f32 v33, v33
v_exp_f32 v34, v34
v_exp_f32 v35, v35
v_exp_f32 v36, v36
v_mfma_f32_32x32x8bf16_1k v[16:31], v[128:129], v[176:177], v[16:31]
v_exp_f32 v37, v37
v_cvt_pk_bf16_f32 v48, v32, v33
v_exp_f32 v38, v38
v_cvt_pk_bf16_f32 v49, v34, v35
v_exp_f32 v39, v39
v_cvt_pk_bf16_f32 v50, v36, v37
v_cvt_pk_bf16_f32 v51, v38, v39
v_mfma_f32_32x32x16_bf16 v[88:103], v[168:171], v[52:55], v[88:103]
v_exp_f32 v40, v40
v_exp_f32 v41, v41
v_exp_f32 v42, v42
v_exp_f32 v43, v43
v_exp_f32 v44, v44
v_mfma_f32_32x32x16_bf16 v[104:119], v[164:167], v[48:51], v[104:119]
v_exp_f32 v45, v45
v_cvt_pk_bf16_f32 v52, v40, v41
v_exp_f32 v46, v46
v_cvt_pk_bf16_f32 v53, v42, v43
v_exp_f32 v47, v47
v_cvt_pk_bf16_f32 v54, v44, v45
v_cvt_pk_bf16_f32 v55, v46, v47
v_mfma_f32_32x32x16_bf16 v[32:47], v[120:123], v[180:183], v[72:87]
v_exp_f32 v16, v16
v_exp_f32 v17, v17
v_exp_f32 v18, v18
v_exp_f32 v19, v19
v_exp_f32 v20, v20
v_mfma_f32_32x32x8bf16_1k v[32:47], v[128:129], v[184:185], v[32:47]
v_exp_f32 v21, v21
v_cvt_pk_bf16_f32 v48, v16, v17
v_exp_f32 v22, v22
v_cvt_pk_bf16_f32 v49, v18, v19
v_exp_f32 v23, v23
v_cvt_pk_bf16_f32 v50, v20, v21
v_cvt_pk_bf16_f32 v51, v22, v23
v_mfma_f32_32x32x16_bf16 v[104:119], v[168:171], v[52:55], v[104:119]
ds_read_b128 v[130:133], v191 offset:51200
ds_read_b64 v[138:139], v192 offset:53248
ds_read_b128 v[134:137], v191 offset:52224
s_mov_b64 exec, s[36:37]
ds_read_b128 v[156:159], v193 offset:53760
ds_read_b128 v[160:163], v193 offset:54400
ds_read_b128 v[164:167], v193 offset:55040
ds_read_b128 v[168:171], v193 offset:55680
s_mov_b64 exec, -1
s_lshr_b32 s43, s2, 3
s_lshl_b32 s43, s43, 9
v_add_u32 v14, s43, v0
s_and_b32 s43, s2, 7
v_lshlrev_b32 v15, 7, v14
s_cmp_lg_u32 s42, 0
s_cbranch_scc1 .Lat_pf27
s_add_u32 s44, s4, 20971520
s_addc_u32 s45, s5, 0
s_mov_b32 s46, 819200
s_mov_b32 s47, 0x00020000
buffer_load_dword v13, v15, s[44:47], 0 offen
s_and_b32 s48, s43, 1
s_mul_i32 s48, s48, 1310720
s_add_u32 s48, s48, 18350080
s_add_u32 s44, s4, s48
s_addc_u32 s45, s5, 0
s_mov_b32 s46, 1310720
s_mov_b32 s47, 0x00020000
buffer_load_dword v13, v15, s[44:47], 0 offen
v_lshrrev_b32 v12, 2, v14
v_lshlrev_b32 v12, 12, v12
v_and_b32 v11, 0x180, v15
v_add_u32 v12, v12, v11
s_lshl_b32 s48, s43, 9
v_add_u32 v12, s48, v12
s_add_u32 s44, s4, 2621440
s_addc_u32 s45, s5, 0
s_mov_b32 s46, 2621440
s_mov_b32 s47, 0x00020000
buffer_load_dword v13, v12, s[44:47], 0 offen
v_lshrrev_b32 v12, 6, v14
v_lshlrev_b32 v12, 16, v12
v_and_b32 v11, 0x1f80, v15
v_add_u32 v12, v12, v11
s_lshl_b32 s48, s43, 13
v_add_u32 v12, s48, v12
s_add_u32 s44, s4, 23068672
s_addc_u32 s45, s5, 0
s_mov_b32 s46, 2621440
s_mov_b32 s47, 0x00020000
buffer_load_dword v13, v12, s[44:47], 0 offen
s_branch .Lat_pfe8
.Lat_pf27:
s_add_u32 s44, s4, 22020096
s_addc_u32 s45, s5, 0
s_mov_b32 s46, 819200
s_mov_b32 s47, 0x00020000
buffer_load_dword v13, v15, s[44:47], 0 offen
s_getpc_b64 s[48:49]
s_add_u32 s48, s48, .Ltab3@rel32@lo+4
s_addc_u32 s49, s49, .Ltab3@rel32@hi+12
s_add_u32 s44, s48, 0
s_addc_u32 s45, s49, 0
s_mov_b32 s46, 819200
s_mov_b32 s47, 0x00020000
buffer_load_dword v13, v15, s[44:47], 0 offen
s_mul_i32 s48, s43, 327680
s_add_u32 s48, s48, 34078720
s_add_u32 s44, s4, s48
s_addc_u32 s45, s5, 0
s_mov_b32 s46, 327680
s_mov_b32 s47, 0x00020000
buffer_load_dword v13, v15, s[44:47], 0 offen
.Lat_pfe8:
s_getpc_b64 s[44:45]
s_add_u32 s44, s44, .Ltext0@rel32@lo+4
s_addc_u32 s45, s45, .Ltext0@rel32@hi+12
s_lshr_b32 s47, s2, 3
s_lshl_b32 s47, s47, 16
v_lshl_add_u32 v15, v0, 7, s47
s_mov_b32 s46, .Ltext1-.Ltext0
s_mov_b32 s47, 0x00020000
buffer_load_dword v13, v15, s[44:47], 0 offen
v_exp_f32 v24, v24
v_exp_f32 v25, v25
v_exp_f32 v26, v26
v_exp_f32 v27, v27
v_exp_f32 v28, v28
v_mfma_f32_32x32x16_bf16 v[88:103], v[140:143], v[48:51], v[88:103]
v_exp_f32 v29, v29
v_cvt_pk_bf16_f32 v52, v24, v25
v_exp_f32 v30, v30
v_cvt_pk_bf16_f32 v53, v26, v27
v_exp_f32 v31, v31
v_cvt_pk_bf16_f32 v54, v28, v29
v_cvt_pk_bf16_f32 v55, v30, v31
v_mfma_f32_32x32x16_bf16 v[16:31], v[124:127], v[172:175], v[56:71]
v_exp_f32 v32, v32
v_exp_f32 v33, v33
v_exp_f32 v34, v34
v_exp_f32 v35, v35
v_exp_f32 v36, v36
v_mfma_f32_32x32x8bf16_1k v[16:31], v[128:129], v[178:179], v[16:31]
v_exp_f32 v37, v37
v_cvt_pk_bf16_f32 v48, v32, v33
v_exp_f32 v38, v38
v_cvt_pk_bf16_f32 v49, v34, v35
v_exp_f32 v39, v39
v_cvt_pk_bf16_f32 v50, v36, v37
v_cvt_pk_bf16_f32 v51, v38, v39
v_mfma_f32_32x32x16_bf16 v[88:103], v[144:147], v[52:55], v[88:103]
v_exp_f32 v40, v40
v_exp_f32 v41, v41
v_exp_f32 v42, v42
v_exp_f32 v43, v43
v_exp_f32 v44, v44
v_mfma_f32_32x32x16_bf16 v[104:119], v[140:143], v[48:51], v[104:119]
v_exp_f32 v45, v45
v_cvt_pk_bf16_f32 v52, v40, v41
v_exp_f32 v46, v46
v_cvt_pk_bf16_f32 v53, v42, v43
v_exp_f32 v47, v47
v_cvt_pk_bf16_f32 v54, v44, v45
v_cvt_pk_bf16_f32 v55, v46, v47
v_mfma_f32_32x32x16_bf16 v[32:47], v[124:127], v[180:183], v[72:87]
v_exp_f32 v16, v16
v_exp_f32 v17, v17
v_exp_f32 v18, v18
v_exp_f32 v19, v19
v_exp_f32 v20, v20
v_mfma_f32_32x32x8bf16_1k v[32:47], v[128:129], v[186:187], v[32:47]
v_exp_f32 v21, v21
v_cvt_pk_bf16_f32 v48, v16, v17
v_exp_f32 v22, v22
v_cvt_pk_bf16_f32 v49, v18, v19
v_exp_f32 v23, v23
v_cvt_pk_bf16_f32 v50, v20, v21
v_cvt_pk_bf16_f32 v51, v22, v23
v_mfma_f32_32x32x16_bf16 v[104:119], v[144:147], v[52:55], v[104:119]
v_exp_f32 v24, v24
v_exp_f32 v25, v25
v_exp_f32 v26, v26
v_exp_f32 v27, v27
v_exp_f32 v28, v28
v_mfma_f32_32x32x16_bf16 v[88:103], v[148:151], v[48:51], v[88:103]
v_exp_f32 v29, v29
v_cvt_pk_bf16_f32 v52, v24, v25
v_exp_f32 v30, v30
v_cvt_pk_bf16_f32 v53, v26, v27
v_exp_f32 v31, v31
v_cvt_pk_bf16_f32 v54, v28, v29
v_cvt_pk_bf16_f32 v55, v30, v31
s_waitcnt lgkmcnt(0)
v_mfma_f32_32x32x16_bf16 v[16:31], v[130:133], v[172:175], v[56:71]
v_exp_f32 v32, v32
v_exp_f32 v33, v33
v_exp_f32 v34, v34
v_exp_f32 v35, v35
v_exp_f32 v36, v36
v_mfma_f32_32x32x8bf16_1k v[16:31], v[138:139], v[176:177], v[16:31]
v_exp_f32 v37, v37
v_cvt_pk_bf16_f32 v48, v32, v33
v_exp_f32 v38, v38
v_cvt_pk_bf16_f32 v49, v34, v35
v_exp_f32 v39, v39
v_cvt_pk_bf16_f32 v50, v36, v37
v_cvt_pk_bf16_f32 v51, v38, v39
v_mfma_f32_32x32x16_bf16 v[88:103], v[152:155], v[52:55], v[88:103]
v_exp_f32 v40, v40
v_exp_f32 v41, v41
v_exp_f32 v42, v42
v_exp_f32 v43, v43
v_exp_f32 v44, v44
v_mfma_f32_32x32x16_bf16 v[104:119], v[148:151], v[48:51], v[104:119]
v_exp_f32 v45, v45
v_cvt_pk_bf16_f32 v52, v40, v41
v_exp_f32 v46, v46
v_cvt_pk_bf16_f32 v53, v42, v43
v_exp_f32 v47, v47
v_cvt_pk_bf16_f32 v54, v44, v45
v_cvt_pk_bf16_f32 v55, v46, v47
v_mfma_f32_32x32x16_bf16 v[32:47], v[130:133], v[180:183], v[72:87]
v_exp_f32 v16, v16
v_exp_f32 v17, v17
v_exp_f32 v18, v18
v_exp_f32 v19, v19
v_exp_f32 v20, v20
v_mfma_f32_32x32x8bf16_1k v[32:47], v[138:139], v[184:185], v[32:47]
v_exp_f32 v21, v21
v_cvt_pk_bf16_f32 v48, v16, v17
v_exp_f32 v22, v22
v_cvt_pk_bf16_f32 v49, v18, v19
v_exp_f32 v23, v23
v_cvt_pk_bf16_f32 v50, v20, v21
v_cvt_pk_bf16_f32 v51, v22, v23
v_mfma_f32_32x32x16_bf16 v[104:119], v[152:155], v[52:55], v[104:119]
ds_read_b128 v[120:123], v194 offset:0
ds_read_b64 v[128:129], v195 offset:2048
ds_read_b128 v[124:127], v194 offset:1024
s_mov_b64 exec, s[36:37]
ds_read_b128 v[140:143], v196 offset:2560
ds_read_b128 v[144:147], v196 offset:3200
ds_read_b128 v[148:151], v196 offset:3840
ds_read_b128 v[152:155], v196 offset:4480
s_mov_b64 exec, -1
v_exp_f32 v24, v24
v_exp_f32 v25, v25
v_exp_f32 v26, v26
v_exp_f32 v27, v27
v_exp_f32 v28, v28
v_mfma_f32_32x32x16_bf16 v[88:103], v[156:159], v[48:51], v[88:103]
v_exp_f32 v29, v29
v_cvt_pk_bf16_f32 v52, v24, v25
v_exp_f32 v30, v30
v_cvt_pk_bf16_f32 v53, v26, v27
v_exp_f32 v31, v31
v_cvt_pk_bf16_f32 v54, v28, v29
v_cvt_pk_bf16_f32 v55, v30, v31
v_mfma_f32_32x32x16_bf16 v[16:31], v[134:137], v[172:175], v[56:71]
v_exp_f32 v32, v32
v_exp_f32 v33, v33
v_exp_f32 v34, v34
v_exp_f32 v35, v35
v_exp_f32 v36, v36
v_mfma_f32_32x32x8bf16_1k v[16:31], v[138:139], v[178:179], v[16:31]
v_exp_f32 v37, v37
v_cvt_pk_bf16_f32 v48, v32, v33
v_exp_f32 v38, v38
v_cvt_pk_bf16_f32 v49, v34, v35
v_exp_f32 v39, v39
v_cvt_pk_bf16_f32 v50, v36, v37
v_cvt_pk_bf16_f32 v51, v38, v39
v_mfma_f32_32x32x16_bf16 v[88:103], v[160:163], v[52:55], v[88:103]
v_exp_f32 v40, v40
v_exp_f32 v41, v41
v_exp_f32 v42, v42
v_exp_f32 v43, v43
v_exp_f32 v44, v44
v_mfma_f32_32x32x16_bf16 v[104:119], v[156:159], v[48:51], v[104:119]
v_exp_f32 v45, v45
v_cvt_pk_bf16_f32 v52, v40, v41
v_exp_f32 v46, v46
v_cvt_pk_bf16_f32 v53, v42, v43
v_exp_f32 v47, v47
v_cvt_pk_bf16_f32 v54, v44, v45
v_cvt_pk_bf16_f32 v55, v46, v47
v_mfma_f32_32x32x16_bf16 v[32:47], v[134:137], v[180:183], v[72:87]
v_exp_f32 v16, v16
v_exp_f32 v17, v17
v_exp_f32 v18, v18
v_exp_f32 v19, v19
v_exp_f32 v20, v20
v_mfma_f32_32x32x8bf16_1k v[32:47], v[138:139], v[186:187], v[32:47]
v_exp_f32 v21, v21
v_cvt_pk_bf16_f32 v48, v16, v17
v_exp_f32 v22, v22
v_cvt_pk_bf16_f32 v49, v18, v19
v_exp_f32 v23, v23
v_cvt_pk_bf16_f32 v50, v20, v21
v_cvt_pk_bf16_f32 v51, v22, v23
v_mfma_f32_32x32x16_bf16 v[104:119], v[160:163], v[52:55], v[104:119]
v_exp_f32 v24, v24
v_exp_f32 v25, v25
v_exp_f32 v26, v26
v_exp_f32 v27, v27
v_exp_f32 v28, v28
v_mfma_f32_32x32x16_bf16 v[88:103], v[164:167], v[48:51], v[88:103]
v_exp_f32 v29, v29
v_cvt_pk_bf16_f32 v52, v24, v25
v_exp_f32 v30, v30
v_cvt_pk_bf16_f32 v53, v26, v27
v_exp_f32 v31, v31
v_cvt_pk_bf16_f32 v54, v28, v29
v_cvt_pk_bf16_f32 v55, v30, v31
s_waitcnt lgkmcnt(0)
v_mfma_f32_32x32x16_bf16 v[16:31], v[120:123], v[172:175], v[56:71]
v_exp_f32 v32, v32
v_exp_f32 v33, v33
v_exp_f32 v34, v34
v_exp_f32 v35, v35
v_exp_f32 v36, v36
v_mfma_f32_32x32x8bf16_1k v[16:31], v[128:129], v[176:177], v[16:31]
v_exp_f32 v37, v37
v_cvt_pk_bf16_f32 v48, v32, v33
v_exp_f32 v38, v38
v_cvt_pk_bf16_f32 v49, v34, v35
v_exp_f32 v39, v39
v_cvt_pk_bf16_f32 v50, v36, v37
v_cvt_pk_bf16_f32 v51, v38, v39
v_mfma_f32_32x32x16_bf16 v[88:103], v[168:171], v[52:55], v[88:103]
v_exp_f32 v40, v40
v_exp_f32 v41, v41
v_exp_f32 v42, v42
v_exp_f32 v43, v43
v_exp_f32 v44, v44
v_mfma_f32_32x32x16_bf16 v[104:119], v[164:167], v[48:51], v[104:119]
v_exp_f32 v45, v45
v_cvt_pk_bf16_f32 v52, v40, v41
v_exp_f32 v46, v46
v_cvt_pk_bf16_f32 v53, v42, v43
v_exp_f32 v47, v47
v_cvt_pk_bf16_f32 v54, v44, v45
v_cvt_pk_bf16_f32 v55, v46, v47
v_mfma_f32_32x32x16_bf16 v[32:47], v[120:123], v[180:183], v[72:87]
v_exp_f32 v16, v16
v_exp_f32 v17, v17
v_exp_f32 v18, v18
v_exp_f32 v19, v19
v_exp_f32 v20, v20
v_mfma_f32_32x32x8bf16_1k v[32:47], v[128:129], v[184:185], v[32:47]
v_exp_f32 v21, v21
v_cvt_pk_bf16_f32 v48, v16, v17
v_exp_f32 v22, v22
v_cvt_pk_bf16_f32 v49, v18, v19
v_exp_f32 v23, v23
v_cvt_pk_bf16_f32 v50, v20, v21
v_cvt_pk_bf16_f32 v51, v22, v23
v_mfma_f32_32x32x16_bf16 v[104:119], v[168:171], v[52:55], v[104:119]
ds_read_b128 v[130:133], v194 offset:10240
ds_read_b64 v[138:139], v195 offset:12288
ds_read_b128 v[134:137], v194 offset:11264
s_mov_b64 exec, s[36:37]
ds_read_b128 v[156:159], v196 offset:12800
ds_read_b128 v[160:163], v196 offset:13440
ds_read_b128 v[164:167], v196 offset:14080
ds_read_b128 v[168:171], v196 offset:14720
s_mov_b64 exec, -1
v_exp_f32 v24, v24
v_exp_f32 v25, v25
v_exp_f32 v26, v26
v_exp_f32 v27, v27
v_exp_f32 v28, v28
v_mfma_f32_32x32x16_bf16 v[88:103], v[140:143], v[48:51], v[88:103]
v_exp_f32 v29, v29
v_cvt_pk_bf16_f32 v52, v24, v25
v_exp_f32 v30, v30
v_cvt_pk_bf16_f32 v53, v26, v27
v_exp_f32 v31, v31
v_cvt_pk_bf16_f32 v54, v28, v29
v_cvt_pk_bf16_f32 v55, v30, v31
v_mfma_f32_32x32x16_bf16 v[16:31], v[124:127], v[172:175], v[56:71]
v_exp_f32 v32, v32
v_exp_f32 v33, v33
v_exp_f32 v34, v34
v_exp_f32 v35, v35
v_exp_f32 v36, v36
v_mfma_f32_32x32x8bf16_1k v[16:31], v[128:129], v[178:179], v[16:31]
v_exp_f32 v37, v37
v_cvt_pk_bf16_f32 v48, v32, v33
v_exp_f32 v38, v38
v_cvt_pk_bf16_f32 v49, v34, v35
v_exp_f32 v39, v39
v_cvt_pk_bf16_f32 v50, v36, v37
v_cvt_pk_bf16_f32 v51, v38, v39
v_mfma_f32_32x32x16_bf16 v[88:103], v[144:147], v[52:55], v[88:103]
v_exp_f32 v40, v40
v_exp_f32 v41, v41
v_exp_f32 v42, v42
v_exp_f32 v43, v43
v_exp_f32 v44, v44
v_mfma_f32_32x32x16_bf16 v[104:119], v[140:143], v[48:51], v[104:119]
v_exp_f32 v45, v45
v_cvt_pk_bf16_f32 v52, v40, v41
v_exp_f32 v46, v46
v_cvt_pk_bf16_f32 v53, v42, v43
v_exp_f32 v47, v47
v_cvt_pk_bf16_f32 v54, v44, v45
v_cvt_pk_bf16_f32 v55, v46, v47
v_mfma_f32_32x32x16_bf16 v[32:47], v[124:127], v[180:183], v[72:87]
v_exp_f32 v16, v16
v_exp_f32 v17, v17
v_exp_f32 v18, v18
v_exp_f32 v19, v19
v_exp_f32 v20, v20
v_mfma_f32_32x32x8bf16_1k v[32:47], v[128:129], v[186:187], v[32:47]
v_exp_f32 v21, v21
v_cvt_pk_bf16_f32 v48, v16, v17
v_exp_f32 v22, v22
v_cvt_pk_bf16_f32 v49, v18, v19
v_exp_f32 v23, v23
v_cvt_pk_bf16_f32 v50, v20, v21
v_cvt_pk_bf16_f32 v51, v22, v23
v_mfma_f32_32x32x16_bf16 v[104:119], v[144:147], v[52:55], v[104:119]
v_exp_f32 v24, v24
v_exp_f32 v25, v25
v_exp_f32 v26, v26
v_exp_f32 v27, v27
v_exp_f32 v28, v28
v_mfma_f32_32x32x16_bf16 v[88:103], v[148:151], v[48:51], v[88:103]
v_exp_f32 v29, v29
v_cvt_pk_bf16_f32 v52, v24, v25
v_exp_f32 v30, v30
v_cvt_pk_bf16_f32 v53, v26, v27
v_exp_f32 v31, v31
v_cvt_pk_bf16_f32 v54, v28, v29
v_cvt_pk_bf16_f32 v55, v30, v31
s_waitcnt lgkmcnt(0)
v_mfma_f32_32x32x16_bf16 v[16:31], v[130:133], v[172:175], v[56:71]
v_exp_f32 v32, v32
v_exp_f32 v33, v33
v_exp_f32 v34, v34
v_exp_f32 v35, v35
v_exp_f32 v36, v36
v_mfma_f32_32x32x8bf16_1k v[16:31], v[138:139], v[176:177], v[16:31]
v_exp_f32 v37, v37
v_cvt_pk_bf16_f32 v48, v32, v33
v_exp_f32 v38, v38
v_cvt_pk_bf16_f32 v49, v34, v35
v_exp_f32 v39, v39
v_cvt_pk_bf16_f32 v50, v36, v37
v_cvt_pk_bf16_f32 v51, v38, v39
v_mfma_f32_32x32x16_bf16 v[88:103], v[152:155], v[52:55], v[88:103]
v_exp_f32 v40, v40
v_exp_f32 v41, v41
v_exp_f32 v42, v42
v_exp_f32 v43, v43
v_exp_f32 v44, v44
v_mfma_f32_32x32x16_bf16 v[104:119], v[148:151], v[48:51], v[104:119]
v_exp_f32 v45, v45
v_cvt_pk_bf16_f32 v52, v40, v41
v_exp_f32 v46, v46
v_cvt_pk_bf16_f32 v53, v42, v43
v_exp_f32 v47, v47
v_cvt_pk_bf16_f32 v54, v44, v45
v_cvt_pk_bf16_f32 v55, v46, v47
v_mfma_f32_32x32x16_bf16 v[32:47], v[130:133], v[180:183], v[72:87]
v_exp_f32 v16, v16
v_exp_f32 v17, v17
v_exp_f32 v18, v18
v_exp_f32 v19, v19
v_exp_f32 v20, v20
v_mfma_f32_32x32x8bf16_1k v[32:47], v[138:139], v[184:185], v[32:47]
v_exp_f32 v21, v21
v_cvt_pk_bf16_f32 v48, v16, v17
v_exp_f32 v22, v22
v_cvt_pk_bf16_f32 v49, v18, v19
v_exp_f32 v23, v23
v_cvt_pk_bf16_f32 v50, v20, v21
v_cvt_pk_bf16_f32 v51, v22, v23
v_mfma_f32_32x32x16_bf16 v[104:119], v[152:155], v[52:55], v[104:119]
ds_read_b128 v[120:123], v194 offset:20480
ds_read_b64 v[128:129], v195 offset:22528
ds_read_b128 v[124:127], v194 offset:21504
s_mov_b64 exec, s[36:37]
ds_read_b128 v[140:143], v196 offset:23040
ds_read_b128 v[144:147], v196 offset:23680
ds_read_b128 v[148:151], v196 offset:24320
ds_read_b128 v[152:155], v196 offset:24960
s_mov_b64 exec, -1
v_exp_f32 v24, v24
v_exp_f32 v25, v25
v_exp_f32 v26, v26
v_exp_f32 v27, v27
v_exp_f32 v28, v28
v_mfma_f32_32x32x16_bf16 v[88:103], v[156:159], v[48:51], v[88:103]
v_exp_f32 v29, v29
v_cvt_pk_bf16_f32 v52, v24, v25
v_exp_f32 v30, v30
v_cvt_pk_bf16_f32 v53, v26, v27
v_exp_f32 v31, v31
v_cvt_pk_bf16_f32 v54, v28, v29
v_cvt_pk_bf16_f32 v55, v30, v31
v_mfma_f32_32x32x16_bf16 v[16:31], v[134:137], v[172:175], v[56:71]
v_exp_f32 v32, v32
v_exp_f32 v33, v33
v_exp_f32 v34, v34
v_exp_f32 v35, v35
v_exp_f32 v36, v36
v_mfma_f32_32x32x8bf16_1k v[16:31], v[138:139], v[178:179], v[16:31]
v_exp_f32 v37, v37
v_cvt_pk_bf16_f32 v48, v32, v33
v_exp_f32 v38, v38
v_cvt_pk_bf16_f32 v49, v34, v35
v_exp_f32 v39, v39
v_cvt_pk_bf16_f32 v50, v36, v37
v_cvt_pk_bf16_f32 v51, v38, v39
v_mfma_f32_32x32x16_bf16 v[88:103], v[160:163], v[52:55], v[88:103]
v_exp_f32 v40, v40
v_exp_f32 v41, v41
v_exp_f32 v42, v42
v_exp_f32 v43, v43
v_exp_f32 v44, v44
v_mfma_f32_32x32x16_bf16 v[104:119], v[156:159], v[48:51], v[104:119]
v_exp_f32 v45, v45
v_cvt_pk_bf16_f32 v52, v40, v41
v_exp_f32 v46, v46
v_cvt_pk_bf16_f32 v53, v42, v43
v_exp_f32 v47, v47
v_cvt_pk_bf16_f32 v54, v44, v45
v_cvt_pk_bf16_f32 v55, v46, v47
v_mfma_f32_32x32x16_bf16 v[32:47], v[134:137], v[180:183], v[72:87]
v_exp_f32 v16, v16
v_exp_f32 v17, v17
v_exp_f32 v18, v18
v_exp_f32 v19, v19
v_exp_f32 v20, v20
v_mfma_f32_32x32x8bf16_1k v[32:47], v[138:139], v[186:187], v[32:47]
v_exp_f32 v21, v21
v_cvt_pk_bf16_f32 v48, v16, v17
v_exp_f32 v22, v22
v_cvt_pk_bf16_f32 v49, v18, v19
v_exp_f32 v23, v23
v_cvt_pk_bf16_f32 v50, v20, v21
v_cvt_pk_bf16_f32 v51, v22, v23
v_mfma_f32_32x32x16_bf16 v[104:119], v[160:163], v[52:55], v[104:119]
v_exp_f32 v24, v24
v_exp_f32 v25, v25
v_exp_f32 v26, v26
v_exp_f32 v27, v27
v_exp_f32 v28, v28
v_mfma_f32_32x32x16_bf16 v[88:103], v[164:167], v[48:51], v[88:103]
v_exp_f32 v29, v29
v_cvt_pk_bf16_f32 v52, v24, v25
v_exp_f32 v30, v30
v_cvt_pk_bf16_f32 v53, v26, v27
v_exp_f32 v31, v31
v_cvt_pk_bf16_f32 v54, v28, v29
v_cvt_pk_bf16_f32 v55, v30, v31
s_waitcnt lgkmcnt(0)
v_mfma_f32_32x32x16_bf16 v[16:31], v[120:123], v[172:175], v[56:71]
v_exp_f32 v32, v32
v_exp_f32 v33, v33
v_exp_f32 v34, v34
v_exp_f32 v35, v35
v_exp_f32 v36, v36
v_mfma_f32_32x32x8bf16_1k v[16:31], v[128:129], v[176:177], v[16:31]
v_exp_f32 v37, v37
v_cvt_pk_bf16_f32 v48, v32, v33
v_exp_f32 v38, v38
v_cvt_pk_bf16_f32 v49, v34, v35
v_exp_f32 v39, v39
v_cvt_pk_bf16_f32 v50, v36, v37
v_cvt_pk_bf16_f32 v51, v38, v39
v_mfma_f32_32x32x16_bf16 v[88:103], v[168:171], v[52:55], v[88:103]
v_exp_f32 v40, v40
v_exp_f32 v41, v41
v_exp_f32 v42, v42
v_exp_f32 v43, v43
v_exp_f32 v44, v44
v_mfma_f32_32x32x16_bf16 v[104:119], v[164:167], v[48:51], v[104:119]
v_exp_f32 v45, v45
v_cvt_pk_bf16_f32 v52, v40, v41
v_exp_f32 v46, v46
v_cvt_pk_bf16_f32 v53, v42, v43
v_exp_f32 v47, v47
v_cvt_pk_bf16_f32 v54, v44, v45
v_cvt_pk_bf16_f32 v55, v46, v47
v_mfma_f32_32x32x16_bf16 v[32:47], v[120:123], v[180:183], v[72:87]
v_exp_f32 v16, v16
v_exp_f32 v17, v17
v_exp_f32 v18, v18
v_exp_f32 v19, v19
v_exp_f32 v20, v20
v_mfma_f32_32x32x8bf16_1k v[32:47], v[128:129], v[184:185], v[32:47]
v_exp_f32 v21, v21
v_cvt_pk_bf16_f32 v48, v16, v17
v_exp_f32 v22, v22
v_cvt_pk_bf16_f32 v49, v18, v19
v_exp_f32 v23, v23
v_cvt_pk_bf16_f32 v50, v20, v21
v_cvt_pk_bf16_f32 v51, v22, v23
v_mfma_f32_32x32x16_bf16 v[104:119], v[168:171], v[52:55], v[104:119]
ds_read_b128 v[130:133], v194 offset:30720
ds_read_b64 v[138:139], v195 offset:32768
ds_read_b128 v[134:137], v194 offset:31744
s_mov_b64 exec, s[36:37]
ds_read_b128 v[156:159], v196 offset:33280
ds_read_b128 v[160:163], v196 offset:33920
ds_read_b128 v[164:167], v196 offset:34560
ds_read_b128 v[168:171], v196 offset:35200
s_mov_b64 exec, -1
v_exp_f32 v24, v24
v_exp_f32 v25, v25
v_exp_f32 v26, v26
v_exp_f32 v27, v27
v_exp_f32 v28, v28
v_mfma_f32_32x32x16_bf16 v[88:103], v[140:143], v[48:51], v[88:103]
v_exp_f32 v29, v29
v_cvt_pk_bf16_f32 v52, v24, v25
v_exp_f32 v30, v30
v_cvt_pk_bf16_f32 v53, v26, v27
v_exp_f32 v31, v31
v_cvt_pk_bf16_f32 v54, v28, v29
v_cvt_pk_bf16_f32 v55, v30, v31
v_mfma_f32_32x32x16_bf16 v[16:31], v[124:127], v[172:175], v[56:71]
v_exp_f32 v32, v32
v_exp_f32 v33, v33
v_exp_f32 v34, v34
v_exp_f32 v35, v35
v_exp_f32 v36, v36
v_mfma_f32_32x32x8bf16_1k v[16:31], v[128:129], v[178:179], v[16:31]
v_exp_f32 v37, v37
v_cvt_pk_bf16_f32 v48, v32, v33
v_exp_f32 v38, v38
v_cvt_pk_bf16_f32 v49, v34, v35
v_exp_f32 v39, v39
v_cvt_pk_bf16_f32 v50, v36, v37
v_cvt_pk_bf16_f32 v51, v38, v39
v_mfma_f32_32x32x16_bf16 v[88:103], v[144:147], v[52:55], v[88:103]
v_exp_f32 v40, v40
v_exp_f32 v41, v41
v_exp_f32 v42, v42
v_exp_f32 v43, v43
v_exp_f32 v44, v44
v_mfma_f32_32x32x16_bf16 v[104:119], v[140:143], v[48:51], v[104:119]
v_exp_f32 v45, v45
v_cvt_pk_bf16_f32 v52, v40, v41
v_exp_f32 v46, v46
v_cvt_pk_bf16_f32 v53, v42, v43
v_exp_f32 v47, v47
v_cvt_pk_bf16_f32 v54, v44, v45
v_cvt_pk_bf16_f32 v55, v46, v47
v_mfma_f32_32x32x16_bf16 v[32:47], v[124:127], v[180:183], v[72:87]
v_exp_f32 v16, v16
v_exp_f32 v17, v17
v_exp_f32 v18, v18
v_exp_f32 v19, v19
v_exp_f32 v20, v20
v_mfma_f32_32x32x8bf16_1k v[32:47], v[128:129], v[186:187], v[32:47]
v_exp_f32 v21, v21
v_cvt_pk_bf16_f32 v48, v16, v17
v_exp_f32 v22, v22
v_cvt_pk_bf16_f32 v49, v18, v19
v_exp_f32 v23, v23
v_cvt_pk_bf16_f32 v50, v20, v21
v_cvt_pk_bf16_f32 v51, v22, v23
v_mfma_f32_32x32x16_bf16 v[104:119], v[144:147], v[52:55], v[104:119]
v_exp_f32 v24, v24
v_exp_f32 v25, v25
v_exp_f32 v26, v26
v_exp_f32 v27, v27
v_exp_f32 v28, v28
v_mfma_f32_32x32x16_bf16 v[88:103], v[148:151], v[48:51], v[88:103]
v_exp_f32 v29, v29
v_cvt_pk_bf16_f32 v52, v24, v25
v_exp_f32 v30, v30
v_cvt_pk_bf16_f32 v53, v26, v27
v_exp_f32 v31, v31
v_cvt_pk_bf16_f32 v54, v28, v29
v_cvt_pk_bf16_f32 v55, v30, v31
s_waitcnt lgkmcnt(0)
v_mfma_f32_32x32x16_bf16 v[16:31], v[130:133], v[172:175], v[56:71]
v_exp_f32 v32, v32
v_exp_f32 v33, v33
v_exp_f32 v34, v34
v_exp_f32 v35, v35
v_exp_f32 v36, v36
v_mfma_f32_32x32x8bf16_1k v[16:31], v[138:139], v[176:177], v[16:31]
v_exp_f32 v37, v37
v_cvt_pk_bf16_f32 v48, v32, v33
v_exp_f32 v38, v38
v_cvt_pk_bf16_f32 v49, v34, v35
v_exp_f32 v39, v39
v_cvt_pk_bf16_f32 v50, v36, v37
v_cvt_pk_bf16_f32 v51, v38, v39
v_mfma_f32_32x32x16_bf16 v[88:103], v[152:155], v[52:55], v[88:103]
v_exp_f32 v40, v40
v_exp_f32 v41, v41
v_exp_f32 v42, v42
v_exp_f32 v43, v43
v_exp_f32 v44, v44
v_mfma_f32_32x32x16_bf16 v[104:119], v[148:151], v[48:51], v[104:119]
v_exp_f32 v45, v45
v_cvt_pk_bf16_f32 v52, v40, v41
v_exp_f32 v46, v46
v_cvt_pk_bf16_f32 v53, v42, v43
v_exp_f32 v47, v47
v_cvt_pk_bf16_f32 v54, v44, v45
v_cvt_pk_bf16_f32 v55, v46, v47
v_mfma_f32_32x32x16_bf16 v[32:47], v[130:133], v[180:183], v[72:87]
v_exp_f32 v16, v16
v_exp_f32 v17, v17
v_exp_f32 v18, v18
v_exp_f32 v19, v19
v_exp_f32 v20, v20
v_mfma_f32_32x32x8bf16_1k v[32:47], v[138:139], v[184:185], v[32:47]
v_exp_f32 v21, v21
v_cvt_pk_bf16_f32 v48, v16, v17
v_exp_f32 v22, v22
v_cvt_pk_bf16_f32 v49, v18, v19
v_exp_f32 v23, v23
v_cvt_pk_bf16_f32 v50, v20, v21
v_cvt_pk_bf16_f32 v51, v22, v23
v_mfma_f32_32x32x16_bf16 v[104:119], v[152:155], v[52:55], v[104:119]
v_exp_f32 v24, v24
v_exp_f32 v25, v25
v_exp_f32 v26, v26
v_exp_f32 v27, v27
v_exp_f32 v28, v28
v_mfma_f32_32x32x16_bf16 v[88:103], v[156:159], v[48:51], v[88:103]
v_exp_f32 v29, v29
v_cvt_pk_bf16_f32 v52, v24, v25
v_exp_f32 v30, v30
v_cvt_pk_bf16_f32 v53, v26, v27
v_exp_f32 v31, v31
v_cvt_pk_bf16_f32 v54, v28, v29
v_cvt_pk_bf16_f32 v55, v30, v31
v_mfma_f32_32x32x16_bf16 v[16:31], v[134:137], v[172:175], v[56:71]
v_exp_f32 v32, v32
v_exp_f32 v33, v33
v_exp_f32 v34, v34
v_exp_f32 v35, v35
v_exp_f32 v36, v36
v_mfma_f32_32x32x8bf16_1k v[16:31], v[138:139], v[178:179], v[16:31]
v_exp_f32 v37, v37
v_cvt_pk_bf16_f32 v48, v32, v33
v_exp_f32 v38, v38
v_cvt_pk_bf16_f32 v49, v34, v35
v_exp_f32 v39, v39
v_cvt_pk_bf16_f32 v50, v36, v37
v_cvt_pk_bf16_f32 v51, v38, v39
v_mfma_f32_32x32x16_bf16 v[88:103], v[160:163], v[52:55], v[88:103]
s_setprio 0
s_cmp_le_u32 s24, s38
s_cbranch_scc1 .Lat_nb9
s_barrier
.Lat_nb9:
v_exp_f32 v40, v40
v_exp_f32 v41, v41
v_exp_f32 v42, v42
v_exp_f32 v43, v43
v_exp_f32 v44, v44
v_mfma_f32_32x32x16_bf16 v[104:119], v[156:159], v[48:51], v[104:119]
v_exp_f32 v45, v45
v_cvt_pk_bf16_f32 v52, v40, v41
v_exp_f32 v46, v46
v_cvt_pk_bf16_f32 v53, v42, v43
v_exp_f32 v47, v47
v_cvt_pk_bf16_f32 v54, v44, v45
v_cvt_pk_bf16_f32 v55, v46, v47
v_mfma_f32_32x32x16_bf16 v[32:47], v[134:137], v[180:183], v[72:87]
v_exp_f32 v16, v16
v_exp_f32 v17, v17
v_exp_f32 v18, v18
v_exp_f32 v19, v19
v_exp_f32 v20, v20
v_mfma_f32_32x32x8bf16_1k v[32:47], v[138:139], v[186:187], v[32:47]
v_exp_f32 v21, v21
v_cvt_pk_bf16_f32 v48, v16, v17
v_exp_f32 v22, v22
v_cvt_pk_bf16_f32 v49, v18, v19
v_exp_f32 v23, v23
v_cvt_pk_bf16_f32 v50, v20, v21
v_cvt_pk_bf16_f32 v51, v22, v23
v_mfma_f32_32x32x16_bf16 v[104:119], v[160:163], v[52:55], v[104:119]
s_cmp_le_u32 s24, s38
s_cbranch_scc1 .Lat_nb10
s_barrier
ds_read_b128 v[208:211], v9 offset:0
ds_read_b128 v[212:215], v9 offset:1024
ds_read_b128 v[216:219], v9 offset:2048
ds_read_b128 v[220:223], v9 offset:3072
ds_read_b128 v[224:227], v9 offset:10240
ds_read_b128 v[228:231], v9 offset:11264
ds_read_b128 v[232:235], v9 offset:12288
ds_read_b128 v[236:239], v9 offset:13312
.Lat_nb10:
v_exp_f32 v24, v24
v_exp_f32 v25, v25
v_exp_f32 v26, v26
v_exp_f32 v27, v27
v_exp_f32 v28, v28
v_mfma_f32_32x32x16_bf16 v[88:103], v[164:167], v[48:51], v[88:103]
v_exp_f32 v29, v29
v_cvt_pk_bf16_f32 v52, v24, v25
v_exp_f32 v30, v30
v_cvt_pk_bf16_f32 v53, v26, v27
v_exp_f32 v31, v31
v_cvt_pk_bf16_f32 v54, v28, v29
v_cvt_pk_bf16_f32 v55, v30, v31
v_exp_f32 v32, v32
v_exp_f32 v33, v33
v_exp_f32 v34, v34
v_exp_f32 v35, v35
v_exp_f32 v36, v36
v_exp_f32 v37, v37
v_cvt_pk_bf16_f32 v48, v32, v33
v_exp_f32 v38, v38
v_cvt_pk_bf16_f32 v49, v34, v35
v_exp_f32 v39, v39
v_cvt_pk_bf16_f32 v50, v36, v37
v_cvt_pk_bf16_f32 v51, v38, v39
v_mfma_f32_32x32x16_bf16 v[88:103], v[168:171], v[52:55], v[88:103]
v_exp_f32 v40, v40
v_exp_f32 v41, v41
v_exp_f32 v42, v42
v_exp_f32 v43, v43
v_exp_f32 v44, v44
v_mfma_f32_32x32x16_bf16 v[104:119], v[164:167], v[48:51], v[104:119]
v_exp_f32 v45, v45
v_cvt_pk_bf16_f32 v52, v40, v41
v_exp_f32 v46, v46
v_cvt_pk_bf16_f32 v53, v42, v43
v_exp_f32 v47, v47
v_cvt_pk_bf16_f32 v54, v44, v45
v_cvt_pk_bf16_f32 v55, v46, v47
s_nop 1
v_mfma_f32_32x32x16_bf16 v[104:119], v[168:171], v[52:55], v[104:119]
v_cmp_eq_u32 vcc, 0, v5
s_nop 1
v_cndmask_b32 v100, v96, v100, vcc
s_nop 7
v_cndmask_b32 v116, v112, v116, vcc
v_add_f32 v7, v100, v116
v_mov_b32 v8, 0x5f000000
v_cmp_nle_f32 vcc, v7, v8
s_cmp_lg_u32 s38, 0
s_cbranch_scc1 .Lat_comb12
s_cbranch_vccnz .Lat_fb11
.Lat_comb12:
s_cmp_lg_u32 s24, 0
s_cbranch_scc1 .Lat_p113
v_mov_b32 v101, v56
v_mov_b32 v117, v72
s_waitcnt vmcnt(0) lgkmcnt(0)
s_barrier
ds_write_b128 v9, v[104:107] offset:0
ds_write_b128 v9, v[108:111] offset:1024
ds_write_b128 v9, v[112:115] offset:2048
ds_write_b128 v9, v[116:119] offset:3072
ds_write_b128 v9, v[88:91] offset:10240
ds_write_b128 v9, v[92:95] offset:11264
ds_write_b128 v9, v[96:99] offset:12288
ds_write_b128 v9, v[100:103] offset:13312
s_waitcnt lgkmcnt(0)
s_barrier
s_barrier
s_endpgm
.Lat_p113:
s_waitcnt lgkmcnt(0)
v_min_f32 v16, v56, v221
v_min_f32 v24, v72, v237
v_sub_f32 v18, v16, v56
v_sub_f32 v20, v16, v221
v_sub_f32 v26, v24, v72
v_sub_f32 v28, v24, v237
v_exp_f32 v18, v18
v_exp_f32 v20, v20
v_exp_f32 v26, v26
v_exp_f32 v28, v28
v_mul_f32 v16, v18, v100
v_mul_f32 v24, v26, v116
v_fmac_f32 v16, v20, v220
v_fmac_f32 v24, v28, v236
v_rcp_f32 v16, v16
v_rcp_f32 v24, v24
v_mul_f32 v18, v18, v16
v_mul_f32 v20, v20, v16
v_mul_f32 v26, v26, v24
v_mul_f32 v28, v28, v24
v_pk_mul_f32 v[88:89], v[88:89], v[18:19] op_sel_hi:[1,0]
v_pk_mul_f32 v[90:91], v[90:91], v[18:19] op_sel_hi:[1,0]
v_pk_mul_f32 v[92:93], v[92:93], v[18:19] op_sel_hi:[1,0]
v_pk_mul_f32 v[94:95], v[94:95], v[18:19] op_sel_hi:[1,0]
v_pk_mul_f32 v[96:97], v[96:97], v[18:19] op_sel_hi:[1,0]
v_pk_mul_f32 v[98:99], v[98:99], v[18:19] op_sel_hi:[1,0]
v_pk_mul_f32 v[104:105], v[104:105], v[26:27] op_sel_hi:[1,0]
v_pk_mul_f32 v[106:107], v[106:107], v[26:27] op_sel_hi:[1,0]
v_pk_mul_f32 v[108:109], v[108:109], v[26:27] op_sel_hi:[1,0]
v_pk_mul_f32 v[110:111], v[110:111], v[26:27] op_sel_hi:[1,0]
v_pk_mul_f32 v[112:113], v[112:113], v[26:27] op_sel_hi:[1,0]
v_pk_mul_f32 v[114:115], v[114:115], v[26:27] op_sel_hi:[1,0]
v_pk_fma_f32 v[88:89], v[208:209], v[20:21], v[88:89] op_sel_hi:[1,0,1]
v_pk_fma_f32 v[90:91], v[210:211], v[20:21], v[90:91] op_sel_hi:[1,0,1]
v_pk_fma_f32 v[92:93], v[212:213], v[20:21], v[92:93] op_sel_hi:[1,0,1]
v_pk_fma_f32 v[94:95], v[214:215], v[20:21], v[94:95] op_sel_hi:[1,0,1]
v_pk_fma_f32 v[96:97], v[216:217], v[20:21], v[96:97] op_sel_hi:[1,0,1]
v_pk_fma_f32 v[98:99], v[218:219], v[20:21], v[98:99] op_sel_hi:[1,0,1]
v_pk_fma_f32 v[104:105], v[224:225], v[28:29], v[104:105] op_sel_hi:[1,0,1]
v_pk_fma_f32 v[106:107], v[226:227], v[28:29], v[106:107] op_sel_hi:[1,0,1]
v_pk_fma_f32 v[108:109], v[228:229], v[28:29], v[108:109] op_sel_hi:[1,0,1]
v_pk_fma_f32 v[110:111], v[230:231], v[28:29], v[110:111] op_sel_hi:[1,0,1]
v_pk_fma_f32 v[112:113], v[232:233], v[28:29], v[112:113] op_sel_hi:[1,0,1]
v_pk_fma_f32 v[114:115], v[234:235], v[28:29], v[114:115] op_sel_hi:[1,0,1]
v_cvt_pk_bf16_f32 v32, v88, v89
v_cvt_pk_bf16_f32 v33, v90, v91
v_cvt_pk_bf16_f32 v34, v92, v93
v_cvt_pk_bf16_f32 v35, v94, v95
buffer_store_dwordx4 v[32:35], v3, s[16:19], s30 offen sc1
v_cvt_pk_bf16_f32 v40, v104, v105
v_cvt_pk_bf16_f32 v41, v106, v107
v_cvt_pk_bf16_f32 v42, v108, v109
v_cvt_pk_bf16_f32 v43, v110, v111
buffer_store_dwordx4 v[40:43], v3, s[16:19], s31 offen sc1
v_cvt_pk_bf16_f32 v36, v96, v97
v_cvt_pk_bf16_f32 v37, v98, v99
v_cvt_pk_bf16_f32 v44, v112, v113
v_cvt_pk_bf16_f32 v45, v114, v115
s_mov_b32 exec_hi, 0
buffer_store_dwordx2 v[36:37], v6, s[16:19], s32 offen sc1
buffer_store_dwordx2 v[44:45], v6, s[16:19], s33 offen sc1
s_cmp_lg_u32 s38, 0
s_cbranch_scc1 .Lat_e14
s_barrier
.Lat_e14:
s_endpgm
.Lat_fb11:
s_cmp_eq_u32 s24, 0
s_cbranch_scc1 .Lat_e15
s_waitcnt lgkmcnt(0)
s_barrier
.Lat_e15:
s_mov_b32 s38, 1
s_mov_b32 s39, 0
v_mov_b32 v10, v188
v_mov_b32 v11, v189
v_mov_b32 v200, 0xff800000
v_mov_b32 v201, 0xff800000
.Lat_fl16:
ds_read_b128 v[120:123], v10
ds_read_b64 v[128:129], v11 offset:2048
ds_read_b128 v[124:127], v10 offset:1024
s_waitcnt lgkmcnt(0)
v_mfma_f32_32x32x16_bf16 v[16:31], v[120:123], v[172:175], 0
v_mfma_f32_32x32x16_bf16 v[32:47], v[120:123], v[180:183], 0
v_mfma_f32_32x32x8bf16_1k v[16:31], v[128:129], v[176:177], v[16:31]
v_mfma_f32_32x32x8bf16_1k v[32:47], v[128:129], v[184:185], v[32:47]
s_nop 10
v_max3_f32 v200, v16, v17, v200
v_max3_f32 v200, v18, v19, v200
v_max3_f32 v200, v20, v21, v200
v_max3_f32 v200, v22, v23, v200
v_max3_f32 v200, v24, v25, v200
v_max3_f32 v200, v26, v27, v200
v_max3_f32 v200, v28, v29, v200
v_max3_f32 v200, v30, v31, v200
v_max3_f32 v201, v32, v33, v201
v_max3_f32 v201, v34, v35, v201
v_max3_f32 v201, v36, v37, v201
v_max3_f32 v201, v38, v39, v201
v_max3_f32 v201, v40, v41, v201
v_max3_f32 v201, v42, v43, v201
v_max3_f32 v201, v44, v45, v201
v_max3_f32 v201, v46, v47, v201
v_mfma_f32_32x32x16_bf16 v[16:31], v[124:127], v[172:175], 0
v_mfma_f32_32x32x16_bf16 v[32:47], v[124:127], v[180:183], 0
v_mfma_f32_32x32x8bf16_1k v[16:31], v[128:129], v[178:179], v[16:31]
v_mfma_f32_32x32x8bf16_1k v[32:47], v[128:129], v[186:187], v[32:47]
s_nop 10
v_max3_f32 v200, v16, v17, v200
v_max3_f32 v200, v18, v19, v200
v_max3_f32 v200, v20, v21, v200
v_max3_f32 v200, v22, v23, v200
v_max3_f32 v200, v24, v25, v200
v_max3_f32 v200, v26, v27, v200
v_max3_f32 v200, v28, v29, v200
v_max3_f32 v200, v30, v31, v200
v_max3_f32 v201, v32, v33, v201
v_max3_f32 v201, v34, v35, v201
v_max3_f32 v201, v36, v37, v201
v_max3_f32 v201, v38, v39, v201
v_max3_f32 v201, v40, v41, v201
v_max3_f32 v201, v42, v43, v201
v_max3_f32 v201, v44, v45, v201
v_max3_f32 v201, v46, v47, v201
v_add_u32 v10, 10240, v10
v_add_u32 v11, 10240, v11
s_add_u32 s39, s39, 1
s_cmp_lt_u32 s39, 16
s_cbranch_scc1 .Lat_fl16
ds_read_b128 v[120:123], v188 offset:0
ds_read_b64 v[128:129], v189 offset:2048
ds_read_b128 v[124:127], v188 offset:1024
s_mov_b64 exec, s[36:37]
ds_read_b128 v[140:143], v190 offset:2560
ds_read_b128 v[144:147], v190 offset:3200
ds_read_b128 v[148:151], v190 offset:3840
ds_read_b128 v[152:155], v190 offset:4480
s_mov_b64 exec, -1
v_permlane32_swap_b32 v200, v201
v_max_f32 v200, v200, v201
v_mov_b32 v201, v200
s_nop 1
v_permlane32_swap_b32 v200, v201
v_sub_f32 v56, 0, v200
v_sub_f32 v57, 0, v200
v_sub_f32 v72, 0, v201
v_sub_f32 v73, 0, v201
v_mov_b64 v[58:59], v[56:57]
v_mov_b64 v[74:75], v[72:73]
v_mov_b64 v[60:61], v[56:57]
v_mov_b64 v[76:77], v[72:73]
v_mov_b64 v[62:63], v[56:57]
v_mov_b64 v[78:79], v[72:73]
v_mov_b64 v[64:65], v[56:57]
v_mov_b64 v[80:81], v[72:73]
v_mov_b64 v[66:67], v[56:57]
v_mov_b64 v[82:83], v[72:73]
v_mov_b64 v[68:69], v[56:57]
v_mov_b64 v[84:85], v[72:73]
v_mov_b64 v[70:71], v[56:57]
v_mov_b64 v[86:87], v[72:73]
s_waitcnt lgkmcnt(0)
s_branch .Lat_main2
.p2align 8
.globl p4_kernel
.type p4_kernel,@function
p4_kernel:
s_cmp_lt_u32 s2, 256
s_cbranch_scc1 .Lp4_role1
s_sub_u32 s2, s2, 256
s_endpgm
.Lp4_role1:
s_load_dwordx2 s[4:5], s[0:1], 64
s_load_dwordx2 s[6:7], s[0:1], 64
s_and_b32 s24, s2, 7
s_bfe_u32 s25, s2, 0x20003
s_lshl_b32 s20, s24, 2
s_add_u32 s20, s20, s25
s_lshr_b32 s21, s2, 5
v_lshrrev_b32 v1, 6, v0
v_and_b32 v2, 63, v0
v_readfirstlane_b32 s22, v1
v_and_b32 v3, 15, v0
v_bfe_u32 v4, v0, 4, 2
v_lshlrev_b32 v5, 4, v2
s_mul_i32 s24, s21, 102400
s_mul_i32 s23, s22, 5120
s_add_u32 s37, s20, s21
s_mul_i32 s38, s37, 205
s_lshr_b32 s38, s38, 10
s_mul_i32 s38, s38, 5
s_sub_u32 s37, s37, s38
s_add_u32 s37, s20, s21
s_and_b32 s37, s37, 3
s_mov_b32 s42, s37
s_mov_b32 s38, s37
s_lshl_b32 s25, s20, 6
s_lshl_b32 s26, s22, 4
s_add_u32 s25, s25, s26
v_add_u32 v6, s25, v3
v_lshrrev_b32 v7, 5, v6
v_mul_u32_u24 v7, 40960, v7
v_lshl_add_u32 v7, v4, 9, v7
v_and_b32 v8, 31, v6
v_lshl_add_u32 v14, v8, 3, v7
v_lshl_add_u32 v7, v8, 4, v7
v_lshrrev_b32 v1, 3, v2
v_xor_b32 v8, v1, v2
v_and_b32 v8, 7, v8
v_lshlrev_b32 v10, 12, v1
v_lshl_add_u32 v10, v8, 4, v10
v_lshrrev_b32 v8, 1, v4
v_lshl_add_u32 v8, s22, 1, v8
v_xor_b32 v8, v8, v3
v_and_b32 v8, 7, v8
v_lshl_add_u32 v8, v3, 3, v8
v_and_b32 v9, 1, v4
v_lshl_add_u32 v8, v8, 1, v9
s_mov_b32 s39, 81920
v_lshl_add_u32 v12, v8, 3, s39
s_lshl_b32 s40, s22, 10
s_add_u32 s39, s39, s40
v_add_u32 v13, s39, v5
v_add_u32 v11, 0x10000, v5
s_waitcnt lgkmcnt(0)
s_add_u32 s12, s6, 0
s_addc_u32 s13, s7, 0
s_mov_b32 s14, 44564480
s_mov_b32 s15, 0x00020000
s_add_u32 s24, s24, 20971520
s_add_u32 s8, s6, s24
s_addc_u32 s9, s7, 0
s_mov_b32 s10, 102400
s_mov_b32 s11, 0x00020000
s_mul_i32 s36, s37, 20480
s_add_u32 s36, s36, s23
s_add_u32 m0, s23, 0
s_nop 0
buffer_load_dwordx4 v5, s[8:11], s36 offen lds
buffer_load_dwordx4 v5, s[8:11], s36 offen offset:1024 lds
buffer_load_dwordx4 v5, s[8:11], s36 offen offset:2048 lds
buffer_load_dwordx4 v5, s[8:11], s36 offen offset:3072 lds
s_add_u32 m0, s23, 4096
s_add_u32 s36, s36, 4096
buffer_load_dwordx4 v5, s[8:11], s36 offen lds
s_lshl_b32 s27, s38, 13
s_add_u32 s27, s27, 5242880
buffer_load_dwordx4 v[16:19], v7, s[12:15], s27 offen offset:0
buffer_load_dwordx4 v[20:23], v7, s[12:15], s27 offen offset:2048
s_add_u32 s27, s27, 4096
buffer_load_dwordx4 v[24:27], v7, s[12:15], s27 offen offset:0
buffer_load_dwordx4 v[28:31], v7, s[12:15], s27 offen offset:2048
s_add_u32 s37, s37, 1
s_and_b32 s37, s37, 3
s_mul_i32 s36, s37, 20480
s_add_u32 s36, s36, s23
s_add_u32 m0, s23, 20480
s_nop 0
buffer_load_dwordx4 v5, s[8:11], s36 offen lds
buffer_load_dwordx4 v5, s[8:11], s36 offen offset:1024 lds
buffer_load_dwordx4 v5, s[8:11], s36 offen offset:2048 lds
buffer_load_dwordx4 v5, s[8:11], s36 offen offset:3072 lds
s_add_u32 m0, s23, 24576
s_add_u32 s36, s36, 4096
buffer_load_dwordx4 v5, s[8:11], s36 offen lds
s_add_u32 s38, s38, 1
s_and_b32 s38, s38, 3
s_lshl_b32 s27, s38, 13
s_add_u32 s27, s27, 5242880
buffer_load_dwordx4 v[32:35], v7, s[12:15], s27 offen offset:0
buffer_load_dwordx4 v[36:39], v7, s[12:15], s27 offen offset:2048
s_add_u32 s27, s27, 4096
buffer_load_dwordx4 v[40:43], v7, s[12:15], s27 offen offset:0
buffer_load_dwordx4 v[44:47], v7, s[12:15], s27 offen offset:2048
s_mul_i32 s28, s21, 80*4096
s_lshl_b32 s29, s20, 7
s_add_u32 s28, s28, s29
s_lshl_b32 s29, s22, 15
s_add_u32 s28, s28, s29
s_and_b32 s40, s22, 1
s_sub_u32 s40, s40, s22
s_add_u32 s40, s40, 8
s_lshl_b32 s41, s40, 15
s_lshl_b32 s40, s40, 10
s_add_u32 s29, s28, 2621440
s_add_u32 m0, s39, 0
s_nop 0
buffer_load_dwordx4 v10, s[12:15], s29 offen lds
s_add_u32 s29, s28, 2752512
s_add_u32 m0, s39, 4096
s_nop 0
buffer_load_dwordx4 v10, s[12:15], s29 offen lds
s_add_u32 s29, s28, 2621440
s_add_u32 s29, s29, s41
s_add_u32 m0, s39, s40
s_nop 0
buffer_load_dwordx4 v10, s[12:15], s29 offen lds
s_waitcnt vmcnt(16)
s_barrier
ds_read_b128 v[64:67], v5 offset:0
ds_read_b128 v[68:71], v5 offset:1024
ds_read_b128 v[72:75], v5 offset:2048
ds_read_b128 v[76:79], v5 offset:3072
ds_read_b128 v[80:83], v5 offset:4096
ds_read_b128 v[84:87], v5 offset:5120
ds_read_b128 v[88:91], v5 offset:6144
ds_read_b128 v[92:95], v5 offset:7168
ds_read_b128 v[96:99], v5 offset:8192
ds_read_b128 v[100:103], v5 offset:9216
s_waitcnt vmcnt(12) lgkmcnt(9)
v_mfma_f32_16x16x32_bf16 v[124:127], v[16:19], v[64:67], 0
ds_read_b128 v[104:107], v5 offset:10240
s_add_u32 s37, s37, 1
s_and_b32 s37, s37, 3
s_mul_i32 s36, s37, 20480
s_add_u32 s36, s36, s23
s_add_u32 m0, s23, 40960
s_nop 0
buffer_load_dwordx4 v5, s[8:11], s36 offen lds
s_waitcnt lgkmcnt(9)
v_mfma_f32_16x16x32_bf16 v[128:131], v[16:19], v[68:71], 0
ds_read_b128 v[108:111], v5 offset:11264
buffer_load_dwordx4 v5, s[8:11], s36 offen offset:1024 lds
s_waitcnt lgkmcnt(9)
v_mfma_f32_16x16x32_bf16 v[132:135], v[16:19], v[72:75], 0
ds_read_b128 v[112:115], v5 offset:12288
buffer_load_dwordx4 v5, s[8:11], s36 offen offset:2048 lds
s_waitcnt lgkmcnt(9)
v_mfma_f32_16x16x32_bf16 v[136:139], v[16:19], v[76:79], 0
ds_read_b128 v[116:119], v5 offset:13312
buffer_load_dwordx4 v5, s[8:11], s36 offen offset:3072 lds
s_waitcnt lgkmcnt(9)
v_mfma_f32_16x16x32_bf16 v[140:143], v[16:19], v[80:83], 0
ds_read_b128 v[120:123], v5 offset:14336
s_add_u32 m0, s23, 45056
s_add_u32 s36, s36, 4096
buffer_load_dwordx4 v5, s[8:11], s36 offen lds
s_waitcnt lgkmcnt(9)
v_mfma_f32_16x16x32_bf16 v[124:127], v[20:23], v[84:87], v[124:127]
ds_read_b128 v[64:67], v5 offset:15360
s_add_u32 s38, s38, 1
s_and_b32 s38, s38, 3
s_lshl_b32 s27, s38, 13
s_add_u32 s27, s27, 5242880
buffer_load_dwordx4 v[48:51], v7, s[12:15], s27 offen offset:0
s_waitcnt lgkmcnt(9)
v_mfma_f32_16x16x32_bf16 v[128:131], v[20:23], v[88:91], v[128:131]
ds_read_b128 v[68:71], v5 offset:16384
buffer_load_dwordx4 v[52:55], v7, s[12:15], s27 offen offset:2048
s_waitcnt lgkmcnt(9)
v_mfma_f32_16x16x32_bf16 v[132:135], v[20:23], v[92:95], v[132:135]
ds_read_b128 v[72:75], v5 offset:17408
s_add_u32 s27, s27, 4096
buffer_load_dwordx4 v[56:59], v7, s[12:15], s27 offen offset:0
s_waitcnt lgkmcnt(9)
v_mfma_f32_16x16x32_bf16 v[136:139], v[20:23], v[96:99], v[136:139]
ds_read_b128 v[76:79], v5 offset:18432
buffer_load_dwordx4 v[60:63], v7, s[12:15], s27 offen offset:2048
s_waitcnt lgkmcnt(9)
v_mfma_f32_16x16x32_bf16 v[140:143], v[20:23], v[100:103], v[140:143]
ds_read_b128 v[80:83], v5 offset:19456
s_waitcnt lgkmcnt(9)
v_mfma_f32_16x16x32_bf16 v[124:127], v[24:27], v[104:107], v[124:127]
s_waitcnt vmcnt(16)
s_barrier
ds_read_b128 v[84:87], v5 offset:20480
s_waitcnt lgkmcnt(9)
v_mfma_f32_16x16x32_bf16 v[128:131], v[24:27], v[108:111], v[128:131]
ds_read_b128 v[88:91], v5 offset:21504
s_add_u32 s37, s37, 1
s_and_b32 s37, s37, 3
s_mul_i32 s36, s37, 20480
s_add_u32 s36, s36, s23
s_add_u32 m0, s23, 61440
s_nop 0
buffer_load_dwordx4 v5, s[8:11], s36 offen lds
s_waitcnt lgkmcnt(9)
v_mfma_f32_16x16x32_bf16 v[132:135], v[24:27], v[112:115], v[132:135]
ds_read_b128 v[92:95], v5 offset:22528
s_waitcnt lgkmcnt(9)
v_mfma_f32_16x16x32_bf16 v[136:139], v[24:27], v[116:119], v[136:139]
ds_read_b128 v[96:99], v5 offset:23552
buffer_load_dwordx4 v5, s[8:11], s36 offen offset:1024 lds
s_waitcnt lgkmcnt(9)
v_mfma_f32_16x16x32_bf16 v[140:143], v[24:27], v[120:123], v[140:143]
ds_read_b128 v[100:103], v5 offset:24576
buffer_load_dwordx4 v5, s[8:11], s36 offen offset:2048 lds
s_waitcnt lgkmcnt(9)
v_mfma_f32_16x16x32_bf16 v[124:127], v[28:31], v[64:67], v[124:127]
ds_read_b128 v[104:107], v5 offset:25600
s_waitcnt lgkmcnt(9)
v_mfma_f32_16x16x32_bf16 v[128:131], v[28:31], v[68:71], v[128:131]
ds_read_b128 v[108:111], v5 offset:26624
buffer_load_dwordx4 v5, s[8:11], s36 offen offset:3072 lds
s_waitcnt lgkmcnt(9)
v_mfma_f32_16x16x32_bf16 v[132:135], v[28:31], v[72:75], v[132:135]
ds_read_b128 v[112:115], v5 offset:27648
s_waitcnt lgkmcnt(9)
v_mfma_f32_16x16x32_bf16 v[136:139], v[28:31], v[76:79], v[136:139]
ds_read_b128 v[116:119], v5 offset:28672
s_add_u32 m0, s23, 65536
s_add_u32 s36, s36, 4096
buffer_load_dwordx4 v5, s[8:11], s36 offen lds
s_waitcnt lgkmcnt(9)
v_mfma_f32_16x16x32_bf16 v[140:143], v[28:31], v[80:83], v[140:143]
ds_read_b128 v[120:123], v5 offset:29696
s_add_u32 s38, s38, 1
s_and_b32 s38, s38, 3
s_lshl_b32 s27, s38, 13
s_add_u32 s27, s27, 5242880
buffer_load_dwordx4 v[16:19], v7, s[12:15], s27 offen offset:0
s_waitcnt vmcnt(18) lgkmcnt(9)
v_mfma_f32_16x16x32_bf16 v[124:127], v[32:35], v[84:87], v[124:127]
ds_read_b128 v[64:67], v5 offset:30720
s_waitcnt lgkmcnt(9)
v_mfma_f32_16x16x32_bf16 v[128:131], v[32:35], v[88:91], v[128:131]
ds_read_b128 v[68:71], v5 offset:31744
buffer_load_dwordx4 v[20:23], v7, s[12:15], s27 offen offset:2048
s_waitcnt lgkmcnt(9)
v_mfma_f32_16x16x32_bf16 v[132:135], v[32:35], v[92:95], v[132:135]
ds_read_b128 v[72:75], v5 offset:32768
s_waitcnt lgkmcnt(9)
v_mfma_f32_16x16x32_bf16 v[136:139], v[32:35], v[96:99], v[136:139]
ds_read_b128 v[76:79], v5 offset:33792
s_add_u32 s27, s27, 4096
buffer_load_dwordx4 v[24:27], v7, s[12:15], s27 offen offset:0
s_waitcnt lgkmcnt(9)
v_mfma_f32_16x16x32_bf16 v[140:143], v[32:35], v[100:103], v[140:143]
ds_read_b128 v[80:83], v5 offset:34816
buffer_load_dwordx4 v[28:31], v7, s[12:15], s27 offen offset:2048
s_waitcnt lgkmcnt(9)
v_mfma_f32_16x16x32_bf16 v[124:127], v[36:39], v[104:107], v[124:127]
ds_read_b128 v[84:87], v5 offset:35840
s_waitcnt lgkmcnt(9)
v_mfma_f32_16x16x32_bf16 v[128:131], v[36:39], v[108:111], v[128:131]
ds_read_b128 v[88:91], v5 offset:36864
s_waitcnt lgkmcnt(9)
v_mfma_f32_16x16x32_bf16 v[132:135], v[36:39], v[112:115], v[132:135]
ds_read_b128 v[92:95], v5 offset:37888
s_waitcnt lgkmcnt(9)
v_mfma_f32_16x16x32_bf16 v[136:139], v[36:39], v[116:119], v[136:139]
ds_read_b128 v[96:99], v5 offset:38912
s_waitcnt lgkmcnt(9)
v_mfma_f32_16x16x32_bf16 v[140:143], v[36:39], v[120:123], v[140:143]
ds_read_b128 v[100:103], v5 offset:39936
s_waitcnt lgkmcnt(9)
v_mfma_f32_16x16x32_bf16 v[124:127], v[40:43], v[64:67], v[124:127]
s_waitcnt vmcnt(13)
s_barrier
ds_read_b128 v[104:107], v5 offset:40960
s_waitcnt lgkmcnt(9)
v_mfma_f32_16x16x32_bf16 v[128:131], v[40:43], v[68:71], v[128:131]
ds_read_b128 v[108:111], v5 offset:41984
s_mov_b32 s37, 4
s_mul_i32 s36, s37, 20480
s_add_u32 s36, s36, s23
s_add_u32 m0, s23, 0
s_nop 0
buffer_load_dwordx4 v5, s[8:11], s36 offen lds
s_waitcnt lgkmcnt(9)
v_mfma_f32_16x16x32_bf16 v[132:135], v[40:43], v[72:75], v[132:135]
ds_read_b128 v[112:115], v5 offset:43008
s_waitcnt lgkmcnt(9)
v_mfma_f32_16x16x32_bf16 v[136:139], v[40:43], v[76:79], v[136:139]
ds_read_b128 v[116:119], v5 offset:44032
buffer_load_dwordx4 v5, s[8:11], s36 offen offset:1024 lds
s_waitcnt lgkmcnt(9)
v_mfma_f32_16x16x32_bf16 v[140:143], v[40:43], v[80:83], v[140:143]
ds_read_b128 v[120:123], v5 offset:45056
buffer_load_dwordx4 v5, s[8:11], s36 offen offset:2048 lds
s_waitcnt lgkmcnt(9)
v_mfma_f32_16x16x32_bf16 v[124:127], v[44:47], v[84:87], v[124:127]
ds_read_b128 v[64:67], v5 offset:46080
s_waitcnt lgkmcnt(9)
v_mfma_f32_16x16x32_bf16 v[128:131], v[44:47], v[88:91], v[128:131]
ds_read_b128 v[68:71], v5 offset:47104
buffer_load_dwordx4 v5, s[8:11], s36 offen offset:3072 lds
s_waitcnt lgkmcnt(9)
v_mfma_f32_16x16x32_bf16 v[132:135], v[44:47], v[92:95], v[132:135]
ds_read_b128 v[72:75], v5 offset:48128
s_waitcnt lgkmcnt(9)
v_mfma_f32_16x16x32_bf16 v[136:139], v[44:47], v[96:99], v[136:139]
ds_read_b128 v[76:79], v5 offset:49152
s_add_u32 m0, s23, 4096
s_add_u32 s36, s36, 4096
buffer_load_dwordx4 v5, s[8:11], s36 offen lds
s_waitcnt lgkmcnt(9)
v_mfma_f32_16x16x32_bf16 v[140:143], v[44:47], v[100:103], v[140:143]
ds_read_b128 v[80:83], v5 offset:50176
s_mov_b32 s38, 4
s_lshl_b32 s27, s38, 13
s_add_u32 s27, s27, 5242880
buffer_load_dwordx2 v[32:33], v14, s[12:15], s27 offen offset:0
s_waitcnt vmcnt(15) lgkmcnt(9)
v_mfma_f32_16x16x32_bf16 v[124:127], v[48:51], v[104:107], v[124:127]
ds_read_b128 v[84:87], v5 offset:51200
s_waitcnt lgkmcnt(9)
v_mfma_f32_16x16x32_bf16 v[128:131], v[48:51], v[108:111], v[128:131]
ds_read_b128 v[88:91], v5 offset:52224
buffer_load_dwordx2 v[34:35], v14, s[12:15], s27 offen offset:256
s_waitcnt lgkmcnt(9)
v_mfma_f32_16x16x32_bf16 v[132:135], v[48:51], v[112:115], v[132:135]
ds_read_b128 v[92:95], v5 offset:53248
s_waitcnt lgkmcnt(9)
v_mfma_f32_16x16x32_bf16 v[136:139], v[48:51], v[116:119], v[136:139]
ds_read_b128 v[96:99], v5 offset:54272
buffer_load_dwordx2 v[36:37], v14, s[12:15], s27 offen offset:2048
s_waitcnt lgkmcnt(9)
v_mfma_f32_16x16x32_bf16 v[140:143], v[48:51], v[120:123], v[140:143]
ds_read_b128 v[100:103], v5 offset:55296
buffer_load_dwordx2 v[38:39], v14, s[12:15], s27 offen offset:2304
s_waitcnt lgkmcnt(9)
v_mfma_f32_16x16x32_bf16 v[124:127], v[52:55], v[64:67], v[124:127]
ds_read_b128 v[104:107], v5 offset:56320
s_waitcnt lgkmcnt(9)
v_mfma_f32_16x16x32_bf16 v[128:131], v[52:55], v[68:71], v[128:131]
ds_read_b128 v[108:111], v5 offset:57344
s_add_u32 s27, s27, 4096
buffer_load_dwordx2 v[40:41], v14, s[12:15], s27 offen offset:0
s_waitcnt lgkmcnt(9)
v_mfma_f32_16x16x32_bf16 v[132:135], v[52:55], v[72:75], v[132:135]
ds_read_b128 v[112:115], v5 offset:58368
s_waitcnt lgkmcnt(9)
v_mfma_f32_16x16x32_bf16 v[136:139], v[52:55], v[76:79], v[136:139]
ds_read_b128 v[116:119], v5 offset:59392
buffer_load_dwordx2 v[42:43], v14, s[12:15], s27 offen offset:256
s_waitcnt lgkmcnt(9)
v_mfma_f32_16x16x32_bf16 v[140:143], v[52:55], v[80:83], v[140:143]
ds_read_b128 v[120:123], v5 offset:60416
buffer_load_dwordx2 v[44:45], v14, s[12:15], s27 offen offset:2048
s_waitcnt lgkmcnt(9)
v_mfma_f32_16x16x32_bf16 v[124:127], v[56:59], v[84:87], v[124:127]
buffer_load_dwordx2 v[46:47], v14, s[12:15], s27 offen offset:2304
s_waitcnt vmcnt(17)
s_barrier
ds_read_b128 v[64:67], v5 offset:61440
s_waitcnt lgkmcnt(9)
v_mfma_f32_16x16x32_bf16 v[128:131], v[56:59], v[88:91], v[128:131]
ds_read_b128 v[68:71], v5 offset:62464
s_getpc_b64 s[44:45]
s_add_u32 s44, s44, .Ltext0@rel32@lo+4
s_addc_u32 s45, s45, .Ltext0@rel32@hi+12
s_lshr_b32 s47, s2, 3
s_lshl_b32 s47, s47, 15
v_lshl_add_u32 v180, v0, 7, s47
s_mov_b32 s46, .Ltext1-.Ltext0
s_mov_b32 s47, 0x00020000
buffer_load_dword v181, v180, s[44:47], 0 offen
s_waitcnt lgkmcnt(9)
v_mfma_f32_16x16x32_bf16 v[132:135], v[56:59], v[92:95], v[132:135]
ds_read_b128 v[72:75], v5 offset:63488
s_waitcnt lgkmcnt(9)
v_mfma_f32_16x16x32_bf16 v[136:139], v[56:59], v[96:99], v[136:139]
ds_read_b128 v[76:79], v5 offset:64512
s_waitcnt lgkmcnt(9)
v_mfma_f32_16x16x32_bf16 v[140:143], v[56:59], v[100:103], v[140:143]
ds_read_b128 v[80:83], v11 offset:0
s_waitcnt lgkmcnt(9)
v_mfma_f32_16x16x32_bf16 v[124:127], v[60:63], v[104:107], v[124:127]
ds_read_b128 v[84:87], v11 offset:1024
s_waitcnt lgkmcnt(9)
v_mfma_f32_16x16x32_bf16 v[128:131], v[60:63], v[108:111], v[128:131]
ds_read_b128 v[88:91], v11 offset:2048
s_waitcnt lgkmcnt(9)
v_mfma_f32_16x16x32_bf16 v[132:135], v[60:63], v[112:115], v[132:135]
ds_read_b128 v[92:95], v11 offset:3072
s_waitcnt lgkmcnt(9)
v_mfma_f32_16x16x32_bf16 v[136:139], v[60:63], v[116:119], v[136:139]
ds_read_b128 v[96:99], v11 offset:4096
s_waitcnt lgkmcnt(9)
v_mfma_f32_16x16x32_bf16 v[140:143], v[60:63], v[120:123], v[140:143]
ds_read_b128 v[100:103], v11 offset:5120
s_waitcnt vmcnt(14) lgkmcnt(9)
v_mfma_f32_16x16x32_bf16 v[124:127], v[16:19], v[64:67], v[124:127]
ds_read_b128 v[104:107], v11 offset:6144
s_waitcnt lgkmcnt(9)
v_mfma_f32_16x16x32_bf16 v[128:131], v[16:19], v[68:71], v[128:131]
ds_read_b128 v[108:111], v11 offset:7168
s_waitcnt lgkmcnt(9)
v_mfma_f32_16x16x32_bf16 v[132:135], v[16:19], v[72:75], v[132:135]
ds_read_b128 v[112:115], v11 offset:8192
s_waitcnt lgkmcnt(9)
v_mfma_f32_16x16x32_bf16 v[136:139], v[16:19], v[76:79], v[136:139]
ds_read_b128 v[116:119], v11 offset:9216
s_waitcnt lgkmcnt(9)
v_mfma_f32_16x16x32_bf16 v[140:143], v[16:19], v[80:83], v[140:143]
ds_read_b128 v[120:123], v11 offset:10240
s_waitcnt lgkmcnt(9)
v_mfma_f32_16x16x32_bf16 v[124:127], v[20:23], v[84:87], v[124:127]
ds_read_b128 v[64:67], v11 offset:11264
s_waitcnt lgkmcnt(9)
v_mfma_f32_16x16x32_bf16 v[128:131], v[20:23], v[88:91], v[128:131]
ds_read_b128 v[68:71], v11 offset:12288
s_waitcnt lgkmcnt(9)
v_mfma_f32_16x16x32_bf16 v[132:135], v[20:23], v[92:95], v[132:135]
ds_read_b128 v[72:75], v11 offset:13312
s_waitcnt lgkmcnt(9)
v_mfma_f32_16x16x32_bf16 v[136:139], v[20:23], v[96:99], v[136:139]
ds_read_b128 v[76:79], v11 offset:14336
s_waitcnt lgkmcnt(9)
v_mfma_f32_16x16x32_bf16 v[140:143], v[20:23], v[100:103], v[140:143]
ds_read_b128 v[80:83], v11 offset:15360
s_waitcnt lgkmcnt(9)
v_mfma_f32_16x16x32_bf16 v[124:127], v[24:27], v[104:107], v[124:127]
s_waitcnt vmcnt(9)
s_barrier
ds_read_b128 v[84:87], v5 offset:0
s_waitcnt lgkmcnt(9)
v_mfma_f32_16x16x32_bf16 v[128:131], v[24:27], v[108:111], v[128:131]
ds_read_b128 v[88:91], v5 offset:1024
s_waitcnt lgkmcnt(9)
v_mfma_f32_16x16x32_bf16 v[132:135], v[24:27], v[112:115], v[132:135]
ds_read_b128 v[92:95], v5 offset:2048
s_waitcnt lgkmcnt(9)
v_mfma_f32_16x16x32_bf16 v[136:139], v[24:27], v[116:119], v[136:139]
ds_read_b128 v[96:99], v5 offset:3072
s_waitcnt lgkmcnt(9)
v_mfma_f32_16x16x32_bf16 v[140:143], v[24:27], v[120:123], v[140:143]
ds_read_b128 v[100:103], v5 offset:4096
s_waitcnt lgkmcnt(9)
v_mfma_f32_16x16x32_bf16 v[124:127], v[28:31], v[64:67], v[124:127]
ds_read_b128 v[104:107], v5 offset:5120
s_waitcnt lgkmcnt(9)
v_mfma_f32_16x16x32_bf16 v[128:131], v[28:31], v[68:71], v[128:131]
ds_read_b128 v[108:111], v5 offset:6144
s_waitcnt lgkmcnt(9)
v_mfma_f32_16x16x32_bf16 v[132:135], v[28:31], v[72:75], v[132:135]
ds_read_b128 v[112:115], v5 offset:7168
s_waitcnt lgkmcnt(9)
v_mfma_f32_16x16x32_bf16 v[136:139], v[28:31], v[76:79], v[136:139]
ds_read_b128 v[116:119], v5 offset:8192
s_waitcnt lgkmcnt(9)
v_mfma_f32_16x16x32_bf16 v[140:143], v[28:31], v[80:83], v[140:143]
ds_read_b128 v[120:123], v5 offset:9216
s_waitcnt vmcnt(1) lgkmcnt(9)
v_mfma_f32_16x16x32_bf16 v[124:127], v[32:35], v[84:87], v[124:127]
ds_read_b128 v[64:67], v5 offset:10240
s_waitcnt lgkmcnt(9)
v_mfma_f32_16x16x32_bf16 v[128:131], v[32:35], v[88:91], v[128:131]
ds_read_b128 v[68:71], v5 offset:11264
s_waitcnt lgkmcnt(9)
v_mfma_f32_16x16x32_bf16 v[132:135], v[32:35], v[92:95], v[132:135]
ds_read_b128 v[72:75], v5 offset:12288
s_waitcnt lgkmcnt(9)
v_mfma_f32_16x16x32_bf16 v[136:139], v[32:35], v[96:99], v[136:139]
ds_read_b128 v[76:79], v5 offset:13312
s_waitcnt lgkmcnt(9)
v_mfma_f32_16x16x32_bf16 v[140:143], v[32:35], v[100:103], v[140:143]
ds_read_b128 v[80:83], v5 offset:14336
s_waitcnt lgkmcnt(9)
v_mfma_f32_16x16x32_bf16 v[124:127], v[36:39], v[104:107], v[124:127]
ds_read_b128 v[84:87], v5 offset:15360
s_waitcnt lgkmcnt(9)
v_mfma_f32_16x16x32_bf16 v[128:131], v[36:39], v[108:111], v[128:131]
ds_read_b128 v[88:91], v5 offset:16384
s_waitcnt lgkmcnt(9)
v_mfma_f32_16x16x32_bf16 v[132:135], v[36:39], v[112:115], v[132:135]
ds_read_b128 v[92:95], v5 offset:17408
s_waitcnt lgkmcnt(9)
v_mfma_f32_16x16x32_bf16 v[136:139], v[36:39], v[116:119], v[136:139]
ds_read_b128 v[96:99], v5 offset:18432
s_waitcnt lgkmcnt(9)
v_mfma_f32_16x16x32_bf16 v[140:143], v[36:39], v[120:123], v[140:143]
ds_read_b128 v[100:103], v5 offset:19456
ds_read_b64 v[156:157], v12 offset:0
ds_read_b64 v[158:159], v12 offset:2048
ds_read_b64 v[160:161], v12 offset:4096
ds_read_b64 v[162:163], v12 offset:6144
ds_read_b64 v[164:165], v12 offset:8192
s_waitcnt lgkmcnt(14)
v_mfma_f32_16x16x32_bf16 v[124:127], v[40:43], v[64:67], v[124:127]
s_waitcnt lgkmcnt(13)
v_mfma_f32_16x16x32_bf16 v[128:131], v[40:43], v[68:71], v[128:131]
s_waitcnt lgkmcnt(12)
v_mfma_f32_16x16x32_bf16 v[132:135], v[40:43], v[72:75], v[132:135]
s_waitcnt lgkmcnt(11)
v_mfma_f32_16x16x32_bf16 v[136:139], v[40:43], v[76:79], v[136:139]
s_waitcnt lgkmcnt(10)
v_mfma_f32_16x16x32_bf16 v[140:143], v[40:43], v[80:83], v[140:143]
s_waitcnt lgkmcnt(9)
v_mfma_f32_16x16x32_bf16 v[124:127], v[44:47], v[84:87], v[124:127]
s_waitcnt lgkmcnt(8)
v_mfma_f32_16x16x32_bf16 v[128:131], v[44:47], v[88:91], v[128:131]
s_waitcnt lgkmcnt(7)
v_mfma_f32_16x16x32_bf16 v[132:135], v[44:47], v[92:95], v[132:135]
s_waitcnt lgkmcnt(6)
v_mfma_f32_16x16x32_bf16 v[136:139], v[44:47], v[96:99], v[136:139]
s_waitcnt lgkmcnt(5)
v_mfma_f32_16x16x32_bf16 v[140:143], v[44:47], v[100:103], v[140:143]
s_waitcnt lgkmcnt(0)
s_cmp_eq_u32 s21, 0
s_cselect_b32 s30, 1, 99
v_cmp_eq_u32 vcc, s30, v3
v_lshlrev_b32 v15, 4, v4
s_lshl_b32 s31, s25, 2
s_add_u32 s31, s31, 25714688
s_cmp_lg_u32 s21, 0
s_cbranch_scc1 .Lp4_sk3
s_mov_b64 exec, vcc
buffer_store_dwordx4 v[124:127], v15, s[12:15], s31 offen
s_mov_b64 exec, -1
.Lp4_sk3:
s_nop 0
v_cndmask_b32 v124, v124, 0, vcc
v_cndmask_b32 v125, v125, 0, vcc
v_cndmask_b32 v126, v126, 0, vcc
v_cndmask_b32 v127, v127, 0, vcc
v_lshlrev_b32 v16, 16, v156
v_and_b32 v17, 0xffff0000, v156
v_add_f32 v124, v124, v16
v_add_f32 v125, v125, v17
v_lshlrev_b32 v16, 16, v157
v_and_b32 v17, 0xffff0000, v157
v_add_f32 v126, v126, v16
v_add_f32 v127, v127, v17
v_cvt_pk_bf16_f32 v20, v124, v125
v_cvt_pk_bf16_f32 v21, v126, v127
ds_write_b64 v12, v[20:21] offset:0
v_lshlrev_b32 v16, 16, v158
v_and_b32 v17, 0xffff0000, v158
v_add_f32 v128, v128, v16
v_add_f32 v129, v129, v17
v_lshlrev_b32 v16, 16, v159
v_and_b32 v17, 0xffff0000, v159
v_add_f32 v130, v130, v16
v_add_f32 v131, v131, v17
v_cvt_pk_bf16_f32 v22, v128, v129
v_cvt_pk_bf16_f32 v23, v130, v131
ds_write_b64 v12, v[22:23] offset:2048
v_lshlrev_b32 v16, 16, v160
v_and_b32 v17, 0xffff0000, v160
v_add_f32 v132, v132, v16
v_add_f32 v133, v133, v17
v_lshlrev_b32 v16, 16, v161
v_and_b32 v17, 0xffff0000, v161
v_add_f32 v134, v134, v16
v_add_f32 v135, v135, v17
v_cvt_pk_bf16_f32 v24, v132, v133
v_cvt_pk_bf16_f32 v25, v134, v135
ds_write_b64 v12, v[24:25] offset:4096
v_lshlrev_b32 v16, 16, v162
v_and_b32 v17, 0xffff0000, v162
v_add_f32 v136, v136, v16
v_add_f32 v137, v137, v17
v_lshlrev_b32 v16, 16, v163
v_and_b32 v17, 0xffff0000, v163
v_add_f32 v138, v138, v16
v_add_f32 v139, v139, v17
v_cvt_pk_bf16_f32 v26, v136, v137
v_cvt_pk_bf16_f32 v27, v138, v139
ds_write_b64 v12, v[26:27] offset:6144
v_lshlrev_b32 v16, 16, v164
v_and_b32 v17, 0xffff0000, v164
v_add_f32 v140, v140, v16
v_add_f32 v141, v141, v17
v_lshlrev_b32 v16, 16, v165
v_and_b32 v17, 0xffff0000, v165
v_add_f32 v142, v142, v16
v_add_f32 v143, v143, v17
v_cvt_pk_bf16_f32 v28, v140, v141
v_cvt_pk_bf16_f32 v29, v142, v143
ds_write_b64 v12, v[28:29] offset:8192
v_mul_f32 v144, v124, v124
v_mul_f32 v145, v125, v125
v_mul_f32 v146, v126, v126
v_mul_f32 v147, v127, v127
v_fmac_f32 v144, v128, v128
v_fmac_f32 v145, v129, v129
v_fmac_f32 v146, v130, v130
v_fmac_f32 v147, v131, v131
v_fmac_f32 v144, v132, v132
v_fmac_f32 v145, v133, v133
v_fmac_f32 v146, v134, v134
v_fmac_f32 v147, v135, v135
v_fmac_f32 v144, v136, v136
v_fmac_f32 v145, v137, v137
v_fmac_f32 v146, v138, v138
v_fmac_f32 v147, v139, v139
v_fmac_f32 v144, v140, v140
v_fmac_f32 v145, v141, v141
v_fmac_f32 v146, v142, v142
v_fmac_f32 v147, v143, v143
s_waitcnt lgkmcnt(0)
s_barrier
ds_read_b128 v[16:19], v13 offset:0
ds_read_b128 v[20:23], v13 offset:4096
s_cmp_ge_u32 s22, 2
s_cbranch_scc1 .Lp4_q4
ds_read_b128 v[24:27], v13 offset:8192
s_add_u32 s29, s28, 26476544
s_waitcnt lgkmcnt(0)
buffer_store_dwordx4 v[24:27], v10, s[12:15], s29 offen sc1
.Lp4_q4:
s_add_u32 s29, s28, 26345472
s_add_u32 s28, s28, 26214400
s_waitcnt lgkmcnt(1)
buffer_store_dwordx4 v[16:19], v10, s[12:15], s28 offen sc1
s_waitcnt lgkmcnt(0)
buffer_store_dwordx4 v[20:23], v10, s[12:15], s29 offen sc1
v_add_f32_dpp v144, v144, v144 row_ror:8 row_mask:0xf bank_mask:0xf
v_add_f32_dpp v145, v145, v145 row_ror:8 row_mask:0xf bank_mask:0xf
v_add_f32_dpp v146, v146, v146 row_ror:8 row_mask:0xf bank_mask:0xf
v_add_f32_dpp v147, v147, v147 row_ror:8 row_mask:0xf bank_mask:0xf
v_add_f32_dpp v144, v144, v144 row_ror:4 row_mask:0xf bank_mask:0xf
v_add_f32_dpp v145, v145, v145 row_ror:4 row_mask:0xf bank_mask:0xf
v_add_f32_dpp v146, v146, v146 row_ror:4 row_mask:0xf bank_mask:0xf
v_add_f32_dpp v147, v147, v147 row_ror:4 row_mask:0xf bank_mask:0xf
v_add_f32_dpp v144, v144, v144 row_ror:2 row_mask:0xf bank_mask:0xf
v_add_f32_dpp v145, v145, v145 row_ror:2 row_mask:0xf bank_mask:0xf
v_add_f32_dpp v146, v146, v146 row_ror:2 row_mask:0xf bank_mask:0xf
v_add_f32_dpp v147, v147, v147 row_ror:2 row_mask:0xf bank_mask:0xf
v_add_f32_dpp v144, v144, v144 row_ror:1 row_mask:0xf bank_mask:0xf
v_add_f32_dpp v145, v145, v145 row_ror:1 row_mask:0xf bank_mask:0xf
v_add_f32_dpp v146, v146, v146 row_ror:1 row_mask:0xf bank_mask:0xf
v_add_f32_dpp v147, v147, v147 row_ror:1 row_mask:0xf bank_mask:0xf
v_cmp_eq_u32 vcc, 1, v3
s_nop 1
v_cndmask_b32 v144, v144, v145, vcc
v_cmp_eq_u32 vcc, 2, v3
s_nop 1
v_cndmask_b32 v144, v144, v146, vcc
v_cmp_eq_u32 vcc, 3, v3
s_nop 1
v_cndmask_b32 v144, v144, v147, vcc
v_cmp_gt_u32 vcc, 4, v3
v_lshl_add_u32 v15, v3, 2, v15
s_lshl_b32 s31, s25, 2
s_add_u32 s31, s31, 25698304
s_mov_b64 exec, vcc
buffer_atomic_add_f32 v144, v15, s[12:15], s31 offen sc1
.Lp4_end2:
s_endpgm
.p2align 8
.globl cf2_kernel
.type cf2_kernel,@function
cf2_kernel:
s_cmp_lt_u32 s2, 320
s_cbranch_scc1 .Lcf2_role1
s_sub_u32 s2, s2, 320
s_endpgm
.Lcf2_role1:
s_load_dwordx2 s[4:5], s[0:1], 64
v_lshrrev_b32 v4, 6, v0
v_and_b32 v5, 63, v0
v_readfirstlane_b32 s22, v4
v_lshlrev_b32 v1, 4, v5
v_bfe_u32 v2, v0, 4, 2
v_and_b32 v3, 15, v0
s_getpc_b64 s[26:27]
s_add_u32 s26, s26, .Ltabcf@rel32@lo+4
s_addc_u32 s27, s27, .Ltabcf@rel32@hi+12
s_add_u32 s8, s26, 0
s_addc_u32 s9, s27, 0
s_mov_b32 s10, 20480
s_mov_b32 s11, 0x00020000
s_mul_i32 s23, s22, 5120
s_mov_b32 m0, s23
s_nop 0
buffer_load_dwordx4 v1, s[8:11], m0 offen offset:0 lds
buffer_load_dwordx4 v1, s[8:11], m0 offen offset:1024 lds
buffer_load_dwordx4 v1, s[8:11], m0 offen offset:2048 lds
buffer_load_dwordx4 v1, s[8:11], m0 offen offset:3072 lds
s_add_u32 m0, s23, 4096
s_nop 0
buffer_load_dwordx4 v1, s[8:11], m0 offen lds
s_and_b32 s24, s22, 1
s_lshr_b32 s25, s22, 1
s_lshl_b32 s26, s24, 11
s_lshl_b32 s27, s25, 10
s_add_u32 s26, s26, s27
s_lshl_b32 s27, s2, 13
s_add_u32 s28, s27, s26
s_add_u32 s29, s28, 26214400
s_add_u32 s30, s28, 28835840
s_add_u32 s34, s29, 4096
s_add_u32 s35, s30, 4096
s_lshl_b32 s31, s26, 1
s_add_u32 s31, s31, 25698304
s_lshl_b32 s32, s22, 11
s_add_u32 s32, s32, s27
s_add_u32 s32, s32, 23068672
v_lshlrev_b32 v6, 1, v1
s_waitcnt lgkmcnt(0)
s_add_u32 s12, s4, 0
s_addc_u32 s13, s5, 0
s_mov_b32 s14, 44564480
s_mov_b32 s15, 0x00020000
buffer_load_dwordx4 v[8:11], v1, s[12:15], s29 offen
buffer_load_dwordx4 v[12:15], v1, s[12:15], s34 offen
buffer_load_dwordx4 v[16:19], v6, s[12:15], s31 offen
buffer_load_dwordx4 v[20:23], v6, s[12:15], s31 offen offset:16
buffer_load_dwordx4 v[24:27], v6, s[12:15], s32 offen
buffer_load_dwordx4 v[28:31], v6, s[12:15], s32 offen offset:16
s_lshl_b32 s33, s22, 4
v_add_u32 v4, s33, v3
v_cvt_f32_u32 v4, v4
v_mul_f32 v4, 0x3a000000, v4
v_lshlrev_b32 v5, 2, v2
v_cvt_f32_u32 v7, v5
v_mul_f32 v40, v4, v7
v_add_f32 v41, v40, v4
v_add_f32 v42, v41, v4
v_add_f32 v43, v42, v4
v_mul_f32 v4, 0x41800000, v4
v_add_f32 v44, v40, v4
v_add_f32 v45, v41, v4
v_add_f32 v46, v42, v4
v_add_f32 v47, v43, v4
v_add_u32 v5, s33, v5
v_cvt_f32_u32 v5, v5
v_cvt_f32_u32 v4, v3
v_mul_f32 v4, 0x3a000000, v4
v_add_f32 v7, 0x3c000000, v4
v_mul_f32 v56, v4, v5
v_mul_f32 v60, v7, v5
v_add_f32 v57, v56, v4
v_add_f32 v61, v60, v7
v_add_f32 v58, v57, v4
v_add_f32 v62, v61, v7
v_add_f32 v59, v58, v4
v_add_f32 v63, v62, v7
v_cos_f32 v32, v40
v_sin_f32 v40, v40
v_cos_f32 v33, v41
v_sin_f32 v41, v41
v_cos_f32 v34, v42
v_sin_f32 v42, v42
v_cos_f32 v35, v43
v_sin_f32 v43, v43
v_cos_f32 v36, v44
v_sin_f32 v44, v44
v_cos_f32 v37, v45
v_sin_f32 v45, v45
v_cos_f32 v38, v46
v_sin_f32 v46, v46
v_cos_f32 v39, v47
v_sin_f32 v47, v47
v_cos_f32 v48, v56
v_sin_f32 v56, v56
v_cos_f32 v49, v57
v_sin_f32 v57, v57
v_cos_f32 v50, v58
v_sin_f32 v58, v58
v_cos_f32 v51, v59
v_sin_f32 v59, v59
v_cos_f32 v52, v60
v_sin_f32 v60, v60
v_cos_f32 v53, v61
v_sin_f32 v61, v61
v_cos_f32 v54, v62
v_sin_f32 v62, v62
v_cos_f32 v55, v63
v_sin_f32 v63, v63
s_lshl_b32 s36, s24, 12
s_lshl_b32 s37, s25, 11
s_add_u32 s36, s36, s37
v_add_u32 v4, s36, v1
v_mov_b32 v7, 0x3727c5ac
s_waitcnt vmcnt(2)
v_fmamk_f32 v16, v16, 0x3acccccd, v7
v_fmamk_f32 v17, v17, 0x3acccccd, v7
v_fmamk_f32 v18, v18, 0x3acccccd, v7
v_fmamk_f32 v19, v19, 0x3acccccd, v7
v_fmamk_f32 v20, v20, 0x3acccccd, v7
v_fmamk_f32 v21, v21, 0x3acccccd, v7
v_fmamk_f32 v22, v22, 0x3acccccd, v7
v_fmamk_f32 v23, v23, 0x3acccccd, v7
v_rsq_f32 v16, v16
v_rsq_f32 v17, v17
v_rsq_f32 v18, v18
v_rsq_f32 v19, v19
v_rsq_f32 v20, v20
v_rsq_f32 v21, v21
v_rsq_f32 v22, v22
v_rsq_f32 v23, v23
v_lshlrev_b32 v232, 16, v8
v_and_b32 v233, 0xffff0000, v8
v_lshlrev_b32 v234, 16, v9
v_and_b32 v235, 0xffff0000, v9
v_lshlrev_b32 v236, 16, v10
v_and_b32 v237, 0xffff0000, v10
v_lshlrev_b32 v238, 16, v11
v_and_b32 v239, 0xffff0000, v11
v_fma_mixlo_f16 v224, v232, v16, 0
v_fma_mixlo_f16 v225, v234, v18, 0
v_fma_mixlo_f16 v226, v236, v20, 0
v_fma_mixlo_f16 v227, v238, v22, 0
v_fma_mixhi_f16 v224, v233, v17, 0
v_fma_mixhi_f16 v225, v235, v19, 0
v_fma_mixhi_f16 v226, v237, v21, 0
v_fma_mixhi_f16 v227, v239, v23, 0
s_nop 0
ds_write_b128 v4, v[224:227] offset:20480
v_lshlrev_b32 v232, 16, v12
v_and_b32 v233, 0xffff0000, v12
v_lshlrev_b32 v234, 16, v13
v_and_b32 v235, 0xffff0000, v13
v_lshlrev_b32 v236, 16, v14
v_and_b32 v237, 0xffff0000, v14
v_lshlrev_b32 v238, 16, v15
v_and_b32 v239, 0xffff0000, v15
v_fma_mixlo_f16 v228, v232, v16, 0
v_fma_mixlo_f16 v229, v234, v18, 0
v_fma_mixlo_f16 v230, v236, v20, 0
v_fma_mixlo_f16 v231, v238, v22, 0
v_fma_mixhi_f16 v228, v233, v17, 0
v_fma_mixhi_f16 v229, v235, v19, 0
v_fma_mixhi_f16 v230, v237, v21, 0
v_fma_mixhi_f16 v231, v239, v23, 0
s_nop 0
ds_write_b128 v4, v[228:231] offset:21504
s_waitcnt vmcnt(0)
s_and_b32 s40, s2, 1
s_mul_i32 s40, s40, 1310720
s_lshr_b32 s41, s2, 3
s_lshl_b32 s41, s41, 15
s_add_u32 s40, s40, s41
s_add_u32 s40, s40, 18350080
v_lshlrev_b32 v248, 7, v0
buffer_load_dword v249, v248, s[12:15], s40 offen
s_getpc_b64 s[44:45]
s_add_u32 s44, s44, .Ltext0@rel32@lo+4
s_addc_u32 s45, s45, .Ltext0@rel32@hi+12
s_lshr_b32 s47, s2, 3
s_lshl_b32 s47, s47, 15
v_lshl_add_u32 v248, v0, 7, s47
s_mov_b32 s46, .Ltext1-.Ltext0
s_mov_b32 s47, 0x00020000
buffer_load_dword v250, v248, s[44:47], 0 offen
v_lshlrev_b32 v232, 16, v24
v_and_b32 v233, 0xffff0000, v24
v_lshlrev_b32 v234, 16, v25
v_and_b32 v235, 0xffff0000, v25
v_lshlrev_b32 v236, 16, v26
v_and_b32 v237, 0xffff0000, v26
v_lshlrev_b32 v238, 16, v27
v_and_b32 v239, 0xffff0000, v27
v_lshlrev_b32 v240, 16, v28
v_and_b32 v241, 0xffff0000, v28
v_lshlrev_b32 v242, 16, v29
v_and_b32 v243, 0xffff0000, v29
v_lshlrev_b32 v244, 16, v30
v_and_b32 v245, 0xffff0000, v30
v_lshlrev_b32 v246, 16, v31
v_and_b32 v247, 0xffff0000, v31
v_max_f32 v5, |v232|, |v233|
v_max3_f32 v5, |v234|, |v235|, v5
v_max3_f32 v5, |v236|, |v237|, v5
v_max3_f32 v5, |v238|, |v239|, v5
v_max3_f32 v5, |v240|, |v241|, v5
v_max3_f32 v5, |v242|, |v243|, v5
v_max3_f32 v5, |v244|, |v245|, v5
v_max3_f32 v5, |v246|, |v247|, v5
s_nop 1
v_max_f32_dpp v5, v5, v5 row_ror:8 row_mask:0xf bank_mask:0xf
s_nop 1
v_max_f32_dpp v5, v5, v5 row_ror:4 row_mask:0xf bank_mask:0xf
s_nop 1
v_max_f32_dpp v5, v5, v5 row_ror:2 row_mask:0xf bank_mask:0xf
s_nop 1
v_max_f32_dpp v5, v5, v5 row_ror:1 row_mask:0xf bank_mask:0xf
s_lshl_b32 s37, s22, 4
v_lshl_add_u32 v7, v2, 2, s37
ds_write_b32 v7, v5 offset:28672
s_lshl_b32 s37, s22, 12
v_add_u32 v5, s37, v1
s_lshl_b32 s37, s25, 13
v_add_u32 v7, s37, v1
v_mov_b32 v6, 0
s_waitcnt lgkmcnt(0)
s_barrier
ds_read_b128 v[96:99], v5 offset:0
ds_read_b128 v[100:103], v5 offset:1024
ds_read_b128 v[108:111], v5 offset:2048
ds_read_b128 v[112:115], v5 offset:3072
ds_read_b128 v[64:67], v1 offset:20480
ds_read_b128 v[68:71], v1 offset:21504
ds_read_b128 v[72:75], v1 offset:22528
ds_read_b128 v[76:79], v1 offset:23552
ds_read_b128 v[80:83], v1 offset:24576
ds_read_b128 v[84:87], v1 offset:25600
ds_read_b128 v[88:91], v1 offset:26624
ds_read_b128 v[92:95], v1 offset:27648
ds_read_b128 v[208:211], v6 offset:28672
ds_read_b128 v[212:215], v6 offset:28688
ds_read_b128 v[216:219], v6 offset:28704
ds_read_b128 v[220:223], v6 offset:28720
ds_read_b128 v[168:171], v1 offset:16384
ds_read_b128 v[172:175], v1 offset:17408
ds_read_b128 v[180:183], v1 offset:18432
ds_read_b128 v[184:187], v1 offset:19456
s_waitcnt lgkmcnt(12)
v_xor_b32 v104, 0x80008000, v100
v_xor_b32 v105, 0x80008000, v101
v_xor_b32 v106, 0x80008000, v102
v_xor_b32 v107, 0x80008000, v103
v_xor_b32 v116, 0x80008000, v112
v_xor_b32 v117, 0x80008000, v113
v_xor_b32 v118, 0x80008000, v114
v_xor_b32 v119, 0x80008000, v115
v_mfma_f32_16x16x32_f16 v[192:195], v[64:67], v[96:99], 0
v_mfma_f32_16x16x32_f16 v[196:199], v[64:67], v[100:103], 0
v_mfma_f32_16x16x32_f16 v[192:195], v[68:71], v[104:107], v[192:195]
v_mfma_f32_16x16x32_f16 v[196:199], v[68:71], v[96:99], v[196:199]
v_mfma_f32_16x16x32_f16 v[192:195], v[72:75], v[108:111], v[192:195]
v_mfma_f32_16x16x32_f16 v[196:199], v[72:75], v[112:115], v[196:199]
v_mfma_f32_16x16x32_f16 v[192:195], v[76:79], v[116:119], v[192:195]
v_mfma_f32_16x16x32_f16 v[196:199], v[76:79], v[108:111], v[196:199]
s_waitcnt lgkmcnt(8)
v_mfma_f32_16x16x32_f16 v[200:203], v[80:83], v[96:99], 0
v_mfma_f32_16x16x32_f16 v[204:207], v[80:83], v[100:103], 0
v_mfma_f32_16x16x32_f16 v[200:203], v[84:87], v[104:107], v[200:203]
v_mfma_f32_16x16x32_f16 v[204:207], v[84:87], v[96:99], v[204:207]
v_mfma_f32_16x16x32_f16 v[200:203], v[88:91], v[108:111], v[200:203]
v_mfma_f32_16x16x32_f16 v[204:207], v[88:91], v[112:115], v[204:207]
v_mfma_f32_16x16x32_f16 v[200:203], v[92:95], v[116:119], v[200:203]
v_mfma_f32_16x16x32_f16 v[204:207], v[92:95], v[108:111], v[204:207]
s_waitcnt lgkmcnt(4)
v_max3_f32 v4, v208, v209, v210
v_max3_f32 v4, v211, v212, v4
v_max3_f32 v4, v213, v214, v4
v_max3_f32 v4, v215, v216, v4
v_max3_f32 v4, v217, v218, v4
v_max3_f32 v4, v219, v220, v4
v_max3_f32 v4, v221, v222, v4
v_max_f32 v4, v223, v4
v_frexp_exp_i32_f32 v4, v4
v_max_i32 v4, -100, v4
v_min_i32 v4, 100, v4
v_ldexp_f32 v6, 1.0, v4
v_sub_u32 v4, 0, v4
v_ldexp_f32 v4, 1.0, v4
v_pk_mul_f32 v[232:233], v[232:233], v[4:5] op_sel_hi:[1,0]
v_pk_mul_f32 v[234:235], v[234:235], v[4:5] op_sel_hi:[1,0]
v_pk_mul_f32 v[236:237], v[236:237], v[4:5] op_sel_hi:[1,0]
v_pk_mul_f32 v[238:239], v[238:239], v[4:5] op_sel_hi:[1,0]
v_pk_mul_f32 v[240:241], v[240:241], v[4:5] op_sel_hi:[1,0]
v_pk_mul_f32 v[242:243], v[242:243], v[4:5] op_sel_hi:[1,0]
v_pk_mul_f32 v[244:245], v[244:245], v[4:5] op_sel_hi:[1,0]
v_pk_mul_f32 v[246:247], v[246:247], v[4:5] op_sel_hi:[1,0]
ds_read_b128 v[120:123], v7 offset:0
ds_read_b128 v[124:127], v7 offset:1024
ds_read_b128 v[132:135], v7 offset:2048
ds_read_b128 v[136:139], v7 offset:3072
ds_read_b128 v[144:147], v7 offset:4096
ds_read_b128 v[148:151], v7 offset:5120
ds_read_b128 v[156:159], v7 offset:6144
ds_read_b128 v[160:163], v7 offset:7168
s_waitcnt lgkmcnt(8)
v_xor_b32 v176, 0x80008000, v172
v_xor_b32 v177, 0x80008000, v173
v_xor_b32 v178, 0x80008000, v174
v_xor_b32 v179, 0x80008000, v175
v_xor_b32 v188, 0x80008000, v184
v_xor_b32 v189, 0x80008000, v185
v_xor_b32 v190, 0x80008000, v186
v_xor_b32 v191, 0x80008000, v187
v_mul_f32 v16, v192, v32
v_mul_f32 v17, v196, v32
v_fma_mixlo_f16 v224, v196, v40, v16
v_fma_mixlo_f16 v228, -v192, v40, v17
v_mul_f32 v18, v193, v33
v_mul_f32 v19, v197, v33
v_fma_mixhi_f16 v224, v197, v41, v18
v_fma_mixhi_f16 v228, -v193, v41, v19
v_mul_f32 v20, v194, v34
v_mul_f32 v21, v198, v34
v_fma_mixlo_f16 v225, v198, v42, v20
v_fma_mixlo_f16 v229, -v194, v42, v21
v_mul_f32 v22, v195, v35
v_mul_f32 v23, v199, v35
v_fma_mixhi_f16 v225, v199, v43, v22
v_fma_mixhi_f16 v229, -v195, v43, v23
v_mul_f32 v16, v200, v36
v_mul_f32 v17, v204, v36
v_fma_mixlo_f16 v226, v204, v44, v16
v_fma_mixlo_f16 v230, -v200, v44, v17
v_mul_f32 v18, v201, v37
v_mul_f32 v19, v205, v37
v_fma_mixhi_f16 v226, v205, v45, v18
v_fma_mixhi_f16 v230, -v201, v45, v19
v_mul_f32 v20, v202, v38
v_mul_f32 v21, v206, v38
v_fma_mixlo_f16 v227, v206, v46, v20
v_fma_mixlo_f16 v231, -v202, v46, v21
v_mul_f32 v22, v203, v39
v_mul_f32 v23, v207, v39
v_fma_mixhi_f16 v227, v207, v47, v22
v_fma_mixhi_f16 v231, -v203, v47, v23
s_nop 0
v_mfma_f32_16x16x32_f16 v[208:211], v[168:171], v[224:227], 0
v_mfma_f32_16x16x32_f16 v[212:215], v[172:175], v[224:227], 0
v_mfma_f32_16x16x32_f16 v[208:211], v[176:179], v[228:231], v[208:211]
v_mfma_f32_16x16x32_f16 v[212:215], v[168:171], v[228:231], v[212:215]
v_mfma_f32_16x16x32_f16 v[216:219], v[180:183], v[224:227], 0
v_mfma_f32_16x16x32_f16 v[220:223], v[184:187], v[224:227], 0
v_mfma_f32_16x16x32_f16 v[216:219], v[188:191], v[228:231], v[216:219]
v_mfma_f32_16x16x32_f16 v[220:223], v[180:183], v[228:231], v[220:223]
s_waitcnt lgkmcnt(0)
v_xor_b32 v128, 0x80008000, v124
v_xor_b32 v129, 0x80008000, v125
v_xor_b32 v130, 0x80008000, v126
v_xor_b32 v131, 0x80008000, v127
v_xor_b32 v140, 0x80008000, v136
v_xor_b32 v141, 0x80008000, v137
v_xor_b32 v142, 0x80008000, v138
v_xor_b32 v143, 0x80008000, v139
v_xor_b32 v152, 0x80008000, v148
v_xor_b32 v153, 0x80008000, v149
v_xor_b32 v154, 0x80008000, v150
v_xor_b32 v155, 0x80008000, v151
v_xor_b32 v164, 0x80008000, v160
v_xor_b32 v165, 0x80008000, v161
v_xor_b32 v166, 0x80008000, v162
v_xor_b32 v167, 0x80008000, v163
v_mul_f32 v16, v208, v232
v_mul_f32 v17, v212, v232
v_fma_mixlo_f16 v80, -v212, v233, v16
v_fma_mixlo_f16 v84, v208, v233, v17
v_mul_f32 v18, v209, v234
v_mul_f32 v19, v213, v234
v_fma_mixhi_f16 v80, -v213, v235, v18
v_fma_mixhi_f16 v84, v209, v235, v19
v_mul_f32 v20, v210, v236
v_mul_f32 v21, v214, v236
v_fma_mixlo_f16 v81, -v214, v237, v20
v_fma_mixlo_f16 v85, v210, v237, v21
v_mul_f32 v22, v211, v238
v_mul_f32 v23, v215, v238
v_fma_mixhi_f16 v81, -v215, v239, v22
v_fma_mixhi_f16 v85, v211, v239, v23
v_mul_f32 v16, v216, v240
v_mul_f32 v17, v220, v240
v_fma_mixlo_f16 v82, -v220, v241, v16
v_fma_mixlo_f16 v86, v216, v241, v17
v_mul_f32 v18, v217, v242
v_mul_f32 v19, v221, v242
v_fma_mixhi_f16 v82, -v221, v243, v18
v_fma_mixhi_f16 v86, v217, v243, v19
v_mul_f32 v20, v218, v244
v_mul_f32 v21, v222, v244
v_fma_mixlo_f16 v83, -v222, v245, v20
v_fma_mixlo_f16 v87, v218, v245, v21
v_mul_f32 v22, v219, v246
v_mul_f32 v23, v223, v246
v_fma_mixhi_f16 v83, -v223, v247, v22
v_fma_mixhi_f16 v87, v219, v247, v23
s_nop 0
v_mfma_f32_16x16x32_f16 v[192:195], v[80:83], v[168:171], 0
v_mfma_f32_16x16x32_f16 v[196:199], v[80:83], v[176:179], 0
v_mfma_f32_16x16x32_f16 v[192:195], v[84:87], v[172:175], v[192:195]
v_mfma_f32_16x16x32_f16 v[196:199], v[84:87], v[168:171], v[196:199]
v_mfma_f32_16x16x32_f16 v[200:203], v[80:83], v[180:183], 0
v_mfma_f32_16x16x32_f16 v[204:207], v[80:83], v[188:191], 0
v_mfma_f32_16x16x32_f16 v[200:203], v[84:87], v[184:187], v[200:203]
v_mfma_f32_16x16x32_f16 v[204:207], v[84:87], v[180:183], v[204:207]
s_lshl_b32 s36, s25, 10
s_lshl_b32 s37, s24, 3
s_add_u32 s36, s36, s37
v_add_u32 v4, s36, v1
s_lshl_b32 s36, s24, 12
v_add_u32 v5, s36, v1
s_barrier
v_mul_f32 v16, v192, v48
v_mul_f32 v17, v196, v48
v_fma_mixlo_f16 v224, -v196, v56, v16
v_fma_mixlo_f16 v228, v192, v56, v17
v_mul_f32 v18, v193, v49
v_mul_f32 v19, v197, v49
v_fma_mixhi_f16 v224, -v197, v57, v18
v_fma_mixhi_f16 v228, v193, v57, v19
v_mul_f32 v20, v194, v50
v_mul_f32 v21, v198, v50
v_fma_mixlo_f16 v225, -v198, v58, v20
v_fma_mixlo_f16 v229, v194, v58, v21
v_mul_f32 v22, v195, v51
v_mul_f32 v23, v199, v51
v_fma_mixhi_f16 v225, -v199, v59, v22
v_fma_mixhi_f16 v229, v195, v59, v23
ds_write_b64 v4, v[224:225] offset:28672
ds_write_b64 v4, v[228:229] offset:30720
v_mul_f32 v16, v200, v52
v_mul_f32 v17, v204, v52
v_fma_mixlo_f16 v226, -v204, v60, v16
v_fma_mixlo_f16 v230, v200, v60, v17
v_mul_f32 v18, v201, v53
v_mul_f32 v19, v205, v53
v_fma_mixhi_f16 v226, -v205, v61, v18
v_fma_mixhi_f16 v230, v201, v61, v19
v_mul_f32 v20, v202, v54
v_mul_f32 v21, v206, v54
v_fma_mixlo_f16 v227, -v206, v62, v20
v_fma_mixlo_f16 v231, v202, v62, v21
v_mul_f32 v22, v203, v55
v_mul_f32 v23, v207, v55
v_fma_mixhi_f16 v227, -v207, v63, v22
v_fma_mixhi_f16 v231, v203, v63, v23
ds_write_b64 v4, v[226:227] offset:32768
ds_write_b64 v4, v[230:231] offset:34816
v_lshlrev_b32 v232, 16, v8
v_and_b32 v233, 0xffff0000, v8
v_lshlrev_b32 v234, 16, v9
v_and_b32 v235, 0xffff0000, v9
v_lshlrev_b32 v236, 16, v10
v_and_b32 v237, 0xffff0000, v10
v_lshlrev_b32 v238, 16, v11
v_and_b32 v239, 0xffff0000, v11
v_lshlrev_b32 v240, 16, v12
v_and_b32 v241, 0xffff0000, v12
v_lshlrev_b32 v242, 16, v13
v_and_b32 v243, 0xffff0000, v13
v_lshlrev_b32 v244, 16, v14
v_and_b32 v245, 0xffff0000, v14
v_lshlrev_b32 v246, 16, v15
v_and_b32 v247, 0xffff0000, v15
s_cmp_eq_u32 s2, 0
s_cselect_b32 s36, 0, 1.0
v_mul_f32 v7, s36, v6
s_waitcnt lgkmcnt(0)
s_barrier
ds_read_b128 v[64:67], v5 offset:28672
ds_read_b128 v[68:71], v5 offset:30720
ds_read_b128 v[72:75], v5 offset:29696
ds_read_b128 v[76:79], v5 offset:31744
s_waitcnt lgkmcnt(2)
v_mfma_f32_16x16x32_f16 v[208:211], v[120:123], v[64:67], 0
v_mfma_f32_16x16x32_f16 v[212:215], v[120:123], v[68:71], 0
v_mfma_f32_16x16x32_f16 v[208:211], v[124:127], v[68:71], v[208:211]
v_mfma_f32_16x16x32_f16 v[212:215], v[128:131], v[64:67], v[212:215]
v_mfma_f32_16x16x32_f16 v[216:219], v[144:147], v[64:67], 0
v_mfma_f32_16x16x32_f16 v[220:223], v[144:147], v[68:71], 0
v_mfma_f32_16x16x32_f16 v[216:219], v[148:151], v[68:71], v[216:219]
v_mfma_f32_16x16x32_f16 v[220:223], v[152:155], v[64:67], v[220:223]
s_waitcnt lgkmcnt(0)
v_mfma_f32_16x16x32_f16 v[208:211], v[132:135], v[72:75], v[208:211]
v_mfma_f32_16x16x32_f16 v[212:215], v[132:135], v[76:79], v[212:215]
v_mfma_f32_16x16x32_f16 v[208:211], v[136:139], v[76:79], v[208:211]
v_mfma_f32_16x16x32_f16 v[212:215], v[140:143], v[72:75], v[212:215]
v_mfma_f32_16x16x32_f16 v[216:219], v[156:159], v[72:75], v[216:219]
v_mfma_f32_16x16x32_f16 v[220:223], v[156:159], v[76:79], v[220:223]
v_mfma_f32_16x16x32_f16 v[216:219], v[160:163], v[76:79], v[216:219]
v_mfma_f32_16x16x32_f16 v[220:223], v[164:167], v[72:75], v[220:223]
s_nop 2
v_fmac_f32 v232, v208, v6
v_fmac_f32 v233, v209, v6
v_fmac_f32 v234, v210, v6
v_fmac_f32 v235, v211, v6
v_fmac_f32 v236, v216, v6
v_fmac_f32 v237, v217, v6
v_fmac_f32 v238, v218, v6
v_fmac_f32 v239, v219, v6
v_cvt_pk_bf16_f32 v224, v232, v233
v_cvt_pk_bf16_f32 v225, v234, v235
v_cvt_pk_bf16_f32 v226, v236, v237
v_cvt_pk_bf16_f32 v227, v238, v239
buffer_store_dwordx4 v[224:227], v1, s[12:15], s30 offen sc1
v_fmac_f32 v240, v212, v7
v_fmac_f32 v241, v213, v7
v_fmac_f32 v242, v214, v7
v_fmac_f32 v243, v215, v7
v_fmac_f32 v244, v220, v7
v_fmac_f32 v245, v221, v7
v_fmac_f32 v246, v222, v7
v_fmac_f32 v247, v223, v7
v_cvt_pk_bf16_f32 v228, v240, v241
v_cvt_pk_bf16_f32 v229, v242, v243
v_cvt_pk_bf16_f32 v230, v244, v245
v_cvt_pk_bf16_f32 v231, v246, v247
buffer_store_dwordx4 v[228:231], v1, s[12:15], s35 offen sc1
s_endpgm
.p2align 8
.globl qkv2_kernel
.type qkv2_kernel,@function
qkv2_kernel:
s_mov_b32 s46, 26214400
s_branch .Lq_common
.p2align 8
.globl at2_kernel
.type at2_kernel,@function
at2_kernel:
s_mov_b32 s42, 26214400
s_branch .Lat_common
.p2align 8
.globl fin_kernel
.type fin_kernel,@function
fin_kernel:
s_cmp_lt_u32 s2, 256
s_cbranch_scc1 .Lfin_role1
s_sub_u32 s2, s2, 256
s_endpgm
.Lfin_role1:
s_load_dwordx2 s[4:5], s[0:1], 48
s_load_dwordx2 s[6:7], s[0:1], 64
s_and_b32 s24, s2, 7
s_bfe_u32 s25, s2, 0x20003
s_lshl_b32 s20, s24, 2
s_add_u32 s20, s20, s25
s_lshr_b32 s21, s2, 5
v_lshrrev_b32 v1, 6, v0
v_and_b32 v2, 63, v0
v_readfirstlane_b32 s22, v1
v_and_b32 v3, 15, v0
v_bfe_u32 v4, v0, 4, 2
v_lshlrev_b32 v5, 4, v2
s_mul_i32 s24, s21, 102400
s_mul_i32 s23, s22, 5120
s_add_u32 s37, s20, s21
s_mul_i32 s38, s37, 205
s_lshr_b32 s38, s38, 10
s_mul_i32 s38, s38, 5
s_sub_u32 s37, s37, s38
s_add_u32 s37, s20, s21
s_and_b32 s37, s37, 3
s_mov_b32 s42, s37
s_mov_b32 s38, s37
s_getpc_b64 s[26:27]
s_add_u32 s26, s26, .Ltab3@rel32@lo+4
s_addc_u32 s27, s27, .Ltab3@rel32@hi+12
s_add_u32 s8, s26, s24
s_addc_u32 s9, s27, 0
s_mov_b32 s10, 102400
s_mov_b32 s11, 0x00020000
s_mul_i32 s36, s37, 20480
s_add_u32 s36, s36, s23
s_add_u32 m0, s23, 0
s_nop 0
buffer_load_dwordx4 v5, s[8:11], s36 offen lds
buffer_load_dwordx4 v5, s[8:11], s36 offen offset:1024 lds
buffer_load_dwordx4 v5, s[8:11], s36 offen offset:2048 lds
buffer_load_dwordx4 v5, s[8:11], s36 offen offset:3072 lds
s_add_u32 m0, s23, 4096
s_add_u32 s36, s36, 4096
buffer_load_dwordx4 v5, s[8:11], s36 offen lds
s_add_u32 s37, s37, 1
s_and_b32 s37, s37, 3
s_mul_i32 s36, s37, 20480
s_add_u32 s36, s36, s23
s_add_u32 m0, s23, 20480
s_nop 0
buffer_load_dwordx4 v5, s[8:11], s36 offen lds
buffer_load_dwordx4 v5, s[8:11], s36 offen offset:1024 lds
buffer_load_dwordx4 v5, s[8:11], s36 offen offset:2048 lds
buffer_load_dwordx4 v5, s[8:11], s36 offen offset:3072 lds
s_add_u32 m0, s23, 24576
s_add_u32 s36, s36, 4096
buffer_load_dwordx4 v5, s[8:11], s36 offen lds
s_lshl_b32 s25, s20, 6
s_lshl_b32 s26, s22, 4
s_add_u32 s25, s25, s26
v_add_u32 v6, s25, v3
v_lshrrev_b32 v7, 5, v6
v_mul_u32_u24 v7, 40960, v7
v_lshl_add_u32 v7, v4, 9, v7
v_and_b32 v8, 31, v6
v_lshl_add_u32 v14, v8, 3, v7
v_lshl_add_u32 v7, v8, 4, v7
v_and_b32 v8, 3, v6
v_bfe_u32 v9, v6, 2, 1
v_lshl_or_b32 v8, v9, 4, v8
v_bfe_u32 v9, v6, 7, 2
v_lshl_or_b32 v8, v9, 2, v8
v_bfe_u32 v9, v6, 9, 1
v_lshl_or_b32 v8, v9, 5, v8
v_bfe_u32 v9, v6, 3, 4
v_lshl_or_b32 v8, v8, 5, v9
v_lshrrev_b32 v9, 10, v6
v_lshl_or_b32 v10, v9, 4, v8
v_mul_u32_u24 v10, 1280, v10
v_lshl_add_u32 v12, v4, 3, v10
v_lshl_add_u32 v10, v4, 4, v10
v_lshlrev_b32 v13, 2, v6
v_add_u32 v11, 0x10000, v5
s_waitcnt lgkmcnt(0)
s_add_u32 s12, s6, 0
s_addc_u32 s13, s7, 0
s_mov_b32 s14, 44564480
s_mov_b32 s15, 0x00020000
s_add_u32 s24, s24, 22020096
s_add_u32 s32, s6, s24
s_addc_u32 s33, s7, 0
s_mov_b32 s34, 102400
s_mov_b32 s35, 0x00020000
s_and_b32 s40, s2, 7
s_mul_i32 s40, s40, 327680
s_lshr_b32 s41, s2, 3
s_mul_i32 s41, s41, 10240
s_add_u32 s40, s40, s41
s_add_u32 s40, s40, 31457280
v_lshlrev_b32 v180, 7, v0
v_min_u32 v180, 10112, v180
buffer_load_dword v181, v180, s[12:15], s40 offen
s_lshl_b32 s27, s38, 13
s_add_u32 s27, s27, 34078720
buffer_load_dwordx4 v[16:19], v7, s[12:15], s27 offen offset:0
buffer_load_dwordx4 v[20:23], v7, s[12:15], s27 offen offset:2048
s_add_u32 s27, s27, 4096
buffer_load_dwordx4 v[24:27], v7, s[12:15], s27 offen offset:0
buffer_load_dwordx4 v[28:31], v7, s[12:15], s27 offen offset:2048
s_add_u32 s38, s38, 1
s_and_b32 s38, s38, 3
s_lshl_b32 s27, s38, 13
s_add_u32 s27, s27, 34078720
buffer_load_dwordx4 v[32:35], v7, s[12:15], s27 offen offset:0
buffer_load_dwordx4 v[36:39], v7, s[12:15], s27 offen offset:2048
s_add_u32 s27, s27, 4096
buffer_load_dwordx4 v[40:43], v7, s[12:15], s27 offen offset:0
buffer_load_dwordx4 v[44:47], v7, s[12:15], s27 offen offset:2048
s_mul_i32 s28, s21, 80*4096
s_lshl_b32 s29, s25, 1
s_add_u32 s28, s28, s29
s_waitcnt vmcnt(14)
s_barrier
ds_read_b128 v[64:67], v5 offset:0
ds_read_b128 v[68:71], v5 offset:1024
ds_read_b128 v[72:75], v5 offset:2048
ds_read_b128 v[76:79], v5 offset:3072
ds_read_b128 v[80:83], v5 offset:4096
ds_read_b128 v[84:87], v5 offset:5120
ds_read_b128 v[88:91], v5 offset:6144
ds_read_b128 v[92:95], v5 offset:7168
ds_read_b128 v[96:99], v5 offset:8192
ds_read_b128 v[100:103], v5 offset:9216
s_waitcnt vmcnt(4) lgkmcnt(9)
v_mfma_f32_16x16x32_bf16 v[124:127], v[64:67], v[16:19], 0
ds_read_b128 v[104:107], v5 offset:10240
s_add_u32 s37, s37, 1
s_and_b32 s37, s37, 3
s_mul_i32 s36, s37, 20480
s_add_u32 s36, s36, s23
s_add_u32 m0, s23, 40960
s_nop 0
buffer_load_dwordx4 v5, s[8:11], s36 offen lds
s_waitcnt lgkmcnt(9)
v_mfma_f32_16x16x32_bf16 v[128:131], v[68:71], v[16:19], 0
ds_read_b128 v[108:111], v5 offset:11264
buffer_load_dwordx4 v5, s[8:11], s36 offen offset:1024 lds
s_waitcnt lgkmcnt(9)
v_mfma_f32_16x16x32_bf16 v[132:135], v[72:75], v[16:19], 0
ds_read_b128 v[112:115], v5 offset:12288
buffer_load_dwordx4 v5, s[8:11], s36 offen offset:2048 lds
s_waitcnt lgkmcnt(9)
v_mfma_f32_16x16x32_bf16 v[136:139], v[76:79], v[16:19], 0
ds_read_b128 v[116:119], v5 offset:13312
buffer_load_dwordx4 v5, s[8:11], s36 offen offset:3072 lds
s_waitcnt lgkmcnt(9)
v_mfma_f32_16x16x32_bf16 v[140:143], v[80:83], v[16:19], 0
ds_read_b128 v[120:123], v5 offset:14336
s_add_u32 m0, s23, 45056
s_add_u32 s36, s36, 4096
buffer_load_dwordx4 v5, s[8:11], s36 offen lds
s_waitcnt lgkmcnt(9)
v_mfma_f32_16x16x32_bf16 v[124:127], v[84:87], v[20:23], v[124:127]
ds_read_b128 v[64:67], v5 offset:15360
s_add_u32 s38, s38, 1
s_and_b32 s38, s38, 3
s_lshl_b32 s27, s38, 13
s_add_u32 s27, s27, 34078720
buffer_load_dwordx4 v[48:51], v7, s[12:15], s27 offen offset:0
s_waitcnt lgkmcnt(9)
v_mfma_f32_16x16x32_bf16 v[128:131], v[88:91], v[20:23], v[128:131]
ds_read_b128 v[68:71], v5 offset:16384
buffer_load_dwordx4 v[52:55], v7, s[12:15], s27 offen offset:2048
s_waitcnt lgkmcnt(9)
v_mfma_f32_16x16x32_bf16 v[132:135], v[92:95], v[20:23], v[132:135]
ds_read_b128 v[72:75], v5 offset:17408
s_add_u32 s27, s27, 4096
buffer_load_dwordx4 v[56:59], v7, s[12:15], s27 offen offset:0
s_waitcnt lgkmcnt(9)
v_mfma_f32_16x16x32_bf16 v[136:139], v[96:99], v[20:23], v[136:139]
ds_read_b128 v[76:79], v5 offset:18432
buffer_load_dwordx4 v[60:63], v7, s[12:15], s27 offen offset:2048
s_waitcnt lgkmcnt(9)
v_mfma_f32_16x16x32_bf16 v[140:143], v[100:103], v[20:23], v[140:143]
ds_read_b128 v[80:83], v5 offset:19456
s_waitcnt lgkmcnt(9)
v_mfma_f32_16x16x32_bf16 v[124:127], v[104:107], v[24:27], v[124:127]
s_waitcnt vmcnt(18)
s_barrier
ds_read_b128 v[84:87], v5 offset:20480
s_waitcnt lgkmcnt(9)
v_mfma_f32_16x16x32_bf16 v[128:131], v[108:111], v[24:27], v[128:131]
ds_read_b128 v[88:91], v5 offset:21504
s_add_u32 s37, s37, 1
s_and_b32 s37, s37, 3
s_mul_i32 s36, s37, 20480
s_add_u32 s36, s36, s23
s_add_u32 m0, s23, 61440
s_nop 0
buffer_load_dwordx4 v5, s[8:11], s36 offen lds
s_waitcnt lgkmcnt(9)
v_mfma_f32_16x16x32_bf16 v[132:135], v[112:115], v[24:27], v[132:135]
ds_read_b128 v[92:95], v5 offset:22528
s_waitcnt lgkmcnt(9)
v_mfma_f32_16x16x32_bf16 v[136:139], v[116:119], v[24:27], v[136:139]
ds_read_b128 v[96:99], v5 offset:23552
buffer_load_dwordx4 v5, s[8:11], s36 offen offset:1024 lds
s_waitcnt lgkmcnt(9)
v_mfma_f32_16x16x32_bf16 v[140:143], v[120:123], v[24:27], v[140:143]
ds_read_b128 v[100:103], v5 offset:24576
buffer_load_dwordx4 v5, s[8:11], s36 offen offset:2048 lds
s_waitcnt lgkmcnt(9)
v_mfma_f32_16x16x32_bf16 v[124:127], v[64:67], v[28:31], v[124:127]
ds_read_b128 v[104:107], v5 offset:25600
s_waitcnt lgkmcnt(9)
v_mfma_f32_16x16x32_bf16 v[128:131], v[68:71], v[28:31], v[128:131]
ds_read_b128 v[108:111], v5 offset:26624
buffer_load_dwordx4 v5, s[8:11], s36 offen offset:3072 lds
s_waitcnt lgkmcnt(9)
v_mfma_f32_16x16x32_bf16 v[132:135], v[72:75], v[28:31], v[132:135]
ds_read_b128 v[112:115], v5 offset:27648
s_waitcnt lgkmcnt(9)
v_mfma_f32_16x16x32_bf16 v[136:139], v[76:79], v[28:31], v[136:139]
ds_read_b128 v[116:119], v5 offset:28672
s_add_u32 m0, s23, 65536
s_add_u32 s36, s36, 4096
buffer_load_dwordx4 v5, s[8:11], s36 offen lds
s_waitcnt lgkmcnt(9)
v_mfma_f32_16x16x32_bf16 v[140:143], v[80:83], v[28:31], v[140:143]
ds_read_b128 v[120:123], v5 offset:29696
s_add_u32 s38, s38, 1
s_and_b32 s38, s38, 3
s_lshl_b32 s27, s38, 13
s_add_u32 s27, s27, 34078720
buffer_load_dwordx4 v[16:19], v7, s[12:15], s27 offen offset:0
s_waitcnt vmcnt(15) lgkmcnt(9)
v_mfma_f32_16x16x32_bf16 v[124:127], v[84:87], v[32:35], v[124:127]
ds_read_b128 v[64:67], v5 offset:30720
s_waitcnt lgkmcnt(9)
v_mfma_f32_16x16x32_bf16 v[128:131], v[88:91], v[32:35], v[128:131]
ds_read_b128 v[68:71], v5 offset:31744
buffer_load_dwordx4 v[20:23], v7, s[12:15], s27 offen offset:2048
s_waitcnt lgkmcnt(9)
v_mfma_f32_16x16x32_bf16 v[132:135], v[92:95], v[32:35], v[132:135]
ds_read_b128 v[72:75], v5 offset:32768
s_waitcnt lgkmcnt(9)
v_mfma_f32_16x16x32_bf16 v[136:139], v[96:99], v[32:35], v[136:139]
ds_read_b128 v[76:79], v5 offset:33792
s_add_u32 s27, s27, 4096
buffer_load_dwordx4 v[24:27], v7, s[12:15], s27 offen offset:0
s_waitcnt lgkmcnt(9)
v_mfma_f32_16x16x32_bf16 v[140:143], v[100:103], v[32:35], v[140:143]
ds_read_b128 v[80:83], v5 offset:34816
buffer_load_dwordx4 v[28:31], v7, s[12:15], s27 offen offset:2048
s_waitcnt lgkmcnt(9)
v_mfma_f32_16x16x32_bf16 v[124:127], v[104:107], v[36:39], v[124:127]
ds_read_b128 v[84:87], v5 offset:35840
s_waitcnt lgkmcnt(9)
v_mfma_f32_16x16x32_bf16 v[128:131], v[108:111], v[36:39], v[128:131]
ds_read_b128 v[88:91], v5 offset:36864
s_waitcnt lgkmcnt(9)
v_mfma_f32_16x16x32_bf16 v[132:135], v[112:115], v[36:39], v[132:135]
ds_read_b128 v[92:95], v5 offset:37888
s_waitcnt lgkmcnt(9)
v_mfma_f32_16x16x32_bf16 v[136:139], v[116:119], v[36:39], v[136:139]
ds_read_b128 v[96:99], v5 offset:38912
s_waitcnt lgkmcnt(9)
v_mfma_f32_16x16x32_bf16 v[140:143], v[120:123], v[36:39], v[140:143]
ds_read_b128 v[100:103], v5 offset:39936
s_waitcnt lgkmcnt(9)
v_mfma_f32_16x16x32_bf16 v[124:127], v[64:67], v[40:43], v[124:127]
s_waitcnt vmcnt(13)
s_barrier
ds_read_b128 v[104:107], v5 offset:40960
s_waitcnt lgkmcnt(9)
v_mfma_f32_16x16x32_bf16 v[128:131], v[68:71], v[40:43], v[128:131]
ds_read_b128 v[108:111], v5 offset:41984
s_mov_b32 s37, 4
s_mul_i32 s36, s37, 20480
s_add_u32 s36, s36, s23
s_add_u32 m0, s23, 0
s_nop 0
buffer_load_dwordx4 v5, s[8:11], s36 offen lds
s_waitcnt lgkmcnt(9)
v_mfma_f32_16x16x32_bf16 v[132:135], v[72:75], v[40:43], v[132:135]
ds_read_b128 v[112:115], v5 offset:43008
s_waitcnt lgkmcnt(9)
v_mfma_f32_16x16x32_bf16 v[136:139], v[76:79], v[40:43], v[136:139]
ds_read_b128 v[116:119], v5 offset:44032
buffer_load_dwordx4 v5, s[8:11], s36 offen offset:1024 lds
s_waitcnt lgkmcnt(9)
v_mfma_f32_16x16x32_bf16 v[140:143], v[80:83], v[40:43], v[140:143]
ds_read_b128 v[120:123], v5 offset:45056
buffer_load_dwordx4 v5, s[8:11], s36 offen offset:2048 lds
s_waitcnt lgkmcnt(9)
v_mfma_f32_16x16x32_bf16 v[124:127], v[84:87], v[44:47], v[124:127]
ds_read_b128 v[64:67], v5 offset:46080
s_waitcnt lgkmcnt(9)
v_mfma_f32_16x16x32_bf16 v[128:131], v[88:91], v[44:47], v[128:131]
ds_read_b128 v[68:71], v5 offset:47104
buffer_load_dwordx4 v5, s[8:11], s36 offen offset:3072 lds
s_waitcnt lgkmcnt(9)
v_mfma_f32_16x16x32_bf16 v[132:135], v[92:95], v[44:47], v[132:135]
ds_read_b128 v[72:75], v5 offset:48128
s_waitcnt lgkmcnt(9)
v_mfma_f32_16x16x32_bf16 v[136:139], v[96:99], v[44:47], v[136:139]
ds_read_b128 v[76:79], v5 offset:49152
s_add_u32 m0, s23, 4096
s_add_u32 s36, s36, 4096
buffer_load_dwordx4 v5, s[8:11], s36 offen lds
s_waitcnt lgkmcnt(9)
v_mfma_f32_16x16x32_bf16 v[140:143], v[100:103], v[44:47], v[140:143]
ds_read_b128 v[80:83], v5 offset:50176
s_mov_b32 s38, 4
s_lshl_b32 s27, s38, 13
s_add_u32 s27, s27, 34078720
buffer_load_dwordx4 v[32:35], v7, s[12:15], s27 offen offset:0
s_waitcnt vmcnt(15) lgkmcnt(9)
v_mfma_f32_16x16x32_bf16 v[124:127], v[104:107], v[48:51], v[124:127]
ds_read_b128 v[84:87], v5 offset:51200
s_waitcnt lgkmcnt(9)
v_mfma_f32_16x16x32_bf16 v[128:131], v[108:111], v[48:51], v[128:131]
ds_read_b128 v[88:91], v5 offset:52224
buffer_load_dwordx4 v[36:39], v7, s[12:15], s27 offen offset:2048
s_waitcnt lgkmcnt(9)
v_mfma_f32_16x16x32_bf16 v[132:135], v[112:115], v[48:51], v[132:135]
ds_read_b128 v[92:95], v5 offset:53248
s_waitcnt lgkmcnt(9)
v_mfma_f32_16x16x32_bf16 v[136:139], v[116:119], v[48:51], v[136:139]
ds_read_b128 v[96:99], v5 offset:54272
s_add_u32 s27, s27, 4096
buffer_load_dwordx4 v[40:43], v7, s[12:15], s27 offen offset:0
s_waitcnt lgkmcnt(9)
v_mfma_f32_16x16x32_bf16 v[140:143], v[120:123], v[48:51], v[140:143]
ds_read_b128 v[100:103], v5 offset:55296
buffer_load_dwordx4 v[44:47], v7, s[12:15], s27 offen offset:2048
s_waitcnt lgkmcnt(9)
v_mfma_f32_16x16x32_bf16 v[124:127], v[64:67], v[52:55], v[124:127]
ds_read_b128 v[104:107], v5 offset:56320
s_waitcnt lgkmcnt(9)
v_mfma_f32_16x16x32_bf16 v[128:131], v[68:71], v[52:55], v[128:131]
ds_read_b128 v[108:111], v5 offset:57344
s_waitcnt lgkmcnt(9)
v_mfma_f32_16x16x32_bf16 v[132:135], v[72:75], v[52:55], v[132:135]
ds_read_b128 v[112:115], v5 offset:58368
s_waitcnt lgkmcnt(9)
v_mfma_f32_16x16x32_bf16 v[136:139], v[76:79], v[52:55], v[136:139]
ds_read_b128 v[116:119], v5 offset:59392
s_waitcnt lgkmcnt(9)
v_mfma_f32_16x16x32_bf16 v[140:143], v[80:83], v[52:55], v[140:143]
ds_read_b128 v[120:123], v5 offset:60416
s_waitcnt lgkmcnt(9)
v_mfma_f32_16x16x32_bf16 v[124:127], v[84:87], v[56:59], v[124:127]
s_waitcnt vmcnt(13)
s_barrier
ds_read_b128 v[64:67], v5 offset:61440
s_waitcnt lgkmcnt(9)
v_mfma_f32_16x16x32_bf16 v[128:131], v[88:91], v[56:59], v[128:131]
ds_read_b128 v[68:71], v5 offset:62464
s_mov_b32 s37, s42
s_mul_i32 s36, s37, 20480
s_add_u32 s36, s36, s23
s_add_u32 m0, s23, 20480
s_nop 0
buffer_load_dwordx4 v5, s[32:35], s36 offen lds
s_waitcnt lgkmcnt(9)
v_mfma_f32_16x16x32_bf16 v[132:135], v[92:95], v[56:59], v[132:135]
ds_read_b128 v[72:75], v5 offset:63488
s_waitcnt lgkmcnt(9)
v_mfma_f32_16x16x32_bf16 v[136:139], v[96:99], v[56:59], v[136:139]
ds_read_b128 v[76:79], v5 offset:64512
buffer_load_dwordx4 v5, s[32:35], s36 offen offset:1024 lds
s_waitcnt lgkmcnt(9)
v_mfma_f32_16x16x32_bf16 v[140:143], v[100:103], v[56:59], v[140:143]
ds_read_b128 v[80:83], v11 offset:0
buffer_load_dwordx4 v5, s[32:35], s36 offen offset:2048 lds
s_waitcnt lgkmcnt(9)
v_mfma_f32_16x16x32_bf16 v[124:127], v[104:107], v[60:63], v[124:127]
ds_read_b128 v[84:87], v11 offset:1024
s_waitcnt lgkmcnt(9)
v_mfma_f32_16x16x32_bf16 v[128:131], v[108:111], v[60:63], v[128:131]
ds_read_b128 v[88:91], v11 offset:2048
buffer_load_dwordx4 v5, s[32:35], s36 offen offset:3072 lds
s_waitcnt lgkmcnt(9)
v_mfma_f32_16x16x32_bf16 v[132:135], v[112:115], v[60:63], v[132:135]
ds_read_b128 v[92:95], v11 offset:3072
s_waitcnt lgkmcnt(9)
v_mfma_f32_16x16x32_bf16 v[136:139], v[116:119], v[60:63], v[136:139]
ds_read_b128 v[96:99], v11 offset:4096
s_add_u32 m0, s23, 24576
s_add_u32 s36, s36, 4096
buffer_load_dwordx4 v5, s[32:35], s36 offen lds
s_waitcnt lgkmcnt(9)
v_mfma_f32_16x16x32_bf16 v[140:143], v[120:123], v[60:63], v[140:143]
ds_read_b128 v[100:103], v11 offset:5120
s_mov_b32 s38, s42
s_lshl_b32 s27, s38, 13
s_add_u32 s27, s27, 31457280
buffer_load_dwordx4 v[48:51], v7, s[12:15], s27 offen offset:0
s_waitcnt vmcnt(15) lgkmcnt(9)
v_mfma_f32_16x16x32_bf16 v[124:127], v[64:67], v[16:19], v[124:127]
ds_read_b128 v[104:107], v11 offset:6144
s_waitcnt lgkmcnt(9)
v_mfma_f32_16x16x32_bf16 v[128:131], v[68:71], v[16:19], v[128:131]
ds_read_b128 v[108:111], v11 offset:7168
buffer_load_dwordx4 v[52:55], v7, s[12:15], s27 offen offset:2048
s_waitcnt lgkmcnt(9)
v_mfma_f32_16x16x32_bf16 v[132:135], v[72:75], v[16:19], v[132:135]
ds_read_b128 v[112:115], v11 offset:8192
s_waitcnt lgkmcnt(9)
v_mfma_f32_16x16x32_bf16 v[136:139], v[76:79], v[16:19], v[136:139]
ds_read_b128 v[116:119], v11 offset:9216
s_add_u32 s27, s27, 4096
buffer_load_dwordx4 v[56:59], v7, s[12:15], s27 offen offset:0
s_waitcnt lgkmcnt(9)
v_mfma_f32_16x16x32_bf16 v[140:143], v[80:83], v[16:19], v[140:143]
ds_read_b128 v[120:123], v11 offset:10240
buffer_load_dwordx4 v[60:63], v7, s[12:15], s27 offen offset:2048
s_waitcnt lgkmcnt(9)
v_mfma_f32_16x16x32_bf16 v[124:127], v[84:87], v[20:23], v[124:127]
ds_read_b128 v[64:67], v11 offset:11264
s_waitcnt lgkmcnt(9)
v_mfma_f32_16x16x32_bf16 v[128:131], v[88:91], v[20:23], v[128:131]
ds_read_b128 v[68:71], v11 offset:12288
s_waitcnt lgkmcnt(9)
v_mfma_f32_16x16x32_bf16 v[132:135], v[92:95], v[20:23], v[132:135]
ds_read_b128 v[72:75], v11 offset:13312
s_waitcnt lgkmcnt(9)
v_mfma_f32_16x16x32_bf16 v[136:139], v[96:99], v[20:23], v[136:139]
ds_read_b128 v[76:79], v11 offset:14336
s_waitcnt lgkmcnt(9)
v_mfma_f32_16x16x32_bf16 v[140:143], v[100:103], v[20:23], v[140:143]
ds_read_b128 v[80:83], v11 offset:15360
s_waitcnt lgkmcnt(9)
v_mfma_f32_16x16x32_bf16 v[124:127], v[104:107], v[24:27], v[124:127]
s_waitcnt vmcnt(13)
s_barrier
ds_read_b128 v[84:87], v5 offset:0
s_waitcnt lgkmcnt(9)
v_mfma_f32_16x16x32_bf16 v[128:131], v[108:111], v[24:27], v[128:131]
ds_read_b128 v[88:91], v5 offset:1024
s_add_u32 s37, s37, 1
s_and_b32 s37, s37, 3
s_mul_i32 s36, s37, 20480
s_add_u32 s36, s36, s23
s_add_u32 m0, s23, 40960
s_nop 0
buffer_load_dwordx4 v5, s[32:35], s36 offen lds
s_waitcnt lgkmcnt(9)
v_mfma_f32_16x16x32_bf16 v[132:135], v[112:115], v[24:27], v[132:135]
ds_read_b128 v[92:95], v5 offset:2048
s_waitcnt lgkmcnt(9)
v_mfma_f32_16x16x32_bf16 v[136:139], v[116:119], v[24:27], v[136:139]
ds_read_b128 v[96:99], v5 offset:3072
buffer_load_dwordx4 v5, s[32:35], s36 offen offset:1024 lds
s_waitcnt lgkmcnt(9)
v_mfma_f32_16x16x32_bf16 v[140:143], v[120:123], v[24:27], v[140:143]
ds_read_b128 v[100:103], v5 offset:4096
buffer_load_dwordx4 v5, s[32:35], s36 offen offset:2048 lds
s_waitcnt lgkmcnt(9)
v_mfma_f32_16x16x32_bf16 v[124:127], v[64:67], v[28:31], v[124:127]
ds_read_b128 v[104:107], v5 offset:5120
s_waitcnt lgkmcnt(9)
v_mfma_f32_16x16x32_bf16 v[128:131], v[68:71], v[28:31], v[128:131]
ds_read_b128 v[108:111], v5 offset:6144
buffer_load_dwordx4 v5, s[32:35], s36 offen offset:3072 lds
s_waitcnt lgkmcnt(9)
v_mfma_f32_16x16x32_bf16 v[132:135], v[72:75], v[28:31], v[132:135]
ds_read_b128 v[112:115], v5 offset:7168
s_waitcnt lgkmcnt(9)
v_mfma_f32_16x16x32_bf16 v[136:139], v[76:79], v[28:31], v[136:139]
ds_read_b128 v[116:119], v5 offset:8192
s_add_u32 m0, s23, 45056
s_add_u32 s36, s36, 4096
buffer_load_dwordx4 v5, s[32:35], s36 offen lds
s_waitcnt lgkmcnt(9)
v_mfma_f32_16x16x32_bf16 v[140:143], v[80:83], v[28:31], v[140:143]
ds_read_b128 v[120:123], v5 offset:9216
s_add_u32 s38, s38, 1
s_and_b32 s38, s38, 3
s_lshl_b32 s27, s38, 13
s_add_u32 s27, s27, 31457280
buffer_load_dwordx4 v[16:19], v7, s[12:15], s27 offen offset:0
s_waitcnt vmcnt(15) lgkmcnt(9)
v_mfma_f32_16x16x32_bf16 v[124:127], v[84:87], v[32:35], v[124:127]
ds_read_b128 v[64:67], v5 offset:10240
s_waitcnt lgkmcnt(9)
v_mfma_f32_16x16x32_bf16 v[128:131], v[88:91], v[32:35], v[128:131]
ds_read_b128 v[68:71], v5 offset:11264
buffer_load_dwordx4 v[20:23], v7, s[12:15], s27 offen offset:2048
s_waitcnt lgkmcnt(9)
v_mfma_f32_16x16x32_bf16 v[132:135], v[92:95], v[32:35], v[132:135]
ds_read_b128 v[72:75], v5 offset:12288
s_waitcnt lgkmcnt(9)
v_mfma_f32_16x16x32_bf16 v[136:139], v[96:99], v[32:35], v[136:139]
ds_read_b128 v[76:79], v5 offset:13312
s_add_u32 s27, s27, 4096
buffer_load_dwordx4 v[24:27], v7, s[12:15], s27 offen offset:0
s_waitcnt lgkmcnt(9)
v_mfma_f32_16x16x32_bf16 v[140:143], v[100:103], v[32:35], v[140:143]
ds_read_b128 v[80:83], v5 offset:14336
buffer_load_dwordx4 v[28:31], v7, s[12:15], s27 offen offset:2048
s_waitcnt lgkmcnt(9)
v_mfma_f32_16x16x32_bf16 v[124:127], v[104:107], v[36:39], v[124:127]
ds_read_b128 v[84:87], v5 offset:15360
s_waitcnt lgkmcnt(9)
v_mfma_f32_16x16x32_bf16 v[128:131], v[108:111], v[36:39], v[128:131]
ds_read_b128 v[88:91], v5 offset:16384
s_waitcnt lgkmcnt(9)
v_mfma_f32_16x16x32_bf16 v[132:135], v[112:115], v[36:39], v[132:135]
ds_read_b128 v[92:95], v5 offset:17408
s_waitcnt lgkmcnt(9)
v_mfma_f32_16x16x32_bf16 v[136:139], v[116:119], v[36:39], v[136:139]
ds_read_b128 v[96:99], v5 offset:18432
s_waitcnt lgkmcnt(9)
v_mfma_f32_16x16x32_bf16 v[140:143], v[120:123], v[36:39], v[140:143]
ds_read_b128 v[100:103], v5 offset:19456
s_waitcnt lgkmcnt(9)
v_mfma_f32_16x16x32_bf16 v[124:127], v[64:67], v[40:43], v[124:127]
s_waitcnt vmcnt(13)
s_barrier
ds_read_b128 v[104:107], v5 offset:20480
s_waitcnt lgkmcnt(9)
v_mfma_f32_16x16x32_bf16 v[128:131], v[68:71], v[40:43], v[128:131]
ds_read_b128 v[108:111], v5 offset:21504
s_add_u32 s37, s37, 1
s_and_b32 s37, s37, 3
s_mul_i32 s36, s37, 20480
s_add_u32 s36, s36, s23
s_add_u32 m0, s23, 61440
s_nop 0
buffer_load_dwordx4 v5, s[32:35], s36 offen lds
s_waitcnt lgkmcnt(9)
v_mfma_f32_16x16x32_bf16 v[132:135], v[72:75], v[40:43], v[132:135]
ds_read_b128 v[112:115], v5 offset:22528
s_waitcnt lgkmcnt(9)
v_mfma_f32_16x16x32_bf16 v[136:139], v[76:79], v[40:43], v[136:139]
ds_read_b128 v[116:119], v5 offset:23552
buffer_load_dwordx4 v5, s[32:35], s36 offen offset:1024 lds
s_waitcnt lgkmcnt(9)
v_mfma_f32_16x16x32_bf16 v[140:143], v[80:83], v[40:43], v[140:143]
ds_read_b128 v[120:123], v5 offset:24576
buffer_load_dwordx4 v5, s[32:35], s36 offen offset:2048 lds
s_waitcnt lgkmcnt(9)
v_mfma_f32_16x16x32_bf16 v[124:127], v[84:87], v[44:47], v[124:127]
ds_read_b128 v[64:67], v5 offset:25600
s_waitcnt lgkmcnt(9)
v_mfma_f32_16x16x32_bf16 v[128:131], v[88:91], v[44:47], v[128:131]
ds_read_b128 v[68:71], v5 offset:26624
buffer_load_dwordx4 v5, s[32:35], s36 offen offset:3072 lds
s_waitcnt lgkmcnt(9)
v_mfma_f32_16x16x32_bf16 v[132:135], v[92:95], v[44:47], v[132:135]
ds_read_b128 v[72:75], v5 offset:27648
s_waitcnt lgkmcnt(9)
v_mfma_f32_16x16x32_bf16 v[136:139], v[96:99], v[44:47], v[136:139]
ds_read_b128 v[76:79], v5 offset:28672
s_add_u32 m0, s23, 65536
s_add_u32 s36, s36, 4096
buffer_load_dwordx4 v5, s[32:35], s36 offen lds
s_waitcnt lgkmcnt(9)
v_mfma_f32_16x16x32_bf16 v[140:143], v[100:103], v[44:47], v[140:143]
ds_read_b128 v[80:83], v5 offset:29696
s_add_u32 s38, s38, 1
s_and_b32 s38, s38, 3
s_lshl_b32 s27, s38, 13
s_add_u32 s27, s27, 31457280
buffer_load_dwordx4 v[32:35], v7, s[12:15], s27 offen offset:0
s_waitcnt vmcnt(15) lgkmcnt(9)
v_mfma_f32_16x16x32_bf16 v[124:127], v[104:107], v[48:51], v[124:127]
ds_read_b128 v[84:87], v5 offset:30720
s_waitcnt lgkmcnt(9)
v_mfma_f32_16x16x32_bf16 v[128:131], v[108:111], v[48:51], v[128:131]
ds_read_b128 v[88:91], v5 offset:31744
buffer_load_dwordx4 v[36:39], v7, s[12:15], s27 offen offset:2048
s_waitcnt lgkmcnt(9)
v_mfma_f32_16x16x32_bf16 v[132:135], v[112:115], v[48:51], v[132:135]
ds_read_b128 v[92:95], v5 offset:32768
s_waitcnt lgkmcnt(9)
v_mfma_f32_16x16x32_bf16 v[136:139], v[116:119], v[48:51], v[136:139]
ds_read_b128 v[96:99], v5 offset:33792
s_add_u32 s27, s27, 4096
buffer_load_dwordx4 v[40:43], v7, s[12:15], s27 offen offset:0
s_waitcnt lgkmcnt(9)
v_mfma_f32_16x16x32_bf16 v[140:143], v[120:123], v[48:51], v[140:143]
ds_read_b128 v[100:103], v5 offset:34816
buffer_load_dwordx4 v[44:47], v7, s[12:15], s27 offen offset:2048
s_waitcnt lgkmcnt(9)
v_mfma_f32_16x16x32_bf16 v[124:127], v[64:67], v[52:55], v[124:127]
ds_read_b128 v[104:107], v5 offset:35840
s_waitcnt lgkmcnt(9)
v_mfma_f32_16x16x32_bf16 v[128:131], v[68:71], v[52:55], v[128:131]
ds_read_b128 v[108:111], v5 offset:36864
s_waitcnt lgkmcnt(9)
v_mfma_f32_16x16x32_bf16 v[132:135], v[72:75], v[52:55], v[132:135]
ds_read_b128 v[112:115], v5 offset:37888
s_waitcnt lgkmcnt(9)
v_mfma_f32_16x16x32_bf16 v[136:139], v[76:79], v[52:55], v[136:139]
ds_read_b128 v[116:119], v5 offset:38912
s_waitcnt lgkmcnt(9)
v_mfma_f32_16x16x32_bf16 v[140:143], v[80:83], v[52:55], v[140:143]
ds_read_b128 v[120:123], v5 offset:39936
s_waitcnt lgkmcnt(9)
v_mfma_f32_16x16x32_bf16 v[124:127], v[84:87], v[56:59], v[124:127]
s_waitcnt vmcnt(13)
s_barrier
ds_read_b128 v[64:67], v5 offset:40960
s_waitcnt lgkmcnt(9)
v_mfma_f32_16x16x32_bf16 v[128:131], v[88:91], v[56:59], v[128:131]
ds_read_b128 v[68:71], v5 offset:41984
s_add_u32 s37, s37, 1
s_and_b32 s37, s37, 3
s_mul_i32 s36, s37, 20480
s_add_u32 s36, s36, s23
s_add_u32 m0, s23, 0
s_nop 0
buffer_load_dwordx4 v5, s[32:35], s36 offen lds
s_waitcnt lgkmcnt(9)
v_mfma_f32_16x16x32_bf16 v[132:135], v[92:95], v[56:59], v[132:135]
ds_read_b128 v[72:75], v5 offset:43008
s_waitcnt lgkmcnt(9)
v_mfma_f32_16x16x32_bf16 v[136:139], v[96:99], v[56:59], v[136:139]
ds_read_b128 v[76:79], v5 offset:44032
buffer_load_dwordx4 v5, s[32:35], s36 offen offset:1024 lds
s_waitcnt lgkmcnt(9)
v_mfma_f32_16x16x32_bf16 v[140:143], v[100:103], v[56:59], v[140:143]
ds_read_b128 v[80:83], v5 offset:45056
buffer_load_dwordx4 v5, s[32:35], s36 offen offset:2048 lds
s_waitcnt lgkmcnt(9)
v_mfma_f32_16x16x32_bf16 v[124:127], v[104:107], v[60:63], v[124:127]
ds_read_b128 v[84:87], v5 offset:46080
s_waitcnt lgkmcnt(9)
v_mfma_f32_16x16x32_bf16 v[128:131], v[108:111], v[60:63], v[128:131]
ds_read_b128 v[88:91], v5 offset:47104
buffer_load_dwordx4 v5, s[32:35], s36 offen offset:3072 lds
s_waitcnt lgkmcnt(9)
v_mfma_f32_16x16x32_bf16 v[132:135], v[112:115], v[60:63], v[132:135]
ds_read_b128 v[92:95], v5 offset:48128
s_waitcnt lgkmcnt(9)
v_mfma_f32_16x16x32_bf16 v[136:139], v[116:119], v[60:63], v[136:139]
ds_read_b128 v[96:99], v5 offset:49152
s_add_u32 m0, s23, 4096
s_add_u32 s36, s36, 4096
buffer_load_dwordx4 v5, s[32:35], s36 offen lds
s_waitcnt lgkmcnt(9)
v_mfma_f32_16x16x32_bf16 v[140:143], v[120:123], v[60:63], v[140:143]
ds_read_b128 v[100:103], v5 offset:50176
s_add_u32 s38, s38, 1
s_and_b32 s38, s38, 3
s_lshl_b32 s27, s38, 13
s_add_u32 s27, s27, 31457280
buffer_load_dwordx4 v[48:51], v7, s[12:15], s27 offen offset:0
s_waitcnt vmcnt(15) lgkmcnt(9)
v_mfma_f32_16x16x32_bf16 v[124:127], v[64:67], v[16:19], v[124:127]
ds_read_b128 v[104:107], v5 offset:51200
s_waitcnt lgkmcnt(9)
v_mfma_f32_16x16x32_bf16 v[128:131], v[68:71], v[16:19], v[128:131]
ds_read_b128 v[108:111], v5 offset:52224
buffer_load_dwordx4 v[52:55], v7, s[12:15], s27 offen offset:2048
s_waitcnt lgkmcnt(9)
v_mfma_f32_16x16x32_bf16 v[132:135], v[72:75], v[16:19], v[132:135]
ds_read_b128 v[112:115], v5 offset:53248
s_waitcnt lgkmcnt(9)
v_mfma_f32_16x16x32_bf16 v[136:139], v[76:79], v[16:19], v[136:139]
ds_read_b128 v[116:119], v5 offset:54272
s_add_u32 s27, s27, 4096
buffer_load_dwordx4 v[56:59], v7, s[12:15], s27 offen offset:0
s_waitcnt lgkmcnt(9)
v_mfma_f32_16x16x32_bf16 v[140:143], v[80:83], v[16:19], v[140:143]
ds_read_b128 v[120:123], v5 offset:55296
buffer_load_dwordx4 v[60:63], v7, s[12:15], s27 offen offset:2048
s_waitcnt lgkmcnt(9)
v_mfma_f32_16x16x32_bf16 v[124:127], v[84:87], v[20:23], v[124:127]
ds_read_b128 v[64:67], v5 offset:56320
s_waitcnt lgkmcnt(9)
v_mfma_f32_16x16x32_bf16 v[128:131], v[88:91], v[20:23], v[128:131]
ds_read_b128 v[68:71], v5 offset:57344
s_waitcnt lgkmcnt(9)
v_mfma_f32_16x16x32_bf16 v[132:135], v[92:95], v[20:23], v[132:135]
ds_read_b128 v[72:75], v5 offset:58368
s_waitcnt lgkmcnt(9)
v_mfma_f32_16x16x32_bf16 v[136:139], v[96:99], v[20:23], v[136:139]
ds_read_b128 v[76:79], v5 offset:59392
s_waitcnt lgkmcnt(9)
v_mfma_f32_16x16x32_bf16 v[140:143], v[100:103], v[20:23], v[140:143]
ds_read_b128 v[80:83], v5 offset:60416
s_waitcnt lgkmcnt(9)
v_mfma_f32_16x16x32_bf16 v[124:127], v[104:107], v[24:27], v[124:127]
s_waitcnt vmcnt(13)
s_barrier
ds_read_b128 v[84:87], v5 offset:61440
s_waitcnt lgkmcnt(9)
v_mfma_f32_16x16x32_bf16 v[128:131], v[108:111], v[24:27], v[128:131]
ds_read_b128 v[88:91], v5 offset:62464
s_mov_b32 s37, 4
s_mul_i32 s36, s37, 20480
s_add_u32 s36, s36, s23
s_add_u32 m0, s23, 20480
s_nop 0
buffer_load_dwordx4 v5, s[32:35], s36 offen lds
s_waitcnt lgkmcnt(9)
v_mfma_f32_16x16x32_bf16 v[132:135], v[112:115], v[24:27], v[132:135]
ds_read_b128 v[92:95], v5 offset:63488
s_waitcnt lgkmcnt(9)
v_mfma_f32_16x16x32_bf16 v[136:139], v[116:119], v[24:27], v[136:139]
ds_read_b128 v[96:99], v5 offset:64512
buffer_load_dwordx4 v5, s[32:35], s36 offen offset:1024 lds
s_waitcnt lgkmcnt(9)
v_mfma_f32_16x16x32_bf16 v[140:143], v[120:123], v[24:27], v[140:143]
ds_read_b128 v[100:103], v11 offset:0
buffer_load_dwordx4 v5, s[32:35], s36 offen offset:2048 lds
s_waitcnt lgkmcnt(9)
v_mfma_f32_16x16x32_bf16 v[124:127], v[64:67], v[28:31], v[124:127]
ds_read_b128 v[104:107], v11 offset:1024
s_waitcnt lgkmcnt(9)
v_mfma_f32_16x16x32_bf16 v[128:131], v[68:71], v[28:31], v[128:131]
ds_read_b128 v[108:111], v11 offset:2048
buffer_load_dwordx4 v5, s[32:35], s36 offen offset:3072 lds
s_waitcnt lgkmcnt(9)
v_mfma_f32_16x16x32_bf16 v[132:135], v[72:75], v[28:31], v[132:135]
ds_read_b128 v[112:115], v11 offset:3072
s_waitcnt lgkmcnt(9)
v_mfma_f32_16x16x32_bf16 v[136:139], v[76:79], v[28:31], v[136:139]
ds_read_b128 v[116:119], v11 offset:4096
s_add_u32 m0, s23, 24576
s_add_u32 s36, s36, 4096
buffer_load_dwordx4 v5, s[32:35], s36 offen lds
s_waitcnt lgkmcnt(9)
v_mfma_f32_16x16x32_bf16 v[140:143], v[80:83], v[28:31], v[140:143]
ds_read_b128 v[120:123], v11 offset:5120
s_mov_b32 s38, 4
s_lshl_b32 s27, s38, 13
s_add_u32 s27, s27, 31457280
buffer_load_dwordx2 v[16:17], v14, s[12:15], s27 offen offset:0
s_waitcnt vmcnt(15) lgkmcnt(9)
v_mfma_f32_16x16x32_bf16 v[124:127], v[84:87], v[32:35], v[124:127]
ds_read_b128 v[64:67], v11 offset:6144
s_waitcnt lgkmcnt(9)
v_mfma_f32_16x16x32_bf16 v[128:131], v[88:91], v[32:35], v[128:131]
ds_read_b128 v[68:71], v11 offset:7168
buffer_load_dwordx2 v[18:19], v14, s[12:15], s27 offen offset:256
s_waitcnt lgkmcnt(9)
v_mfma_f32_16x16x32_bf16 v[132:135], v[92:95], v[32:35], v[132:135]
ds_read_b128 v[72:75], v11 offset:8192
s_waitcnt lgkmcnt(9)
v_mfma_f32_16x16x32_bf16 v[136:139], v[96:99], v[32:35], v[136:139]
ds_read_b128 v[76:79], v11 offset:9216
buffer_load_dwordx2 v[20:21], v14, s[12:15], s27 offen offset:2048
s_waitcnt lgkmcnt(9)
v_mfma_f32_16x16x32_bf16 v[140:143], v[100:103], v[32:35], v[140:143]
ds_read_b128 v[80:83], v11 offset:10240
buffer_load_dwordx2 v[22:23], v14, s[12:15], s27 offen offset:2304
s_waitcnt lgkmcnt(9)
v_mfma_f32_16x16x32_bf16 v[124:127], v[104:107], v[36:39], v[124:127]
ds_read_b128 v[84:87], v11 offset:11264
s_waitcnt lgkmcnt(9)
v_mfma_f32_16x16x32_bf16 v[128:131], v[108:111], v[36:39], v[128:131]
ds_read_b128 v[88:91], v11 offset:12288
s_add_u32 s27, s27, 4096
buffer_load_dwordx2 v[24:25], v14, s[12:15], s27 offen offset:0
s_waitcnt lgkmcnt(9)
v_mfma_f32_16x16x32_bf16 v[132:135], v[112:115], v[36:39], v[132:135]
ds_read_b128 v[92:95], v11 offset:13312
s_waitcnt lgkmcnt(9)
v_mfma_f32_16x16x32_bf16 v[136:139], v[116:119], v[36:39], v[136:139]
ds_read_b128 v[96:99], v11 offset:14336
buffer_load_dwordx2 v[26:27], v14, s[12:15], s27 offen offset:256
s_waitcnt lgkmcnt(9)
v_mfma_f32_16x16x32_bf16 v[140:143], v[120:123], v[36:39], v[140:143]
ds_read_b128 v[100:103], v11 offset:15360
buffer_load_dwordx2 v[28:29], v14, s[12:15], s27 offen offset:2048
s_waitcnt lgkmcnt(9)
v_mfma_f32_16x16x32_bf16 v[124:127], v[64:67], v[40:43], v[124:127]
buffer_load_dwordx2 v[30:31], v14, s[12:15], s27 offen offset:2304
s_waitcnt vmcnt(17)
s_barrier
ds_read_b128 v[104:107], v5 offset:0
s_waitcnt lgkmcnt(9)
v_mfma_f32_16x16x32_bf16 v[128:131], v[68:71], v[40:43], v[128:131]
ds_read_b128 v[108:111], v5 offset:1024
s_mov_b32 s29, 25706496
buffer_load_dword v156, v13, s[12:15], s29 offen
s_waitcnt lgkmcnt(9)
v_mfma_f32_16x16x32_bf16 v[132:135], v[72:75], v[40:43], v[132:135]
ds_read_b128 v[112:115], v5 offset:2048
s_waitcnt lgkmcnt(9)
v_mfma_f32_16x16x32_bf16 v[136:139], v[76:79], v[40:43], v[136:139]
ds_read_b128 v[116:119], v5 offset:3072
s_mov_b32 s29, 25714688
buffer_load_dword v157, v13, s[12:15], s29 offen
s_waitcnt lgkmcnt(9)
v_mfma_f32_16x16x32_bf16 v[140:143], v[80:83], v[40:43], v[140:143]
ds_read_b128 v[120:123], v5 offset:4096
s_waitcnt lgkmcnt(9)
v_mfma_f32_16x16x32_bf16 v[124:127], v[84:87], v[44:47], v[124:127]
ds_read_b128 v[64:67], v5 offset:5120
s_waitcnt lgkmcnt(9)
v_mfma_f32_16x16x32_bf16 v[128:131], v[88:91], v[44:47], v[128:131]
ds_read_b128 v[68:71], v5 offset:6144
s_waitcnt lgkmcnt(9)
v_mfma_f32_16x16x32_bf16 v[132:135], v[92:95], v[44:47], v[132:135]
ds_read_b128 v[72:75], v5 offset:7168
s_waitcnt lgkmcnt(9)
v_mfma_f32_16x16x32_bf16 v[136:139], v[96:99], v[44:47], v[136:139]
ds_read_b128 v[76:79], v5 offset:8192
s_waitcnt lgkmcnt(9)
v_mfma_f32_16x16x32_bf16 v[140:143], v[100:103], v[44:47], v[140:143]
ds_read_b128 v[80:83], v5 offset:9216
s_waitcnt vmcnt(15) lgkmcnt(9)
v_mfma_f32_16x16x32_bf16 v[124:127], v[104:107], v[48:51], v[124:127]
ds_read_b128 v[84:87], v5 offset:10240
s_waitcnt lgkmcnt(9)
v_mfma_f32_16x16x32_bf16 v[128:131], v[108:111], v[48:51], v[128:131]
ds_read_b128 v[88:91], v5 offset:11264
s_waitcnt lgkmcnt(9)
v_mfma_f32_16x16x32_bf16 v[132:135], v[112:115], v[48:51], v[132:135]
ds_read_b128 v[92:95], v5 offset:12288
s_waitcnt lgkmcnt(9)
v_mfma_f32_16x16x32_bf16 v[136:139], v[116:119], v[48:51], v[136:139]
ds_read_b128 v[96:99], v5 offset:13312
s_waitcnt lgkmcnt(9)
v_mfma_f32_16x16x32_bf16 v[140:143], v[120:123], v[48:51], v[140:143]
ds_read_b128 v[100:103], v5 offset:14336
s_waitcnt lgkmcnt(9)
v_mfma_f32_16x16x32_bf16 v[124:127], v[64:67], v[52:55], v[124:127]
ds_read_b128 v[104:107], v5 offset:15360
s_waitcnt lgkmcnt(9)
v_mfma_f32_16x16x32_bf16 v[128:131], v[68:71], v[52:55], v[128:131]
ds_read_b128 v[108:111], v5 offset:16384
s_waitcnt lgkmcnt(9)
v_mfma_f32_16x16x32_bf16 v[132:135], v[72:75], v[52:55], v[132:135]
ds_read_b128 v[112:115], v5 offset:17408
s_waitcnt lgkmcnt(9)
v_mfma_f32_16x16x32_bf16 v[136:139], v[76:79], v[52:55], v[136:139]
ds_read_b128 v[116:119], v5 offset:18432
s_waitcnt lgkmcnt(9)
v_mfma_f32_16x16x32_bf16 v[140:143], v[80:83], v[52:55], v[140:143]
ds_read_b128 v[120:123], v5 offset:19456
s_waitcnt lgkmcnt(9)
v_mfma_f32_16x16x32_bf16 v[124:127], v[84:87], v[56:59], v[124:127]
s_waitcnt vmcnt(10)
s_barrier
ds_read_b128 v[64:67], v5 offset:20480
s_waitcnt lgkmcnt(9)
v_mfma_f32_16x16x32_bf16 v[128:131], v[88:91], v[56:59], v[128:131]
ds_read_b128 v[68:71], v5 offset:21504
s_waitcnt lgkmcnt(9)
v_mfma_f32_16x16x32_bf16 v[132:135], v[92:95], v[56:59], v[132:135]
ds_read_b128 v[72:75], v5 offset:22528
s_waitcnt lgkmcnt(9)
v_mfma_f32_16x16x32_bf16 v[136:139], v[96:99], v[56:59], v[136:139]
ds_read_b128 v[76:79], v5 offset:23552
s_waitcnt lgkmcnt(9)
v_mfma_f32_16x16x32_bf16 v[140:143], v[100:103], v[56:59], v[140:143]
ds_read_b128 v[80:83], v5 offset:24576
s_waitcnt lgkmcnt(9)
v_mfma_f32_16x16x32_bf16 v[124:127], v[104:107], v[60:63], v[124:127]
ds_read_b128 v[84:87], v5 offset:25600
s_waitcnt lgkmcnt(9)
v_mfma_f32_16x16x32_bf16 v[128:131], v[108:111], v[60:63], v[128:131]
ds_read_b128 v[88:91], v5 offset:26624
s_waitcnt lgkmcnt(9)
v_mfma_f32_16x16x32_bf16 v[132:135], v[112:115], v[60:63], v[132:135]
ds_read_b128 v[92:95], v5 offset:27648
s_waitcnt lgkmcnt(9)
v_mfma_f32_16x16x32_bf16 v[136:139], v[116:119], v[60:63], v[136:139]
ds_read_b128 v[96:99], v5 offset:28672
s_waitcnt lgkmcnt(9)
v_mfma_f32_16x16x32_bf16 v[140:143], v[120:123], v[60:63], v[140:143]
ds_read_b128 v[100:103], v5 offset:29696
s_waitcnt vmcnt(2) lgkmcnt(9)
v_mfma_f32_16x16x32_bf16 v[124:127], v[64:67], v[16:19], v[124:127]
ds_read_b128 v[104:107], v5 offset:30720
s_waitcnt lgkmcnt(9)
v_mfma_f32_16x16x32_bf16 v[128:131], v[68:71], v[16:19], v[128:131]
ds_read_b128 v[108:111], v5 offset:31744
s_waitcnt lgkmcnt(9)
v_mfma_f32_16x16x32_bf16 v[132:135], v[72:75], v[16:19], v[132:135]
ds_read_b128 v[112:115], v5 offset:32768
s_waitcnt lgkmcnt(9)
v_mfma_f32_16x16x32_bf16 v[136:139], v[76:79], v[16:19], v[136:139]
ds_read_b128 v[116:119], v5 offset:33792
s_waitcnt lgkmcnt(9)
v_mfma_f32_16x16x32_bf16 v[140:143], v[80:83], v[16:19], v[140:143]
ds_read_b128 v[120:123], v5 offset:34816
s_waitcnt lgkmcnt(9)
v_mfma_f32_16x16x32_bf16 v[124:127], v[84:87], v[20:23], v[124:127]
ds_read_b128 v[64:67], v5 offset:35840
s_waitcnt lgkmcnt(9)
v_mfma_f32_16x16x32_bf16 v[128:131], v[88:91], v[20:23], v[128:131]
ds_read_b128 v[68:71], v5 offset:36864
s_waitcnt lgkmcnt(9)
v_mfma_f32_16x16x32_bf16 v[132:135], v[92:95], v[20:23], v[132:135]
ds_read_b128 v[72:75], v5 offset:37888
s_waitcnt lgkmcnt(9)
v_mfma_f32_16x16x32_bf16 v[136:139], v[96:99], v[20:23], v[136:139]
ds_read_b128 v[76:79], v5 offset:38912
s_waitcnt lgkmcnt(9)
v_mfma_f32_16x16x32_bf16 v[140:143], v[100:103], v[20:23], v[140:143]
ds_read_b128 v[80:83], v5 offset:39936
s_waitcnt lgkmcnt(9)
v_mfma_f32_16x16x32_bf16 v[124:127], v[104:107], v[24:27], v[124:127]
s_waitcnt lgkmcnt(8)
v_mfma_f32_16x16x32_bf16 v[128:131], v[108:111], v[24:27], v[128:131]
s_waitcnt lgkmcnt(7)
v_mfma_f32_16x16x32_bf16 v[132:135], v[112:115], v[24:27], v[132:135]
s_waitcnt lgkmcnt(6)
v_mfma_f32_16x16x32_bf16 v[136:139], v[116:119], v[24:27], v[136:139]
s_waitcnt lgkmcnt(5)
v_mfma_f32_16x16x32_bf16 v[140:143], v[120:123], v[24:27], v[140:143]
s_waitcnt lgkmcnt(4)
v_mfma_f32_16x16x32_bf16 v[124:127], v[64:67], v[28:31], v[124:127]
s_waitcnt lgkmcnt(3)
v_mfma_f32_16x16x32_bf16 v[128:131], v[68:71], v[28:31], v[128:131]
s_waitcnt lgkmcnt(2)
v_mfma_f32_16x16x32_bf16 v[132:135], v[72:75], v[28:31], v[132:135]
s_waitcnt lgkmcnt(1)
v_mfma_f32_16x16x32_bf16 v[136:139], v[76:79], v[28:31], v[136:139]
s_waitcnt lgkmcnt(0)
v_mfma_f32_16x16x32_bf16 v[140:143], v[80:83], v[28:31], v[140:143]
s_add_u32 s16, s4, 0
s_addc_u32 s17, s5, 0
s_mov_b32 s18, 2621440
s_mov_b32 s19, 0x00020000
s_mul_i32 s28, s21, 160
s_waitcnt vmcnt(0)
v_add_f32 v156, v156, v157
v_add_f32 v124, v124, v156
v_add_f32 v125, v125, v156
v_add_f32 v126, v126, v156
v_add_f32 v127, v127, v156
v_add_f32 v128, v128, v156
v_add_f32 v129, v129, v156
v_add_f32 v130, v130, v156
v_add_f32 v131, v131, v156
v_add_f32 v132, v132, v156
v_add_f32 v133, v133, v156
v_add_f32 v134, v134, v156
v_add_f32 v135, v135, v156
v_add_f32 v136, v136, v156
v_add_f32 v137, v137, v156
v_add_f32 v138, v138, v156
v_add_f32 v139, v139, v156
v_add_f32 v140, v140, v156
v_add_f32 v141, v141, v156
v_add_f32 v142, v142, v156
v_add_f32 v143, v143, v156
v_cvt_pk_bf16_f32 v16, v124, v125
v_cvt_pk_bf16_f32 v17, v126, v127
v_cvt_pk_bf16_f32 v18, v128, v129
v_cvt_pk_bf16_f32 v19, v130, v131
v_cvt_pk_bf16_f32 v20, v132, v133
v_cvt_pk_bf16_f32 v21, v134, v135
v_cvt_pk_bf16_f32 v22, v136, v137
v_cvt_pk_bf16_f32 v23, v138, v139
v_cvt_pk_bf16_f32 v24, v140, v141
v_cvt_pk_bf16_f32 v25, v142, v143
buffer_store_dwordx4 v[16:19], v10, s[16:19], s28 offen
buffer_store_dwordx4 v[20:23], v10, s[16:19], s28 offen offset:64
buffer_store_dwordx2 v[24:25], v12, s[16:19], s28 offen offset:128
.Lfin_end2:
s_endpgm
.Ltext1:
.section .rodata,"a"
.p2align 6
.amdhsa_kernel k0_kernel
  .amdhsa_next_free_vgpr 208
  .amdhsa_next_free_sgpr 96
  .amdhsa_accum_offset 208
  .amdhsa_group_segment_fixed_size 0
  .amdhsa_kernarg_size 72
  .amdhsa_user_sgpr_count 2
  .amdhsa_user_sgpr_kernarg_segment_ptr 1
  .amdhsa_system_sgpr_workgroup_id_x 1
.end_amdhsa_kernel
.p2align 6
.amdhsa_kernel k1_kernel
  .amdhsa_next_free_vgpr 252
  .amdhsa_next_free_sgpr 96
  .amdhsa_accum_offset 252
  .amdhsa_group_segment_fixed_size 0
  .amdhsa_kernarg_size 72
  .amdhsa_user_sgpr_count 2
  .amdhsa_user_sgpr_kernarg_segment_ptr 1
  .amdhsa_system_sgpr_workgroup_id_x 1
.end_amdhsa_kernel
.p2align 6
.amdhsa_kernel qkv_kernel
  .amdhsa_next_free_vgpr 416
  .amdhsa_next_free_sgpr 96
  .amdhsa_accum_offset 256
  .amdhsa_group_segment_fixed_size 0
  .amdhsa_kernarg_size 72
  .amdhsa_user_sgpr_count 2
  .amdhsa_user_sgpr_kernarg_segment_ptr 1
  .amdhsa_system_sgpr_workgroup_id_x 1
.end_amdhsa_kernel
.p2align 6
.amdhsa_kernel at_kernel
  .amdhsa_next_free_vgpr 240
  .amdhsa_next_free_sgpr 96
  .amdhsa_accum_offset 240
  .amdhsa_group_segment_fixed_size 0
  .amdhsa_kernarg_size 72
  .amdhsa_user_sgpr_count 2
  .amdhsa_user_sgpr_kernarg_segment_ptr 1
  .amdhsa_system_sgpr_workgroup_id_x 1
.end_amdhsa_kernel
.p2align 6
.amdhsa_kernel p4_kernel
  .amdhsa_next_free_vgpr 192
  .amdhsa_next_free_sgpr 96
  .amdhsa_accum_offset 192
  .amdhsa_group_segment_fixed_size 0
  .amdhsa_kernarg_size 72
  .amdhsa_user_sgpr_count 2
  .amdhsa_user_sgpr_kernarg_segment_ptr 1
  .amdhsa_system_sgpr_workgroup_id_x 1
.end_amdhsa_kernel
.p2align 6
.amdhsa_kernel cf2_kernel
  .amdhsa_next_free_vgpr 252
  .amdhsa_next_free_sgpr 96
  .amdhsa_accum_offset 252
  .amdhsa_group_segment_fixed_size 0
  .amdhsa_kernarg_size 72
  .amdhsa_user_sgpr_count 2
  .amdhsa_user_sgpr_kernarg_segment_ptr 1
  .amdhsa_system_sgpr_workgroup_id_x 1
.end_amdhsa_kernel
.p2align 6
.amdhsa_kernel qkv2_kernel
  .amdhsa_next_free_vgpr 416
  .amdhsa_next_free_sgpr 96
  .amdhsa_accum_offset 256
  .amdhsa_group_segment_fixed_size 0
  .amdhsa_kernarg_size 72
  .amdhsa_user_sgpr_count 2
  .amdhsa_user_sgpr_kernarg_segment_ptr 1
  .amdhsa_system_sgpr_workgroup_id_x 1
.end_amdhsa_kernel
.p2align 6
.amdhsa_kernel at2_kernel
  .amdhsa_next_free_vgpr 240
  .amdhsa_next_free_sgpr 96
  .amdhsa_accum_offset 240
  .amdhsa_group_segment_fixed_size 0
  .amdhsa_kernarg_size 72
  .amdhsa_user_sgpr_count 2
  .amdhsa_user_sgpr_kernarg_segment_ptr 1
  .amdhsa_system_sgpr_workgroup_id_x 1
.end_amdhsa_kernel
.p2align 6
.amdhsa_kernel fin_kernel
  .amdhsa_next_free_vgpr 192
  .amdhsa_next_free_sgpr 96
  .amdhsa_accum_offset 192
  .amdhsa_group_segment_fixed_size 0
  .amdhsa_kernarg_size 72
  .amdhsa_user_sgpr_count 2
  .amdhsa_user_sgpr_kernarg_segment_ptr 1
  .amdhsa_system_sgpr_workgroup_id_x 1
.end_amdhsa_kernel
.altmacro
.set .Lzq0, 15717
.set .Lzq1, 15717
.set .Lzq2, 15717
.set .Lzq3, 15717
.set .Lzq4, 15717
.set .Lzq5, 15717
.set .Lzq6, 15717
.set .Lzq7, 15716
.set .Lzq8, 15716
.set .Lzq9, 15716
.set .Lzq10, 15716
.set .Lzq11, 15716
.set .Lzq12, 15715
.set .Lzq13, 15715
.set .Lzq14, 15715
.set .Lzq15, 15714
.set .Lzq16, 15714
.set .Lzq17, 15714
.set .Lzq18, 15713
.set .Lzq19, 15713
.set .Lzq20, 15713
.set .Lzq21, 15712
.set .Lzq22, 15712
.set .Lzq23, 15711
.set .Lzq24, 15711
.set .Lzq25, 15710
.set .Lzq26, 15710
.set .Lzq27, 15709
.set .Lzq28, 15708
.set .Lzq29, 15708
.set .Lzq30, 15707
.set .Lzq31, 15706
.set .Lzq32, 15706
.set .Lzq33, 15705
.set .Lzq34, 15704
.set .Lzq35, 15704
.set .Lzq36, 15703
.set .Lzq37, 15702
.set .Lzq38, 15701
.set .Lzq39, 15700
.set .Lzq40, 15700
.set .Lzq41, 15699
.set .Lzq42, 15698
.set .Lzq43, 15697
.set .Lzq44, 15696
.set .Lzq45, 15695
.set .Lzq46, 15694
.set .Lzq47, 15693
.set .Lzq48, 15692
.set .Lzq49, 15691
.set .Lzq50, 15690
.set .Lzq51, 15689
.set .Lzq52, 15688
.set .Lzq53, 15687
.set .Lzq54, 15686
.set .Lzq55, 15684
.set .Lzq56, 15683
.set .Lzq57, 15682
.set .Lzq58, 15681
.set .Lzq59, 15680
.set .Lzq60, 15678
.set .Lzq61, 15677
.set .Lzq62, 15676
.set .Lzq63, 15675
.set .Lzq64, 15673
.set .Lzq65, 15672
.set .Lzq66, 15671
.set .Lzq67, 15669
.set .Lzq68, 15668
.set .Lzq69, 15666
.set .Lzq70, 15665
.set .Lzq71, 15664
.set .Lzq72, 15662
.set .Lzq73, 15661
.set .Lzq74, 15659
.set .Lzq75, 15658
.set .Lzq76, 15656
.set .Lzq77, 15655
.set .Lzq78, 15653
.set .Lzq79, 15651
.set .Lzq80, 15650
.set .Lzq81, 15648
.set .Lzq82, 15647
.set .Lzq83, 15645
.set .Lzq84, 15643
.set .Lzq85, 15642
.set .Lzq86, 15640
.set .Lzq87, 15638
.set .Lzq88, 15637
.set .Lzq89, 15635
.set .Lzq90, 15633
.set .Lzq91, 15632
.set .Lzq92, 15630
.set .Lzq93, 15628
.set .Lzq94, 15626
.set .Lzq95, 15624
.set .Lzq96, 15623
.set .Lzq97, 15621
.set .Lzq98, 15619
.set .Lzq99, 15617
.set .Lzq100, 15614
.set .Lzq101, 15611
.set .Lzq102, 15607
.set .Lzq103, 15603
.set .Lzq104, 15599
.set .Lzq105, 15595
.set .Lzq106, 15592
.set .Lzq107, 15588
.set .Lzq108, 15584
.set .Lzq109, 15580
.set .Lzq110, 15576
.set .Lzq111, 15572
.set .Lzq112, 15568
.set .Lzq113, 15564
.set .Lzq114, 15560
.set .Lzq115, 15556
.set .Lzq116, 15552
.set .Lzq117, 15548
.set .Lzq118, 15544
.set .Lzq119, 15539
.set .Lzq120, 15535
.set .Lzq121, 15531
.set .Lzq122, 15527
.set .Lzq123, 15523
.set .Lzq124, 15519
.set .Lzq125, 15514
.set .Lzq126, 15510
.set .Lzq127, 15506
.set .Lzq128, 15502
.set .Lzq129, 15497
.set .Lzq130, 15493
.set .Lzq131, 15489
.set .Lzq132, 15481
.set .Lzq133, 15472
.set .Lzq134, 15463
.set .Lzq135, 15455
.set .Lzq136, 15446
.set .Lzq137, 15437
.set .Lzq138, 15428
.set .Lzq139, 15419
.set .Lzq140, 15411
.set .Lzq141, 15402
.set .Lzq142, 15393
.set .Lzq143, 15384
.set .Lzq144, 15375
.set .Lzq145, 15366
.set .Lzq146, 15355
.set .Lzq147, 15337
.set .Lzq148, 15319
.set .Lzq149, 15301
.set .Lzq150, 15284
.set .Lzq151, 15266
.set .Lzq152, 15248
.set .Lzq153, 15228
.set .Lzq154, 15192
.set .Lzq155, 15156
.set .Lzq156, 15120
.set .Lzq157, 15064
.set .Lzq158, 14992
.set .Lzq159, 14864
.set .Lzq160, 0
.set .Lzq161, 47632
.set .Lzq162, 47760
.set .Lzq163, 47832
.set .Lzq164, 47888
.set .Lzq165, 47924
.set .Lzq166, 47960
.set .Lzq167, 47996
.set .Lzq168, 48016
.set .Lzq169, 48034
.set .Lzq170, 48052
.set .Lzq171, 48069
.set .Lzq172, 48087
.set .Lzq173, 48105
.set .Lzq174, 48123
.set .Lzq175, 48134
.set .Lzq176, 48143
.set .Lzq177, 48152
.set .Lzq178, 48161
.set .Lzq179, 48170
.set .Lzq180, 48179
.set .Lzq181, 48187
.set .Lzq182, 48196
.set .Lzq183, 48205
.set .Lzq184, 48214
.set .Lzq185, 48223
.set .Lzq186, 48231
.set .Lzq187, 48240
.set .Lzq188, 48249
.set .Lzq189, 48257
.set .Lzq190, 48261
.set .Lzq191, 48265
.set .Lzq192, 48270
.set .Lzq193, 48274
.set .Lzq194, 48278
.set .Lzq195, 48282
.set .Lzq196, 48287
.set .Lzq197, 48291
.set .Lzq198, 48295
.set .Lzq199, 48299
.set .Lzq200, 48303
.set .Lzq201, 48307
.set .Lzq202, 48312
.set .Lzq203, 48316
.set .Lzq204, 48320
.set .Lzq205, 48324
.set .Lzq206, 48328
.set .Lzq207, 48332
.set .Lzq208, 48336
.set .Lzq209, 48340
.set .Lzq210, 48344
.set .Lzq211, 48348
.set .Lzq212, 48352
.set .Lzq213, 48356
.set .Lzq214, 48360
.set .Lzq215, 48363
.set .Lzq216, 48367
.set .Lzq217, 48371
.set .Lzq218, 48375
.set .Lzq219, 48379
.set .Lzq220, 48382
.set .Lzq221, 48385
.set .Lzq222, 48387
.set .Lzq223, 48389
.set .Lzq224, 48391
.set .Lzq225, 48392
.set .Lzq226, 48394
.set .Lzq227, 48396
.set .Lzq228, 48398
.set .Lzq229, 48400
.set .Lzq230, 48401
.set .Lzq231, 48403
.set .Lzq232, 48405
.set .Lzq233, 48406
.set .Lzq234, 48408
.set .Lzq235, 48410
.set .Lzq236, 48411
.set .Lzq237, 48413
.set .Lzq238, 48415
.set .Lzq239, 48416
.set .Lzq240, 48418
.set .Lzq241, 48419
.set .Lzq242, 48421
.set .Lzq243, 48423
.set .Lzq244, 48424
.set .Lzq245, 48426
.set .Lzq246, 48427
.set .Lzq247, 48429
.set .Lzq248, 48430
.set .Lzq249, 48432
.set .Lzq250, 48433
.set .Lzq251, 48434
.set .Lzq252, 48436
.set .Lzq253, 48437
.set .Lzq254, 48439
.set .Lzq255, 48440
.set .Lzq256, 48441
.set .Lzq257, 48443
.set .Lzq258, 48444
.set .Lzq259, 48445
.set .Lzq260, 48446
.set .Lzq261, 48448
.set .Lzq262, 48449
.set .Lzq263, 48450
.set .Lzq264, 48451
.set .Lzq265, 48452
.set .Lzq266, 48454
.set .Lzq267, 48455
.set .Lzq268, 48456
.set .Lzq269, 48457
.set .Lzq270, 48458
.set .Lzq271, 48459
.set .Lzq272, 48460
.set .Lzq273, 48461
.set .Lzq274, 48462
.set .Lzq275, 48463
.set .Lzq276, 48464
.set .Lzq277, 48465
.set .Lzq278, 48466
.set .Lzq279, 48467
.set .Lzq280, 48468
.set .Lzq281, 48468
.set .Lzq282, 48469
.set .Lzq283, 48470
.set .Lzq284, 48471
.set .Lzq285, 48472
.set .Lzq286, 48472
.set .Lzq287, 48473
.set .Lzq288, 48474
.set .Lzq289, 48474
.set .Lzq290, 48475
.set .Lzq291, 48476
.set .Lzq292, 48476
.set .Lzq293, 48477
.set .Lzq294, 48478
.set .Lzq295, 48478
.set .Lzq296, 48479
.set .Lzq297, 48479
.set .Lzq298, 48480
.set .Lzq299, 48480
.set .Lzq300, 48481
.set .Lzq301, 48481
.set .Lzq302, 48481
.set .Lzq303, 48482
.set .Lzq304, 48482
.set .Lzq305, 48482
.set .Lzq306, 48483
.set .Lzq307, 48483
.set .Lzq308, 48483
.set .Lzq309, 48484
.set .Lzq310, 48484
.set .Lzq311, 48484
.set .Lzq312, 48484
.set .Lzq313, 48484
.set .Lzq314, 48485
.set .Lzq315, 48485
.set .Lzq316, 48485
.set .Lzq317, 48485
.set .Lzq318, 48485
.set .Lzq319, 48485
.set .Lzq320, 48485
.set .Lzq321, 48485
.set .Lzq322, 48485
.set .Lzq323, 48485
.set .Lzq324, 48485
.set .Lzq325, 48485
.set .Lzq326, 48485
.set .Lzq327, 48484
.set .Lzq328, 48484
.set .Lzq329, 48484
.set .Lzq330, 48484
.set .Lzq331, 48484
.set .Lzq332, 48483
.set .Lzq333, 48483
.set .Lzq334, 48483
.set .Lzq335, 48482
.set .Lzq336, 48482
.set .Lzq337, 48482
.set .Lzq338, 48481
.set .Lzq339, 48481
.set .Lzq340, 48481
.set .Lzq341, 48480
.set .Lzq342, 48480
.set .Lzq343, 48479
.set .Lzq344, 48479
.set .Lzq345, 48478
.set .Lzq346, 48478
.set .Lzq347, 48477
.set .Lzq348, 48476
.set .Lzq349, 48476
.set .Lzq350, 48475
.set .Lzq351, 48474
.set .Lzq352, 48474
.set .Lzq353, 48473
.set .Lzq354, 48472
.set .Lzq355, 48472
.set .Lzq356, 48471
.set .Lzq357, 48470
.set .Lzq358, 48469
.set .Lzq359, 48468
.set .Lzq360, 48468
.set .Lzq361, 48467
.set .Lzq362, 48466
.set .Lzq363, 48465
.set .Lzq364, 48464
.set .Lzq365, 48463
.set .Lzq366, 48462
.set .Lzq367, 48461
.set .Lzq368, 48460
.set .Lzq369, 48459
.set .Lzq370, 48458
.set .Lzq371, 48457
.set .Lzq372, 48456
.set .Lzq373, 48455
.set .Lzq374, 48454
.set .Lzq375, 48452
.set .Lzq376, 48451
.set .Lzq377, 48450
.set .Lzq378, 48449
.set .Lzq379, 48448
.set .Lzq380, 48446
.set .Lzq381, 48445
.set .Lzq382, 48444
.set .Lzq383, 48443
.set .Lzq384, 48441
.set .Lzq385, 48440
.set .Lzq386, 48439
.set .Lzq387, 48437
.set .Lzq388, 48436
.set .Lzq389, 48434
.set .Lzq390, 48433
.set .Lzq391, 48432
.set .Lzq392, 48430
.set .Lzq393, 48429
.set .Lzq394, 48427
.set .Lzq395, 48426
.set .Lzq396, 48424
.set .Lzq397, 48423
.set .Lzq398, 48421
.set .Lzq399, 48419
.set .Lzq400, 48418
.set .Lzq401, 48416
.set .Lzq402, 48415
.set .Lzq403, 48413
.set .Lzq404, 48411
.set .Lzq405, 48410
.set .Lzq406, 48408
.set .Lzq407, 48406
.set .Lzq408, 48405
.set .Lzq409, 48403
.set .Lzq410, 48401
.set .Lzq411, 48400
.set .Lzq412, 48398
.set .Lzq413, 48396
.set .Lzq414, 48394
.set .Lzq415, 48392
.set .Lzq416, 48391
.set .Lzq417, 48389
.set .Lzq418, 48387
.set .Lzq419, 48385
.set .Lzq420, 48382
.set .Lzq421, 48379
.set .Lzq422, 48375
.set .Lzq423, 48371
.set .Lzq424, 48367
.set .Lzq425, 48363
.set .Lzq426, 48360
.set .Lzq427, 48356
.set .Lzq428, 48352
.set .Lzq429, 48348
.set .Lzq430, 48344
.set .Lzq431, 48340
.set .Lzq432, 48336
.set .Lzq433, 48332
.set .Lzq434, 48328
.set .Lzq435, 48324
.set .Lzq436, 48320
.set .Lzq437, 48316
.set .Lzq438, 48312
.set .Lzq439, 48307
.set .Lzq440, 48303
.set .Lzq441, 48299
.set .Lzq442, 48295
.set .Lzq443, 48291
.set .Lzq444, 48287
.set .Lzq445, 48282
.set .Lzq446, 48278
.set .Lzq447, 48274
.set .Lzq448, 48270
.set .Lzq449, 48265
.set .Lzq450, 48261
.set .Lzq451, 48257
.set .Lzq452, 48249
.set .Lzq453, 48240
.set .Lzq454, 48231
.set .Lzq455, 48223
.set .Lzq456, 48214
.set .Lzq457, 48205
.set .Lzq458, 48196
.set .Lzq459, 48187
.set .Lzq460, 48179
.set .Lzq461, 48170
.set .Lzq462, 48161
.set .Lzq463, 48152
.set .Lzq464, 48143
.set .Lzq465, 48134
.set .Lzq466, 48123
.set .Lzq467, 48105
.set .Lzq468, 48087
.set .Lzq469, 48069
.set .Lzq470, 48052
.set .Lzq471, 48034
.set .Lzq472, 48016
.set .Lzq473, 47996
.set .Lzq474, 47960
.set .Lzq475, 47924
.set .Lzq476, 47888
.set .Lzq477, 47832
.set .Lzq478, 47760
.set .Lzq479, 47632
.set .Lzq480, 0
.set .Lzq481, 14864
.set .Lzq482, 14992
.set .Lzq483, 15064
.set .Lzq484, 15120
.set .Lzq485, 15156
.set .Lzq486, 15192
.set .Lzq487, 15228
.set .Lzq488, 15248
.set .Lzq489, 15266
.set .Lzq490, 15284
.set .Lzq491, 15301
.set .Lzq492, 15319
.set .Lzq493, 15337
.set .Lzq494, 15355
.set .Lzq495, 15366
.set .Lzq496, 15375
.set .Lzq497, 15384
.set .Lzq498, 15393
.set .Lzq499, 15402
.set .Lzq500, 15411
.set .Lzq501, 15419
.set .Lzq502, 15428
.set .Lzq503, 15437
.set .Lzq504, 15446
.set .Lzq505, 15455
.set .Lzq506, 15463
.set .Lzq507, 15472
.set .Lzq508, 15481
.set .Lzq509, 15489
.set .Lzq510, 15493
.set .Lzq511, 15497
.set .Lzq512, 15502
.set .Lzq513, 15506
.set .Lzq514, 15510
.set .Lzq515, 15514
.set .Lzq516, 15519
.set .Lzq517, 15523
.set .Lzq518, 15527
.set .Lzq519, 15531
.set .Lzq520, 15535
.set .Lzq521, 15539
.set .Lzq522, 15544
.set .Lzq523, 15548
.set .Lzq524, 15552
.set .Lzq525, 15556
.set .Lzq526, 15560
.set .Lzq527, 15564
.set .Lzq528, 15568
.set .Lzq529, 15572
.set .Lzq530, 15576
.set .Lzq531, 15580
.set .Lzq532, 15584
.set .Lzq533, 15588
.set .Lzq534, 15592
.set .Lzq535, 15595
.set .Lzq536, 15599
.set .Lzq537, 15603
.set .Lzq538, 15607
.set .Lzq539, 15611
.set .Lzq540, 15614
.set .Lzq541, 15617
.set .Lzq542, 15619
.set .Lzq543, 15621
.set .Lzq544, 15623
.set .Lzq545, 15624
.set .Lzq546, 15626
.set .Lzq547, 15628
.set .Lzq548, 15630
.set .Lzq549, 15632
.set .Lzq550, 15633
.set .Lzq551, 15635
.set .Lzq552, 15637
.set .Lzq553, 15638
.set .Lzq554, 15640
.set .Lzq555, 15642
.set .Lzq556, 15643
.set .Lzq557, 15645
.set .Lzq558, 15647
.set .Lzq559, 15648
.set .Lzq560, 15650
.set .Lzq561, 15651
.set .Lzq562, 15653
.set .Lzq563, 15655
.set .Lzq564, 15656
.set .Lzq565, 15658
.set .Lzq566, 15659
.set .Lzq567, 15661
.set .Lzq568, 15662
.set .Lzq569, 15664
.set .Lzq570, 15665
.set .Lzq571, 15666
.set .Lzq572, 15668
.set .Lzq573, 15669
.set .Lzq574, 15671
.set .Lzq575, 15672
.set .Lzq576, 15673
.set .Lzq577, 15675
.set .Lzq578, 15676
.set .Lzq579, 15677
.set .Lzq580, 15678
.set .Lzq581, 15680
.set .Lzq582, 15681
.set .Lzq583, 15682
.set .Lzq584, 15683
.set .Lzq585, 15684
.set .Lzq586, 15686
.set .Lzq587, 15687
.set .Lzq588, 15688
.set .Lzq589, 15689
.set .Lzq590, 15690
.set .Lzq591, 15691
.set .Lzq592, 15692
.set .Lzq593, 15693
.set .Lzq594, 15694
.set .Lzq595, 15695
.set .Lzq596, 15696
.set .Lzq597, 15697
.set .Lzq598, 15698
.set .Lzq599, 15699
.set .Lzq600, 15700
.set .Lzq601, 15700
.set .Lzq602, 15701
.set .Lzq603, 15702
.set .Lzq604, 15703
.set .Lzq605, 15704
.set .Lzq606, 15704
.set .Lzq607, 15705
.set .Lzq608, 15706
.set .Lzq609, 15706
.set .Lzq610, 15707
.set .Lzq611, 15708
.set .Lzq612, 15708
.set .Lzq613, 15709
.set .Lzq614, 15710
.set .Lzq615, 15710
.set .Lzq616, 15711
.set .Lzq617, 15711
.set .Lzq618, 15712
.set .Lzq619, 15712
.set .Lzq620, 15713
.set .Lzq621, 15713
.set .Lzq622, 15713
.set .Lzq623, 15714
.set .Lzq624, 15714
.set .Lzq625, 15714
.set .Lzq626, 15715
.set .Lzq627, 15715
.set .Lzq628, 15715
.set .Lzq629, 15716
.set .Lzq630, 15716
.set .Lzq631, 15716
.set .Lzq632, 15716
.set .Lzq633, 15716
.set .Lzq634, 15717
.set .Lzq635, 15717
.set .Lzq636, 15717
.set .Lzq637, 15717
.set .Lzq638, 15717
.set .Lzq639, 15717
.set .Lzq640, 15650
.set .Lzq641, 48418
.set .Lzq642, 0

.macro zze1 zza
.short .Lzq\zza
.endm
.macro zzf zzn, zzj
.if \zzj >= 2
zze1 %(((\zzj/2)*\zzn + (\zzj%2)*160)%640)
.elseif \zzj == 0
zze1 %(640 + (\zzn%2))
.else
zze1 642
.endif
.endm
.macro zze8 zza,zzb,zzc,zzd,zze,zzf,zzg,zzh
.short .Lzq\zza,.Lzq\zzb,.Lzq\zzc,.Lzq\zzd,.Lzq\zze,.Lzq\zzf,.Lzq\zzg,.Lzq\zzh
.endm
.macro zzg1 zzk, zzp, zzn, zzj
.if \zzj >= 2
zze8 %((\zzk*(\zzn)+\zzp)%640), %((\zzk*(\zzn+1)+\zzp)%640), %((\zzk*(\zzn+2)+\zzp)%640), %((\zzk*(\zzn+3)+\zzp)%640), %((\zzk*(\zzn+4)+\zzp)%640), %((\zzk*(\zzn+5)+\zzp)%640), %((\zzk*(\zzn+6)+\zzp)%640), %((\zzk*(\zzn+7)+\zzp)%640)
.elseif \zzj == 0
zze8 640,641,640,641,640,641,640,641
.else
zze8 642,642,642,642,642,642,642,642
.endif
.endm
.macro zzg3 zzk, zzn
.if \zzk > 0
zze8 %((\zzk*\zzn)%640), %((\zzk*\zzn+160)%640), %(((\zzk+1)*\zzn)%640), %(((\zzk+1)*\zzn+160)%640), %(((\zzk+4)*\zzn)%640), %(((\zzk+4)*\zzn+160)%640), %(((\zzk+5)*\zzn)%640), %(((\zzk+5)*\zzn+160)%640)
.else
zze8 %(640+(\zzn%2)), 642, %(((\zzk+1)*\zzn)%640), %(((\zzk+1)*\zzn+160)%640), %(((\zzk+4)*\zzn)%640), %(((\zzk+4)*\zzn+160)%640), %(((\zzk+5)*\zzn)%640), %(((\zzk+5)*\zzn+160)%640)
.endif
.endm
.p2align 8
.Ltab3:
.set .Lq, 0
.rept 51200
zzg3 %(16*((.Lq/320)%20) + 8*((.Lq/32)%2) + 2*((.Lq/16)%2)), %(80*(.Lq/6400) + (1-((.Lq/64)%5)/4)*(32*(((.Lq/64)%5)/2) + 8*((.Lq%16)/4) + 4*(((.Lq/64)%5)%2) + .Lq%4) + (((.Lq/64)%5)/4)*(64 + .Lq%16))
.set .Lq, .Lq+1
.endr
.noaltmacro
.p2align 8
.Ltabcf:
.long 0x30003000,0x30003000,0x30003000,0x30003000,0x2ff63000,0x2fa82fd9,0xa2460000,0xa8a5a63e,0x2fd93000,0x2ea72f64,0xafd9b000,0xaea7af64,0x2fa83000,0x2d132ea7,0x28a50000,0x2e2f2c72
.long 0x2f643000,0x2a1f2da8,0x2f643000,0x2a1f2da8,0x2f0e3000,0x22462c72,0xab8b0000,0xaff6aea7,0x2ea73000,0xa63e2a1f,0xaea7b000,0x263eaa1f,0x2e2f3000,0xab8b263e,0x2d130000,0x2f0e2fd9
.long 0x2da83000,0xada80000,0x2da83000,0xada80000,0x2d133000,0xaf0ea63e,0xae2f0000,0xab8bafd9,0x2c723000,0xafd9aa1f,0xac72b000,0x2fd92a1f,0x2b8b3000,0xaff6ac72,0x2f0e0000,0xa2462ea7
.long 0x2a1f3000,0xaf64ada8,0x2a1f3000,0xaf64ada8,0x28a53000,0xae2faea7,0xafa80000,0x2d13ac72,0x263e3000,0xac72af64,0xa63eb000,0x2c722f64,0x22463000,0xa8a5afd9,0x2ff60000,0xafa8263e
.long 0x30003000,0x30003000,0x30003000,0x30003000,0x2f0e2f64,0x2e2f2ea7,0xab8baa1f,0xad13ac72,0x2c722da8,0x263e2a1f,0xac72ada8,0xa63eaa1f,0x22462a1f,0xab8ba63e,0x2ff62f64,0x2f0e2fd9
.long 0xaa1f0000,0xaf64ada8,0xaa1f0000,0xaf64ada8,0xae2faa1f,0xafa8afd9,0xad13af64,0x28a5a63e,0xafd9ada8,0xac72af64,0x2fd92da8,0x2c722f64,0xafa8af64,0x2246ac72,0xa8a52a1f,0xaff6aea7
.long 0xada8b000,0x2da80000,0xada8b000,0x2da80000,0xa8a5af64,0x2ff62c72,0x2fa82a1f,0x22462ea7,0x263eada8,0x2ea72f64,0xa63e2da8,0xaea7af64,0x2d13aa1f,0x28a52fd9,0xae2faf64,0x2fa8263e
.long 0x2f640000,0xaa1f2da8,0x2f640000,0xaa1f2da8,0x2ff62a1f,0xaf0e263e,0xa2462f64,0xab8bafd9,0x2ea72da8,0xafd9aa1f,0xaea7ada8,0x2fd92a1f,0x2b8b2f64,0xad13aea7,0x2f0eaa1f,0xae2f2c72
.long 0x30003000,0x30003000,0x30003000,0x30003000,0x2d132da8,0x2b8b2c72,0xae2fada8,0xaf0eaea7,0xa63e0000,0xac72aa1f,0x263e0000,0x2c722a1f,0xaf0eada8,0xaff6afd9,0x2b8b2da8,0xa246263e
.long 0xaf64b000,0xaa1fada8,0xaf64b000,0xaa1fada8,0xa8a5ada8,0x2d13263e,0x2fa82da8,0x2e2f2fd9,0x2c720000,0x2fd92f64,0xac720000,0xafd9af64,0x2ff62da8,0x28a52ea7,0xa246ada8,0x2fa82c72
.long 0x2da83000,0xada80000,0x2da83000,0xada80000,0xa2462da8,0xafa8aea7,0xaff6ada8,0x28a5ac72,0xaea70000,0xa63eaf64,0x2ea70000,0x263e2f64,0xafa8ada8,0x2e2fa63e,0xa8a52da8,0xad13afd9
.long 0xaa1fb000,0x2f642da8,0xaa1fb000,0x2f642da8,0x2b8bada8,0x22462fd9,0x2f0e2da8,0xaff6a63e,0x2fd90000,0xaea72a1f,0xafd90000,0x2ea7aa1f,0x2e2f2da8,0xaf0eac72,0x2d13ada8,0xab8b2ea7
.long 0x30003000,0x30003000,0x30003000,0x30003000,0x28a52a1f,0x2246263e,0xafa8af64,0xaff6afd9,0xaea7ada8,0xafd9af64,0x2ea72da8,0x2fd92f64,0xae2faf64,0xa8a5ac72,0xad13aa1f,0xafa8aea7
.long 0x2a1f0000,0x2f642da8,0x2a1f0000,0x2f642da8,0x2ff62f64,0x2b8b2ea7,0xa2462a1f,0xaf0eac72,0x263e2da8,0xaea7aa1f,0xa63eada8,0x2ea72a1f,0xaf0eaa1f,0xad13afd9,0x2b8b2f64,0xae2fa63e
.long 0xada8b000,0x2da80000,0xada8b000,0x2da80000,0x2b8baa1f,0x2e2f2fd9,0x2f0e2f64,0xad13263e,0x2fd92da8,0xac722a1f,0xafd9ada8,0x2c72aa1f,0x22462f64,0xaf0eaea7,0x2ff62a1f,0xab8b2c72
.long 0xaf640000,0x2a1fada8,0xaf640000,0x2a1fada8,0xad13af64,0x2fa82c72,0x2e2faa1f,0xa8a52ea7,0x2c72ada8,0xa63e2f64,0xac722da8,0x263eaf64,0x2fa82a1f,0xaff6a63e,0x28a5af64,0xa2462fd9
.long 0x0,0x0,0x0,0x0,0xa2460000,0xa8a5a63e,0xaff6b000,0xafa8afd9,0xa63e0000,0xac72aa1f,0x263e0000,0x2c722a1f,0xa8a50000,0xae2fac72,0x2fa83000,0x2d132ea7
.long 0xaa1f0000,0xaf64ada8,0xaa1f0000,0xaf64ada8,0xab8b0000,0xaff6aea7,0xaf0eb000,0xa246ac72,0xac720000,0xafd9af64,0x2c720000,0x2fd92f64,0xad130000,0xaf0eafd9,0x2e2f3000,0xab8b263e
.long 0xada80000,0xada8b000,0xada80000,0xada8b000,0xae2f0000,0xab8bafd9,0xad13b000,0x2f0e263e,0xaea70000,0xa63eaf64,0x2ea70000,0x263e2f64,0xaf0e0000,0x2246aea7,0x2b8b3000,0xaff6ac72
.long 0xaf640000,0x2a1fada8,0xaf640000,0x2a1fada8,0xafa80000,0x2d13ac72,0xa8a5b000,0x2e2f2ea7,0xafd90000,0x2ea7aa1f,0x2fd90000,0xaea72a1f,0xaff60000,0x2fa8a63e,0x22463000,0xa8a5afd9
.long 0x0,0x0,0x0,0x0,0xab8baa1f,0xad13ac72,0xaf0eaf64,0xae2faea7,0xaea7ada8,0xafd9af64,0x2ea72da8,0x2fd92f64,0xaff6af64,0xaf0eafd9,0x22462a1f,0xab8ba63e
.long 0xaf64b000,0xaa1fada8,0xaf64b000,0xaa1fada8,0xad13af64,0x28a5a63e,0x2e2f2a1f,0x2fa82fd9,0xa63eada8,0x2ea72a1f,0x263e2da8,0xaea7aa1f,0x28a5aa1f,0x2ff62ea7,0xafa8af64,0x2246ac72
.long 0x2da80000,0x2da83000,0x2da80000,0x2da83000,0x2fa82a1f,0x22462ea7,0x28a52f64,0xaff6ac72,0x2fd92da8,0xac722a1f,0xafd9ada8,0x2c72aa1f,0x2e2f2f64,0xafa8a63e,0x2d13aa1f,0x28a52fd9
.long 0x2a1f3000,0xaf64ada8,0x2a1f3000,0xaf64ada8,0xa2462f64,0xab8bafd9,0xaff6aa1f,0x2f0ea63e,0xac722da8,0x263eaf64,0x2c72ada8,0xa63e2f64,0xaf0e2a1f,0x2e2fac72,0x2b8b2f64,0xad13aea7
.long 0x0,0x0,0x0,0x0,0xae2fada8,0xaf0eaea7,0xad13ada8,0xab8bac72,0xafd9b000,0xaea7af64,0x2fd93000,0x2ea72f64,0xab8bada8,0x2246a63e,0xaf0eada8,0xaff6afd9
.long 0x2a1f0000,0x2f642da8,0x2a1f0000,0x2f642da8,0x2fa82da8,0x2e2f2fd9,0x28a52da8,0xad13a63e,0x2ea73000,0xa63e2a1f,0xaea7b000,0x263eaa1f,0x22462da8,0xafa8ac72,0x2ff62da8,0x28a52ea7
.long 0xada80000,0xada8b000,0xada80000,0xada8b000,0xaff6ada8,0x28a5ac72,0x2246ada8,0x2fa82ea7,0xac72b000,0x2fd92a1f,0x2c723000,0xafd9aa1f,0x28a5ada8,0x2d132fd9,0xafa8ada8,0x2e2fa63e
.long 0x2f640000,0xaa1f2da8,0x2f640000,0xaa1f2da8,0x2f0e2da8,0xaff6a63e,0xab8b2da8,0xa246afd9,0x263e3000,0xac72af64,0xa63eb000,0x2c722f64,0xad132da8,0x2b8baea7,0x2e2f2da8,0xaf0eac72
.long 0x0,0x0,0x0,0x0,0xafa8af64,0xaff6afd9,0xa8a5aa1f,0xa246a63e,0xac72ada8,0xa63eaa1f,0x2c722da8,0x263e2a1f,0x2d132a1f,0x2fa82ea7,0xae2faf64,0xa8a5ac72
.long 0x2f643000,0x2a1f2da8,0x2f643000,0x2a1f2da8,0xa2462a1f,0xaf0eac72,0xaff6af64,0xab8baea7,0xafd9ada8,0xac72af64,0x2fd92da8,0x2c722f64,0xab8baf64,0x2e2f263e,0xaf0eaa1f,0xad13afd9
.long 0x2da80000,0x2da83000,0x2da80000,0x2da83000,0x2f0e2f64,0xad13263e,0xab8b2a1f,0xae2fafd9,0xa63e2da8,0xaea7af64,0x263eada8,0x2ea72f64,0xaff6aa1f,0x2b8bac72,0x22462f64,0xaf0eaea7
.long 0xaa1fb000,0x2f642da8,0xaa1fb000,0x2f642da8,0x2e2faa1f,0xa8a52ea7,0x2d132f64,0xafa8ac72,0x2ea72da8,0xafd9aa1f,0xaea7ada8,0x2fd92a1f,0xa8a52f64,0x2246afd9,0x2fa82a1f,0xaff6a63e
.long 0x30003000,0x30003000,0x30003000,0x30003000,0xaff6b000,0xafa8afd9,0x22460000,0x28a5263e,0x2fd93000,0x2ea72f64,0xafd9b000,0xaea7af64,0xafa8b000,0xad13aea7,0xa8a50000,0xae2fac72
.long 0x2f643000,0x2a1f2da8,0x2f643000,0x2a1f2da8,0xaf0eb000,0xa246ac72,0x2b8b0000,0x2ff62ea7,0x2ea73000,0xa63e2a1f,0xaea7b000,0x263eaa1f,0xae2fb000,0x2b8ba63e,0xad130000,0xaf0eafd9
.long 0x2da83000,0xada80000,0x2da83000,0xada80000,0xad13b000,0x2f0e263e,0x2e2f0000,0x2b8b2fd9,0x2c723000,0xafd9aa1f,0xac72b000,0x2fd92a1f,0xab8bb000,0x2ff62c72,0xaf0e0000,0x2246aea7
.long 0x2a1f3000,0xaf64ada8,0x2a1f3000,0xaf64ada8,0xa8a5b000,0x2e2f2ea7,0x2fa80000,0xad132c72,0x263e3000,0xac72af64,0xa63eb000,0x2c722f64,0xa246b000,0x28a52fd9,0xaff60000,0x2fa8a63e
.long 0x30003000,0x30003000,0x30003000,0x30003000,0xaf0eaf64,0xae2faea7,0x2b8b2a1f,0x2d132c72,0x2c722da8,0x263e2a1f,0xac72ada8,0xa63eaa1f,0xa246aa1f,0x2b8b263e,0xaff6af64,0xaf0eafd9
.long 0xaa1f0000,0xaf64ada8,0xaa1f0000,0xaf64ada8,0x2e2f2a1f,0x2fa82fd9,0x2d132f64,0xa8a5263e,0xafd9ada8,0xac72af64,0x2fd92da8,0x2c722f64,0x2fa82f64,0xa2462c72,0x28a5aa1f,0x2ff62ea7
.long 0xada8b000,0x2da80000,0xada8b000,0x2da80000,0x28a52f64,0xaff6ac72,0xafa8aa1f,0xa246aea7,0x263eada8,0x2ea72f64,0xa63e2da8,0xaea7af64,0xad132a1f,0xa8a5afd9,0x2e2f2f64,0xafa8a63e
.long 0x2f640000,0xaa1f2da8,0x2f640000,0xaa1f2da8,0xaff6aa1f,0x2f0ea63e,0x2246af64,0x2b8b2fd9,0x2ea72da8,0xafd9aa1f,0xaea7ada8,0x2fd92a1f,0xab8baf64,0x2d132ea7,0xaf0e2a1f,0x2e2fac72
.long 0x30003000,0x30003000,0x30003000,0x30003000,0xad13ada8,0xab8bac72,0x2e2f2da8,0x2f0e2ea7,0xa63e0000,0xac72aa1f,0x263e0000,0x2c722a1f,0x2f0e2da8,0x2ff62fd9,0xab8bada8,0x2246a63e
.long 0xaf64b000,0xaa1fada8,0xaf64b000,0xaa1fada8,0x28a52da8,0xad13a63e,0xafa8ada8,0xae2fafd9,0x2c720000,0x2fd92f64,0xac720000,0xafd9af64,0xaff6ada8,0xa8a5aea7,0x22462da8,0xafa8ac72
.long 0x2da83000,0xada80000,0x2da83000,0xada80000,0x2246ada8,0x2fa82ea7,0x2ff62da8,0xa8a52c72,0xaea70000,0xa63eaf64,0x2ea70000,0x263e2f64,0x2fa82da8,0xae2f263e,0x28a5ada8,0x2d132fd9
.long 0xaa1fb000,0x2f642da8,0xaa1fb000,0x2f642da8,0xab8b2da8,0xa246afd9,0xaf0eada8,0x2ff6263e,0x2fd90000,0xaea72a1f,0xafd90000,0x2ea7aa1f,0xae2fada8,0x2f0e2c72,0xad132da8,0x2b8baea7
.long 0x30003000,0x30003000,0x30003000,0x30003000,0xa8a5aa1f,0xa246a63e,0x2fa82f64,0x2ff62fd9,0xaea7ada8,0xafd9af64,0x2ea72da8,0x2fd92f64,0x2e2f2f64,0x28a52c72,0x2d132a1f,0x2fa82ea7
.long 0x2a1f0000,0x2f642da8,0x2a1f0000,0x2f642da8,0xaff6af64,0xab8baea7,0x2246aa1f,0x2f0e2c72,0x263e2da8,0xaea7aa1f,0xa63eada8,0x2ea72a1f,0x2f0e2a1f,0x2d132fd9,0xab8baf64,0x2e2f263e
.long 0xada8b000,0x2da80000,0xada8b000,0x2da80000,0xab8b2a1f,0xae2fafd9,0xaf0eaf64,0x2d13a63e,0x2fd92da8,0xac722a1f,0xafd9ada8,0x2c72aa1f,0xa246af64,0x2f0e2ea7,0xaff6aa1f,0x2b8bac72
.long 0xaf640000,0x2a1fada8,0xaf640000,0x2a1fada8,0x2d132f64,0xafa8ac72,0xae2f2a1f,0x28a5aea7,0x2c72ada8,0xa63e2f64,0xac722da8,0x263eaf64,0xafa8aa1f,0x2ff6263e,0xa8a52f64,0x2246afd9
.long 0x0,0x0,0x0,0x0,0x22460000,0x28a5263e,0x2ff63000,0x2fa82fd9,0xa63e0000,0xac72aa1f,0x263e0000,0x2c722a1f,0x28a50000,0x2e2f2c72,0xafa8b000,0xad13aea7
.long 0xaa1f0000,0xaf64ada8,0xaa1f0000,0xaf64ada8,0x2b8b0000,0x2ff62ea7,0x2f0e3000,0x22462c72,0xac720000,0xafd9af64,0x2c720000,0x2fd92f64,0x2d130000,0x2f0e2fd9,0xae2fb000,0x2b8ba63e
.long 0xada80000,0xada8b000,0xada80000,0xada8b000,0x2e2f0000,0x2b8b2fd9,0x2d133000,0xaf0ea63e,0xaea70000,0xa63eaf64,0x2ea70000,0x263e2f64,0x2f0e0000,0xa2462ea7,0xab8bb000,0x2ff62c72
.long 0xaf640000,0x2a1fada8,0xaf640000,0x2a1fada8,0x2fa80000,0xad132c72,0x28a53000,0xae2faea7,0xafd90000,0x2ea7aa1f,0x2fd90000,0xaea72a1f,0x2ff60000,0xafa8263e,0xa246b000,0x28a52fd9
.long 0x0,0x0,0x0,0x0,0x2b8b2a1f,0x2d132c72,0x2f0e2f64,0x2e2f2ea7,0xaea7ada8,0xafd9af64,0x2ea72da8,0x2fd92f64,0x2ff62f64,0x2f0e2fd9,0xa246aa1f,0x2b8b263e
.long 0xaf64b000,0xaa1fada8,0xaf64b000,0xaa1fada8,0x2d132f64,0xa8a5263e,0xae2faa1f,0xafa8afd9,0xa63eada8,0x2ea72a1f,0x263e2da8,0xaea7aa1f,0xa8a52a1f,0xaff6aea7,0x2fa82f64,0xa2462c72
.long 0x2da80000,0x2da83000,0x2da80000,0x2da83000,0xafa8aa1f,0xa246aea7,0xa8a5af64,0x2ff62c72,0x2fd92da8,0xac722a1f,0xafd9ada8,0x2c72aa1f,0xae2faf64,0x2fa8263e,0xad132a1f,0xa8a5afd9
.long 0x2a1f3000,0xaf64ada8,0x2a1f3000,0xaf64ada8,0x2246af64,0x2b8b2fd9,0x2ff62a1f,0xaf0e263e,0xac722da8,0x263eaf64,0x2c72ada8,0xa63e2f64,0x2f0eaa1f,0xae2f2c72,0xab8baf64,0x2d132ea7
.long 0x0,0x0,0x0,0x0,0x2e2f2da8,0x2f0e2ea7,0x2d132da8,0x2b8b2c72,0xafd9b000,0xaea7af64,0x2fd93000,0x2ea72f64,0x2b8b2da8,0xa246263e,0x2f0e2da8,0x2ff62fd9
.long 0x2a1f0000,0x2f642da8,0x2a1f0000,0x2f642da8,0xafa8ada8,0xae2fafd9,0xa8a5ada8,0x2d13263e,0x2ea73000,0xa63e2a1f,0xaea7b000,0x263eaa1f,0xa246ada8,0x2fa82c72,0xaff6ada8,0xa8a5aea7
.long 0xada80000,0xada8b000,0xada80000,0xada8b000,0x2ff62da8,0xa8a52c72,0xa2462da8,0xafa8aea7,0xac72b000,0x2fd92a1f,0x2c723000,0xafd9aa1f,0xa8a52da8,0xad13afd9,0x2fa82da8,0xae2f263e
.long 0x2f640000,0xaa1f2da8,0x2f640000,0xaa1f2da8,0xaf0eada8,0x2ff6263e,0x2b8bada8,0x22462fd9,0x263e3000,0xac72af64,0xa63eb000,0x2c722f64,0x2d13ada8,0xab8b2ea7,0xae2fada8,0x2f0e2c72
.long 0x0,0x0,0x0,0x0,0x2fa82f64,0x2ff62fd9,0x28a52a1f,0x2246263e,0xac72ada8,0xa63eaa1f,0x2c722da8,0x263e2a1f,0xad13aa1f,0xafa8aea7,0x2e2f2f64,0x28a52c72
.long 0x2f643000,0x2a1f2da8,0x2f643000,0x2a1f2da8,0x2246aa1f,0x2f0e2c72,0x2ff62f64,0x2b8b2ea7,0xafd9ada8,0xac72af64,0x2fd92da8,0x2c722f64,0x2b8b2f64,0xae2fa63e,0x2f0e2a1f,0x2d132fd9
.long 0x2da80000,0x2da83000,0x2da80000,0x2da83000,0xaf0eaf64,0x2d13a63e,0x2b8baa1f,0x2e2f2fd9,0xa63e2da8,0xaea7af64,0x263eada8,0x2ea72f64,0x2ff62a1f,0xab8b2c72,0xa246af64,0x2f0e2ea7
.long 0xaa1fb000,0x2f642da8,0xaa1fb000,0x2f642da8,0xae2f2a1f,0x28a5aea7,0xad13af64,0x2fa82c72,0x2ea72da8,0xafd9aa1f,0xaea7ada8,0x2fd92a1f,0x28a5af64,0xa2462fd9,0xafa8aa1f,0x2ff6263e
.long 0x3000,0xb000,0x3000,0xb000,0xa2463000,0x28a5afd9,0xaff60000,0x2fa8263e,0xa63e3000,0x2c72af64,0x263eb000,0xac722f64,0xa8a53000,0x2e2faea7,0x2fa80000,0xad13ac72
.long 0xaa1f3000,0x2f64ada8,0xaa1f3000,0x2f64ada8,0xab8b3000,0x2ff6ac72,0xaf0e0000,0x22462ea7,0xac723000,0x2fd9aa1f,0x2c72b000,0xafd92a1f,0xad133000,0x2f0ea63e,0x2e2f0000,0x2b8bafd9
.long 0xada83000,0x2da80000,0xada83000,0x2da80000,0xae2f3000,0x2b8b263e,0xad130000,0xaf0e2fd9,0xaea73000,0x263e2a1f,0x2ea7b000,0xa63eaa1f,0xaf0e3000,0xa2462c72,0x2b8b0000,0x2ff6aea7
.long 0xaf643000,0xaa1f2da8,0xaf643000,0xaa1f2da8,0xafa83000,0xad132ea7,0xa8a50000,0xae2f2c72,0xafd93000,0xaea72f64,0x2fd9b000,0x2ea7af64,0xaff63000,0xafa82fd9,0x22460000,0x28a5a63e
.long 0x3000,0xb000,0x3000,0xb000,0xab8b2f64,0x2d13aea7,0xaf0eaa1f,0x2e2f2c72,0xaea72da8,0x2fd9aa1f,0x2ea7ada8,0xafd92a1f,0xaff62a1f,0x2f0e263e,0x22462f64,0x2b8bafd9
.long 0xaf640000,0x2a1f2da8,0xaf640000,0x2a1f2da8,0xad13aa1f,0xa8a52fd9,0x2e2faf64,0xafa8263e,0xa63eada8,0xaea72f64,0x263e2da8,0x2ea7af64,0x28a5af64,0xaff62c72,0xafa82a1f,0xa2462ea7
.long 0x2da8b000,0xada80000,0x2da8b000,0xada80000,0x2fa8af64,0xa246ac72,0x28a52a1f,0x2ff6aea7,0x2fd9ada8,0x2c72af64,0xafd92da8,0xac722f64,0x2e2faa1f,0x2fa8afd9,0x2d13af64,0xa8a5a63e
.long 0x2a1f0000,0x2f64ada8,0x2a1f0000,0x2f64ada8,0xa2462a1f,0x2b8ba63e,0xaff62f64,0xaf0e2fd9,0xac722da8,0xa63e2a1f,0x2c72ada8,0x263eaa1f,0xaf0e2f64,0xae2f2ea7,0x2b8baa1f,0x2d13ac72
.long 0x3000,0xb000,0x3000,0xb000,0xae2f2da8,0x2f0eac72,0xad13ada8,0x2b8b2ea7,0xafd90000,0x2ea72a1f,0x2fd90000,0xaea7aa1f,0xab8bada8,0xa2462fd9,0xaf0e2da8,0x2ff6a63e
.long 0x2a1fb000,0xaf642da8,0x2a1fb000,0xaf642da8,0x2fa8ada8,0xae2fa63e,0x28a52da8,0x2d13afd9,0x2ea70000,0x263eaf64,0xaea70000,0xa63e2f64,0x22462da8,0x2fa8aea7,0x2ff6ada8,0xa8a5ac72
.long 0xada83000,0x2da80000,0xada83000,0x2da80000,0xaff62da8,0xa8a52ea7,0x2246ada8,0xafa82c72,0xac720000,0xafd92f64,0x2c720000,0x2fd9af64,0x28a5ada8,0xad13263e,0xafa82da8,0xae2f2fd9
.long 0x2f64b000,0x2a1fada8,0x2f64b000,0x2a1fada8,0x2f0eada8,0x2ff6afd9,0xab8b2da8,0x2246263e,0x263e0000,0x2c72aa1f,0xa63e0000,0xac722a1f,0xad132da8,0xab8b2c72,0x2e2fada8,0x2f0eaea7
.long 0x3000,0xb000,0x3000,0xb000,0xafa82a1f,0x2ff6a63e,0xa8a5af64,0x22462fd9,0xac72ada8,0x263e2f64,0x2c722da8,0xa63eaf64,0x2d13af64,0xafa82c72,0xae2faa1f,0x28a52ea7
.long 0x2f640000,0xaa1fada8,0x2f640000,0xaa1fada8,0xa2462f64,0x2f0eaea7,0xaff62a1f,0x2b8b2c72,0xafd92da8,0x2c722a1f,0x2fd9ada8,0xac72aa1f,0xab8baa1f,0xae2f2fd9,0xaf0e2f64,0x2d13263e
.long 0x2da8b000,0xada80000,0x2da8b000,0xada80000,0x2f0eaa1f,0x2d13afd9,0xab8b2f64,0x2e2fa63e,0xa63e2da8,0x2ea7aa1f,0x263eada8,0xaea72a1f,0xaff62f64,0xab8b2ea7,0x22462a1f,0x2f0eac72
.long 0xaa1f0000,0xaf642da8,0xaa1f0000,0xaf642da8,0x2e2faf64,0x28a5ac72,0x2d13aa1f,0x2fa8aea7,0x2ea7ada8,0x2fd9af64,0xaea72da8,0xafd92f64,0xa8a52a1f,0xa246263e,0x2fa8af64,0x2ff6afd9
.long 0xb0000000,0x30000000,0xb0000000,0x30000000,0xaff60000,0x2fa8263e,0x2246b000,0xa8a52fd9,0xafd90000,0x2ea72a1f,0x2fd90000,0xaea7aa1f,0xafa80000,0x2d132c72,0xa8a53000,0x2e2faea7
.long 0xaf640000,0x2a1f2da8,0xaf640000,0x2a1f2da8,0xaf0e0000,0x22462ea7,0x2b8bb000,0xaff62c72,0xaea70000,0xa63e2f64,0x2ea70000,0x263eaf64,0xae2f0000,0xab8b2fd9,0xad133000,0x2f0ea63e
.long 0xada80000,0xada83000,0xada80000,0xada83000,0xad130000,0xaf0e2fd9,0x2e2fb000,0xab8ba63e,0xac720000,0xafd92f64,0x2c720000,0x2fd9af64,0xab8b0000,0xaff62ea7,0xaf0e3000,0xa2462c72
.long 0xaa1f0000,0xaf642da8,0xaa1f0000,0xaf642da8,0xa8a50000,0xae2f2c72,0x2fa8b000,0x2d13aea7,0xa63e0000,0xac722a1f,0x263e0000,0x2c72aa1f,0xa2460000,0xa8a5263e,0xaff63000,0xafa82fd9
.long 0xb0000000,0x30000000,0xb0000000,0x30000000,0xaf0eaa1f,0x2e2f2c72,0x2b8baf64,0xad132ea7,0xac72ada8,0x263e2f64,0x2c722da8,0xa63eaf64,0xa246af64,0xab8b2fd9,0xaff62a1f,0x2f0e263e
.long 0x2a1fb000,0xaf642da8,0x2a1fb000,0xaf642da8,0x2e2faf64,0xafa8263e,0x2d132a1f,0x28a5afd9,0x2fd9ada8,0xac72aa1f,0xafd92da8,0x2c722a1f,0x2fa8aa1f,0x2246aea7,0x28a5af64,0xaff62c72
.long 0x2da80000,0x2da8b000,0x2da80000,0x2da8b000,0x28a52a1f,0x2ff6aea7,0xafa82f64,0x22462c72,0xa63e2da8,0x2ea7aa1f,0x263eada8,0xaea72a1f,0xad132f64,0x28a5263e,0x2e2faa1f,0x2fa8afd9
.long 0xaf643000,0xaa1f2da8,0xaf643000,0xaa1f2da8,0xaff62f64,0xaf0e2fd9,0x2246aa1f,0xab8b263e,0xaea72da8,0xafd92f64,0x2ea7ada8,0x2fd9af64,0xab8b2a1f,0xad132c72,0xaf0e2f64,0xae2f2ea7
.long 0xb0000000,0x30000000,0xb0000000,0x30000000,0xad13ada8,0x2b8b2ea7,0x2e2fada8,0xaf0e2c72,0x263eb000,0xac722f64,0xa63e3000,0x2c72af64,0x2f0eada8,0xaff6263e,0xab8bada8,0xa2462fd9
.long 0x2f640000,0xaa1fada8,0x2f640000,0xaa1fada8,0x28a52da8,0x2d13afd9,0xafa82da8,0x2e2f263e,0xac723000,0x2fd9aa1f,0x2c72b000,0xafd92a1f,0xaff62da8,0x28a52c72,0x22462da8,0x2fa8aea7
.long 0xada80000,0xada83000,0xada80000,0xada83000,0x2246ada8,0xafa82c72,0x2ff6ada8,0x28a5aea7,0x2ea7b000,0xa63eaa1f,0xaea73000,0x263e2a1f,0x2fa8ada8,0x2e2fafd9,0x28a5ada8,0xad13263e
.long 0x2a1f0000,0x2f64ada8,0x2a1f0000,0x2f64ada8,0xab8b2da8,0x2246263e,0xaf0e2da8,0xaff62fd9,0xafd93000,0xaea72f64,0x2fd9b000,0x2ea7af64,0xae2f2da8,0xaf0e2ea7,0xad132da8,0xab8b2c72
.long 0xb0000000,0x30000000,0xb0000000,0x30000000,0xa8a5af64,0x22462fd9,0x2fa8aa1f,0xaff6263e,0x2ea7ada8,0xafd92a1f,0xaea72da8,0x2fd9aa1f,0x2e2f2a1f,0xa8a5aea7,0x2d13af64,0xafa82c72
.long 0xaa1f3000,0x2f64ada8,0xaa1f3000,0x2f64ada8,0xaff62a1f,0x2b8b2c72,0x2246af64,0xaf0e2ea7,0xa63eada8,0xaea72f64,0x263e2da8,0x2ea7af64,0x2f0eaf64,0xad13a63e,0xab8baa1f,0xae2f2fd9
.long 0x2da80000,0x2da8b000,0x2da80000,0x2da8b000,0xab8b2f64,0x2e2fa63e,0xaf0e2a1f,0xad132fd9,0xafd92da8,0xac722f64,0x2fd9ada8,0x2c72af64,0xa246aa1f,0xaf0e2c72,0xaff62f64,0xab8b2ea7
.long 0x2f64b000,0x2a1fada8,0x2f64b000,0x2a1fada8,0x2d13aa1f,0x2fa8aea7,0xae2f2f64,0xa8a52c72,0xac722da8,0xa63e2a1f,0x2c72ada8,0x263eaa1f,0xafa82f64,0xaff62fd9,0xa8a52a1f,0xa246263e
.long 0x3000,0xb000,0x3000,0xb000,0x2246b000,0xa8a52fd9,0x2ff60000,0xafa8a63e,0xa63e3000,0x2c72af64,0x263eb000,0xac722f64,0x28a5b000,0xae2f2ea7,0xafa80000,0x2d132c72
.long 0xaa1f3000,0x2f64ada8,0xaa1f3000,0x2f64ada8,0x2b8bb000,0xaff62c72,0x2f0e0000,0xa246aea7,0xac723000,0x2fd9aa1f,0x2c72b000,0xafd92a1f,0x2d13b000,0xaf0e263e,0xae2f0000,0xab8b2fd9
.long 0xada83000,0x2da80000,0xada83000,0x2da80000,0x2e2fb000,0xab8ba63e,0x2d130000,0x2f0eafd9,0xaea73000,0x263e2a1f,0x2ea7b000,0xa63eaa1f,0x2f0eb000,0x2246ac72,0xab8b0000,0xaff62ea7
.long 0xaf643000,0xaa1f2da8,0xaf643000,0xaa1f2da8,0x2fa8b000,0x2d13aea7,0x28a50000,0x2e2fac72,0xafd93000,0xaea72f64,0x2fd9b000,0x2ea7af64,0x2ff6b000,0x2fa8afd9,0xa2460000,0xa8a5263e
.long 0x3000,0xb000,0x3000,0xb000,0x2b8baf64,0xad132ea7,0x2f0e2a1f,0xae2fac72,0xaea72da8,0x2fd9aa1f,0x2ea7ada8,0xafd92a1f,0x2ff6aa1f,0xaf0ea63e,0xa246af64,0xab8b2fd9
.long 0xaf640000,0x2a1f2da8,0xaf640000,0x2a1f2da8,0x2d132a1f,0x28a5afd9,0xae2f2f64,0x2fa8a63e,0xa63eada8,0xaea72f64,0x263e2da8,0x2ea7af64,0xa8a52f64,0x2ff6ac72,0x2fa8aa1f,0x2246aea7
.long 0x2da8b000,0xada80000,0x2da8b000,0xada80000,0xafa82f64,0x22462c72,0xa8a5aa1f,0xaff62ea7,0x2fd9ada8,0x2c72af64,0xafd92da8,0xac722f64,0xae2f2a1f,0xafa82fd9,0xad132f64,0x28a5263e
.long 0x2a1f0000,0x2f64ada8,0x2a1f0000,0x2f64ada8,0x2246aa1f,0xab8b263e,0x2ff6af64,0x2f0eafd9,0xac722da8,0xa63e2a1f,0x2c72ada8,0x263eaa1f,0x2f0eaf64,0x2e2faea7,0xab8b2a1f,0xad132c72
.long 0x3000,0xb000,0x3000,0xb000,0x2e2fada8,0xaf0e2c72,0x2d132da8,0xab8baea7,0xafd90000,0x2ea72a1f,0x2fd90000,0xaea7aa1f,0x2b8b2da8,0x2246afd9,0x2f0eada8,0xaff6263e
.long 0x2a1fb000,0xaf642da8,0x2a1fb000,0xaf642da8,0xafa82da8,0x2e2f263e,0xa8a5ada8,0xad132fd9,0x2ea70000,0x263eaf64,0xaea70000,0xa63e2f64,0xa246ada8,0xafa82ea7,0xaff62da8,0x28a52c72
.long 0xada83000,0x2da80000,0xada83000,0x2da80000,0x2ff6ada8,0x28a5aea7,0xa2462da8,0x2fa8ac72,0xac720000,0xafd92f64,0x2c720000,0x2fd9af64,0xa8a52da8,0x2d13a63e,0x2fa8ada8,0x2e2fafd9
.long 0x2f64b000,0x2a1fada8,0x2f64b000,0x2a1fada8,0xaf0e2da8,0xaff62fd9,0x2b8bada8,0xa246a63e,0x263e0000,0x2c72aa1f,0xa63e0000,0xac722a1f,0x2d13ada8,0x2b8bac72,0xae2f2da8,0xaf0e2ea7
.long 0x3000,0xb000,0x3000,0xb000,0x2fa8aa1f,0xaff6263e,0x28a52f64,0xa246afd9,0xac72ada8,0x263e2f64,0x2c722da8,0xa63eaf64,0xad132f64,0x2fa8ac72,0x2e2f2a1f,0xa8a5aea7
.long 0x2f640000,0xaa1fada8,0x2f640000,0xaa1fada8,0x2246af64,0xaf0e2ea7,0x2ff6aa1f,0xab8bac72,0xafd92da8,0x2c722a1f,0x2fd9ada8,0xac72aa1f,0x2b8b2a1f,0x2e2fafd9,0x2f0eaf64,0xad13a63e
.long 0x2da8b000,0xada80000,0x2da8b000,0xada80000,0xaf0e2a1f,0xad132fd9,0x2b8baf64,0xae2f263e,0xa63e2da8,0x2ea7aa1f,0x263eada8,0xaea72a1f,0x2ff6af64,0x2b8baea7,0xa246aa1f,0xaf0e2c72
.long 0xaa1f0000,0xaf642da8,0xaa1f0000,0xaf642da8,0xae2f2f64,0xa8a52c72,0xad132a1f,0xafa82ea7,0x2ea7ada8,0x2fd9af64,0xaea72da8,0xafd92f64,0x28a5aa1f,0x2246a63e,0xafa82f64,0xaff62fd9
.long 0xb0000000,0x30000000,0xb0000000,0x30000000,0x2ff60000,0xafa8a63e,0xa2463000,0x28a5afd9,0xafd90000,0x2ea72a1f,0x2fd90000,0xaea7aa1f,0x2fa80000,0xad13ac72,0x28a5b000,0xae2f2ea7
.long 0xaf640000,0x2a1f2da8,0xaf640000,0x2a1f2da8,0x2f0e0000,0xa246aea7,0xab8b3000,0x2ff6ac72,0xaea70000,0xa63e2f64,0x2ea70000,0x263eaf64,0x2e2f0000,0x2b8bafd9,0x2d13b000,0xaf0e263e
.long 0xada80000,0xada83000,0xada80000,0xada83000,0x2d130000,0x2f0eafd9,0xae2f3000,0x2b8b263e,0xac720000,0xafd92f64,0x2c720000,0x2fd9af64,0x2b8b0000,0x2ff6aea7,0x2f0eb000,0x2246ac72
.long 0xaa1f0000,0xaf642da8,0xaa1f0000,0xaf642da8,0x28a50000,0x2e2fac72,0xafa83000,0xad132ea7,0xa63e0000,0xac722a1f,0x263e0000,0x2c72aa1f,0x22460000,0x28a5a63e,0x2ff6b000,0x2fa8afd9
.long 0xb0000000,0x30000000,0xb0000000,0x30000000,0x2f0e2a1f,0xae2fac72,0xab8b2f64,0x2d13aea7,0xac72ada8,0x263e2f64,0x2c722da8,0xa63eaf64,0x22462f64,0x2b8bafd9,0x2ff6aa1f,0xaf0ea63e
.long 0x2a1fb000,0xaf642da8,0x2a1fb000,0xaf642da8,0xae2f2f64,0x2fa8a63e,0xad13aa1f,0xa8a52fd9,0x2fd9ada8,0xac72aa1f,0xafd92da8,0x2c722a1f,0xafa82a1f,0xa2462ea7,0xa8a52f64,0x2ff6ac72
.long 0x2da80000,0x2da8b000,0x2da80000,0x2da8b000,0xa8a5aa1f,0xaff62ea7,0x2fa8af64,0xa246ac72,0xa63e2da8,0x2ea7aa1f,0x263eada8,0xaea72a1f,0x2d13af64,0xa8a5a63e,0xae2f2a1f,0xafa82fd9
.long 0xaf643000,0xaa1f2da8,0xaf643000,0xaa1f2da8,0x2ff6af64,0x2f0eafd9,0xa2462a1f,0x2b8ba63e,0xaea72da8,0xafd92f64,0x2ea7ada8,0x2fd9af64,0x2b8baa1f,0x2d13ac72,0x2f0eaf64,0x2e2faea7
.long 0xb0000000,0x30000000,0xb0000000,0x30000000,0x2d132da8,0xab8baea7,0xae2f2da8,0x2f0eac72,0x263eb000,0xac722f64,0xa63e3000,0x2c72af64,0xaf0e2da8,0x2ff6a63e,0x2b8b2da8,0x2246afd9
.long 0x2f640000,0xaa1fada8,0x2f640000,0xaa1fada8,0xa8a5ada8,0xad132fd9,0x2fa8ada8,0xae2fa63e,0xac723000,0x2fd9aa1f,0x2c72b000,0xafd92a1f,0x2ff6ada8,0xa8a5ac72,0xa246ada8,0xafa82ea7
.long 0xada80000,0xada83000,0xada80000,0xada83000,0xa2462da8,0x2fa8ac72,0xaff62da8,0xa8a52ea7,0x2ea7b000,0xa63eaa1f,0xaea73000,0x263e2a1f,0xafa82da8,0xae2f2fd9,0xa8a52da8,0x2d13a63e
.long 0x2a1f0000,0x2f64ada8,0x2a1f0000,0x2f64ada8,0x2b8bada8,0xa246a63e,0x2f0eada8,0x2ff6afd9,0xafd93000,0xaea72f64,0x2fd9b000,0x2ea7af64,0x2e2fada8,0x2f0eaea7,0x2d13ada8,0x2b8bac72
.long 0xb0000000,0x30000000,0xb0000000,0x30000000,0x28a52f64,0xa246afd9,0xafa82a1f,0x2ff6a63e,0x2ea7ada8,0xafd92a1f,0xaea72da8,0x2fd9aa1f,0xae2faa1f,0x28a52ea7,0xad132f64,0x2fa8ac72
.long 0xaa1f3000,0x2f64ada8,0xaa1f3000,0x2f64ada8,0x2ff6aa1f,0xab8bac72,0xa2462f64,0x2f0eaea7,0xa63eada8,0xaea72f64,0x263e2da8,0x2ea7af64,0xaf0e2f64,0x2d13263e,0x2b8b2a1f,0x2e2fafd9
.long 0x2da80000,0x2da8b000,0x2da80000,0x2da8b000,0x2b8baf64,0xae2f263e,0x2f0eaa1f,0x2d13afd9,0xafd92da8,0xac722f64,0x2fd9ada8,0x2c72af64,0x22462a1f,0x2f0eac72,0x2ff6af64,0x2b8baea7
.long 0x2f64b000,0x2a1fada8,0x2f64b000,0x2a1fada8,0xad132a1f,0xafa82ea7,0x2e2faf64,0x28a5ac72,0xac722da8,0xa63e2a1f,0x2c72ada8,0x263eaa1f,0x2fa8af64,0x2ff6afd9,0x28a5aa1f,0x2246a63e
.long 0xb0003000,0xb0003000,0xb0003000,0xb0003000,0xaff63000,0xafa82fd9,0x22460000,0x28a5a63e,0xafd93000,0xaea72f64,0x2fd9b000,0x2ea7af64,0xafa83000,0xad132ea7,0xa8a50000,0xae2f2c72
.long 0xaf643000,0xaa1f2da8,0xaf643000,0xaa1f2da8,0xaf0e3000,0xa2462c72,0x2b8b0000,0x2ff6aea7,0xaea73000,0x263e2a1f,0x2ea7b000,0xa63eaa1f,0xae2f3000,0x2b8b263e,0xad130000,0xaf0e2fd9
.long 0xada83000,0x2da80000,0xada83000,0x2da80000,0xad133000,0x2f0ea63e,0x2e2f0000,0x2b8bafd9,0xac723000,0x2fd9aa1f,0x2c72b000,0xafd92a1f,0xab8b3000,0x2ff6ac72,0xaf0e0000,0x22462ea7
.long 0xaa1f3000,0x2f64ada8,0xaa1f3000,0x2f64ada8,0xa8a53000,0x2e2faea7,0x2fa80000,0xad13ac72,0xa63e3000,0x2c72af64,0x263eb000,0xac722f64,0xa2463000,0x28a5afd9,0xaff60000,0x2fa8263e
.long 0xb0003000,0xb0003000,0xb0003000,0xb0003000,0xaf0e2f64,0xae2f2ea7,0x2b8baa1f,0x2d13ac72,0xac722da8,0xa63e2a1f,0x2c72ada8,0x263eaa1f,0xa2462a1f,0x2b8ba63e,0xaff62f64,0xaf0e2fd9
.long 0x2a1f0000,0x2f64ada8,0x2a1f0000,0x2f64ada8,0x2e2faa1f,0x2fa8afd9,0x2d13af64,0xa8a5a63e,0x2fd9ada8,0x2c72af64,0xafd92da8,0xac722f64,0x2fa8af64,0xa246ac72,0x28a52a1f,0x2ff6aea7
.long 0x2da8b000,0xada80000,0x2da8b000,0xada80000,0x28a5af64,0xaff62c72,0xafa82a1f,0xa2462ea7,0xa63eada8,0xaea72f64,0x263e2da8,0x2ea7af64,0xad13aa1f,0xa8a52fd9,0x2e2faf64,0xafa8263e
.long 0xaf640000,0x2a1f2da8,0xaf640000,0x2a1f2da8,0xaff62a1f,0x2f0e263e,0x22462f64,0x2b8bafd9,0xaea72da8,0x2fd9aa1f,0x2ea7ada8,0xafd92a1f,0xab8b2f64,0x2d13aea7,0xaf0eaa1f,0x2e2f2c72
.long 0xb0003000,0xb0003000,0xb0003000,0xb0003000,0xad132da8,0xab8b2c72,0x2e2fada8,0x2f0eaea7,0x263e0000,0x2c72aa1f,0xa63e0000,0xac722a1f,0x2f0eada8,0x2ff6afd9,0xab8b2da8,0x2246263e
.long 0x2f64b000,0x2a1fada8,0x2f64b000,0x2a1fada8,0x28a5ada8,0xad13263e,0xafa82da8,0xae2f2fd9,0xac720000,0xafd92f64,0x2c720000,0x2fd9af64,0xaff62da8,0xa8a52ea7,0x2246ada8,0xafa82c72
.long 0xada83000,0x2da80000,0xada83000,0x2da80000,0x22462da8,0x2fa8aea7,0x2ff6ada8,0xa8a5ac72,0x2ea70000,0x263eaf64,0xaea70000,0xa63e2f64,0x2fa8ada8,0xae2fa63e,0x28a52da8,0x2d13afd9
.long 0x2a1fb000,0xaf642da8,0x2a1fb000,0xaf642da8,0xab8bada8,0xa2462fd9,0xaf0e2da8,0x2ff6a63e,0xafd90000,0x2ea72a1f,0x2fd90000,0xaea7aa1f,0xae2f2da8,0x2f0eac72,0xad13ada8,0x2b8b2ea7
.long 0xb0003000,0xb0003000,0xb0003000,0xb0003000,0xa8a52a1f,0xa246263e,0x2fa8af64,0x2ff6afd9,0x2ea7ada8,0x2fd9af64,0xaea72da8,0xafd92f64,0x2e2faf64,0x28a5ac72,0x2d13aa1f,0x2fa8aea7
.long 0xaa1f0000,0xaf642da8,0xaa1f0000,0xaf642da8,0xaff62f64,0xab8b2ea7,0x22462a1f,0x2f0eac72,0xa63e2da8,0x2ea7aa1f,0x263eada8,0xaea72a1f,0x2f0eaa1f,0x2d13afd9,0xab8b2f64,0x2e2fa63e
.long 0x2da8b000,0xada80000,0x2da8b000,0xada80000,0xab8baa1f,0xae2f2fd9,0xaf0e2f64,0x2d13263e,0xafd92da8,0x2c722a1f,0x2fd9ada8,0xac72aa1f,0xa2462f64,0x2f0eaea7,0xaff62a1f,0x2b8b2c72
.long 0x2f640000,0xaa1fada8,0x2f640000,0xaa1fada8,0x2d13af64,0xafa82c72,0xae2faa1f,0x28a52ea7,0xac72ada8,0x263e2f64,0x2c722da8,0xa63eaf64,0xafa82a1f,0x2ff6a63e,0xa8a5af64,0x22462fd9
.long 0x0,0x0,0x0,0x0,0x22460000,0x28a5a63e,0x2ff6b000,0x2fa8afd9,0x263e0000,0x2c72aa1f,0xa63e0000,0xac722a1f,0x28a50000,0x2e2fac72,0xafa83000,0xad132ea7
.long 0x2a1f0000,0x2f64ada8,0x2a1f0000,0x2f64ada8,0x2b8b0000,0x2ff6aea7,0x2f0eb000,0x2246ac72,0x2c720000,0x2fd9af64,0xac720000,0xafd92f64,0x2d130000,0x2f0eafd9,0xae2f3000,0x2b8b263e
.long 0x2da80000,0x2da8b000,0x2da80000,0x2da8b000,0x2e2f0000,0x2b8bafd9,0x2d13b000,0xaf0e263e,0x2ea70000,0x263eaf64,0xaea70000,0xa63e2f64,0x2f0e0000,0xa246aea7,0xab8b3000,0x2ff6ac72
.long 0x2f640000,0xaa1fada8,0x2f640000,0xaa1fada8,0x2fa80000,0xad13ac72,0x28a5b000,0xae2f2ea7,0x2fd90000,0xaea7aa1f,0xafd90000,0x2ea72a1f,0x2ff60000,0xafa8a63e,0xa2463000,0x28a5afd9
.long 0x0,0x0,0x0,0x0,0x2b8baa1f,0x2d13ac72,0x2f0eaf64,0x2e2faea7,0x2ea7ada8,0x2fd9af64,0xaea72da8,0xafd92f64,0x2ff6af64,0x2f0eafd9,0xa2462a1f,0x2b8ba63e
.long 0x2f64b000,0x2a1fada8,0x2f64b000,0x2a1fada8,0x2d13af64,0xa8a5a63e,0xae2f2a1f,0xafa82fd9,0x263eada8,0xaea72a1f,0xa63e2da8,0x2ea7aa1f,0xa8a5aa1f,0xaff62ea7,0x2fa8af64,0xa246ac72
.long 0xada80000,0xada83000,0xada80000,0xada83000,0xafa82a1f,0xa2462ea7,0xa8a52f64,0x2ff6ac72,0xafd92da8,0x2c722a1f,0x2fd9ada8,0xac72aa1f,0xae2f2f64,0x2fa8a63e,0xad13aa1f,0xa8a52fd9
.long 0xaa1f3000,0x2f64ada8,0xaa1f3000,0x2f64ada8,0x22462f64,0x2b8bafd9,0x2ff6aa1f,0xaf0ea63e,0x2c722da8,0xa63eaf64,0xac72ada8,0x263e2f64,0x2f0e2a1f,0xae2fac72,0xab8b2f64,0x2d13aea7
.long 0x0,0x0,0x0,0x0,0x2e2fada8,0x2f0eaea7,0x2d13ada8,0x2b8bac72,0x2fd9b000,0x2ea7af64,0xafd93000,0xaea72f64,0x2b8bada8,0xa246a63e,0x2f0eada8,0x2ff6afd9
.long 0xaa1f0000,0xaf642da8,0xaa1f0000,0xaf642da8,0xafa82da8,0xae2f2fd9,0xa8a52da8,0x2d13a63e,0xaea73000,0x263e2a1f,0x2ea7b000,0xa63eaa1f,0xa2462da8,0x2fa8ac72,0xaff62da8,0xa8a52ea7
.long 0x2da80000,0x2da8b000,0x2da80000,0x2da8b000,0x2ff6ada8,0xa8a5ac72,0xa246ada8,0xafa82ea7,0x2c72b000,0xafd92a1f,0xac723000,0x2fd9aa1f,0xa8a5ada8,0xad132fd9,0x2fa8ada8,0xae2fa63e
.long 0xaf640000,0x2a1f2da8,0xaf640000,0x2a1f2da8,0xaf0e2da8,0x2ff6a63e,0x2b8b2da8,0x2246afd9,0xa63e3000,0x2c72af64,0x263eb000,0xac722f64,0x2d132da8,0xab8baea7,0xae2f2da8,0x2f0eac72
.long 0x0,0x0,0x0,0x0,0x2fa8af64,0x2ff6afd9,0x28a5aa1f,0x2246a63e,0x2c72ada8,0x263eaa1f,0xac722da8,0xa63e2a1f,0xad132a1f,0xafa82ea7,0x2e2faf64,0x28a5ac72
.long 0xaf643000,0xaa1f2da8,0xaf643000,0xaa1f2da8,0x22462a1f,0x2f0eac72,0x2ff6af64,0x2b8baea7,0x2fd9ada8,0x2c72af64,0xafd92da8,0xac722f64,0x2b8baf64,0xae2f263e,0x2f0eaa1f,0x2d13afd9
.long 0xada80000,0xada83000,0xada80000,0xada83000,0xaf0e2f64,0x2d13263e,0x2b8b2a1f,0x2e2fafd9,0x263e2da8,0x2ea7af64,0xa63eada8,0xaea72f64,0x2ff6aa1f,0xab8bac72,0xa2462f64,0x2f0eaea7
.long 0x2a1fb000,0xaf642da8,0x2a1fb000,0xaf642da8,0xae2faa1f,0x28a52ea7,0xad132f64,0x2fa8ac72,0xaea72da8,0x2fd9aa1f,0x2ea7ada8,0xafd92a1f,0x28a52f64,0xa246afd9,0xafa82a1f,0x2ff6a63e
.long 0xb0003000,0xb0003000,0xb0003000,0xb0003000,0x2ff6b000,0x2fa8afd9,0xa2460000,0xa8a5263e,0xafd93000,0xaea72f64,0x2fd9b000,0x2ea7af64,0x2fa8b000,0x2d13aea7,0x28a50000,0x2e2fac72
.long 0xaf643000,0xaa1f2da8,0xaf643000,0xaa1f2da8,0x2f0eb000,0x2246ac72,0xab8b0000,0xaff62ea7,0xaea73000,0x263e2a1f,0x2ea7b000,0xa63eaa1f,0x2e2fb000,0xab8ba63e,0x2d130000,0x2f0eafd9
.long 0xada83000,0x2da80000,0xada83000,0x2da80000,0x2d13b000,0xaf0e263e,0xae2f0000,0xab8b2fd9,0xac723000,0x2fd9aa1f,0x2c72b000,0xafd92a1f,0x2b8bb000,0xaff62c72,0x2f0e0000,0xa246aea7
.long 0xaa1f3000,0x2f64ada8,0xaa1f3000,0x2f64ada8,0x28a5b000,0xae2f2ea7,0xafa80000,0x2d132c72,0xa63e3000,0x2c72af64,0x263eb000,0xac722f64,0x2246b000,0xa8a52fd9,0x2ff60000,0xafa8a63e
.long 0xb0003000,0xb0003000,0xb0003000,0xb0003000,0x2f0eaf64,0x2e2faea7,0xab8b2a1f,0xad132c72,0xac722da8,0xa63e2a1f,0x2c72ada8,0x263eaa1f,0x2246aa1f,0xab8b263e,0x2ff6af64,0x2f0eafd9
.long 0x2a1f0000,0x2f64ada8,0x2a1f0000,0x2f64ada8,0xae2f2a1f,0xafa82fd9,0xad132f64,0x28a5263e,0x2fd9ada8,0x2c72af64,0xafd92da8,0xac722f64,0xafa82f64,0x22462c72,0xa8a5aa1f,0xaff62ea7
.long 0x2da8b000,0xada80000,0x2da8b000,0xada80000,0xa8a52f64,0x2ff6ac72,0x2fa8aa1f,0x2246aea7,0xa63eada8,0xaea72f64,0x263e2da8,0x2ea7af64,0x2d132a1f,0x28a5afd9,0xae2f2f64,0x2fa8a63e
.long 0xaf640000,0x2a1f2da8,0xaf640000,0x2a1f2da8,0x2ff6aa1f,0xaf0ea63e,0xa246af64,0xab8b2fd9,0xaea72da8,0x2fd9aa1f,0x2ea7ada8,0xafd92a1f,0x2b8baf64,0xad132ea7,0x2f0e2a1f,0xae2fac72
.long 0xb0003000,0xb0003000,0xb0003000,0xb0003000,0x2d13ada8,0x2b8bac72,0xae2f2da8,0xaf0e2ea7,0x263e0000,0x2c72aa1f,0xa63e0000,0xac722a1f,0xaf0e2da8,0xaff62fd9,0x2b8bada8,0xa246a63e
.long 0x2f64b000,0x2a1fada8,0x2f64b000,0x2a1fada8,0xa8a52da8,0x2d13a63e,0x2fa8ada8,0x2e2fafd9,0xac720000,0xafd92f64,0x2c720000,0x2fd9af64,0x2ff6ada8,0x28a5aea7,0xa2462da8,0x2fa8ac72
.long 0xada83000,0x2da80000,0xada83000,0x2da80000,0xa246ada8,0xafa82ea7,0xaff62da8,0x28a52c72,0x2ea70000,0x263eaf64,0xaea70000,0xa63e2f64,0xafa82da8,0x2e2f263e,0xa8a5ada8,0xad132fd9
.long 0x2a1fb000,0xaf642da8,0x2a1fb000,0xaf642da8,0x2b8b2da8,0x2246afd9,0x2f0eada8,0xaff6263e,0xafd90000,0x2ea72a1f,0x2fd90000,0xaea7aa1f,0x2e2fada8,0xaf0e2c72,0x2d132da8,0xab8baea7
.long 0xb0003000,0xb0003000,0xb0003000,0xb0003000,0x28a5aa1f,0x2246a63e,0xafa82f64,0xaff62fd9,0x2ea7ada8,0x2fd9af64,0xaea72da8,0xafd92f64,0xae2f2f64,0xa8a52c72,0xad132a1f,0xafa82ea7
.long 0xaa1f0000,0xaf642da8,0xaa1f0000,0xaf642da8,0x2ff6af64,0x2b8baea7,0xa246aa1f,0xaf0e2c72,0xa63e2da8,0x2ea7aa1f,0x263eada8,0xaea72a1f,0xaf0e2a1f,0xad132fd9,0x2b8baf64,0xae2f263e
.long 0x2da8b000,0xada80000,0x2da8b000,0xada80000,0x2b8b2a1f,0x2e2fafd9,0x2f0eaf64,0xad13a63e,0xafd92da8,0x2c722a1f,0x2fd9ada8,0xac72aa1f,0x2246af64,0xaf0e2ea7,0x2ff6aa1f,0xab8bac72
.long 0x2f640000,0xaa1fada8,0x2f640000,0xaa1fada8,0xad132f64,0x2fa8ac72,0x2e2f2a1f,0xa8a5aea7,0xac72ada8,0x263e2f64,0x2c722da8,0xa63eaf64,0x2fa8aa1f,0xaff6263e,0x28a52f64,0xa246afd9
.long 0x0,0x0,0x0,0x0,0xa2460000,0xa8a5263e,0xaff63000,0xafa82fd9,0x263e0000,0x2c72aa1f,0xa63e0000,0xac722a1f,0xa8a50000,0xae2f2c72,0x2fa8b000,0x2d13aea7
.long 0x2a1f0000,0x2f64ada8,0x2a1f0000,0x2f64ada8,0xab8b0000,0xaff62ea7,0xaf0e3000,0xa2462c72,0x2c720000,0x2fd9af64,0xac720000,0xafd92f64,0xad130000,0xaf0e2fd9,0x2e2fb000,0xab8ba63e
.long 0x2da80000,0x2da8b000,0x2da80000,0x2da8b000,0xae2f0000,0xab8b2fd9,0xad133000,0x2f0ea63e,0x2ea70000,0x263eaf64,0xaea70000,0xa63e2f64,0xaf0e0000,0x22462ea7,0x2b8bb000,0xaff62c72
.long 0x2f640000,0xaa1fada8,0x2f640000,0xaa1fada8,0xafa80000,0x2d132c72,0xa8a53000,0x2e2faea7,0x2fd90000,0xaea7aa1f,0xafd90000,0x2ea72a1f,0xaff60000,0x2fa8263e,0x2246b000,0xa8a52fd9
.long 0x0,0x0,0x0,0x0,0xab8b2a1f,0xad132c72,0xaf0e2f64,0xae2f2ea7,0x2ea7ada8,0x2fd9af64,0xaea72da8,0xafd92f64,0xaff62f64,0xaf0e2fd9,0x2246aa1f,0xab8b263e
.long 0x2f64b000,0x2a1fada8,0x2f64b000,0x2a1fada8,0xad132f64,0x28a5263e,0x2e2faa1f,0x2fa8afd9,0x263eada8,0xaea72a1f,0xa63e2da8,0x2ea7aa1f,0x28a52a1f,0x2ff6aea7,0xafa82f64,0x22462c72
.long 0xada80000,0xada83000,0xada80000,0xada83000,0x2fa8aa1f,0x2246aea7,0x28a5af64,0xaff62c72,0xafd92da8,0x2c722a1f,0x2fd9ada8,0xac72aa1f,0x2e2faf64,0xafa8263e,0x2d132a1f,0x28a5afd9
.long 0xaa1f3000,0x2f64ada8,0xaa1f3000,0x2f64ada8,0xa246af64,0xab8b2fd9,0xaff62a1f,0x2f0e263e,0x2c722da8,0xa63eaf64,0xac72ada8,0x263e2f64,0xaf0eaa1f,0x2e2f2c72,0x2b8baf64,0xad132ea7
.long 0x0,0x0,0x0,0x0,0xae2f2da8,0xaf0e2ea7,0xad132da8,0xab8b2c72,0x2fd9b000,0x2ea7af64,0xafd93000,0xaea72f64,0xab8b2da8,0x2246263e,0xaf0e2da8,0xaff62fd9
.long 0xaa1f0000,0xaf642da8,0xaa1f0000,0xaf642da8,0x2fa8ada8,0x2e2fafd9,0x28a5ada8,0xad13263e,0xaea73000,0x263e2a1f,0x2ea7b000,0xa63eaa1f,0x2246ada8,0xafa82c72,0x2ff6ada8,0x28a5aea7
.long 0x2da80000,0x2da8b000,0x2da80000,0x2da8b000,0xaff62da8,0x28a52c72,0x22462da8,0x2fa8aea7,0x2c72b000,0xafd92a1f,0xac723000,0x2fd9aa1f,0x28a52da8,0x2d13afd9,0xafa82da8,0x2e2f263e
.long 0xaf640000,0x2a1f2da8,0xaf640000,0x2a1f2da8,0x2f0eada8,0xaff6263e,0xab8bada8,0xa2462fd9,0xa63e3000,0x2c72af64,0x263eb000,0xac722f64,0xad13ada8,0x2b8b2ea7,0x2e2fada8,0xaf0e2c72
.long 0x0,0x0,0x0,0x0,0xafa82f64,0xaff62fd9,0xa8a52a1f,0xa246263e,0x2c72ada8,0x263eaa1f,0xac722da8,0xa63e2a1f,0x2d13aa1f,0x2fa8aea7,0xae2f2f64,0xa8a52c72
.long 0xaf643000,0xaa1f2da8,0xaf643000,0xaa1f2da8,0xa246aa1f,0xaf0e2c72,0xaff62f64,0xab8b2ea7,0x2fd9ada8,0x2c72af64,0xafd92da8,0xac722f64,0xab8b2f64,0x2e2fa63e,0xaf0e2a1f,0xad132fd9
.long 0xada80000,0xada83000,0xada80000,0xada83000,0x2f0eaf64,0xad13a63e,0xab8baa1f,0xae2f2fd9,0x263e2da8,0x2ea7af64,0xa63eada8,0xaea72f64,0xaff62a1f,0x2b8b2c72,0x2246af64,0xaf0e2ea7
.long 0x2a1fb000,0xaf642da8,0x2a1fb000,0xaf642da8,0x2e2f2a1f,0xa8a5aea7,0x2d13af64,0xafa82c72,0xaea72da8,0x2fd9aa1f,0x2ea7ada8,0xafd92a1f,0xa8a5af64,0x22462fd9,0x2fa8aa1f,0xaff6263e
.long 0x3000,0xb000,0x3000,0xb000,0x22463000,0xa8a5afd9,0x2ff60000,0xafa8263e,0x263e3000,0xac72af64,0xa63eb000,0x2c722f64,0x28a53000,0xae2faea7,0xafa80000,0x2d13ac72
.long 0x2a1f3000,0xaf64ada8,0x2a1f3000,0xaf64ada8,0x2b8b3000,0xaff6ac72,0x2f0e0000,0xa2462ea7,0x2c723000,0xafd9aa1f,0xac72b000,0x2fd92a1f,0x2d133000,0xaf0ea63e,0xae2f0000,0xab8bafd9
.long 0x2da83000,0xada80000,0x2da83000,0xada80000,0x2e2f3000,0xab8b263e,0x2d130000,0x2f0e2fd9,0x2ea73000,0xa63e2a1f,0xaea7b000,0x263eaa1f,0x2f0e3000,0x22462c72,0xab8b0000,0xaff6aea7
.long 0x2f643000,0x2a1f2da8,0x2f643000,0x2a1f2da8,0x2fa83000,0x2d132ea7,0x28a50000,0x2e2f2c72,0x2fd93000,0x2ea72f64,0xafd9b000,0xaea7af64,0x2ff63000,0x2fa82fd9,0xa2460000,0xa8a5a63e
.long 0x3000,0xb000,0x3000,0xb000,0x2b8b2f64,0xad13aea7,0x2f0eaa1f,0xae2f2c72,0x2ea72da8,0xafd9aa1f,0xaea7ada8,0x2fd92a1f,0x2ff62a1f,0xaf0e263e,0xa2462f64,0xab8bafd9
.long 0x2f640000,0xaa1f2da8,0x2f640000,0xaa1f2da8,0x2d13aa1f,0x28a52fd9,0xae2faf64,0x2fa8263e,0x263eada8,0x2ea72f64,0xa63e2da8,0xaea7af64,0xa8a5af64,0x2ff62c72,0x2fa82a1f,0x22462ea7
.long 0xada8b000,0x2da80000,0xada8b000,0x2da80000,0xafa8af64,0x2246ac72,0xa8a52a1f,0xaff6aea7,0xafd9ada8,0xac72af64,0x2fd92da8,0x2c722f64,0xae2faa1f,0xafa8afd9,0xad13af64,0x28a5a63e
.long 0xaa1f0000,0xaf64ada8,0xaa1f0000,0xaf64ada8,0x22462a1f,0xab8ba63e,0x2ff62f64,0x2f0e2fd9,0x2c722da8,0x263e2a1f,0xac72ada8,0xa63eaa1f,0x2f0e2f64,0x2e2f2ea7,0xab8baa1f,0xad13ac72
.long 0x3000,0xb000,0x3000,0xb000,0x2e2f2da8,0xaf0eac72,0x2d13ada8,0xab8b2ea7,0x2fd90000,0xaea72a1f,0xafd90000,0x2ea7aa1f,0x2b8bada8,0x22462fd9,0x2f0e2da8,0xaff6a63e
.long 0xaa1fb000,0x2f642da8,0xaa1fb000,0x2f642da8,0xafa8ada8,0x2e2fa63e,0xa8a52da8,0xad13afd9,0xaea70000,0xa63eaf64,0x2ea70000,0x263e2f64,0xa2462da8,0xafa8aea7,0xaff6ada8,0x28a5ac72
.long 0x2da83000,0xada80000,0x2da83000,0xada80000,0x2ff62da8,0x28a52ea7,0xa246ada8,0x2fa82c72,0x2c720000,0x2fd92f64,0xac720000,0xafd9af64,0xa8a5ada8,0x2d13263e,0x2fa82da8,0x2e2f2fd9
.long 0xaf64b000,0xaa1fada8,0xaf64b000,0xaa1fada8,0xaf0eada8,0xaff6afd9,0x2b8b2da8,0xa246263e,0xa63e0000,0xac72aa1f,0x263e0000,0x2c722a1f,0x2d132da8,0x2b8b2c72,0xae2fada8,0xaf0eaea7
.long 0x3000,0xb000,0x3000,0xb000,0x2fa82a1f,0xaff6a63e,0x28a5af64,0xa2462fd9,0x2c72ada8,0xa63e2f64,0xac722da8,0x263eaf64,0xad13af64,0x2fa82c72,0x2e2faa1f,0xa8a52ea7
.long 0xaf640000,0x2a1fada8,0xaf640000,0x2a1fada8,0x22462f64,0xaf0eaea7,0x2ff62a1f,0xab8b2c72,0x2fd92da8,0xac722a1f,0xafd9ada8,0x2c72aa1f,0x2b8baa1f,0x2e2f2fd9,0x2f0e2f64,0xad13263e
.long 0xada8b000,0x2da80000,0xada8b000,0x2da80000,0xaf0eaa1f,0xad13afd9,0x2b8b2f64,0xae2fa63e,0x263e2da8,0xaea7aa1f,0xa63eada8,0x2ea72a1f,0x2ff62f64,0x2b8b2ea7,0xa2462a1f,0xaf0eac72
.long 0x2a1f0000,0x2f642da8,0x2a1f0000,0x2f642da8,0xae2faf64,0xa8a5ac72,0xad13aa1f,0xafa8aea7,0xaea7ada8,0xafd9af64,0x2ea72da8,0x2fd92f64,0x28a52a1f,0x2246263e,0xafa8af64,0xaff6afd9
.long 0x30000000,0xb0000000,0x30000000,0xb0000000,0x2ff60000,0xafa8263e,0xa246b000,0x28a52fd9,0x2fd90000,0xaea72a1f,0xafd90000,0x2ea7aa1f,0x2fa80000,0xad132c72,0x28a53000,0xae2faea7
.long 0x2f640000,0xaa1f2da8,0x2f640000,0xaa1f2da8,0x2f0e0000,0xa2462ea7,0xab8bb000,0x2ff62c72,0x2ea70000,0x263e2f64,0xaea70000,0xa63eaf64,0x2e2f0000,0x2b8b2fd9,0x2d133000,0xaf0ea63e
.long 0x2da80000,0x2da83000,0x2da80000,0x2da83000,0x2d130000,0x2f0e2fd9,0xae2fb000,0x2b8ba63e,0x2c720000,0x2fd92f64,0xac720000,0xafd9af64,0x2b8b0000,0x2ff62ea7,0x2f0e3000,0x22462c72
.long 0x2a1f0000,0x2f642da8,0x2a1f0000,0x2f642da8,0x28a50000,0x2e2f2c72,0xafa8b000,0xad13aea7,0x263e0000,0x2c722a1f,0xa63e0000,0xac72aa1f,0x22460000,0x28a5263e,0x2ff63000,0x2fa82fd9
.long 0x30000000,0xb0000000,0x30000000,0xb0000000,0x2f0eaa1f,0xae2f2c72,0xab8baf64,0x2d132ea7,0x2c72ada8,0xa63e2f64,0xac722da8,0x263eaf64,0x2246af64,0x2b8b2fd9,0x2ff62a1f,0xaf0e263e
.long 0xaa1fb000,0x2f642da8,0xaa1fb000,0x2f642da8,0xae2faf64,0x2fa8263e,0xad132a1f,0xa8a5afd9,0xafd9ada8,0x2c72aa1f,0x2fd92da8,0xac722a1f,0xafa8aa1f,0xa246aea7,0xa8a5af64,0x2ff62c72
.long 0xada80000,0xada8b000,0xada80000,0xada8b000,0xa8a52a1f,0xaff6aea7,0x2fa82f64,0xa2462c72,0x263e2da8,0xaea7aa1f,0xa63eada8,0x2ea72a1f,0x2d132f64,0xa8a5263e,0xae2faa1f,0xafa8afd9
.long 0x2f643000,0x2a1f2da8,0x2f643000,0x2a1f2da8,0x2ff62f64,0x2f0e2fd9,0xa246aa1f,0x2b8b263e,0x2ea72da8,0x2fd92f64,0xaea7ada8,0xafd9af64,0x2b8b2a1f,0x2d132c72,0x2f0e2f64,0x2e2f2ea7
.long 0x30000000,0xb0000000,0x30000000,0xb0000000,0x2d13ada8,0xab8b2ea7,0xae2fada8,0x2f0e2c72,0xa63eb000,0x2c722f64,0x263e3000,0xac72af64,0xaf0eada8,0x2ff6263e,0x2b8bada8,0x22462fd9
.long 0xaf640000,0x2a1fada8,0xaf640000,0x2a1fada8,0xa8a52da8,0xad13afd9,0x2fa82da8,0xae2f263e,0x2c723000,0xafd9aa1f,0xac72b000,0x2fd92a1f,0x2ff62da8,0xa8a52c72,0xa2462da8,0xafa8aea7
.long 0x2da80000,0x2da83000,0x2da80000,0x2da83000,0xa246ada8,0x2fa82c72,0xaff6ada8,0xa8a5aea7,0xaea7b000,0x263eaa1f,0x2ea73000,0xa63e2a1f,0xafa8ada8,0xae2fafd9,0xa8a5ada8,0x2d13263e
.long 0xaa1f0000,0xaf64ada8,0xaa1f0000,0xaf64ada8,0x2b8b2da8,0xa246263e,0x2f0e2da8,0x2ff62fd9,0x2fd93000,0x2ea72f64,0xafd9b000,0xaea7af64,0x2e2f2da8,0x2f0e2ea7,0x2d132da8,0x2b8b2c72
.long 0x30000000,0xb0000000,0x30000000,0xb0000000,0x28a5af64,0xa2462fd9,0xafa8aa1f,0x2ff6263e,0xaea7ada8,0x2fd92a1f,0x2ea72da8,0xafd9aa1f,0xae2f2a1f,0x28a5aea7,0xad13af64,0x2fa82c72
.long 0x2a1f3000,0xaf64ada8,0x2a1f3000,0xaf64ada8,0x2ff62a1f,0xab8b2c72,0xa246af64,0x2f0e2ea7,0x263eada8,0x2ea72f64,0xa63e2da8,0xaea7af64,0xaf0eaf64,0x2d13a63e,0x2b8baa1f,0x2e2f2fd9
.long 0xada80000,0xada8b000,0xada80000,0xada8b000,0x2b8b2f64,0xae2fa63e,0x2f0e2a1f,0x2d132fd9,0x2fd92da8,0x2c722f64,0xafd9ada8,0xac72af64,0x2246aa1f,0x2f0e2c72,0x2ff62f64,0x2b8b2ea7
.long 0xaf64b000,0xaa1fada8,0xaf64b000,0xaa1fada8,0xad13aa1f,0xafa8aea7,0x2e2f2f64,0x28a52c72,0x2c722da8,0x263e2a1f,0xac72ada8,0xa63eaa1f,0x2fa82f64,0x2ff62fd9,0x28a52a1f,0x2246263e
.long 0x3000,0xb000,0x3000,0xb000,0xa246b000,0x28a52fd9,0xaff60000,0x2fa8a63e,0x263e3000,0xac72af64,0xa63eb000,0x2c722f64,0xa8a5b000,0x2e2f2ea7,0x2fa80000,0xad132c72
.long 0x2a1f3000,0xaf64ada8,0x2a1f3000,0xaf64ada8,0xab8bb000,0x2ff62c72,0xaf0e0000,0x2246aea7,0x2c723000,0xafd9aa1f,0xac72b000,0x2fd92a1f,0xad13b000,0x2f0e263e,0x2e2f0000,0x2b8b2fd9
.long 0x2da83000,0xada80000,0x2da83000,0xada80000,0xae2fb000,0x2b8ba63e,0xad130000,0xaf0eafd9,0x2ea73000,0xa63e2a1f,0xaea7b000,0x263eaa1f,0xaf0eb000,0xa246ac72,0x2b8b0000,0x2ff62ea7
.long 0x2f643000,0x2a1f2da8,0x2f643000,0x2a1f2da8,0xafa8b000,0xad13aea7,0xa8a50000,0xae2fac72,0x2fd93000,0x2ea72f64,0xafd9b000,0xaea7af64,0xaff6b000,0xafa8afd9,0x22460000,0x28a5263e
.long 0x3000,0xb000,0x3000,0xb000,0xab8baf64,0x2d132ea7,0xaf0e2a1f,0x2e2fac72,0x2ea72da8,0xafd9aa1f,0xaea7ada8,0x2fd92a1f,0xaff6aa1f,0x2f0ea63e,0x2246af64,0x2b8b2fd9
.long 0x2f640000,0xaa1f2da8,0x2f640000,0xaa1f2da8,0xad132a1f,0xa8a5afd9,0x2e2f2f64,0xafa8a63e,0x263eada8,0x2ea72f64,0xa63e2da8,0xaea7af64,0x28a52f64,0xaff6ac72,0xafa8aa1f,0xa246aea7
.long 0xada8b000,0x2da80000,0xada8b000,0x2da80000,0x2fa82f64,0xa2462c72,0x28a5aa1f,0x2ff62ea7,0xafd9ada8,0xac72af64,0x2fd92da8,0x2c722f64,0x2e2f2a1f,0x2fa82fd9,0x2d132f64,0xa8a5263e
.long 0xaa1f0000,0xaf64ada8,0xaa1f0000,0xaf64ada8,0xa246aa1f,0x2b8b263e,0xaff6af64,0xaf0eafd9,0x2c722da8,0x263e2a1f,0xac72ada8,0xa63eaa1f,0xaf0eaf64,0xae2faea7,0x2b8b2a1f,0x2d132c72
.long 0x3000,0xb000,0x3000,0xb000,0xae2fada8,0x2f0e2c72,0xad132da8,0x2b8baea7,0x2fd90000,0xaea72a1f,0xafd90000,0x2ea7aa1f,0xab8b2da8,0xa246afd9,0xaf0eada8,0x2ff6263e
.long 0xaa1fb000,0x2f642da8,0xaa1fb000,0x2f642da8,0x2fa82da8,0xae2f263e,0x28a5ada8,0x2d132fd9,0xaea70000,0xa63eaf64,0x2ea70000,0x263e2f64,0x2246ada8,0x2fa82ea7,0x2ff62da8,0xa8a52c72
.long 0x2da83000,0xada80000,0x2da83000,0xada80000,0xaff6ada8,0xa8a5aea7,0x22462da8,0xafa8ac72,0x2c720000,0x2fd92f64,0xac720000,0xafd9af64,0x28a52da8,0xad13a63e,0xafa8ada8,0xae2fafd9
.long 0xaf64b000,0xaa1fada8,0xaf64b000,0xaa1fada8,0x2f0e2da8,0x2ff62fd9,0xab8bada8,0x2246a63e,0xa63e0000,0xac72aa1f,0x263e0000,0x2c722a1f,0xad13ada8,0xab8bac72,0x2e2f2da8,0x2f0e2ea7
.long 0x3000,0xb000,0x3000,0xb000,0xafa8aa1f,0x2ff6263e,0xa8a52f64,0x2246afd9,0x2c72ada8,0xa63e2f64,0xac722da8,0x263eaf64,0x2d132f64,0xafa8ac72,0xae2f2a1f,0x28a5aea7
.long 0xaf640000,0x2a1fada8,0xaf640000,0x2a1fada8,0xa246af64,0x2f0e2ea7,0xaff6aa1f,0x2b8bac72,0x2fd92da8,0xac722a1f,0xafd9ada8,0x2c72aa1f,0xab8b2a1f,0xae2fafd9,0xaf0eaf64,0x2d13a63e
.long 0xada8b000,0x2da80000,0xada8b000,0x2da80000,0x2f0e2a1f,0x2d132fd9,0xab8baf64,0x2e2f263e,0x263e2da8,0xaea7aa1f,0xa63eada8,0x2ea72a1f,0xaff6af64,0xab8baea7,0x2246aa1f,0x2f0e2c72
.long 0x2a1f0000,0x2f642da8,0x2a1f0000,0x2f642da8,0x2e2f2f64,0x28a52c72,0x2d132a1f,0x2fa82ea7,0xaea7ada8,0xafd9af64,0x2ea72da8,0x2fd92f64,0xa8a5aa1f,0xa246a63e,0x2fa82f64,0x2ff62fd9
.long 0x30000000,0xb0000000,0x30000000,0xb0000000,0xaff60000,0x2fa8a63e,0x22463000,0xa8a5afd9,0x2fd90000,0xaea72a1f,0xafd90000,0x2ea7aa1f,0xafa80000,0x2d13ac72,0xa8a5b000,0x2e2f2ea7
.long 0x2f640000,0xaa1f2da8,0x2f640000,0xaa1f2da8,0xaf0e0000,0x2246aea7,0x2b8b3000,0xaff6ac72,0x2ea70000,0x263e2f64,0xaea70000,0xa63eaf64,0xae2f0000,0xab8bafd9,0xad13b000,0x2f0e263e
.long 0x2da80000,0x2da83000,0x2da80000,0x2da83000,0xad130000,0xaf0eafd9,0x2e2f3000,0xab8b263e,0x2c720000,0x2fd92f64,0xac720000,0xafd9af64,0xab8b0000,0xaff6aea7,0xaf0eb000,0xa246ac72
.long 0x2a1f0000,0x2f642da8,0x2a1f0000,0x2f642da8,0xa8a50000,0xae2fac72,0x2fa83000,0x2d132ea7,0x263e0000,0x2c722a1f,0xa63e0000,0xac72aa1f,0xa2460000,0xa8a5a63e,0xaff6b000,0xafa8afd9
.long 0x30000000,0xb0000000,0x30000000,0xb0000000,0xaf0e2a1f,0x2e2fac72,0x2b8b2f64,0xad13aea7,0x2c72ada8,0xa63e2f64,0xac722da8,0x263eaf64,0xa2462f64,0xab8bafd9,0xaff6aa1f,0x2f0ea63e
.long 0xaa1fb000,0x2f642da8,0xaa1fb000,0x2f642da8,0x2e2f2f64,0xafa8a63e,0x2d13aa1f,0x28a52fd9,0xafd9ada8,0x2c72aa1f,0x2fd92da8,0xac722a1f,0x2fa82a1f,0x22462ea7,0x28a52f64,0xaff6ac72
.long 0xada80000,0xada8b000,0xada80000,0xada8b000,0x28a5aa1f,0x2ff62ea7,0xafa8af64,0x2246ac72,0x263e2da8,0xaea7aa1f,0xa63eada8,0x2ea72a1f,0xad13af64,0x28a5a63e,0x2e2f2a1f,0x2fa82fd9
.long 0x2f643000,0x2a1f2da8,0x2f643000,0x2a1f2da8,0xaff6af64,0xaf0eafd9,0x22462a1f,0xab8ba63e,0x2ea72da8,0x2fd92f64,0xaea7ada8,0xafd9af64,0xab8baa1f,0xad13ac72,0xaf0eaf64,0xae2faea7
.long 0x30000000,0xb0000000,0x30000000,0xb0000000,0xad132da8,0x2b8baea7,0x2e2f2da8,0xaf0eac72,0xa63eb000,0x2c722f64,0x263e3000,0xac72af64,0x2f0e2da8,0xaff6a63e,0xab8b2da8,0xa246afd9
.long 0xaf640000,0x2a1fada8,0xaf640000,0x2a1fada8,0x28a5ada8,0x2d132fd9,0xafa8ada8,0x2e2fa63e,0x2c723000,0xafd9aa1f,0xac72b000,0x2fd92a1f,0xaff6ada8,0x28a5ac72,0x2246ada8,0x2fa82ea7
.long 0x2da80000,0x2da83000,0x2da80000,0x2da83000,0x22462da8,0xafa8ac72,0x2ff62da8,0x28a52ea7,0xaea7b000,0x263eaa1f,0x2ea73000,0xa63e2a1f,0x2fa82da8,0x2e2f2fd9,0x28a52da8,0xad13a63e
.long 0xaa1f0000,0xaf64ada8,0xaa1f0000,0xaf64ada8,0xab8bada8,0x2246a63e,0xaf0eada8,0xaff6afd9,0x2fd93000,0x2ea72f64,0xafd9b000,0xaea7af64,0xae2fada8,0xaf0eaea7,0xad13ada8,0xab8bac72
.long 0x30000000,0xb0000000,0x30000000,0xb0000000,0xa8a52f64,0x2246afd9,0x2fa82a1f,0xaff6a63e,0xaea7ada8,0x2fd92a1f,0x2ea72da8,0xafd9aa1f,0x2e2faa1f,0xa8a52ea7,0x2d132f64,0xafa8ac72
.long 0x2a1f3000,0xaf64ada8,0x2a1f3000,0xaf64ada8,0xaff6aa1f,0x2b8bac72,0x22462f64,0xaf0eaea7,0x263eada8,0x2ea72f64,0xa63e2da8,0xaea7af64,0x2f0e2f64,0xad13263e,0xab8b2a1f,0xae2fafd9
.long 0xada80000,0xada8b000,0xada80000,0xada8b000,0xab8baf64,0x2e2f263e,0xaf0eaa1f,0xad13afd9,0x2fd92da8,0x2c722f64,0xafd9ada8,0xac72af64,0xa2462a1f,0xaf0eac72,0xaff6af64,0xab8baea7
.long 0xaf64b000,0xaa1fada8,0xaf64b000,0xaa1fada8,0x2d132a1f,0x2fa82ea7,0xae2faf64,0xa8a5ac72,0x2c722da8,0x263e2a1f,0xac72ada8,0xa63eaa1f,0xafa8af64,0xaff6afd9,0xa8a5aa1f,0xa246a63e
.long 0x31a831a8,0x31a831a8,0x31a831a8,0x31a831a8,0x318c31a8,0x30b4313a,0xb18cb1a8,0xb0b4b13a,0x313a31a8,0x2c543000,0x313a31a8,0x2c543000,0x30b431a8,0xa86a2c54,0xb0b4b1a8,0x286aac54
.long 0x300031a8,0xb0000000,0x300031a8,0xb0000000,0x2e4931a8,0xb18cac54,0xae49b1a8,0x318c2c54,0x2c5431a8,0xb13ab000,0x2c5431a8,0xb13ab000,0x286a31a8,0xae49b13a,0xa86ab1a8,0x2e49313a
.long 0x31a8,0xb1a8,0x31a8,0xb1a8,0xa86a31a8,0x2e49b13a,0x286ab1a8,0xae49313a,0xac5431a8,0x313ab000,0xac5431a8,0x313ab000,0xae4931a8,0x318cac54,0x2e49b1a8,0xb18c2c54
.long 0xb00031a8,0x30000000,0xb00031a8,0x30000000,0xb0b431a8,0x286a2c54,0x30b4b1a8,0xa86aac54,0xb13a31a8,0xac543000,0xb13a31a8,0xac543000,0xb18c31a8,0xb0b4313a,0x318cb1a8,0x30b4b13a
.long 0x31a831a8,0x31a831a8,0x31a831a8,0x31a831a8,0x2e493000,0x286a2c54,0xae49b000,0xa86aac54,0xac540000,0xb13ab000,0xac540000,0xb13ab000,0xb18cb000,0xae49b13a,0x318c3000,0x2e49313a
.long 0xb000b1a8,0x30000000,0xb000b1a8,0x30000000,0x286ab000,0x30b4313a,0xa86a3000,0xb0b4b13a,0x313a0000,0xac543000,0x313a0000,0xac543000,0x30b43000,0xb18cac54,0xb0b4b000,0x318c2c54
.long 0x31a8,0xb1a8,0x31a8,0xb1a8,0xb0b43000,0x318cac54,0x30b4b000,0xb18c2c54,0xb13a0000,0x2c543000,0xb13a0000,0x2c543000,0xa86ab000,0xb0b4313a,0x286a3000,0x30b4b13a
.long 0x3000b1a8,0xb0000000,0x3000b1a8,0xb0000000,0x318cb000,0x2e49b13a,0xb18c3000,0xae49313a,0x2c540000,0x313ab000,0x2c540000,0x313ab000,0xae493000,0xa86a2c54,0x2e49b000,0x286aac54
.long 0x31a831a8,0x31a831a8,0x31a831a8,0x31a831a8,0xa86a0000,0xae49ac54,0x286a0000,0x2e492c54,0xb13ab1a8,0xac54b000,0xb13ab1a8,0xac54b000,0x2e490000,0x318c313a,0xae490000,0xb18cb13a
.long 0x300031a8,0xb0000000,0x300031a8,0xb0000000,0xb0b40000,0xa86ab13a,0x30b40000,0x286a313a,0xac54b1a8,0x313a3000,0xac54b1a8,0x313a3000,0x318c0000,0xb0b42c54,0xb18c0000,0x30b4ac54
.long 0x31a8,0xb1a8,0x31a8,0xb1a8,0xb18c0000,0x30b42c54,0x318c0000,0xb0b4ac54,0x2c54b1a8,0xb13a3000,0x2c54b1a8,0xb13a3000,0x30b40000,0x286ab13a,0xb0b40000,0xa86a313a
.long 0xb00031a8,0x30000000,0xb00031a8,0x30000000,0xae490000,0xb18c313a,0x2e490000,0x318cb13a,0x313ab1a8,0x2c54b000,0x313ab1a8,0x2c54b000,0x286a0000,0x2e49ac54,0xa86a0000,0xae492c54
.long 0x31a831a8,0x31a831a8,0x31a831a8,0x31a831a8,0xb0b4b000,0xb18cb13a,0x30b43000,0x318c313a,0x2c540000,0x313a3000,0x2c540000,0x313a3000,0x286a3000,0xb0b4ac54,0xa86ab000,0x30b42c54
.long 0xb000b1a8,0x30000000,0xb000b1a8,0x30000000,0x318c3000,0xae492c54,0xb18cb000,0x2e49ac54,0xb13a0000,0x2c54b000,0xb13a0000,0x2c54b000,0x2e49b000,0xa86a313a,0xae493000,0x286ab13a
.long 0x31a8,0xb1a8,0x31a8,0xb1a8,0xae49b000,0x286a313a,0x2e493000,0xa86ab13a,0x313a0000,0xac54b000,0x313a0000,0xac54b000,0xb18c3000,0x2e492c54,0x318cb000,0xae49ac54
.long 0x3000b1a8,0xb0000000,0x3000b1a8,0xb0000000,0xa86a3000,0x30b4ac54,0x286ab000,0xb0b42c54,0xac540000,0xb13a3000,0xac540000,0xb13a3000,0x30b4b000,0x318cb13a,0xb0b43000,0xb18c313a
.long 0x0,0x0,0x0,0x0,0xa86a0000,0xae49ac54,0x286a0000,0x2e492c54,0xac540000,0xb13ab000,0xac540000,0xb13ab000,0xae490000,0xb18cb13a,0x2e490000,0x318c313a
.long 0xb0000000,0xb000b1a8,0xb0000000,0xb000b1a8,0xb0b40000,0xa86ab13a,0x30b40000,0x286a313a,0xb13a0000,0x2c54b000,0xb13a0000,0x2c54b000,0xb18c0000,0x30b4ac54,0x318c0000,0xb0b42c54
.long 0xb1a80000,0x31a80000,0xb1a80000,0x31a80000,0xb18c0000,0x30b42c54,0x318c0000,0xb0b4ac54,0xb13a0000,0x2c543000,0xb13a0000,0x2c543000,0xb0b40000,0xa86a313a,0x30b40000,0x286ab13a
.long 0xb0000000,0xb00031a8,0xb0000000,0xb00031a8,0xae490000,0xb18c313a,0x2e490000,0x318cb13a,0xac540000,0xb13a3000,0xac540000,0xb13a3000,0xa86a0000,0xae492c54,0x286a0000,0x2e49ac54
.long 0x0,0x0,0x0,0x0,0xb0b4b000,0xb18cb13a,0x30b43000,0x318c313a,0xb13ab1a8,0xac54b000,0xb13ab1a8,0xac54b000,0xa86ab000,0x30b42c54,0x286a3000,0xb0b4ac54
.long 0x30000000,0x300031a8,0x30000000,0x300031a8,0x318c3000,0xae492c54,0xb18cb000,0x2e49ac54,0x2c5431a8,0xb13ab000,0x2c5431a8,0xb13ab000,0xae493000,0x286ab13a,0x2e49b000,0xa86a313a
.long 0xb1a80000,0x31a80000,0xb1a80000,0x31a80000,0xae49b000,0x286a313a,0x2e493000,0xa86ab13a,0x2c54b1a8,0xb13a3000,0x2c54b1a8,0xb13a3000,0x318cb000,0xae49ac54,0xb18c3000,0x2e492c54
.long 0x30000000,0x3000b1a8,0x30000000,0x3000b1a8,0xa86a3000,0x30b4ac54,0x286ab000,0xb0b42c54,0xb13a31a8,0xac543000,0xb13a31a8,0xac543000,0xb0b43000,0xb18c313a,0x30b4b000,0x318cb13a
.long 0x0,0x0,0x0,0x0,0xb18cb1a8,0xb0b4b13a,0x318c31a8,0x30b4313a,0x2c540000,0x313a3000,0x2c540000,0x313a3000,0x30b431a8,0xa86a2c54,0xb0b4b1a8,0x286aac54
.long 0xb0000000,0xb000b1a8,0xb0000000,0xb000b1a8,0xae49b1a8,0x318c2c54,0x2e4931a8,0xb18cac54,0x313a0000,0xac543000,0x313a0000,0xac543000,0x286a31a8,0xae49b13a,0xa86ab1a8,0x2e49313a
.long 0xb1a80000,0x31a80000,0xb1a80000,0x31a80000,0x286ab1a8,0xae49313a,0xa86a31a8,0x2e49b13a,0x313a0000,0xac54b000,0x313a0000,0xac54b000,0xae4931a8,0x318cac54,0x2e49b1a8,0xb18c2c54
.long 0xb0000000,0xb00031a8,0xb0000000,0xb00031a8,0x30b4b1a8,0xa86aac54,0xb0b431a8,0x286a2c54,0x2c540000,0x313ab000,0x2c540000,0x313ab000,0xb18c31a8,0xb0b4313a,0x318cb1a8,0x30b4b13a
.long 0x0,0x0,0x0,0x0,0xae49b000,0xa86aac54,0x2e493000,0x286a2c54,0x313a31a8,0x2c543000,0x313a31a8,0x2c543000,0xb18cb000,0xae49b13a,0x318c3000,0x2e49313a
.long 0x30000000,0x300031a8,0x30000000,0x300031a8,0xa86a3000,0xb0b4b13a,0x286ab000,0x30b4313a,0xac54b1a8,0x313a3000,0xac54b1a8,0x313a3000,0x30b43000,0xb18cac54,0xb0b4b000,0x318c2c54
.long 0xb1a80000,0x31a80000,0xb1a80000,0x31a80000,0x30b4b000,0xb18c2c54,0xb0b43000,0x318cac54,0xac5431a8,0x313ab000,0xac5431a8,0x313ab000,0xa86ab000,0xb0b4313a,0x286a3000,0x30b4b13a
.long 0x30000000,0x3000b1a8,0x30000000,0x3000b1a8,0xb18c3000,0xae49313a,0x318cb000,0x2e49b13a,0x313ab1a8,0x2c54b000,0x313ab1a8,0x2c54b000,0xae493000,0xa86a2c54,0x2e49b000,0x286aac54
.long 0xb1a831a8,0xb1a831a8,0xb1a831a8,0xb1a831a8,0xb18c31a8,0xb0b4313a,0x318cb1a8,0x30b4b13a,0xb13a31a8,0xac543000,0xb13a31a8,0xac543000,0xb0b431a8,0x286a2c54,0x30b4b1a8,0xa86aac54
.long 0xb00031a8,0x30000000,0xb00031a8,0x30000000,0xae4931a8,0x318cac54,0x2e49b1a8,0xb18c2c54,0xac5431a8,0x313ab000,0xac5431a8,0x313ab000,0xa86a31a8,0x2e49b13a,0x286ab1a8,0xae49313a
.long 0x31a8,0xb1a8,0x31a8,0xb1a8,0x286a31a8,0xae49b13a,0xa86ab1a8,0x2e49313a,0x2c5431a8,0xb13ab000,0x2c5431a8,0xb13ab000,0x2e4931a8,0xb18cac54,0xae49b1a8,0x318c2c54
.long 0x300031a8,0xb0000000,0x300031a8,0xb0000000,0x30b431a8,0xa86a2c54,0xb0b4b1a8,0x286aac54,0x313a31a8,0x2c543000,0x313a31a8,0x2c543000,0x318c31a8,0x30b4313a,0xb18cb1a8,0xb0b4b13a
.long 0xb1a831a8,0xb1a831a8,0xb1a831a8,0xb1a831a8,0xae493000,0xa86a2c54,0x2e49b000,0x286aac54,0x2c540000,0x313ab000,0x2c540000,0x313ab000,0x318cb000,0x2e49b13a,0xb18c3000,0xae49313a
.long 0x3000b1a8,0xb0000000,0x3000b1a8,0xb0000000,0xa86ab000,0xb0b4313a,0x286a3000,0x30b4b13a,0xb13a0000,0x2c543000,0xb13a0000,0x2c543000,0xb0b43000,0x318cac54,0x30b4b000,0xb18c2c54
.long 0x31a8,0xb1a8,0x31a8,0xb1a8,0x30b43000,0xb18cac54,0xb0b4b000,0x318c2c54,0x313a0000,0xac543000,0x313a0000,0xac543000,0x286ab000,0x30b4313a,0xa86a3000,0xb0b4b13a
.long 0xb000b1a8,0x30000000,0xb000b1a8,0x30000000,0xb18cb000,0xae49b13a,0x318c3000,0x2e49313a,0xac540000,0xb13ab000,0xac540000,0xb13ab000,0x2e493000,0x286a2c54,0xae49b000,0xa86aac54
.long 0xb1a831a8,0xb1a831a8,0xb1a831a8,0xb1a831a8,0x286a0000,0x2e49ac54,0xa86a0000,0xae492c54,0x313ab1a8,0x2c54b000,0x313ab1a8,0x2c54b000,0xae490000,0xb18c313a,0x2e490000,0x318cb13a
.long 0xb00031a8,0x30000000,0xb00031a8,0x30000000,0x30b40000,0x286ab13a,0xb0b40000,0xa86a313a,0x2c54b1a8,0xb13a3000,0x2c54b1a8,0xb13a3000,0xb18c0000,0x30b42c54,0x318c0000,0xb0b4ac54
.long 0x31a8,0xb1a8,0x31a8,0xb1a8,0x318c0000,0xb0b42c54,0xb18c0000,0x30b4ac54,0xac54b1a8,0x313a3000,0xac54b1a8,0x313a3000,0xb0b40000,0xa86ab13a,0x30b40000,0x286a313a
.long 0x300031a8,0xb0000000,0x300031a8,0xb0000000,0x2e490000,0x318c313a,0xae490000,0xb18cb13a,0xb13ab1a8,0xac54b000,0xb13ab1a8,0xac54b000,0xa86a0000,0xae49ac54,0x286a0000,0x2e492c54
.long 0xb1a831a8,0xb1a831a8,0xb1a831a8,0xb1a831a8,0x30b4b000,0x318cb13a,0xb0b43000,0xb18c313a,0xac540000,0xb13a3000,0xac540000,0xb13a3000,0xa86a3000,0x30b4ac54,0x286ab000,0xb0b42c54
.long 0x3000b1a8,0xb0000000,0x3000b1a8,0xb0000000,0xb18c3000,0x2e492c54,0x318cb000,0xae49ac54,0x313a0000,0xac54b000,0x313a0000,0xac54b000,0xae49b000,0x286a313a,0x2e493000,0xa86ab13a
.long 0x31a8,0xb1a8,0x31a8,0xb1a8,0x2e49b000,0xa86a313a,0xae493000,0x286ab13a,0xb13a0000,0x2c54b000,0xb13a0000,0x2c54b000,0x318c3000,0xae492c54,0xb18cb000,0x2e49ac54
.long 0xb000b1a8,0x30000000,0xb000b1a8,0x30000000,0x286a3000,0xb0b4ac54,0xa86ab000,0x30b42c54,0x2c540000,0x313a3000,0x2c540000,0x313a3000,0xb0b4b000,0xb18cb13a,0x30b43000,0x318c313a
.long 0x0,0x0,0x0,0x0,0x286a0000,0x2e49ac54,0xa86a0000,0xae492c54,0x2c540000,0x313ab000,0x2c540000,0x313ab000,0x2e490000,0x318cb13a,0xae490000,0xb18c313a
.long 0x30000000,0x3000b1a8,0x30000000,0x3000b1a8,0x30b40000,0x286ab13a,0xb0b40000,0xa86a313a,0x313a0000,0xac54b000,0x313a0000,0xac54b000,0x318c0000,0xb0b4ac54,0xb18c0000,0x30b42c54
.long 0x31a80000,0xb1a80000,0x31a80000,0xb1a80000,0x318c0000,0xb0b42c54,0xb18c0000,0x30b4ac54,0x313a0000,0xac543000,0x313a0000,0xac543000,0x30b40000,0x286a313a,0xb0b40000,0xa86ab13a
.long 0x30000000,0x300031a8,0x30000000,0x300031a8,0x2e490000,0x318c313a,0xae490000,0xb18cb13a,0x2c540000,0x313a3000,0x2c540000,0x313a3000,0x286a0000,0x2e492c54,0xa86a0000,0xae49ac54
.long 0x0,0x0,0x0,0x0,0x30b4b000,0x318cb13a,0xb0b43000,0xb18c313a,0x313ab1a8,0x2c54b000,0x313ab1a8,0x2c54b000,0x286ab000,0xb0b42c54,0xa86a3000,0x30b4ac54
.long 0xb0000000,0xb00031a8,0xb0000000,0xb00031a8,0xb18c3000,0x2e492c54,0x318cb000,0xae49ac54,0xac5431a8,0x313ab000,0xac5431a8,0x313ab000,0x2e493000,0xa86ab13a,0xae49b000,0x286a313a
.long 0x31a80000,0xb1a80000,0x31a80000,0xb1a80000,0x2e49b000,0xa86a313a,0xae493000,0x286ab13a,0xac54b1a8,0x313a3000,0xac54b1a8,0x313a3000,0xb18cb000,0x2e49ac54,0x318c3000,0xae492c54
.long 0xb0000000,0xb000b1a8,0xb0000000,0xb000b1a8,0x286a3000,0xb0b4ac54,0xa86ab000,0x30b42c54,0x313a31a8,0x2c543000,0x313a31a8,0x2c543000,0x30b43000,0x318c313a,0xb0b4b000,0xb18cb13a
.long 0x0,0x0,0x0,0x0,0x318cb1a8,0x30b4b13a,0xb18c31a8,0xb0b4313a,0xac540000,0xb13a3000,0xac540000,0xb13a3000,0xb0b431a8,0x286a2c54,0x30b4b1a8,0xa86aac54
.long 0x30000000,0x3000b1a8,0x30000000,0x3000b1a8,0x2e49b1a8,0xb18c2c54,0xae4931a8,0x318cac54,0xb13a0000,0x2c543000,0xb13a0000,0x2c543000,0xa86a31a8,0x2e49b13a,0x286ab1a8,0xae49313a
.long 0x31a80000,0xb1a80000,0x31a80000,0xb1a80000,0xa86ab1a8,0x2e49313a,0x286a31a8,0xae49b13a,0xb13a0000,0x2c54b000,0xb13a0000,0x2c54b000,0x2e4931a8,0xb18cac54,0xae49b1a8,0x318c2c54
.long 0x30000000,0x300031a8,0x30000000,0x300031a8,0xb0b4b1a8,0x286aac54,0x30b431a8,0xa86a2c54,0xac540000,0xb13ab000,0xac540000,0xb13ab000,0x318c31a8,0x30b4313a,0xb18cb1a8,0xb0b4b13a
.long 0x0,0x0,0x0,0x0,0x2e49b000,0x286aac54,0xae493000,0xa86a2c54,0xb13a31a8,0xac543000,0xb13a31a8,0xac543000,0x318cb000,0x2e49b13a,0xb18c3000,0xae49313a
.long 0xb0000000,0xb00031a8,0xb0000000,0xb00031a8,0x286a3000,0x30b4b13a,0xa86ab000,0xb0b4313a,0x2c54b1a8,0xb13a3000,0x2c54b1a8,0xb13a3000,0xb0b43000,0x318cac54,0x30b4b000,0xb18c2c54
.long 0x31a80000,0xb1a80000,0x31a80000,0xb1a80000,0xb0b4b000,0x318c2c54,0x30b43000,0xb18cac54,0x2c5431a8,0xb13ab000,0x2c5431a8,0xb13ab000,0x286ab000,0x30b4313a,0xa86a3000,0xb0b4b13a
.long 0xb0000000,0xb000b1a8,0xb0000000,0xb000b1a8,0x318c3000,0x2e49313a,0xb18cb000,0xae49b13a,0xb13ab1a8,0xac54b000,0xb13ab1a8,0xac54b000,0x2e493000,0x286a2c54,0xae49b000,0xa86aac54
```
